```python
import torch

def _softmax(x, axis=-1):
    return torch.softmax(x, dim=axis)

def _gelu(x):
    return torch.nn.functional.gelu(x, approximate='tanh')

def _silu(x):
    return torch.nn.functional.silu(x)

def _sigmoid(x):
    return torch.sigmoid(x)

def _layernorm(x, axis=-1, eps=1e-05):
    m = x.mean(dim=axis, keepdim=True)
    v = x.var(dim=axis, keepdim=True, unbiased=False)
    return (x - m) / torch.sqrt(v + eps)

def _scatter_add(tgt, idx, src, axis=0):
    return tgt.clone().index_add_(axis, idx, src)

def _segment_sum(src, seg, n):
    out = torch.zeros((n,) + src.shape[1:], dtype=src.dtype)
    return out.index_add_(0, seg, src)

def _pad(x, pw):
    flat = tuple((v for pair in reversed(pw) for v in pair))
    return torch.nn.functional.pad(x, flat)
kernel_name = 'recurrent_scan__memory_aug_recurrent_mem_tr__dense_activation_relu__prompt'

def setup_inputs():

    _w = lambda a: (lambda t: t.to(torch.bfloat16) if t.is_floating_point() else t)(torch.as_tensor(a))

    def _A_setup():
        B, S, Dm = (1, 2048, 640)
        H, Dh = (32, 192)
        M, seg = (8, 32)
        seg = min(seg, S)
        S = S // seg * seg
        return {'x': _w((lambda *s: torch.randn(*s, dtype=torch.bfloat16) * 0.05)(B, S, Dm)), 'mem0': _w((lambda *s: torch.randn(*s, dtype=torch.bfloat16) * 0.2)(B, M, Dm)), 'Wq': _w((lambda *s: torch.randn(*s, dtype=torch.bfloat16) * 0.8)(Dm, H, Dh) * Dm ** (-0.5)), 'Wk': _w((lambda *s: torch.randn(*s, dtype=torch.bfloat16) * 0.8)(Dm, H, Dh) * Dm ** (-0.5)), 'Wv': _w((lambda *s: torch.randn(*s, dtype=torch.bfloat16) * 0.2)(Dm, H, Dh) * Dm ** (-0.5)), 'Wo': _w((lambda *s: torch.randn(*s, dtype=torch.bfloat16) * 0.2)(H, Dh, Dm) * (H * Dh) ** (-0.5)), 'seg_len': seg}
    _A_in = _A_setup()

    def _B_setup():
        B, S, D, Dff = (1, 2048, 640, 1536)
        return {'x': _w((lambda *s: torch.randn(*s, dtype=torch.bfloat16) * 0.05)(B, S, D)), 'w1': _w((lambda *s: torch.randn(*s, dtype=torch.bfloat16) * 0.1)(D, Dff)), 'w2': _w((lambda *s: torch.randn(*s, dtype=torch.bfloat16) * 0.1)(Dff, D))}
    _B_in = _B_setup()
    return {'A_x': _A_in['x'], 'A_mem0': _A_in['mem0'], 'A_Wq': _A_in['Wq'], 'A_Wk': _A_in['Wk'], 'A_Wv': _A_in['Wv'], 'A_Wo': _A_in['Wo'], 'A_seg_len': _A_in['seg_len'], 'B_x': _B_in['x'], 'B_w1': _B_in['w1'], 'B_w2': _B_in['w2']}

def reference(A_x, A_mem0, A_Wq, A_Wk, A_Wv, A_Wo, A_seg_len, B_x, B_w1, B_w2):

    def _A_ref(x, mem0, Wq, Wk, Wv, Wo, seg_len):
        B, S, Dm = x.shape
        H, Dh = (Wq.shape[1], Wq.shape[2])
        M = mem0.shape[1]
        scale = Dh ** (-0.5)
        n_seg = S // seg_len
        L = M + seg_len
        idx = torch.arange(L)
        mask = (idx[:, None] < M) | (idx[:, None] >= idx[None, :])
        mem = mem0
        outs = []
        for s in range(n_seg):
            xs = x[:, s * seg_len:(s + 1) * seg_len, :].clone()
            h = torch.concatenate([mem, xs], axis=1)
            q = torch.einsum('btd,dhe->bhte', h, Wq)
            k = torch.einsum('btd,dhe->bhte', h, Wk)
            v = torch.einsum('btd,dhe->bhte', h, Wv)
            scores = torch.einsum('bhqe,bhke->bhqk', q, k) * scale
            scores = torch.where(mask[None, None], scores, -1000000000.0)
            p = _softmax(scores, axis=-1)
            o = torch.einsum('bhqk,bhke->bhqe', p, v)
            o = torch.einsum('bhte,hed->btd', o, Wo)
            mem = o[:, :M, :].clone()
            outs.append(o[:, M:, :])
        return torch.concatenate(outs, axis=1)

    def _B_ref(x, w1, w2):
        h = torch.einsum('bsd,df->bsf', x, w1)
        zero = torch.zeros_like(h)
        h = torch.maximum(h, zero)
        return torch.einsum('bsf,fd->bsd', h, w2)
    x = A_x
    xn = _layernorm(x, axis=-1)
    s = _A_ref(xn, A_mem0, A_Wq, A_Wk, A_Wv, A_Wo, A_seg_len)
    g = _silu(_B_ref(xn, B_w1, B_w2))
    return x + s * g
```

```asm
; @launch grid=(256,1,1) block=(256,1,1) lds=163840
.amdgcn_target "amdgcn-amd-amdhsa--gfx950"
.text
.globl recurrent_scan__memory_aug_recurrent_mem_tr__dense_activation_relu__prompt_kernel
.p2align 8
.type recurrent_scan__memory_aug_recurrent_mem_tr__dense_activation_relu__prompt_kernel,@function
recurrent_scan__memory_aug_recurrent_mem_tr__dense_activation_relu__prompt_kernel:
    s_cmp_ge_u32 s2, 256
    s_cbranch_scc1 L_end
    s_load_dwordx2 s[32:33], s[0:1], 96
    s_load_dwordx4 s[60:63], s[0:1], 16
    s_load_dwordx4 s[64:67], s[0:1], 32
    s_load_dwordx4 s[52:55], s[0:1], 0
    s_load_dwordx4 s[56:59], s[0:1], 64
    s_load_dwordx4 s[72:75], s[0:1], 80
    s_getreg_b32 s24, hwreg(HW_REG_XCC_ID)
    v_and_b32 v1, 63, v0
    v_lshlrev_b32 v2, 4, v1
    v_lshrrev_b32 v3, 6, v0
    s_nop 0
    v_readfirstlane_b32 s22, v3
    s_and_b32 s20, s2, 7
    s_lshr_b32 s21, s2, 3
    s_and_b32 s24, s24, 15
    s_lshl_b32 s96, s20, 4
    s_and_b32 s25, s24, 12
    s_add_u32 s96, s96, s25
    s_and_b32 s25, s24, 3
    s_lshl_b32 s25, s25, 3
    s_lshl_b32 s97, 1, s25
    s_waitcnt lgkmcnt(0)
    s_mov_b64 s[70:71], s[72:73]
    s_mov_b64 s[68:69], s[52:53]
    s_mov_b32 s4, s32
    s_and_b32 s5, s33, 0xffff
    s_mov_b32 s6, 0x10000000
    s_mov_b32 s7, 0x00020000
    s_cmp_ge_u32 s21, 22
    s_cbranch_scc1 L_help
    s_sub_u32 s24, s21, 12
    s_cmp_eq_u32 s24, 1
    s_cbranch_scc1 L_urg
    s_cmp_lg_u32 s22, 0
    s_cbranch_scc1 Lrg_1
    v_mov_b32 v3, s96
    v_mov_b32 v4, s97
    s_mov_b64 exec, 1
    global_atomic_add v3, v4, s[74:75] offset:128 sc1
    s_mov_b64 exec, -1
Lrg_1:
    s_cmp_ge_u32 s21, 12
    s_cbranch_scc1 L_wo
    s_mul_i32 s24, s21, 43
    s_lshr_b32 s24, s24, 7
    s_mul_i32 s25, s24, 3
    s_sub_u32 s25, s21, s25
    s_lshl_b32 s26, s20, 2
    s_add_u32 s26, s26, s24
    s_lshl_b32 s27, s25, 2
    s_add_u32 s27, s27, s22
    s_mov_b32 s8, s60
    s_and_b32 s9, s61, 0xffff
    s_mov_b32 s10, 0x780000
    s_mov_b32 s11, 0x00020000
    s_mov_b32 s12, s62
    s_and_b32 s13, s63, 0xffff
    s_mov_b32 s14, 0x780000
    s_mov_b32 s15, 0x00020000
    s_mov_b32 s16, s64
    s_and_b32 s17, s65, 0xffff
    s_mov_b32 s18, 0x780000
    s_mov_b32 s19, 0x00020000
    s_mul_i32 s28, s26, 384
    s_lshl_b32 s29, s25, 7
    s_add_u32 s28, s28, s29
    v_lshrrev_b32 v241, 3, v1
    v_bfe_u32 v242, v1, 4, 1
    s_and_b32 s54, s22, 1
    s_lshl_b32 s54, s54, 1
    v_or_b32 v242, s54, v242
    v_lshlrev_b32 v242, 1, v242
    v_and_b32 v243, 7, v1
    v_xor_b32 v243, v243, v242
    s_mov_b32 s54, 12288
    v_mul_lo_u32 v240, s54, v241
    v_lshl_add_u32 v240, v243, 4, v240
    v_lshrrev_b32 v241, 4, v1
    v_bfe_u32 v242, v1, 2, 2
    v_lshl_add_u32 v243, v241, 3, v242
    v_and_b32 v241, 1, v241
    v_lshlrev_b32 v241, 1, v241
    v_bfe_u32 v242, v1, 3, 1
    v_or_b32 v241, v241, v242
    v_xor_b32 v241, s22, v241
    v_lshlrev_b32 v243, 7, v243
    v_lshl_add_u32 v243, v241, 5, v243
    v_and_b32 v241, 3, v1
    v_lshl_add_u32 v241, v241, 3, v243
    v_add_u32 v243, 40960, v241
    v_add_u32 v242, 122880, v241
    v_add_u32 v241, 81920, v241
    s_mul_i32 s55, s22, 98304
    s_lshl_b32 s56, s22, 10
    s_add_u32 s57, s28, s55
    s_add_u32 m0, s56, 81920
    s_nop 0
    buffer_load_dwordx4 v240, s[12:15], s57 offen nt lds
    s_add_u32 s57, s57, 393216
    s_add_u32 m0, s56, 86016
    s_nop 0
    buffer_load_dwordx4 v240, s[12:15], s57 offen nt lds
    s_add_u32 s57, s57, 393216
    s_add_u32 m0, s56, 90112
    s_nop 0
    buffer_load_dwordx4 v240, s[12:15], s57 offen nt lds
    s_add_u32 s57, s57, 393216
    s_add_u32 m0, s56, 94208
    s_nop 0
    buffer_load_dwordx4 v240, s[12:15], s57 offen nt lds
    s_add_u32 s57, s57, 393216
    s_add_u32 m0, s56, 98304
    s_nop 0
    buffer_load_dwordx4 v240, s[12:15], s57 offen nt lds
    s_add_u32 s57, s57, 393216
    s_add_u32 m0, s56, 102400
    s_nop 0
    buffer_load_dwordx4 v240, s[12:15], s57 offen nt lds
    s_add_u32 s57, s57, 393216
    s_add_u32 m0, s56, 106496
    s_nop 0
    buffer_load_dwordx4 v240, s[12:15], s57 offen nt lds
    s_add_u32 s57, s57, 393216
    s_add_u32 m0, s56, 110592
    s_nop 0
    buffer_load_dwordx4 v240, s[12:15], s57 offen nt lds
    s_add_u32 s57, s57, 393216
    s_add_u32 m0, s56, 114688
    s_nop 0
    buffer_load_dwordx4 v240, s[12:15], s57 offen nt lds
    s_add_u32 s57, s57, 393216
    s_add_u32 m0, s56, 118784
    s_nop 0
    buffer_load_dwordx4 v240, s[12:15], s57 offen nt lds
    s_add_u32 s57, s28, s55
    s_add_u32 s57, s57, 3932160
    s_add_u32 m0, s56, 122880
    s_nop 0
    buffer_load_dwordx4 v240, s[12:15], s57 offen nt lds
    s_add_u32 s57, s57, 393216
    s_add_u32 m0, s56, 126976
    s_nop 0
    buffer_load_dwordx4 v240, s[12:15], s57 offen nt lds
    s_add_u32 s57, s57, 393216
    s_add_u32 m0, s56, 131072
    s_nop 0
    buffer_load_dwordx4 v240, s[12:15], s57 offen nt lds
    s_add_u32 s57, s57, 393216
    s_add_u32 m0, s56, 135168
    s_nop 0
    buffer_load_dwordx4 v240, s[12:15], s57 offen nt lds
    s_add_u32 s57, s57, 393216
    s_add_u32 m0, s56, 139264
    s_nop 0
    buffer_load_dwordx4 v240, s[12:15], s57 offen nt lds
    s_add_u32 s57, s57, 393216
    s_add_u32 m0, s56, 143360
    s_nop 0
    buffer_load_dwordx4 v240, s[12:15], s57 offen nt lds
    s_add_u32 s57, s57, 393216
    s_add_u32 m0, s56, 147456
    s_nop 0
    buffer_load_dwordx4 v240, s[12:15], s57 offen nt lds
    s_add_u32 s57, s57, 393216
    s_add_u32 m0, s56, 151552
    s_nop 0
    buffer_load_dwordx4 v240, s[12:15], s57 offen nt lds
    s_add_u32 s57, s57, 393216
    s_add_u32 m0, s56, 155648
    s_nop 0
    buffer_load_dwordx4 v240, s[12:15], s57 offen nt lds
    s_add_u32 s57, s57, 393216
    s_add_u32 m0, s56, 159744
    s_nop 0
    buffer_load_dwordx4 v240, s[12:15], s57 offen nt lds
    s_add_u32 s57, s28, s55
    s_add_u32 m0, s56, 40960
    s_nop 0
    buffer_load_dwordx4 v240, s[16:19], s57 offen nt lds
    s_add_u32 s57, s57, 393216
    s_add_u32 m0, s56, 45056
    s_nop 0
    buffer_load_dwordx4 v240, s[16:19], s57 offen nt lds
    s_add_u32 s57, s57, 393216
    s_add_u32 m0, s56, 49152
    s_nop 0
    buffer_load_dwordx4 v240, s[16:19], s57 offen nt lds
    s_add_u32 s57, s57, 393216
    s_add_u32 m0, s56, 53248
    s_nop 0
    buffer_load_dwordx4 v240, s[16:19], s57 offen nt lds
    s_add_u32 s57, s57, 393216
    s_add_u32 m0, s56, 57344
    s_nop 0
    buffer_load_dwordx4 v240, s[16:19], s57 offen nt lds
    s_add_u32 s57, s57, 393216
    s_add_u32 m0, s56, 61440
    s_nop 0
    buffer_load_dwordx4 v240, s[16:19], s57 offen nt lds
    s_add_u32 s57, s57, 393216
    s_add_u32 m0, s56, 65536
    s_nop 0
    buffer_load_dwordx4 v240, s[16:19], s57 offen nt lds
    s_add_u32 s57, s57, 393216
    s_add_u32 m0, s56, 69632
    s_nop 0
    buffer_load_dwordx4 v240, s[16:19], s57 offen nt lds
    s_add_u32 s57, s57, 393216
    s_add_u32 m0, s56, 73728
    s_nop 0
    buffer_load_dwordx4 v240, s[16:19], s57 offen nt lds
    s_add_u32 s57, s57, 393216
    s_add_u32 m0, s56, 77824
    s_nop 0
    buffer_load_dwordx4 v240, s[16:19], s57 offen nt lds
    s_mul_i32 s38, s22, 3072
    s_min_u32 s38, s38, 7168
    v_add_u32 v3, s38, v2
    v_add_u32 v5, 81920, v3
    v_add_u32 v7, 81920, v2
    v_and_b32 v14, 15, v1
    v_lshrrev_b32 v15, 4, v1
    s_lshr_b32 s38, s27, 1
    s_lshl_b32 s38, s38, 10
    s_and_b32 s39, s27, 1
    s_lshl_b32 s39, s39, 3
    s_add_u32 s38, s38, s39
    v_add_u32 v8, s38, v2
    v_bfe_u32 v11, v1, 2, 2
    v_and_b32 v12, 3, v1
    v_lshlrev_b32 v182, 8, v11
    v_lshl_add_u32 v182, v15, 6, v182
    v_lshl_add_u32 v182, v12, 4, v182
    v_add_u32 v182, s38, v182
    s_lshr_b32 s38, s27, 1
    s_and_b32 s39, s27, 1
    s_lshl_b32 s39, s39, 9
    s_lshl_b32 s40, s38, 10
    s_add_u32 s40, s40, s39
    v_lshrrev_b32 v9, 1, v11
    v_lshlrev_b32 v9, 8, v9
    v_and_b32 v13, 1, v11
    v_lshl_add_u32 v9, v13, 3, v9
    v_lshl_add_u32 v9, v12, 4, v9
    v_lshl_add_u32 v182, v15, 6, v9
    v_add_u32 v182, s40, v182
    v_lshrrev_b32 v13, 1, v15
    v_lshlrev_b32 v190, 8, v13
    v_lshl_add_u32 v190, v14, 4, v190
    v_add_u32 v190, s40, v190
    v_and_b32 v188, 1, v15
    v_mul_u32_u24 v189, 6144, v188
    v_add_u32 v190, v190, v189
    s_cmp_ge_u32 s38, 3
    s_cselect_b32 s39, 2944, 0
    s_sub_u32 s40, s40, s39
    v_lshl_add_u32 v187, v188, 6, v9
    v_mul_u32_u24 v13, 3072, v13
    v_add3_u32 v187, v187, v13, s40
    v_lshrrev_b32 v13, 5, v1
    v_lshl_or_b32 v188, v13, 31, v187
    v_xor_b32 v13, 1, v13
    v_lshl_or_b32 v189, v13, 31, v187
    v_lshlrev_b32 v13, 4, v12
    v_sub_u32 v9, v9, v13
    v_and_b32 v13, 1, v12
    v_lshl_add_u32 v9, v13, 4, v9
    v_lshrrev_b32 v13, 1, v12
    v_lshl_add_u32 v182, v15, 5, v9
    v_add_u32 v188, s40, v182
    v_lshl_add_u32 v182, v13, 7, v182
    s_add_u32 s41, s40, s39
    v_add_u32 v182, s41, v182
    s_cmp_ge_u32 s38, 3
    s_cselect_b32 s41, 96, 0
    s_sub_u32 s41, s40, s41
    s_add_u32 s41, s41, 3072
    v_lshl_add_u32 v189, v15, 6, v9
    v_add_u32 v189, s41, v189
    v_cmp_eq_u32 vcc, 1, v13
    s_nop 1
    v_cndmask_b32 v187, v188, v189, vcc
    v_and_b32 v13, 1, v15
    v_lshlrev_b32 v13, 2, v13
    v_lshrrev_b32 v9, 1, v15
    v_lshl_add_u32 v13, v9, 1, v13
    v_and_b32 v9, 1, v12
    v_add_u32 v13, v13, v9
    v_lshrrev_b32 v12, 1, v12
    v_lshrrev_b32 v9, 1, v11
    v_lshlrev_b32 v9, 8, v9
    v_lshl_add_u32 v9, v12, 7, v9
    v_lshl_add_u32 v9, v13, 4, v9
    v_and_b32 v183, 1, v11
    v_lshl_add_u32 v9, v183, 3, v9
    s_lshl_b32 s38, s25, 10
    s_lshr_b32 s39, s22, 1
    s_lshl_b32 s39, s39, 9
    s_add_u32 s38, s38, s39
    s_and_b32 s39, s22, 1
    s_lshl_b32 s39, s39, 2
    s_add_u32 s38, s38, s39
    v_add_u32 v9, s38, v9
    v_lshlrev_b32 v183, 8, v11
    v_lshl_add_u32 v183, v13, 4, v183
    v_lshl_add_u32 v183, v12, 2, v183
    s_lshr_b32 s38, s27, 1
    s_cmp_ge_u32 s38, 3
    s_cselect_b32 s39, 3, 0
    s_cselect_b32 s40, 128, 0
    s_sub_u32 s38, s38, s39
    s_lshl_b32 s38, s38, 10
    s_add_u32 s38, s38, s40
    s_and_b32 s39, s27, 1
    s_lshl_b32 s39, s39, 3
    s_add_u32 s38, s38, s39
    v_add_u32 v183, s38, v183
    v_and_b32 v12, 3, v1
    v_lshlrev_b32 v13, 6, v15
    v_lshl_add_u32 v13, v12, 4, v13
    v_lshrrev_b32 v12, 5, v1
    v_lshl_or_b32 v13, v12, 31, v13
    v_lshl_add_u32 v183, v11, 8, v13
    v_add_u32 v183, s38, v183
    v_lshrrev_b32 v9, 1, v11
    v_lshl_add_u32 v9, v9, 8, v13
    v_and_b32 v12, 1, v11
    v_lshl_add_u32 v9, v12, 3, v9
    s_lshl_b32 s38, s25, 10
    s_lshr_b32 s39, s22, 1
    s_lshl_b32 s39, s39, 9
    s_add_u32 s38, s38, s39
    s_and_b32 s39, s22, 1
    s_lshl_b32 s39, s39, 7
    s_add_u32 s38, s38, s39
    v_add_u32 v9, s38, v9
    v_lshlrev_b32 v12, 5, v15
    v_sub_u32 v183, v183, v12
    v_and_b32 v183, 0x7fffffff, v183
    v_and_b32 v9, 0x7fffffff, v9
    s_and_b32 s39, s22, 1
    s_mul_i32 s39, s39, 96
    v_subrev_u32 v9, s39, v9
    v_bfe_u32 v12, v1, 1, 1
    v_lshl_or_b32 v183, v12, 31, v183
    v_lshl_or_b32 v9, v12, 31, v9
    v_mul_u32_u24 v186, 5, v1
    v_lshrrev_b32 v186, 3, v186
    v_lshlrev_b32 v186, 8, v186
    v_mov_b32 v184, 0x44444444
    v_mov_b32 v11, 0xeeeeeeee
    v_and_b32 v12, 2, v1
    v_cmp_lt_u32 vcc, 0, v12
    s_nop 1
    v_cndmask_b32 v184, v184, v11, vcc
    v_mov_b32 v185, 0x05040100
    v_mov_b32 v11, 0x03020706
    v_and_b32 v12, 1, v1
    v_cmp_eq_u32 vcc, 1, v12
    s_nop 1
    v_cndmask_b32 v185, v185, v11, vcc
    s_mov_b32 s34, 0x33333333
    s_mov_b32 s35, 0x33333333
    s_mov_b32 s36, 0xcccccccc
    s_mov_b32 s37, 0xcccccccc
    v_mov_b32 v96, 0
    v_mov_b32 v97, 0
    v_mov_b32 v98, 0
    v_mov_b32 v99, 0
    v_mov_b32 v100, 0
    v_mov_b32 v101, 0
    v_mov_b32 v102, 0
    v_mov_b32 v103, 0
    v_mov_b32 v104, 0
    v_mov_b32 v105, 0
    v_mov_b32 v106, 0
    v_mov_b32 v107, 0
    s_lshl_b32 s38, s27, 2
    v_mov_b32 v254, s38
    v_mov_b32 v252, 1
    v_mov_b32 v253, 2
    v_mov_b32 v248, -1
    v_mov_b32 v249, -1
    v_mov_b32 v250, -1
    v_mov_b32 v251, -1
    s_mul_i32 s58, s26, 6144
    s_mul_i32 s59, s20, 10240
    s_add_u32 s59, s59, 262144
    s_mul_i32 s60, s26, 3072
    s_lshl_b32 s61, s20, 6
    s_lshl_b32 s38, s24, 2
    s_add_u32 s61, s61, s38
    s_add_u32 s61, s61, 139264
    v_mov_b32 v10, 0
    s_mul_i32 s62, s22, 10240
    s_waitcnt vmcnt(20)
    s_barrier
    ds_read_b64_tr_b16 a[80:81], v241 offset:0
    ds_read_b64_tr_b16 a[82:83], v241 offset:512
    ds_read_b64_tr_b16 a[84:85], v241 offset:4096
    ds_read_b64_tr_b16 a[86:87], v241 offset:4608
    ds_read_b64_tr_b16 a[88:89], v241 offset:8192
    ds_read_b64_tr_b16 a[90:91], v241 offset:8704
    ds_read_b64_tr_b16 a[92:93], v241 offset:12288
    ds_read_b64_tr_b16 a[94:95], v241 offset:12800
    ds_read_b64_tr_b16 a[96:97], v241 offset:16384
    ds_read_b64_tr_b16 a[98:99], v241 offset:16896
    ds_read_b64_tr_b16 a[100:101], v241 offset:20480
    ds_read_b64_tr_b16 a[102:103], v241 offset:20992
    ds_read_b64_tr_b16 a[104:105], v241 offset:24576
    ds_read_b64_tr_b16 a[106:107], v241 offset:25088
    ds_read_b64_tr_b16 a[108:109], v241 offset:28672
    ds_read_b64_tr_b16 a[110:111], v241 offset:29184
    ds_read_b64_tr_b16 a[112:113], v241 offset:32768
    ds_read_b64_tr_b16 a[114:115], v241 offset:33280
    ds_read_b64_tr_b16 a[116:117], v241 offset:36864
    ds_read_b64_tr_b16 a[118:119], v241 offset:37376
    s_waitcnt lgkmcnt(0)
    s_barrier
    s_add_u32 s57, s28, s55
    s_add_u32 s57, s57, 3932160
    s_add_u32 m0, s56, 81920
    s_nop 0
    buffer_load_dwordx4 v240, s[16:19], s57 offen nt lds
    s_add_u32 s57, s57, 393216
    s_add_u32 m0, s56, 86016
    s_nop 0
    buffer_load_dwordx4 v240, s[16:19], s57 offen nt lds
    s_add_u32 s57, s57, 393216
    s_add_u32 m0, s56, 90112
    s_nop 0
    buffer_load_dwordx4 v240, s[16:19], s57 offen nt lds
    s_add_u32 s57, s57, 393216
    s_add_u32 m0, s56, 94208
    s_nop 0
    buffer_load_dwordx4 v240, s[16:19], s57 offen nt lds
    s_add_u32 s57, s57, 393216
    s_add_u32 m0, s56, 98304
    s_nop 0
    buffer_load_dwordx4 v240, s[16:19], s57 offen nt lds
    s_add_u32 s57, s57, 393216
    s_add_u32 m0, s56, 102400
    s_nop 0
    buffer_load_dwordx4 v240, s[16:19], s57 offen nt lds
    s_add_u32 s57, s57, 393216
    s_add_u32 m0, s56, 106496
    s_nop 0
    buffer_load_dwordx4 v240, s[16:19], s57 offen nt lds
    s_add_u32 s57, s57, 393216
    s_add_u32 m0, s56, 110592
    s_nop 0
    buffer_load_dwordx4 v240, s[16:19], s57 offen nt lds
    s_add_u32 s57, s57, 393216
    s_add_u32 m0, s56, 114688
    s_nop 0
    buffer_load_dwordx4 v240, s[16:19], s57 offen nt lds
    s_add_u32 s57, s57, 393216
    s_add_u32 m0, s56, 118784
    s_nop 0
    buffer_load_dwordx4 v240, s[16:19], s57 offen nt lds
    s_waitcnt vmcnt(20)
    s_barrier
    ds_read_b64_tr_b16 a[120:121], v242 offset:0
    ds_read_b64_tr_b16 a[122:123], v242 offset:512
    ds_read_b64_tr_b16 a[124:125], v242 offset:4096
    ds_read_b64_tr_b16 a[126:127], v242 offset:4608
    ds_read_b64_tr_b16 a[128:129], v242 offset:8192
    ds_read_b64_tr_b16 a[130:131], v242 offset:8704
    ds_read_b64_tr_b16 a[132:133], v242 offset:12288
    ds_read_b64_tr_b16 a[134:135], v242 offset:12800
    ds_read_b64_tr_b16 a[136:137], v242 offset:16384
    ds_read_b64_tr_b16 a[138:139], v242 offset:16896
    ds_read_b64_tr_b16 a[140:141], v242 offset:20480
    ds_read_b64_tr_b16 a[142:143], v242 offset:20992
    ds_read_b64_tr_b16 a[144:145], v242 offset:24576
    ds_read_b64_tr_b16 a[146:147], v242 offset:25088
    ds_read_b64_tr_b16 a[148:149], v242 offset:28672
    ds_read_b64_tr_b16 a[150:151], v242 offset:29184
    ds_read_b64_tr_b16 a[152:153], v242 offset:32768
    ds_read_b64_tr_b16 a[154:155], v242 offset:33280
    ds_read_b64_tr_b16 a[156:157], v242 offset:36864
    ds_read_b64_tr_b16 a[158:159], v242 offset:37376
    s_waitcnt lgkmcnt(0)
    s_barrier
    s_add_u32 s57, s28, s55
    s_add_u32 m0, s56, 122880
    s_nop 0
    buffer_load_dwordx4 v240, s[8:11], s57 offen nt lds
    s_add_u32 s57, s57, 393216
    s_add_u32 m0, s56, 126976
    s_nop 0
    buffer_load_dwordx4 v240, s[8:11], s57 offen nt lds
    s_add_u32 s57, s57, 393216
    s_add_u32 m0, s56, 131072
    s_nop 0
    buffer_load_dwordx4 v240, s[8:11], s57 offen nt lds
    s_add_u32 s57, s57, 393216
    s_add_u32 m0, s56, 135168
    s_nop 0
    buffer_load_dwordx4 v240, s[8:11], s57 offen nt lds
    s_add_u32 s57, s57, 393216
    s_add_u32 m0, s56, 139264
    s_nop 0
    buffer_load_dwordx4 v240, s[8:11], s57 offen nt lds
    s_add_u32 s57, s57, 393216
    s_add_u32 m0, s56, 143360
    s_nop 0
    buffer_load_dwordx4 v240, s[8:11], s57 offen nt lds
    s_add_u32 s57, s57, 393216
    s_add_u32 m0, s56, 147456
    s_nop 0
    buffer_load_dwordx4 v240, s[8:11], s57 offen nt lds
    s_add_u32 s57, s57, 393216
    s_add_u32 m0, s56, 151552
    s_nop 0
    buffer_load_dwordx4 v240, s[8:11], s57 offen nt lds
    s_add_u32 s57, s57, 393216
    s_add_u32 m0, s56, 155648
    s_nop 0
    buffer_load_dwordx4 v240, s[8:11], s57 offen nt lds
    s_add_u32 s57, s57, 393216
    s_add_u32 m0, s56, 159744
    s_nop 0
    buffer_load_dwordx4 v240, s[8:11], s57 offen nt lds
    s_waitcnt vmcnt(20)
    s_barrier
    ds_read_b64_tr_b16 a[160:161], v243 offset:0
    ds_read_b64_tr_b16 a[162:163], v243 offset:512
    ds_read_b64_tr_b16 a[164:165], v243 offset:4096
    ds_read_b64_tr_b16 a[166:167], v243 offset:4608
    ds_read_b64_tr_b16 a[168:169], v243 offset:8192
    ds_read_b64_tr_b16 a[170:171], v243 offset:8704
    ds_read_b64_tr_b16 a[172:173], v243 offset:12288
    ds_read_b64_tr_b16 a[174:175], v243 offset:12800
    ds_read_b64_tr_b16 a[176:177], v243 offset:16384
    ds_read_b64_tr_b16 a[178:179], v243 offset:16896
    ds_read_b64_tr_b16 a[180:181], v243 offset:20480
    ds_read_b64_tr_b16 a[182:183], v243 offset:20992
    ds_read_b64_tr_b16 a[184:185], v243 offset:24576
    ds_read_b64_tr_b16 a[186:187], v243 offset:25088
    ds_read_b64_tr_b16 a[188:189], v243 offset:28672
    ds_read_b64_tr_b16 a[190:191], v243 offset:29184
    ds_read_b64_tr_b16 a[192:193], v243 offset:32768
    ds_read_b64_tr_b16 a[194:195], v243 offset:33280
    ds_read_b64_tr_b16 a[196:197], v243 offset:36864
    ds_read_b64_tr_b16 a[198:199], v243 offset:37376
    s_waitcnt lgkmcnt(0)
    s_barrier
    s_waitcnt vmcnt(10)
    s_barrier
    ds_read_b64_tr_b16 a[200:201], v241 offset:0
    ds_read_b64_tr_b16 a[202:203], v241 offset:512
    ds_read_b64_tr_b16 a[204:205], v241 offset:4096
    ds_read_b64_tr_b16 a[206:207], v241 offset:4608
    ds_read_b64_tr_b16 a[208:209], v241 offset:8192
    ds_read_b64_tr_b16 a[210:211], v241 offset:8704
    ds_read_b64_tr_b16 a[212:213], v241 offset:12288
    ds_read_b64_tr_b16 a[214:215], v241 offset:12800
    ds_read_b64_tr_b16 a[216:217], v241 offset:16384
    ds_read_b64_tr_b16 a[218:219], v241 offset:16896
    ds_read_b64_tr_b16 a[220:221], v241 offset:20480
    ds_read_b64_tr_b16 a[222:223], v241 offset:20992
    ds_read_b64_tr_b16 a[224:225], v241 offset:24576
    ds_read_b64_tr_b16 a[226:227], v241 offset:25088
    ds_read_b64_tr_b16 a[228:229], v241 offset:28672
    ds_read_b64_tr_b16 a[230:231], v241 offset:29184
    ds_read_b64_tr_b16 a[232:233], v241 offset:32768
    ds_read_b64_tr_b16 a[234:235], v241 offset:33280
    ds_read_b64_tr_b16 a[236:237], v241 offset:36864
    ds_read_b64_tr_b16 a[238:239], v241 offset:37376
    s_waitcnt lgkmcnt(0)
    s_barrier
    s_waitcnt vmcnt(0)
    s_barrier
    ds_read_b64_tr_b16 a[0:1], v242 offset:0
    ds_read_b64_tr_b16 a[2:3], v242 offset:512
    ds_read_b64_tr_b16 a[4:5], v242 offset:4096
    ds_read_b64_tr_b16 a[6:7], v242 offset:4608
    ds_read_b64_tr_b16 a[8:9], v242 offset:8192
    ds_read_b64_tr_b16 a[10:11], v242 offset:8704
    ds_read_b64_tr_b16 a[12:13], v242 offset:12288
    ds_read_b64_tr_b16 a[14:15], v242 offset:12800
    ds_read_b64_tr_b16 a[16:17], v242 offset:16384
    ds_read_b64_tr_b16 a[18:19], v242 offset:16896
    ds_read_b64_tr_b16 a[20:21], v242 offset:20480
    ds_read_b64_tr_b16 a[22:23], v242 offset:20992
    ds_read_b64_tr_b16 a[24:25], v242 offset:24576
    ds_read_b64_tr_b16 a[26:27], v242 offset:25088
    ds_read_b64_tr_b16 a[28:29], v242 offset:28672
    ds_read_b64_tr_b16 a[30:31], v242 offset:29184
    ds_read_b64_tr_b16 a[32:33], v242 offset:32768
    ds_read_b64_tr_b16 a[34:35], v242 offset:33280
    ds_read_b64_tr_b16 a[36:37], v242 offset:36864
    ds_read_b64_tr_b16 a[38:39], v242 offset:37376
    s_waitcnt lgkmcnt(0)
    s_barrier
    s_mov_b32 s31, 262144
    v_lshlrev_b32 v162, 2, v1
    s_mov_b32 exec_hi, 0
Lwr_2:
    global_load_dword v160, v162, s[74:75] offset:128 sc1
    s_mov_b32 s23, 0
    s_mov_b32 s38, 0
    s_waitcnt vmcnt(0)
    v_cmp_eq_u32 vcc, 0x20, v160
    s_nop 0
    s_or_b32 s38, s38, vcc_lo
    v_cmp_eq_u32 vcc, 0x2000, v160
    s_nop 0
    s_or_b32 s38, s38, vcc_lo
    v_cmp_eq_u32 vcc, 0x200000, v160
    s_nop 0
    s_or_b32 s38, s38, vcc_lo
    v_cmp_eq_u32 vcc, 0x20000000, v160
    s_nop 0
    s_or_b32 s38, s38, vcc_lo
    v_sad_u8 v161, v160, 0, 0
    s_bcnt1_i32_b32 s38, s38
    s_cmp_eq_u32 s38, 8
    s_cbranch_scc1 Lwd_3
    v_add_u32_dpp v161, v161, v161 row_shr:1 row_mask:0xf bank_mask:0xf bound_ctrl:0
    s_nop 1
    v_add_u32_dpp v161, v161, v161 row_shr:2 row_mask:0xf bank_mask:0xf bound_ctrl:0
    s_nop 1
    v_add_u32_dpp v161, v161, v161 row_shr:4 row_mask:0xf bank_mask:0xf bound_ctrl:0
    s_nop 1
    v_add_u32_dpp v161, v161, v161 row_shr:8 row_mask:0xf bank_mask:0xf bound_ctrl:0
    s_nop 0
    v_readlane_b32 s38, v161, 15
    v_readlane_b32 s39, v161, 31
    s_mov_b32 s23, 1
    s_add_u32 s38, s38, s39
    s_cmp_eq_u32 s38, 256
    s_cbranch_scc1 Lwd_3
    s_sleep 4
    s_sub_u32 s31, s31, 1
    s_cbranch_scc0 Lwr_2
    s_mov_b32 s31, 10
    s_branch L_fail
Lwd_3:
    s_mov_b64 exec, -1
    s_add_u32 s63, s62, 4194304
    s_add_u32 m0, s62, 0
    s_nop 0
    buffer_load_dwordx4 v2, s[4:7], s63 offen lds
    s_add_u32 s63, s63, 1024
    s_add_u32 m0, s62, 1024
    s_nop 0
    buffer_load_dwordx4 v2, s[4:7], s63 offen lds
    s_add_u32 s63, s63, 1024
    s_add_u32 m0, s62, 2048
    s_nop 0
    buffer_load_dwordx4 v2, s[4:7], s63 offen lds
    s_add_u32 s63, s63, 1024
    s_add_u32 m0, s62, 3072
    s_nop 0
    buffer_load_dwordx4 v2, s[4:7], s63 offen lds
    s_add_u32 s63, s63, 1024
    s_add_u32 m0, s62, 4096
    s_nop 0
    buffer_load_dwordx4 v2, s[4:7], s63 offen lds
    s_add_u32 s63, s63, 1024
    s_add_u32 m0, s62, 5120
    s_nop 0
    buffer_load_dwordx4 v2, s[4:7], s63 offen lds
    s_add_u32 s63, s63, 1024
    s_add_u32 m0, s62, 6144
    s_nop 0
    buffer_load_dwordx4 v2, s[4:7], s63 offen lds
    s_add_u32 s63, s63, 1024
    s_add_u32 m0, s62, 7168
    s_nop 0
    buffer_load_dwordx4 v2, s[4:7], s63 offen lds
    s_add_u32 s63, s63, 1024
    s_add_u32 m0, s62, 8192
    s_nop 0
    buffer_load_dwordx4 v2, s[4:7], s63 offen lds
    s_add_u32 s63, s63, 1024
    s_add_u32 m0, s62, 9216
    s_nop 0
    buffer_load_dwordx4 v2, s[4:7], s63 offen lds
    s_add_u32 s63, s63, 1024
    s_cmp_lg_u32 s23, 0
    s_cbranch_scc1 L_qkvs
    s_mov_b32 s30, 0
    s_mov_b32 s64, 0
    s_add_u32 s57, s28, s55
    s_add_u32 s57, s57, 3932160
    s_add_u32 m0, s56, 81920
    s_nop 0
    buffer_load_dwordx4 v240, s[8:11], s57 offen nt lds
    s_add_u32 s57, s57, 393216
    s_add_u32 m0, s56, 86016
    s_nop 0
    buffer_load_dwordx4 v240, s[8:11], s57 offen nt lds
    s_add_u32 s57, s57, 393216
    s_add_u32 m0, s56, 90112
    s_nop 0
    buffer_load_dwordx4 v240, s[8:11], s57 offen nt lds
    s_add_u32 s57, s57, 393216
    s_add_u32 m0, s56, 94208
    s_nop 0
    buffer_load_dwordx4 v240, s[8:11], s57 offen nt lds
    s_waitcnt vmcnt(4)
    s_barrier
    s_and_b32 s65, s64, 1
    s_mul_i32 s66, s65, 40960
    v_add_u32 v12, s66, v2
    s_xor_b32 s65, s65, 1
    s_mul_i32 s65, s65, 40960
    s_add_u32 s65, s65, s62
    s_add_u32 s66, s64, 1
    s_min_u32 s66, s66, 63
    s_mul_i32 s66, s66, 40960
    s_add_u32 s66, s66, s62
    s_add_u32 s66, s66, 4194304
    s_and_b32 s47, s64, 7
    s_mul_i32 s47, s47, 393216
    s_lshl_b32 s48, s58, 1
    s_add_u32 s47, s47, s48
    ds_read_b128 v[16:19], v12 offset:0
    ds_read_b128 v[20:23], v12 offset:1024
    ds_read_b128 v[24:27], v12 offset:2048
    ds_read_b128 v[28:31], v12 offset:3072
    ds_read_b128 v[32:35], v12 offset:4096
    ds_read_b128 v[36:39], v12 offset:5120
    ds_read_b128 v[40:43], v12 offset:6144
    ds_read_b128 v[44:47], v12 offset:7168
    ds_read_b128 v[48:51], v12 offset:8192
    ds_read_b128 v[52:55], v12 offset:9216
    s_waitcnt lgkmcnt(9)
    v_mfma_f32_16x16x32_bf16 v[148:151], a[160:163], v[16:19], 0
    v_mfma_f32_16x16x32_bf16 v[140:143], a[80:83], v[16:19], 0
    ds_read_b128 v[56:59], v12 offset:10240
    s_add_u32 s57, s57, 393216
    s_add_u32 m0, s56, 98304
    s_nop 0
    buffer_load_dwordx4 v240, s[8:11], s57 offen nt lds
    s_waitcnt lgkmcnt(9)
    v_mfma_f32_16x16x32_bf16 v[148:151], a[164:167], v[20:23], v[148:151]
    v_mfma_f32_16x16x32_bf16 v[140:143], a[84:87], v[20:23], v[140:143]
    ds_read_b128 v[60:63], v12 offset:11264
    s_waitcnt lgkmcnt(9)
    v_mfma_f32_16x16x32_bf16 v[148:151], a[168:171], v[24:27], v[148:151]
    v_mfma_f32_16x16x32_bf16 v[140:143], a[88:91], v[24:27], v[140:143]
    ds_read_b128 v[64:67], v12 offset:12288
    s_add_u32 s57, s57, 393216
    s_add_u32 m0, s56, 102400
    s_nop 0
    buffer_load_dwordx4 v240, s[8:11], s57 offen nt lds
    s_waitcnt lgkmcnt(9)
    v_mfma_f32_16x16x32_bf16 v[148:151], a[172:175], v[28:31], v[148:151]
    v_mfma_f32_16x16x32_bf16 v[140:143], a[92:95], v[28:31], v[140:143]
    ds_read_b128 v[68:71], v12 offset:13312
    s_waitcnt lgkmcnt(9)
    v_mfma_f32_16x16x32_bf16 v[148:151], a[176:179], v[32:35], v[148:151]
    v_mfma_f32_16x16x32_bf16 v[140:143], a[96:99], v[32:35], v[140:143]
    ds_read_b128 v[72:75], v12 offset:14336
    s_add_u32 s57, s57, 393216
    s_add_u32 m0, s56, 106496
    s_nop 0
    buffer_load_dwordx4 v240, s[8:11], s57 offen nt lds
    s_waitcnt lgkmcnt(9)
    v_mfma_f32_16x16x32_bf16 v[148:151], a[180:183], v[36:39], v[148:151]
    v_mfma_f32_16x16x32_bf16 v[140:143], a[100:103], v[36:39], v[140:143]
    ds_read_b128 v[76:79], v12 offset:15360
    s_waitcnt lgkmcnt(9)
    v_mfma_f32_16x16x32_bf16 v[148:151], a[184:187], v[40:43], v[148:151]
    v_mfma_f32_16x16x32_bf16 v[140:143], a[104:107], v[40:43], v[140:143]
    ds_read_b128 v[80:83], v12 offset:16384
    s_add_u32 s57, s57, 393216
    s_add_u32 m0, s56, 110592
    s_nop 0
    buffer_load_dwordx4 v240, s[8:11], s57 offen nt lds
    s_waitcnt lgkmcnt(9)
    v_mfma_f32_16x16x32_bf16 v[148:151], a[188:191], v[44:47], v[148:151]
    v_mfma_f32_16x16x32_bf16 v[140:143], a[108:111], v[44:47], v[140:143]
    ds_read_b128 v[84:87], v12 offset:17408
    s_waitcnt lgkmcnt(9)
    v_mfma_f32_16x16x32_bf16 v[148:151], a[192:195], v[48:51], v[148:151]
    v_mfma_f32_16x16x32_bf16 v[140:143], a[112:115], v[48:51], v[140:143]
    ds_read_b128 v[88:91], v12 offset:18432
    s_add_u32 s57, s57, 393216
    s_add_u32 m0, s56, 114688
    s_nop 0
    buffer_load_dwordx4 v240, s[8:11], s57 offen nt lds
    s_waitcnt lgkmcnt(9)
    v_mfma_f32_16x16x32_bf16 v[148:151], a[196:199], v[52:55], v[148:151]
    v_mfma_f32_16x16x32_bf16 v[140:143], a[116:119], v[52:55], v[140:143]
    ds_read_b128 v[92:95], v12 offset:19456
    s_waitcnt lgkmcnt(9)
    v_mfma_f32_16x16x32_bf16 v[148:151], a[200:203], v[56:59], v[148:151]
    v_mfma_f32_16x16x32_bf16 v[140:143], a[120:123], v[56:59], v[140:143]
    ds_read_b128 v[16:19], v12 offset:20480
    s_add_u32 s57, s57, 393216
    s_add_u32 m0, s56, 118784
    s_nop 0
    buffer_load_dwordx4 v240, s[8:11], s57 offen nt lds
    s_waitcnt lgkmcnt(9)
    v_mfma_f32_16x16x32_bf16 v[148:151], a[204:207], v[60:63], v[148:151]
    v_mfma_f32_16x16x32_bf16 v[140:143], a[124:127], v[60:63], v[140:143]
    ds_read_b128 v[20:23], v12 offset:21504
    s_waitcnt lgkmcnt(9)
    v_mfma_f32_16x16x32_bf16 v[148:151], a[208:211], v[64:67], v[148:151]
    v_mfma_f32_16x16x32_bf16 v[140:143], a[128:131], v[64:67], v[140:143]
    ds_read_b128 v[24:27], v12 offset:22528
    s_add_u32 s63, s62, 4235264
    s_add_u32 m0, s62, 40960
    s_nop 0
    buffer_load_dwordx4 v2, s[4:7], s63 offen lds
    s_waitcnt lgkmcnt(9)
    v_mfma_f32_16x16x32_bf16 v[148:151], a[212:215], v[68:71], v[148:151]
    v_mfma_f32_16x16x32_bf16 v[140:143], a[132:135], v[68:71], v[140:143]
    ds_read_b128 v[28:31], v12 offset:23552
    s_waitcnt lgkmcnt(9)
    v_mfma_f32_16x16x32_bf16 v[148:151], a[216:219], v[72:75], v[148:151]
    v_mfma_f32_16x16x32_bf16 v[140:143], a[136:139], v[72:75], v[140:143]
    ds_read_b128 v[32:35], v12 offset:24576
    s_add_u32 s63, s63, 1024
    s_add_u32 m0, s62, 41984
    s_nop 0
    buffer_load_dwordx4 v2, s[4:7], s63 offen lds
    s_waitcnt lgkmcnt(9)
    v_mfma_f32_16x16x32_bf16 v[148:151], a[220:223], v[76:79], v[148:151]
    v_mfma_f32_16x16x32_bf16 v[140:143], a[140:143], v[76:79], v[140:143]
    ds_read_b128 v[36:39], v12 offset:25600
    s_waitcnt lgkmcnt(9)
    v_mfma_f32_16x16x32_bf16 v[148:151], a[224:227], v[80:83], v[148:151]
    v_mfma_f32_16x16x32_bf16 v[140:143], a[144:147], v[80:83], v[140:143]
    ds_read_b128 v[40:43], v12 offset:26624
    s_add_u32 s63, s63, 1024
    s_add_u32 m0, s62, 43008
    s_nop 0
    buffer_load_dwordx4 v2, s[4:7], s63 offen lds
    s_waitcnt lgkmcnt(9)
    v_mfma_f32_16x16x32_bf16 v[148:151], a[228:231], v[84:87], v[148:151]
    v_mfma_f32_16x16x32_bf16 v[140:143], a[148:151], v[84:87], v[140:143]
    ds_read_b128 v[44:47], v12 offset:27648
    s_waitcnt lgkmcnt(9)
    v_mfma_f32_16x16x32_bf16 v[148:151], a[232:235], v[88:91], v[148:151]
    v_mfma_f32_16x16x32_bf16 v[140:143], a[152:155], v[88:91], v[140:143]
    ds_read_b128 v[48:51], v12 offset:28672
    s_add_u32 s63, s63, 1024
    s_add_u32 m0, s62, 44032
    s_nop 0
    buffer_load_dwordx4 v2, s[4:7], s63 offen lds
    s_waitcnt lgkmcnt(9)
    v_mfma_f32_16x16x32_bf16 v[148:151], a[236:239], v[92:95], v[148:151]
    v_mfma_f32_16x16x32_bf16 v[140:143], a[156:159], v[92:95], v[140:143]
    ds_read_b128 v[52:55], v12 offset:29696
    s_waitcnt lgkmcnt(9)
    v_mfma_f32_16x16x32_bf16 v[152:155], a[160:163], v[16:19], 0
    v_mfma_f32_16x16x32_bf16 v[144:147], a[80:83], v[16:19], 0
    ds_read_b128 v[56:59], v12 offset:30720
    s_add_u32 s63, s63, 1024
    s_add_u32 m0, s62, 45056
    s_nop 0
    buffer_load_dwordx4 v2, s[4:7], s63 offen lds
    s_waitcnt lgkmcnt(9)
    v_mfma_f32_16x16x32_bf16 v[152:155], a[164:167], v[20:23], v[152:155]
    v_mfma_f32_16x16x32_bf16 v[144:147], a[84:87], v[20:23], v[144:147]
    ds_read_b128 v[60:63], v12 offset:31744
    s_waitcnt lgkmcnt(9)
    v_mfma_f32_16x16x32_bf16 v[152:155], a[168:171], v[24:27], v[152:155]
    v_mfma_f32_16x16x32_bf16 v[144:147], a[88:91], v[24:27], v[144:147]
    ds_read_b128 v[64:67], v12 offset:32768
    s_add_u32 s63, s63, 1024
    s_add_u32 m0, s62, 46080
    s_nop 0
    buffer_load_dwordx4 v2, s[4:7], s63 offen lds
    s_waitcnt lgkmcnt(9)
    v_mfma_f32_16x16x32_bf16 v[152:155], a[172:175], v[28:31], v[152:155]
    v_mfma_f32_16x16x32_bf16 v[144:147], a[92:95], v[28:31], v[144:147]
    ds_read_b128 v[68:71], v12 offset:33792
    v_cvt_pk_bf16_f32 v168, v148, v149
    v_cvt_pk_bf16_f32 v169, v150, v151
    s_add_u32 s48, s47, 67108864
    buffer_store_dwordx2 v[168:169], v8, s[4:7], s48 offen
    s_waitcnt lgkmcnt(9)
    v_mfma_f32_16x16x32_bf16 v[152:155], a[176:179], v[32:35], v[152:155]
    v_mfma_f32_16x16x32_bf16 v[144:147], a[96:99], v[32:35], v[144:147]
    ds_read_b128 v[72:75], v12 offset:34816
    s_add_u32 s63, s63, 1024
    s_add_u32 m0, s62, 47104
    s_nop 0
    buffer_load_dwordx4 v2, s[4:7], s63 offen lds
    v_cvt_pk_bf16_f32 v164, v140, v141
    v_cvt_pk_bf16_f32 v165, v142, v143
    s_waitcnt lgkmcnt(9)
    v_mfma_f32_16x16x32_bf16 v[152:155], a[180:183], v[36:39], v[152:155]
    v_mfma_f32_16x16x32_bf16 v[144:147], a[100:103], v[36:39], v[144:147]
    ds_read_b128 v[76:79], v12 offset:35840
    s_waitcnt lgkmcnt(9)
    v_mfma_f32_16x16x32_bf16 v[152:155], a[184:187], v[40:43], v[152:155]
    v_mfma_f32_16x16x32_bf16 v[144:147], a[104:107], v[40:43], v[144:147]
    ds_read_b128 v[80:83], v12 offset:36864
    s_add_u32 s63, s63, 1024
    s_add_u32 m0, s62, 48128
    s_nop 0
    buffer_load_dwordx4 v2, s[4:7], s63 offen lds
    s_waitcnt lgkmcnt(9)
    v_mfma_f32_16x16x32_bf16 v[152:155], a[188:191], v[44:47], v[152:155]
    v_mfma_f32_16x16x32_bf16 v[144:147], a[108:111], v[44:47], v[144:147]
    ds_read_b128 v[84:87], v12 offset:37888
    s_waitcnt lgkmcnt(9)
    v_mfma_f32_16x16x32_bf16 v[152:155], a[192:195], v[48:51], v[152:155]
    v_mfma_f32_16x16x32_bf16 v[144:147], a[112:115], v[48:51], v[144:147]
    ds_read_b128 v[88:91], v12 offset:38912
    s_add_u32 s63, s63, 1024
    s_add_u32 m0, s62, 49152
    s_nop 0
    buffer_load_dwordx4 v2, s[4:7], s63 offen lds
    s_waitcnt lgkmcnt(9)
    v_mfma_f32_16x16x32_bf16 v[152:155], a[196:199], v[52:55], v[152:155]
    v_mfma_f32_16x16x32_bf16 v[144:147], a[116:119], v[52:55], v[144:147]
    ds_read_b128 v[92:95], v12 offset:39936
    s_waitcnt lgkmcnt(9)
    v_mfma_f32_16x16x32_bf16 v[152:155], a[200:203], v[56:59], v[152:155]
    v_mfma_f32_16x16x32_bf16 v[144:147], a[120:123], v[56:59], v[144:147]
    s_add_u32 s63, s63, 1024
    s_add_u32 m0, s62, 50176
    s_nop 0
    buffer_load_dwordx4 v2, s[4:7], s63 offen lds
    s_waitcnt lgkmcnt(8)
    v_mfma_f32_16x16x32_bf16 v[152:155], a[204:207], v[60:63], v[152:155]
    v_mfma_f32_16x16x32_bf16 v[144:147], a[124:127], v[60:63], v[144:147]
    s_waitcnt lgkmcnt(7)
    v_mfma_f32_16x16x32_bf16 v[152:155], a[208:211], v[64:67], v[152:155]
    v_mfma_f32_16x16x32_bf16 v[144:147], a[128:131], v[64:67], v[144:147]
    s_waitcnt lgkmcnt(6)
    v_mfma_f32_16x16x32_bf16 v[152:155], a[212:215], v[68:71], v[152:155]
    v_mfma_f32_16x16x32_bf16 v[144:147], a[132:135], v[68:71], v[144:147]
    s_waitcnt lgkmcnt(5)
    v_mfma_f32_16x16x32_bf16 v[152:155], a[216:219], v[72:75], v[152:155]
    v_mfma_f32_16x16x32_bf16 v[144:147], a[136:139], v[72:75], v[144:147]
    s_waitcnt lgkmcnt(4)
    v_mfma_f32_16x16x32_bf16 v[152:155], a[220:223], v[76:79], v[152:155]
    v_mfma_f32_16x16x32_bf16 v[144:147], a[140:143], v[76:79], v[144:147]
    s_waitcnt lgkmcnt(3)
    v_mfma_f32_16x16x32_bf16 v[152:155], a[224:227], v[80:83], v[152:155]
    v_mfma_f32_16x16x32_bf16 v[144:147], a[144:147], v[80:83], v[144:147]
    s_waitcnt lgkmcnt(2)
    v_mfma_f32_16x16x32_bf16 v[152:155], a[228:231], v[84:87], v[152:155]
    v_mfma_f32_16x16x32_bf16 v[144:147], a[148:151], v[84:87], v[144:147]
    s_waitcnt lgkmcnt(1)
    v_mfma_f32_16x16x32_bf16 v[152:155], a[232:235], v[88:91], v[152:155]
    v_mfma_f32_16x16x32_bf16 v[144:147], a[152:155], v[88:91], v[144:147]
    s_waitcnt lgkmcnt(0)
    v_mfma_f32_16x16x32_bf16 v[152:155], a[236:239], v[92:95], v[152:155]
    v_mfma_f32_16x16x32_bf16 v[144:147], a[156:159], v[92:95], v[144:147]
    s_nop 3
    v_cvt_pk_bf16_f32 v170, v152, v153
    v_cvt_pk_bf16_f32 v171, v154, v155
    s_add_u32 s48, s47, 67115008
    buffer_store_dwordx2 v[170:171], v8, s[4:7], s48 offen
    v_cvt_pk_bf16_f32 v166, v144, v145
    v_cvt_pk_bf16_f32 v167, v146, v147
    s_add_u32 s48, s47, 41943040
    v_permlane16_swap_b32 v164, v166
    v_permlane16_swap_b32 v165, v167
    buffer_store_dwordx4 v[164:167], v190, s[4:7], s48 offen
    s_mov_b32 s64, 1
    s_sub_u32 s51, s64, 1
    s_lshl_b32 s51, s51, 5
    s_add_u32 s51, s51, s26
    s_lshl_b32 s51, s51, 6
    s_add_u32 s51, s51, 4096
    s_waitcnt vmcnt(0)
    s_mov_b64 exec, 1
    buffer_store_dword v252, v254, s[4:7], s51 offen
    s_mov_b64 exec, -1
    s_waitcnt vmcnt(1)
    s_barrier
    ds_read_b64_tr_b16 a[40:41], v241 offset:0
    ds_read_b64_tr_b16 a[42:43], v241 offset:512
    ds_read_b64_tr_b16 a[44:45], v241 offset:4096
    ds_read_b64_tr_b16 a[46:47], v241 offset:4608
    ds_read_b64_tr_b16 a[48:49], v241 offset:8192
    ds_read_b64_tr_b16 a[50:51], v241 offset:8704
    ds_read_b64_tr_b16 a[52:53], v241 offset:12288
    ds_read_b64_tr_b16 a[54:55], v241 offset:12800
    ds_read_b64_tr_b16 a[56:57], v241 offset:16384
    ds_read_b64_tr_b16 a[58:59], v241 offset:16896
    ds_read_b64_tr_b16 a[60:61], v241 offset:20480
    ds_read_b64_tr_b16 a[62:63], v241 offset:20992
    ds_read_b64_tr_b16 a[64:65], v241 offset:24576
    ds_read_b64_tr_b16 a[66:67], v241 offset:25088
    ds_read_b64_tr_b16 a[68:69], v241 offset:28672
    ds_read_b64_tr_b16 a[70:71], v241 offset:29184
    ds_read_b64_tr_b16 a[72:73], v241 offset:32768
    ds_read_b64_tr_b16 a[74:75], v241 offset:33280
    ds_read_b64_tr_b16 a[76:77], v241 offset:36864
    ds_read_b64_tr_b16 a[78:79], v241 offset:37376
    s_waitcnt lgkmcnt(0)
    s_barrier
    s_and_b32 s65, s64, 1
    s_mul_i32 s66, s65, 40960
    v_add_u32 v12, s66, v2
    s_xor_b32 s65, s65, 1
    s_mul_i32 s65, s65, 40960
    s_add_u32 s65, s65, s62
    s_add_u32 s66, s64, 1
    s_min_u32 s66, s66, 63
    s_mul_i32 s66, s66, 40960
    s_add_u32 s66, s66, s62
    s_add_u32 s66, s66, 4194304
    s_and_b32 s47, s64, 7
    s_mul_i32 s47, s47, 393216
    s_lshl_b32 s48, s58, 1
    s_add_u32 s47, s47, s48
    ds_read_b128 v[16:19], v12 offset:0
    ds_read_b128 v[20:23], v12 offset:1024
    ds_read_b128 v[24:27], v12 offset:2048
    ds_read_b128 v[28:31], v12 offset:3072
    ds_read_b128 v[32:35], v12 offset:4096
    ds_read_b128 v[36:39], v12 offset:5120
    ds_read_b128 v[40:43], v12 offset:6144
    ds_read_b128 v[44:47], v12 offset:7168
    ds_read_b128 v[48:51], v12 offset:8192
    ds_read_b128 v[52:55], v12 offset:9216
    s_waitcnt lgkmcnt(9)
    v_mfma_f32_16x16x32_bf16 v[148:151], a[160:163], v[16:19], 0
    v_mfma_f32_16x16x32_bf16 v[140:143], a[80:83], v[16:19], 0
    v_mfma_f32_16x16x32_bf16 v[132:135], a[0:3], v[16:19], 0
    ds_read_b128 v[56:59], v12 offset:10240
    s_waitcnt lgkmcnt(9)
    v_mfma_f32_16x16x32_bf16 v[148:151], a[164:167], v[20:23], v[148:151]
    v_mfma_f32_16x16x32_bf16 v[140:143], a[84:87], v[20:23], v[140:143]
    v_mfma_f32_16x16x32_bf16 v[132:135], a[4:7], v[20:23], v[132:135]
    ds_read_b128 v[60:63], v12 offset:11264
    s_waitcnt lgkmcnt(9)
    v_mfma_f32_16x16x32_bf16 v[148:151], a[168:171], v[24:27], v[148:151]
    v_mfma_f32_16x16x32_bf16 v[140:143], a[88:91], v[24:27], v[140:143]
    v_mfma_f32_16x16x32_bf16 v[132:135], a[8:11], v[24:27], v[132:135]
    ds_read_b128 v[64:67], v12 offset:12288
    s_waitcnt lgkmcnt(9)
    v_mfma_f32_16x16x32_bf16 v[148:151], a[172:175], v[28:31], v[148:151]
    v_mfma_f32_16x16x32_bf16 v[140:143], a[92:95], v[28:31], v[140:143]
    v_mfma_f32_16x16x32_bf16 v[132:135], a[12:15], v[28:31], v[132:135]
    ds_read_b128 v[68:71], v12 offset:13312
    s_waitcnt lgkmcnt(9)
    v_mfma_f32_16x16x32_bf16 v[148:151], a[176:179], v[32:35], v[148:151]
    v_mfma_f32_16x16x32_bf16 v[140:143], a[96:99], v[32:35], v[140:143]
    v_mfma_f32_16x16x32_bf16 v[132:135], a[16:19], v[32:35], v[132:135]
    ds_read_b128 v[72:75], v12 offset:14336
    s_waitcnt lgkmcnt(9)
    v_mfma_f32_16x16x32_bf16 v[148:151], a[180:183], v[36:39], v[148:151]
    v_mfma_f32_16x16x32_bf16 v[140:143], a[100:103], v[36:39], v[140:143]
    v_mfma_f32_16x16x32_bf16 v[132:135], a[20:23], v[36:39], v[132:135]
    ds_read_b128 v[76:79], v12 offset:15360
    s_waitcnt lgkmcnt(9)
    v_mfma_f32_16x16x32_bf16 v[148:151], a[184:187], v[40:43], v[148:151]
    v_mfma_f32_16x16x32_bf16 v[140:143], a[104:107], v[40:43], v[140:143]
    v_mfma_f32_16x16x32_bf16 v[132:135], a[24:27], v[40:43], v[132:135]
    ds_read_b128 v[80:83], v12 offset:16384
    s_waitcnt lgkmcnt(9)
    v_mfma_f32_16x16x32_bf16 v[148:151], a[188:191], v[44:47], v[148:151]
    v_mfma_f32_16x16x32_bf16 v[140:143], a[108:111], v[44:47], v[140:143]
    v_mfma_f32_16x16x32_bf16 v[132:135], a[28:31], v[44:47], v[132:135]
    ds_read_b128 v[84:87], v12 offset:17408
    s_waitcnt lgkmcnt(9)
    v_mfma_f32_16x16x32_bf16 v[148:151], a[192:195], v[48:51], v[148:151]
    v_mfma_f32_16x16x32_bf16 v[140:143], a[112:115], v[48:51], v[140:143]
    v_mfma_f32_16x16x32_bf16 v[132:135], a[32:35], v[48:51], v[132:135]
    ds_read_b128 v[88:91], v12 offset:18432
    s_waitcnt lgkmcnt(9)
    v_mfma_f32_16x16x32_bf16 v[148:151], a[196:199], v[52:55], v[148:151]
    v_mfma_f32_16x16x32_bf16 v[140:143], a[116:119], v[52:55], v[140:143]
    v_mfma_f32_16x16x32_bf16 v[132:135], a[36:39], v[52:55], v[132:135]
    ds_read_b128 v[92:95], v12 offset:19456
    s_waitcnt lgkmcnt(9)
    v_mfma_f32_16x16x32_bf16 v[148:151], a[200:203], v[56:59], v[148:151]
    v_mfma_f32_16x16x32_bf16 v[140:143], a[120:123], v[56:59], v[140:143]
    v_mfma_f32_16x16x32_bf16 v[132:135], a[40:43], v[56:59], v[132:135]
    ds_read_b128 v[16:19], v12 offset:20480
    s_waitcnt lgkmcnt(9)
    v_mfma_f32_16x16x32_bf16 v[148:151], a[204:207], v[60:63], v[148:151]
    v_mfma_f32_16x16x32_bf16 v[140:143], a[124:127], v[60:63], v[140:143]
    v_mfma_f32_16x16x32_bf16 v[132:135], a[44:47], v[60:63], v[132:135]
    ds_read_b128 v[20:23], v12 offset:21504
    s_waitcnt lgkmcnt(9)
    v_mfma_f32_16x16x32_bf16 v[148:151], a[208:211], v[64:67], v[148:151]
    v_mfma_f32_16x16x32_bf16 v[140:143], a[128:131], v[64:67], v[140:143]
    v_mfma_f32_16x16x32_bf16 v[132:135], a[48:51], v[64:67], v[132:135]
    ds_read_b128 v[24:27], v12 offset:22528
    s_waitcnt lgkmcnt(9)
    v_mfma_f32_16x16x32_bf16 v[148:151], a[212:215], v[68:71], v[148:151]
    v_mfma_f32_16x16x32_bf16 v[140:143], a[132:135], v[68:71], v[140:143]
    v_mfma_f32_16x16x32_bf16 v[132:135], a[52:55], v[68:71], v[132:135]
    ds_read_b128 v[28:31], v12 offset:23552
    s_waitcnt lgkmcnt(9)
    v_mfma_f32_16x16x32_bf16 v[148:151], a[216:219], v[72:75], v[148:151]
    v_mfma_f32_16x16x32_bf16 v[140:143], a[136:139], v[72:75], v[140:143]
    v_mfma_f32_16x16x32_bf16 v[132:135], a[56:59], v[72:75], v[132:135]
    ds_read_b128 v[32:35], v12 offset:24576
    s_waitcnt lgkmcnt(9)
    v_mfma_f32_16x16x32_bf16 v[148:151], a[220:223], v[76:79], v[148:151]
    v_mfma_f32_16x16x32_bf16 v[140:143], a[140:143], v[76:79], v[140:143]
    v_mfma_f32_16x16x32_bf16 v[132:135], a[60:63], v[76:79], v[132:135]
    ds_read_b128 v[36:39], v12 offset:25600
    s_waitcnt lgkmcnt(9)
    v_mfma_f32_16x16x32_bf16 v[148:151], a[224:227], v[80:83], v[148:151]
    v_mfma_f32_16x16x32_bf16 v[140:143], a[144:147], v[80:83], v[140:143]
    v_mfma_f32_16x16x32_bf16 v[132:135], a[64:67], v[80:83], v[132:135]
    ds_read_b128 v[40:43], v12 offset:26624
    s_waitcnt lgkmcnt(9)
    v_mfma_f32_16x16x32_bf16 v[148:151], a[228:231], v[84:87], v[148:151]
    v_mfma_f32_16x16x32_bf16 v[140:143], a[148:151], v[84:87], v[140:143]
    v_mfma_f32_16x16x32_bf16 v[132:135], a[68:71], v[84:87], v[132:135]
    ds_read_b128 v[44:47], v12 offset:27648
    s_waitcnt lgkmcnt(9)
    v_mfma_f32_16x16x32_bf16 v[148:151], a[232:235], v[88:91], v[148:151]
    v_mfma_f32_16x16x32_bf16 v[140:143], a[152:155], v[88:91], v[140:143]
    v_mfma_f32_16x16x32_bf16 v[132:135], a[72:75], v[88:91], v[132:135]
    ds_read_b128 v[48:51], v12 offset:28672
    s_waitcnt lgkmcnt(9)
    v_mfma_f32_16x16x32_bf16 v[148:151], a[236:239], v[92:95], v[148:151]
    v_mfma_f32_16x16x32_bf16 v[140:143], a[156:159], v[92:95], v[140:143]
    v_mfma_f32_16x16x32_bf16 v[132:135], a[76:79], v[92:95], v[132:135]
    ds_read_b128 v[52:55], v12 offset:29696
    s_waitcnt lgkmcnt(9)
    v_mfma_f32_16x16x32_bf16 v[152:155], a[160:163], v[16:19], 0
    v_mfma_f32_16x16x32_bf16 v[144:147], a[80:83], v[16:19], 0
    v_mfma_f32_16x16x32_bf16 v[136:139], a[0:3], v[16:19], 0
    ds_read_b128 v[56:59], v12 offset:30720
    s_waitcnt lgkmcnt(9)
    v_mfma_f32_16x16x32_bf16 v[152:155], a[164:167], v[20:23], v[152:155]
    v_mfma_f32_16x16x32_bf16 v[144:147], a[84:87], v[20:23], v[144:147]
    v_mfma_f32_16x16x32_bf16 v[136:139], a[4:7], v[20:23], v[136:139]
    ds_read_b128 v[60:63], v12 offset:31744
    s_waitcnt lgkmcnt(9)
    v_mfma_f32_16x16x32_bf16 v[152:155], a[168:171], v[24:27], v[152:155]
    v_mfma_f32_16x16x32_bf16 v[144:147], a[88:91], v[24:27], v[144:147]
    v_mfma_f32_16x16x32_bf16 v[136:139], a[8:11], v[24:27], v[136:139]
    ds_read_b128 v[64:67], v12 offset:32768
    s_waitcnt lgkmcnt(9)
    v_mfma_f32_16x16x32_bf16 v[152:155], a[172:175], v[28:31], v[152:155]
    v_mfma_f32_16x16x32_bf16 v[144:147], a[92:95], v[28:31], v[144:147]
    v_mfma_f32_16x16x32_bf16 v[136:139], a[12:15], v[28:31], v[136:139]
    ds_read_b128 v[68:71], v12 offset:33792
    v_cvt_pk_bf16_f32 v168, v148, v149
    v_cvt_pk_bf16_f32 v169, v150, v151
    s_add_u32 s48, s47, 67108864
    buffer_store_dwordx2 v[168:169], v8, s[4:7], s48 offen
    s_waitcnt lgkmcnt(9)
    v_mfma_f32_16x16x32_bf16 v[152:155], a[176:179], v[32:35], v[152:155]
    v_mfma_f32_16x16x32_bf16 v[144:147], a[96:99], v[32:35], v[144:147]
    v_mfma_f32_16x16x32_bf16 v[136:139], a[16:19], v[32:35], v[136:139]
    ds_read_b128 v[72:75], v12 offset:34816
    v_cvt_pk_bf16_f32 v164, v140, v141
    v_cvt_pk_bf16_f32 v165, v142, v143
    s_waitcnt lgkmcnt(9)
    v_mfma_f32_16x16x32_bf16 v[152:155], a[180:183], v[36:39], v[152:155]
    v_mfma_f32_16x16x32_bf16 v[144:147], a[100:103], v[36:39], v[144:147]
    v_mfma_f32_16x16x32_bf16 v[136:139], a[20:23], v[36:39], v[136:139]
    ds_read_b128 v[76:79], v12 offset:35840
    v_cvt_pk_bf16_f32 v160, v132, v133
    v_cvt_pk_bf16_f32 v161, v134, v135
    s_waitcnt lgkmcnt(9)
    v_mfma_f32_16x16x32_bf16 v[152:155], a[184:187], v[40:43], v[152:155]
    v_mfma_f32_16x16x32_bf16 v[144:147], a[104:107], v[40:43], v[144:147]
    v_mfma_f32_16x16x32_bf16 v[136:139], a[24:27], v[40:43], v[136:139]
    ds_read_b128 v[80:83], v12 offset:36864
    s_waitcnt lgkmcnt(9)
    v_mfma_f32_16x16x32_bf16 v[152:155], a[188:191], v[44:47], v[152:155]
    v_mfma_f32_16x16x32_bf16 v[144:147], a[108:111], v[44:47], v[144:147]
    v_mfma_f32_16x16x32_bf16 v[136:139], a[28:31], v[44:47], v[136:139]
    ds_read_b128 v[84:87], v12 offset:37888
    s_waitcnt lgkmcnt(9)
    v_mfma_f32_16x16x32_bf16 v[152:155], a[192:195], v[48:51], v[152:155]
    v_mfma_f32_16x16x32_bf16 v[144:147], a[112:115], v[48:51], v[144:147]
    v_mfma_f32_16x16x32_bf16 v[136:139], a[32:35], v[48:51], v[136:139]
    ds_read_b128 v[88:91], v12 offset:38912
    s_waitcnt lgkmcnt(9)
    v_mfma_f32_16x16x32_bf16 v[152:155], a[196:199], v[52:55], v[152:155]
    v_mfma_f32_16x16x32_bf16 v[144:147], a[116:119], v[52:55], v[144:147]
    v_mfma_f32_16x16x32_bf16 v[136:139], a[36:39], v[52:55], v[136:139]
    ds_read_b128 v[92:95], v12 offset:39936
    s_waitcnt lgkmcnt(9)
    v_mfma_f32_16x16x32_bf16 v[152:155], a[200:203], v[56:59], v[152:155]
    v_mfma_f32_16x16x32_bf16 v[144:147], a[120:123], v[56:59], v[144:147]
    v_mfma_f32_16x16x32_bf16 v[136:139], a[40:43], v[56:59], v[136:139]
    s_waitcnt lgkmcnt(8)
    v_mfma_f32_16x16x32_bf16 v[152:155], a[204:207], v[60:63], v[152:155]
    v_mfma_f32_16x16x32_bf16 v[144:147], a[124:127], v[60:63], v[144:147]
    v_mfma_f32_16x16x32_bf16 v[136:139], a[44:47], v[60:63], v[136:139]
    s_waitcnt lgkmcnt(7)
    v_mfma_f32_16x16x32_bf16 v[152:155], a[208:211], v[64:67], v[152:155]
    v_mfma_f32_16x16x32_bf16 v[144:147], a[128:131], v[64:67], v[144:147]
    v_mfma_f32_16x16x32_bf16 v[136:139], a[48:51], v[64:67], v[136:139]
    s_waitcnt lgkmcnt(6)
    v_mfma_f32_16x16x32_bf16 v[152:155], a[212:215], v[68:71], v[152:155]
    v_mfma_f32_16x16x32_bf16 v[144:147], a[132:135], v[68:71], v[144:147]
    v_mfma_f32_16x16x32_bf16 v[136:139], a[52:55], v[68:71], v[136:139]
    s_waitcnt lgkmcnt(5)
    v_mfma_f32_16x16x32_bf16 v[152:155], a[216:219], v[72:75], v[152:155]
    v_mfma_f32_16x16x32_bf16 v[144:147], a[136:139], v[72:75], v[144:147]
    v_mfma_f32_16x16x32_bf16 v[136:139], a[56:59], v[72:75], v[136:139]
    s_waitcnt lgkmcnt(4)
    v_mfma_f32_16x16x32_bf16 v[152:155], a[220:223], v[76:79], v[152:155]
    v_mfma_f32_16x16x32_bf16 v[144:147], a[140:143], v[76:79], v[144:147]
    v_mfma_f32_16x16x32_bf16 v[136:139], a[60:63], v[76:79], v[136:139]
    s_waitcnt lgkmcnt(3)
    v_mfma_f32_16x16x32_bf16 v[152:155], a[224:227], v[80:83], v[152:155]
    v_mfma_f32_16x16x32_bf16 v[144:147], a[144:147], v[80:83], v[144:147]
    v_mfma_f32_16x16x32_bf16 v[136:139], a[64:67], v[80:83], v[136:139]
    s_waitcnt lgkmcnt(2)
    v_mfma_f32_16x16x32_bf16 v[152:155], a[228:231], v[84:87], v[152:155]
    v_mfma_f32_16x16x32_bf16 v[144:147], a[148:151], v[84:87], v[144:147]
    v_mfma_f32_16x16x32_bf16 v[136:139], a[68:71], v[84:87], v[136:139]
    s_waitcnt lgkmcnt(1)
    v_mfma_f32_16x16x32_bf16 v[152:155], a[232:235], v[88:91], v[152:155]
    v_mfma_f32_16x16x32_bf16 v[144:147], a[152:155], v[88:91], v[144:147]
    v_mfma_f32_16x16x32_bf16 v[136:139], a[72:75], v[88:91], v[136:139]
    s_waitcnt lgkmcnt(0)
    v_mfma_f32_16x16x32_bf16 v[152:155], a[236:239], v[92:95], v[152:155]
    v_mfma_f32_16x16x32_bf16 v[144:147], a[156:159], v[92:95], v[144:147]
    v_mfma_f32_16x16x32_bf16 v[136:139], a[76:79], v[92:95], v[136:139]
    v_cvt_pk_bf16_f32 v170, v152, v153
    v_cvt_pk_bf16_f32 v171, v154, v155
    s_add_u32 s48, s47, 67115008
    buffer_store_dwordx2 v[170:171], v8, s[4:7], s48 offen
    v_cvt_pk_bf16_f32 v166, v144, v145
    v_cvt_pk_bf16_f32 v167, v146, v147
    s_add_u32 s48, s47, 41943040
    v_permlane16_swap_b32 v164, v166
    v_permlane16_swap_b32 v165, v167
    buffer_store_dwordx4 v[164:167], v190, s[4:7], s48 offen
    v_cvt_pk_bf16_f32 v162, v136, v137
    v_cvt_pk_bf16_f32 v163, v138, v139
    s_add_u32 s48, s47, 16777216
    v_permlane16_swap_b32 v160, v162
    v_permlane16_swap_b32 v161, v163
    buffer_store_dwordx4 v[160:163], v190, s[4:7], s48 offen
    s_mov_b32 s64, 2
    s_branch Lqt_5
Lq0_8:
    s_mov_b32 s64, 0
    s_and_b32 s65, s64, 1
    s_mul_i32 s66, s65, 40960
    v_add_u32 v12, s66, v2
    s_xor_b32 s65, s65, 1
    s_mul_i32 s65, s65, 40960
    s_add_u32 s65, s65, s62
    s_add_u32 s66, s64, 1
    s_min_u32 s66, s66, 63
    s_mul_i32 s66, s66, 40960
    s_add_u32 s66, s66, s62
    s_add_u32 s66, s66, 4194304
    s_and_b32 s47, s64, 7
    s_mul_i32 s47, s47, 393216
    s_lshl_b32 s48, s58, 1
    s_add_u32 s47, s47, s48
    ds_read_b128 v[16:19], v12 offset:0
    ds_read_b128 v[20:23], v12 offset:1024
    ds_read_b128 v[24:27], v12 offset:2048
    ds_read_b128 v[28:31], v12 offset:3072
    ds_read_b128 v[32:35], v12 offset:4096
    ds_read_b128 v[36:39], v12 offset:5120
    ds_read_b128 v[40:43], v12 offset:6144
    ds_read_b128 v[44:47], v12 offset:7168
    ds_read_b128 v[48:51], v12 offset:8192
    ds_read_b128 v[52:55], v12 offset:9216
    s_waitcnt lgkmcnt(9)
    v_mfma_f32_16x16x32_bf16 v[132:135], a[0:3], v[16:19], 0
    ds_read_b128 v[56:59], v12 offset:10240
    s_waitcnt lgkmcnt(9)
    v_mfma_f32_16x16x32_bf16 v[132:135], a[4:7], v[20:23], v[132:135]
    ds_read_b128 v[60:63], v12 offset:11264
    s_waitcnt lgkmcnt(9)
    v_mfma_f32_16x16x32_bf16 v[132:135], a[8:11], v[24:27], v[132:135]
    ds_read_b128 v[64:67], v12 offset:12288
    s_waitcnt lgkmcnt(9)
    v_mfma_f32_16x16x32_bf16 v[132:135], a[12:15], v[28:31], v[132:135]
    ds_read_b128 v[68:71], v12 offset:13312
    s_waitcnt lgkmcnt(9)
    v_mfma_f32_16x16x32_bf16 v[132:135], a[16:19], v[32:35], v[132:135]
    ds_read_b128 v[72:75], v12 offset:14336
    s_waitcnt lgkmcnt(9)
    v_mfma_f32_16x16x32_bf16 v[132:135], a[20:23], v[36:39], v[132:135]
    ds_read_b128 v[76:79], v12 offset:15360
    s_waitcnt lgkmcnt(9)
    v_mfma_f32_16x16x32_bf16 v[132:135], a[24:27], v[40:43], v[132:135]
    ds_read_b128 v[80:83], v12 offset:16384
    s_waitcnt lgkmcnt(9)
    v_mfma_f32_16x16x32_bf16 v[132:135], a[28:31], v[44:47], v[132:135]
    ds_read_b128 v[84:87], v12 offset:17408
    s_waitcnt lgkmcnt(9)
    v_mfma_f32_16x16x32_bf16 v[132:135], a[32:35], v[48:51], v[132:135]
    ds_read_b128 v[88:91], v12 offset:18432
    s_waitcnt lgkmcnt(9)
    v_mfma_f32_16x16x32_bf16 v[132:135], a[36:39], v[52:55], v[132:135]
    ds_read_b128 v[92:95], v12 offset:19456
    s_waitcnt lgkmcnt(9)
    v_mfma_f32_16x16x32_bf16 v[132:135], a[40:43], v[56:59], v[132:135]
    ds_read_b128 v[16:19], v12 offset:20480
    s_waitcnt lgkmcnt(9)
    v_mfma_f32_16x16x32_bf16 v[132:135], a[44:47], v[60:63], v[132:135]
    ds_read_b128 v[20:23], v12 offset:21504
    s_waitcnt lgkmcnt(9)
    v_mfma_f32_16x16x32_bf16 v[132:135], a[48:51], v[64:67], v[132:135]
    ds_read_b128 v[24:27], v12 offset:22528
    s_waitcnt lgkmcnt(9)
    v_mfma_f32_16x16x32_bf16 v[132:135], a[52:55], v[68:71], v[132:135]
    ds_read_b128 v[28:31], v12 offset:23552
    s_waitcnt lgkmcnt(9)
    v_mfma_f32_16x16x32_bf16 v[132:135], a[56:59], v[72:75], v[132:135]
    ds_read_b128 v[32:35], v12 offset:24576
    s_waitcnt lgkmcnt(9)
    v_mfma_f32_16x16x32_bf16 v[132:135], a[60:63], v[76:79], v[132:135]
    ds_read_b128 v[36:39], v12 offset:25600
    s_waitcnt lgkmcnt(9)
    v_mfma_f32_16x16x32_bf16 v[132:135], a[64:67], v[80:83], v[132:135]
    ds_read_b128 v[40:43], v12 offset:26624
    s_waitcnt lgkmcnt(9)
    v_mfma_f32_16x16x32_bf16 v[132:135], a[68:71], v[84:87], v[132:135]
    ds_read_b128 v[44:47], v12 offset:27648
    s_waitcnt lgkmcnt(9)
    v_mfma_f32_16x16x32_bf16 v[132:135], a[72:75], v[88:91], v[132:135]
    ds_read_b128 v[48:51], v12 offset:28672
    s_waitcnt lgkmcnt(9)
    v_mfma_f32_16x16x32_bf16 v[132:135], a[76:79], v[92:95], v[132:135]
    ds_read_b128 v[52:55], v12 offset:29696
    s_waitcnt lgkmcnt(9)
    v_mfma_f32_16x16x32_bf16 v[136:139], a[0:3], v[16:19], 0
    ds_read_b128 v[56:59], v12 offset:30720
    s_waitcnt lgkmcnt(9)
    v_mfma_f32_16x16x32_bf16 v[136:139], a[4:7], v[20:23], v[136:139]
    ds_read_b128 v[60:63], v12 offset:31744
    s_waitcnt lgkmcnt(9)
    v_mfma_f32_16x16x32_bf16 v[136:139], a[8:11], v[24:27], v[136:139]
    ds_read_b128 v[64:67], v12 offset:32768
    s_waitcnt lgkmcnt(9)
    v_mfma_f32_16x16x32_bf16 v[136:139], a[12:15], v[28:31], v[136:139]
    ds_read_b128 v[68:71], v12 offset:33792
    s_waitcnt lgkmcnt(9)
    v_mfma_f32_16x16x32_bf16 v[136:139], a[16:19], v[32:35], v[136:139]
    ds_read_b128 v[72:75], v12 offset:34816
    s_waitcnt lgkmcnt(9)
    v_mfma_f32_16x16x32_bf16 v[136:139], a[20:23], v[36:39], v[136:139]
    ds_read_b128 v[76:79], v12 offset:35840
    s_waitcnt lgkmcnt(9)
    v_mfma_f32_16x16x32_bf16 v[136:139], a[24:27], v[40:43], v[136:139]
    ds_read_b128 v[80:83], v12 offset:36864
    s_waitcnt lgkmcnt(9)
    v_mfma_f32_16x16x32_bf16 v[136:139], a[28:31], v[44:47], v[136:139]
    ds_read_b128 v[84:87], v12 offset:37888
    s_waitcnt lgkmcnt(9)
    v_mfma_f32_16x16x32_bf16 v[136:139], a[32:35], v[48:51], v[136:139]
    ds_read_b128 v[88:91], v12 offset:38912
    v_cvt_pk_bf16_f32 v160, v132, v133
    v_cvt_pk_bf16_f32 v161, v134, v135
    s_waitcnt lgkmcnt(9)
    v_mfma_f32_16x16x32_bf16 v[136:139], a[36:39], v[52:55], v[136:139]
    ds_read_b128 v[92:95], v12 offset:39936
    s_waitcnt lgkmcnt(9)
    v_mfma_f32_16x16x32_bf16 v[136:139], a[40:43], v[56:59], v[136:139]
    s_waitcnt lgkmcnt(8)
    v_mfma_f32_16x16x32_bf16 v[136:139], a[44:47], v[60:63], v[136:139]
    s_waitcnt lgkmcnt(7)
    v_mfma_f32_16x16x32_bf16 v[136:139], a[48:51], v[64:67], v[136:139]
    s_waitcnt lgkmcnt(6)
    v_mfma_f32_16x16x32_bf16 v[136:139], a[52:55], v[68:71], v[136:139]
    s_waitcnt lgkmcnt(5)
    v_mfma_f32_16x16x32_bf16 v[136:139], a[56:59], v[72:75], v[136:139]
    s_waitcnt lgkmcnt(4)
    v_mfma_f32_16x16x32_bf16 v[136:139], a[60:63], v[76:79], v[136:139]
    s_waitcnt lgkmcnt(3)
    v_mfma_f32_16x16x32_bf16 v[136:139], a[64:67], v[80:83], v[136:139]
    s_waitcnt lgkmcnt(2)
    v_mfma_f32_16x16x32_bf16 v[136:139], a[68:71], v[84:87], v[136:139]
    s_waitcnt lgkmcnt(1)
    v_mfma_f32_16x16x32_bf16 v[136:139], a[72:75], v[88:91], v[136:139]
    s_waitcnt lgkmcnt(0)
    v_mfma_f32_16x16x32_bf16 v[136:139], a[76:79], v[92:95], v[136:139]
    s_nop 7
    v_cvt_pk_bf16_f32 v162, v136, v137
    v_cvt_pk_bf16_f32 v163, v138, v139
    s_add_u32 s48, s47, 16777216
    v_permlane16_swap_b32 v160, v162
    v_permlane16_swap_b32 v161, v163
    buffer_store_dwordx4 v[160:163], v190, s[4:7], s48 offen
    s_barrier
    s_add_u32 s63, s62, 4276224
    s_add_u32 m0, s62, 0
    s_nop 0
    buffer_load_dwordx4 v2, s[4:7], s63 offen lds
    s_add_u32 s63, s63, 1024
    s_add_u32 m0, s62, 1024
    s_nop 0
    buffer_load_dwordx4 v2, s[4:7], s63 offen lds
    s_add_u32 s63, s63, 1024
    s_add_u32 m0, s62, 2048
    s_nop 0
    buffer_load_dwordx4 v2, s[4:7], s63 offen lds
    s_add_u32 s63, s63, 1024
    s_add_u32 m0, s62, 3072
    s_nop 0
    buffer_load_dwordx4 v2, s[4:7], s63 offen lds
    s_add_u32 s63, s63, 1024
    s_add_u32 m0, s62, 4096
    s_nop 0
    buffer_load_dwordx4 v2, s[4:7], s63 offen lds
    s_add_u32 s63, s63, 1024
    s_add_u32 m0, s62, 5120
    s_nop 0
    buffer_load_dwordx4 v2, s[4:7], s63 offen lds
    s_add_u32 s63, s63, 1024
    s_add_u32 m0, s62, 6144
    s_nop 0
    buffer_load_dwordx4 v2, s[4:7], s63 offen lds
    s_add_u32 s63, s63, 1024
    s_add_u32 m0, s62, 7168
    s_nop 0
    buffer_load_dwordx4 v2, s[4:7], s63 offen lds
    s_add_u32 s63, s63, 1024
    s_add_u32 m0, s62, 8192
    s_nop 0
    buffer_load_dwordx4 v2, s[4:7], s63 offen lds
    s_add_u32 s63, s63, 1024
    s_add_u32 m0, s62, 9216
    s_nop 0
    buffer_load_dwordx4 v2, s[4:7], s63 offen lds
    s_add_u32 s63, s63, 1024
    s_mov_b32 s64, 2
    s_waitcnt vmcnt(0)
    s_barrier
    s_branch Lqr_9
Lqt_5:
    s_and_b32 s38, s30, 3
    s_xor_b32 s39, s38, 2
    s_mul_i32 s40, s38, 81920
    s_add_u32 s40, s40, s59
    s_mul_i32 s41, s38, 196608
    s_add_u32 s41, s41, s58
    s_add_u32 s41, s41, 589824
    s_mul_i32 s42, s39, 196608
    s_add_u32 s42, s42, s58
    s_add_u32 s42, s42, 589824
    s_and_b32 s44, s30, 7
    s_mul_i32 s43, s44, 196608
    s_add_u32 s43, s43, s58
    s_add_u32 s43, s43, 117440512
    s_mul_i32 s44, s44, 98304
    s_add_u32 s44, s44, s60
    s_add_u32 s44, s44, 130023424
    s_mul_i32 s45, s38, 98304
    s_add_u32 s45, s45, s60
    s_add_u32 s45, s45, 1376256
    s_mul_i32 s46, s39, 98304
    s_add_u32 s46, s46, s60
    s_add_u32 s46, s46, 1376256
    s_sub_u32 s51, s64, 1
    s_lshl_b32 s51, s51, 5
    s_add_u32 s51, s51, s26
    s_lshl_b32 s51, s51, 6
    s_add_u32 s51, s51, 4096
    s_cmp_eq_u32 s22, 1
    s_cbranch_scc1 Lmw_13
    s_cmp_eq_u32 s22, 2
    s_cbranch_scc1 Lmw_14
    s_cmp_eq_u32 s22, 3
    s_cbranch_scc1 Lmw_15
Lmw_12:
    s_mov_b32 s31, 262144
    buffer_load_dwordx4 v[108:111], v3, s[4:7], s40 offen offset:0 sc1
    buffer_load_dwordx4 v[112:115], v3, s[4:7], s40 offen offset:1024 sc1
    buffer_load_dwordx4 v[116:119], v3, s[4:7], s40 offen offset:2048 sc1
Lp_17:
    buffer_load_dwordx4 v[120:123], v3, s[4:7], s40 offen offset:0 sc1
    buffer_load_dwordx4 v[124:127], v3, s[4:7], s40 offen offset:1024 sc1
    buffer_load_dwordx4 v[128:131], v3, s[4:7], s40 offen offset:2048 sc1
    s_waitcnt vmcnt(3)
    ds_write_b128 v5, v[108:111] offset:0
    ds_write_b128 v5, v[112:115] offset:1024
    ds_write_b128 v5, v[116:119] offset:2048
    v_max3_u32 v160, v108, v112, v116
    v_cmp_eq_u32 vcc, -1, v160
    s_cbranch_vccz LdA_18
    buffer_load_dwordx4 v[108:111], v3, s[4:7], s40 offen offset:0 sc1
    buffer_load_dwordx4 v[112:115], v3, s[4:7], s40 offen offset:1024 sc1
    buffer_load_dwordx4 v[116:119], v3, s[4:7], s40 offen offset:2048 sc1
    s_waitcnt vmcnt(3)
    ds_write_b128 v5, v[120:123] offset:0
    ds_write_b128 v5, v[124:127] offset:1024
    ds_write_b128 v5, v[128:131] offset:2048
    v_max3_u32 v160, v120, v124, v128
    v_cmp_eq_u32 vcc, -1, v160
    s_cbranch_vccz LdB_19
    s_sub_u32 s31, s31, 1
    s_cbranch_scc0 Lp_17
    s_mov_b32 s31, 1
    s_branch L_fail
LdB_19:
    v_smfmac_f32_16x16x64_bf16 v[96:99], v[120:123], a[0:7], v184
    v_smfmac_f32_16x16x64_bf16 v[100:103], v[120:123], a[80:87], v184
    s_waitcnt lgkmcnt(0)
    s_barrier
    ds_read_b128 v[16:19], v7 offset:3072
    ds_read_b128 v[20:23], v7 offset:4096
    v_smfmac_f32_16x16x64_bf16 v[96:99], v[124:127], a[8:15], v184
    ds_read_b128 v[24:27], v7 offset:5120
    v_smfmac_f32_16x16x64_bf16 v[100:103], v[124:127], a[88:95], v184
    ds_read_b128 v[28:31], v7 offset:6144
    v_smfmac_f32_16x16x64_bf16 v[96:99], v[128:131], a[16:23], v184
    ds_read_b128 v[32:35], v7 offset:7168
    v_smfmac_f32_16x16x64_bf16 v[100:103], v[128:131], a[96:103], v184
    ds_read_b128 v[36:39], v7 offset:8192
    v_smfmac_f32_16x16x64_bf16 v[104:107], v[120:123], a[160:167], v184
    ds_read_b128 v[40:43], v7 offset:9216
    v_smfmac_f32_16x16x64_bf16 v[104:107], v[124:127], a[168:175], v184
    v_smfmac_f32_16x16x64_bf16 v[104:107], v[128:131], a[176:183], v184
    s_branch Ldd_20
LdA_18:
    v_smfmac_f32_16x16x64_bf16 v[96:99], v[108:111], a[0:7], v184
    v_smfmac_f32_16x16x64_bf16 v[100:103], v[108:111], a[80:87], v184
    s_waitcnt lgkmcnt(0)
    s_barrier
    ds_read_b128 v[16:19], v7 offset:3072
    ds_read_b128 v[20:23], v7 offset:4096
    v_smfmac_f32_16x16x64_bf16 v[96:99], v[112:115], a[8:15], v184
    ds_read_b128 v[24:27], v7 offset:5120
    v_smfmac_f32_16x16x64_bf16 v[100:103], v[112:115], a[88:95], v184
    ds_read_b128 v[28:31], v7 offset:6144
    v_smfmac_f32_16x16x64_bf16 v[96:99], v[116:119], a[16:23], v184
    ds_read_b128 v[32:35], v7 offset:7168
    v_smfmac_f32_16x16x64_bf16 v[100:103], v[116:119], a[96:103], v184
    ds_read_b128 v[36:39], v7 offset:8192
    v_smfmac_f32_16x16x64_bf16 v[104:107], v[108:111], a[160:167], v184
    ds_read_b128 v[40:43], v7 offset:9216
    v_smfmac_f32_16x16x64_bf16 v[104:107], v[112:115], a[168:175], v184
    v_smfmac_f32_16x16x64_bf16 v[104:107], v[116:119], a[176:183], v184
Ldd_20:
    s_mov_b64 vcc, s[34:35]
    s_waitcnt lgkmcnt(6)
    v_smfmac_f32_16x16x64_bf16 v[96:99], v[16:19], a[24:31], v184
    v_smfmac_f32_16x16x64_bf16 v[100:103], v[16:19], a[104:111], v184
    s_waitcnt lgkmcnt(5)
    v_smfmac_f32_16x16x64_bf16 v[96:99], v[20:23], a[32:39], v184
    v_smfmac_f32_16x16x64_bf16 v[100:103], v[20:23], a[112:119], v184
    s_waitcnt lgkmcnt(4)
    v_smfmac_f32_16x16x64_bf16 v[96:99], v[24:27], a[40:47], v184
    v_smfmac_f32_16x16x64_bf16 v[100:103], v[24:27], a[120:127], v184
    s_waitcnt lgkmcnt(3)
    v_smfmac_f32_16x16x64_bf16 v[96:99], v[28:31], a[48:55], v184
    v_smfmac_f32_16x16x64_bf16 v[100:103], v[28:31], a[128:135], v184
    s_waitcnt lgkmcnt(2)
    v_smfmac_f32_16x16x64_bf16 v[96:99], v[32:35], a[56:63], v184
    v_smfmac_f32_16x16x64_bf16 v[100:103], v[32:35], a[136:143], v184
    s_waitcnt lgkmcnt(1)
    v_smfmac_f32_16x16x64_bf16 v[96:99], v[36:39], a[64:71], v184
    s_waitcnt lgkmcnt(0)
    v_smfmac_f32_16x16x64_bf16 v[96:99], v[40:43], a[72:79], v184
    v_smfmac_f32_16x16x64_bf16 v[100:103], v[36:39], a[144:151], v184
    buffer_store_dword v253, v254, s[4:7], s51 offen
    v_smfmac_f32_16x16x64_bf16 v[100:103], v[40:43], a[152:159], v184
    v_add_f32 v96, v96, v98
    v_add_f32 v97, v97, v99
    v_cvt_pk_bf16_f32 v160, v96, v97
    v_mov_b32 v98, 0
    s_nop 0
    v_mov_b32_dpp v162, v160 quad_perm:[1,0,3,2] row_mask:0xf bank_mask:0xf
    v_perm_b32 v160, v162, v160, v185
    s_nop 0
    v_add_f32 v100, v100, v102
    v_add_f32 v101, v101, v103
    v_cvt_pk_bf16_f32 v161, v100, v101
    v_smfmac_f32_16x16x64_bf16 v[104:107], v[16:19], a[184:191], v184
    s_nop 0
    v_mov_b32_dpp v163, v161 quad_perm:[1,0,3,2] row_mask:0xf bank_mask:0xf
    v_perm_b32 v161, v163, v161, v185
    v_smfmac_f32_16x16x64_bf16 v[104:107], v[20:23], a[192:199], v184
    s_nop 0
    v_cndmask_b32_dpp v176, v161, v160, vcc quad_perm:[2,3,0,1] row_mask:0xf bank_mask:0xf
    s_mov_b64 vcc, s[36:37]
    v_cndmask_b32_dpp v177, v160, v161, vcc quad_perm:[2,3,0,1] row_mask:0xf bank_mask:0xf
    buffer_store_dwordx2 v[176:177], v187, s[4:7], s41 offen
    v_smfmac_f32_16x16x64_bf16 v[104:107], v[24:27], a[200:207], v184
    v_mov_b32 v96, 0
    v_smfmac_f32_16x16x64_bf16 v[104:107], v[28:31], a[208:215], v184
    v_smfmac_f32_16x16x64_bf16 v[104:107], v[32:35], a[216:223], v184
    v_smfmac_f32_16x16x64_bf16 v[104:107], v[36:39], a[224:231], v184
    v_smfmac_f32_16x16x64_bf16 v[104:107], v[40:43], a[232:239], v184
    v_mov_b32 v97, 0
    v_mov_b32 v98, 0
    v_mov_b32 v99, 0
    v_mov_b32 v100, 0
    v_mov_b32 v101, 0
    v_mov_b32 v102, 0
    v_mov_b32 v103, 0
    s_nop 0
    v_add_f32 v104, v104, v106
    v_add_f32 v105, v105, v107
    v_cvt_pk_bf16_f32 v160, v104, v105
    v_mov_b32 v106, 0
    v_mov_b32 v107, 0
    v_mov_b32_dpp v162, v160 quad_perm:[1,0,3,2] row_mask:0xf bank_mask:0xf
    v_perm_b32 v178, v162, v160, v185
    v_mov_b32 v104, 0
    v_mov_b32 v105, 0
    v_mov_b32_dpp v179, v178 quad_perm:[2,3,0,1] row_mask:0xf bank_mask:0xf
    buffer_store_dwordx2 v[178:179], v9, s[4:7], s45 offen
    s_branch Lmj_16
Lmw_13:
    s_mov_b32 s31, 262144
    buffer_load_dwordx4 v[108:111], v3, s[4:7], s40 offen offset:0 sc1
    buffer_load_dwordx4 v[112:115], v3, s[4:7], s40 offen offset:1024 sc1
    buffer_load_dwordx4 v[116:119], v3, s[4:7], s40 offen offset:2048 sc1
Lp_21:
    buffer_load_dwordx4 v[120:123], v3, s[4:7], s40 offen offset:0 sc1
    buffer_load_dwordx4 v[124:127], v3, s[4:7], s40 offen offset:1024 sc1
    buffer_load_dwordx4 v[128:131], v3, s[4:7], s40 offen offset:2048 sc1
    s_waitcnt vmcnt(3)
    ds_write_b128 v5, v[108:111] offset:0
    ds_write_b128 v5, v[112:115] offset:1024
    ds_write_b128 v5, v[116:119] offset:2048
    v_max3_u32 v160, v108, v112, v116
    v_cmp_eq_u32 vcc, -1, v160
    s_cbranch_vccz LdA_22
    buffer_load_dwordx4 v[108:111], v3, s[4:7], s40 offen offset:0 sc1
    buffer_load_dwordx4 v[112:115], v3, s[4:7], s40 offen offset:1024 sc1
    buffer_load_dwordx4 v[116:119], v3, s[4:7], s40 offen offset:2048 sc1
    s_waitcnt vmcnt(3)
    ds_write_b128 v5, v[120:123] offset:0
    ds_write_b128 v5, v[124:127] offset:1024
    ds_write_b128 v5, v[128:131] offset:2048
    v_max3_u32 v160, v120, v124, v128
    v_cmp_eq_u32 vcc, -1, v160
    s_cbranch_vccz LdB_23
    s_sub_u32 s31, s31, 1
    s_cbranch_scc0 Lp_21
    s_mov_b32 s31, 1
    s_branch L_fail
LdB_23:
    v_smfmac_f32_16x16x64_bf16 v[96:99], v[120:123], a[24:31], v184
    v_smfmac_f32_16x16x64_bf16 v[100:103], v[120:123], a[104:111], v184
    s_waitcnt lgkmcnt(0)
    s_barrier
    ds_read_b128 v[16:19], v7 offset:0
    ds_read_b128 v[20:23], v7 offset:1024
    v_smfmac_f32_16x16x64_bf16 v[96:99], v[124:127], a[32:39], v184
    ds_read_b128 v[24:27], v7 offset:2048
    v_smfmac_f32_16x16x64_bf16 v[100:103], v[124:127], a[112:119], v184
    ds_read_b128 v[28:31], v7 offset:6144
    v_smfmac_f32_16x16x64_bf16 v[96:99], v[128:131], a[40:47], v184
    ds_read_b128 v[32:35], v7 offset:7168
    v_smfmac_f32_16x16x64_bf16 v[100:103], v[128:131], a[120:127], v184
    ds_read_b128 v[36:39], v7 offset:8192
    v_smfmac_f32_16x16x64_bf16 v[104:107], v[120:123], a[184:191], v184
    ds_read_b128 v[40:43], v7 offset:9216
    v_smfmac_f32_16x16x64_bf16 v[104:107], v[124:127], a[192:199], v184
    v_smfmac_f32_16x16x64_bf16 v[104:107], v[128:131], a[200:207], v184
    s_branch Ldd_24
LdA_22:
    v_smfmac_f32_16x16x64_bf16 v[96:99], v[108:111], a[24:31], v184
    v_smfmac_f32_16x16x64_bf16 v[100:103], v[108:111], a[104:111], v184
    s_waitcnt lgkmcnt(0)
    s_barrier
    ds_read_b128 v[16:19], v7 offset:0
    ds_read_b128 v[20:23], v7 offset:1024
    v_smfmac_f32_16x16x64_bf16 v[96:99], v[112:115], a[32:39], v184
    ds_read_b128 v[24:27], v7 offset:2048
    v_smfmac_f32_16x16x64_bf16 v[100:103], v[112:115], a[112:119], v184
    ds_read_b128 v[28:31], v7 offset:6144
    v_smfmac_f32_16x16x64_bf16 v[96:99], v[116:119], a[40:47], v184
    ds_read_b128 v[32:35], v7 offset:7168
    v_smfmac_f32_16x16x64_bf16 v[100:103], v[116:119], a[120:127], v184
    ds_read_b128 v[36:39], v7 offset:8192
    v_smfmac_f32_16x16x64_bf16 v[104:107], v[108:111], a[184:191], v184
    ds_read_b128 v[40:43], v7 offset:9216
    v_smfmac_f32_16x16x64_bf16 v[104:107], v[112:115], a[192:199], v184
    v_smfmac_f32_16x16x64_bf16 v[104:107], v[116:119], a[200:207], v184
Ldd_24:
    s_mov_b64 vcc, s[34:35]
    s_waitcnt lgkmcnt(6)
    v_smfmac_f32_16x16x64_bf16 v[96:99], v[16:19], a[0:7], v184
    v_smfmac_f32_16x16x64_bf16 v[100:103], v[16:19], a[80:87], v184
    s_waitcnt lgkmcnt(5)
    v_smfmac_f32_16x16x64_bf16 v[96:99], v[20:23], a[8:15], v184
    v_smfmac_f32_16x16x64_bf16 v[100:103], v[20:23], a[88:95], v184
    s_waitcnt lgkmcnt(4)
    v_smfmac_f32_16x16x64_bf16 v[96:99], v[24:27], a[16:23], v184
    v_smfmac_f32_16x16x64_bf16 v[100:103], v[24:27], a[96:103], v184
    s_waitcnt lgkmcnt(3)
    v_smfmac_f32_16x16x64_bf16 v[96:99], v[28:31], a[48:55], v184
    v_smfmac_f32_16x16x64_bf16 v[100:103], v[28:31], a[128:135], v184
    s_waitcnt lgkmcnt(2)
    v_smfmac_f32_16x16x64_bf16 v[96:99], v[32:35], a[56:63], v184
    v_smfmac_f32_16x16x64_bf16 v[100:103], v[32:35], a[136:143], v184
    s_waitcnt lgkmcnt(1)
    v_smfmac_f32_16x16x64_bf16 v[96:99], v[36:39], a[64:71], v184
    s_waitcnt lgkmcnt(0)
    v_smfmac_f32_16x16x64_bf16 v[96:99], v[40:43], a[72:79], v184
    v_smfmac_f32_16x16x64_bf16 v[100:103], v[36:39], a[144:151], v184
    buffer_store_dword v253, v254, s[4:7], s51 offen
    v_smfmac_f32_16x16x64_bf16 v[100:103], v[40:43], a[152:159], v184
    v_add_f32 v96, v96, v98
    v_add_f32 v97, v97, v99
    v_cvt_pk_bf16_f32 v160, v96, v97
    v_mov_b32 v98, 0
    s_nop 0
    v_mov_b32_dpp v162, v160 quad_perm:[1,0,3,2] row_mask:0xf bank_mask:0xf
    v_perm_b32 v160, v162, v160, v185
    s_nop 0
    v_add_f32 v100, v100, v102
    v_add_f32 v101, v101, v103
    v_cvt_pk_bf16_f32 v161, v100, v101
    v_smfmac_f32_16x16x64_bf16 v[104:107], v[16:19], a[160:167], v184
    s_nop 0
    v_mov_b32_dpp v163, v161 quad_perm:[1,0,3,2] row_mask:0xf bank_mask:0xf
    v_perm_b32 v161, v163, v161, v185
    v_smfmac_f32_16x16x64_bf16 v[104:107], v[20:23], a[168:175], v184
    s_nop 0
    v_cndmask_b32_dpp v176, v161, v160, vcc quad_perm:[2,3,0,1] row_mask:0xf bank_mask:0xf
    s_mov_b64 vcc, s[36:37]
    v_cndmask_b32_dpp v177, v160, v161, vcc quad_perm:[2,3,0,1] row_mask:0xf bank_mask:0xf
    buffer_store_dwordx2 v[176:177], v187, s[4:7], s41 offen
    v_smfmac_f32_16x16x64_bf16 v[104:107], v[24:27], a[176:183], v184
    v_mov_b32 v96, 0
    v_smfmac_f32_16x16x64_bf16 v[104:107], v[28:31], a[208:215], v184
    v_smfmac_f32_16x16x64_bf16 v[104:107], v[32:35], a[216:223], v184
    v_smfmac_f32_16x16x64_bf16 v[104:107], v[36:39], a[224:231], v184
    v_smfmac_f32_16x16x64_bf16 v[104:107], v[40:43], a[232:239], v184
    v_mov_b32 v97, 0
    v_mov_b32 v98, 0
    v_mov_b32 v99, 0
    v_mov_b32 v100, 0
    v_mov_b32 v101, 0
    v_mov_b32 v102, 0
    v_mov_b32 v103, 0
    s_nop 0
    v_add_f32 v104, v104, v106
    v_add_f32 v105, v105, v107
    v_cvt_pk_bf16_f32 v160, v104, v105
    v_mov_b32 v106, 0
    v_mov_b32 v107, 0
    v_mov_b32_dpp v162, v160 quad_perm:[1,0,3,2] row_mask:0xf bank_mask:0xf
    v_perm_b32 v178, v162, v160, v185
    v_mov_b32 v104, 0
    v_mov_b32 v105, 0
    v_mov_b32_dpp v179, v178 quad_perm:[2,3,0,1] row_mask:0xf bank_mask:0xf
    buffer_store_dwordx2 v[178:179], v9, s[4:7], s45 offen
    s_branch Lmj_16
Lmw_14:
    s_mov_b32 s31, 262144
    buffer_load_dwordx4 v[108:111], v3, s[4:7], s40 offen offset:0 sc1
    buffer_load_dwordx4 v[112:115], v3, s[4:7], s40 offen offset:1024 sc1
    buffer_load_dwordx4 v[116:119], v3, s[4:7], s40 offen offset:2048 sc1
Lp_25:
    buffer_load_dwordx4 v[120:123], v3, s[4:7], s40 offen offset:0 sc1
    buffer_load_dwordx4 v[124:127], v3, s[4:7], s40 offen offset:1024 sc1
    buffer_load_dwordx4 v[128:131], v3, s[4:7], s40 offen offset:2048 sc1
    s_waitcnt vmcnt(3)
    ds_write_b128 v5, v[108:111] offset:0
    ds_write_b128 v5, v[112:115] offset:1024
    ds_write_b128 v5, v[116:119] offset:2048
    v_max3_u32 v160, v108, v112, v116
    v_cmp_eq_u32 vcc, -1, v160
    s_cbranch_vccz LdA_26
    buffer_load_dwordx4 v[108:111], v3, s[4:7], s40 offen offset:0 sc1
    buffer_load_dwordx4 v[112:115], v3, s[4:7], s40 offen offset:1024 sc1
    buffer_load_dwordx4 v[116:119], v3, s[4:7], s40 offen offset:2048 sc1
    s_waitcnt vmcnt(3)
    ds_write_b128 v5, v[120:123] offset:0
    ds_write_b128 v5, v[124:127] offset:1024
    ds_write_b128 v5, v[128:131] offset:2048
    v_max3_u32 v160, v120, v124, v128
    v_cmp_eq_u32 vcc, -1, v160
    s_cbranch_vccz LdB_27
    s_sub_u32 s31, s31, 1
    s_cbranch_scc0 Lp_25
    s_mov_b32 s31, 1
    s_branch L_fail
LdB_27:
    v_smfmac_f32_16x16x64_bf16 v[96:99], v[120:123], a[48:55], v184
    v_smfmac_f32_16x16x64_bf16 v[100:103], v[120:123], a[128:135], v184
    s_waitcnt lgkmcnt(0)
    s_barrier
    ds_read_b128 v[16:19], v7 offset:0
    ds_read_b128 v[20:23], v7 offset:1024
    v_smfmac_f32_16x16x64_bf16 v[96:99], v[124:127], a[56:63], v184
    ds_read_b128 v[24:27], v7 offset:2048
    v_smfmac_f32_16x16x64_bf16 v[100:103], v[124:127], a[136:143], v184
    ds_read_b128 v[28:31], v7 offset:3072
    v_smfmac_f32_16x16x64_bf16 v[96:99], v[128:131], a[64:71], v184
    ds_read_b128 v[32:35], v7 offset:4096
    v_smfmac_f32_16x16x64_bf16 v[100:103], v[128:131], a[144:151], v184
    ds_read_b128 v[36:39], v7 offset:5120
    v_smfmac_f32_16x16x64_bf16 v[104:107], v[120:123], a[208:215], v184
    ds_read_b128 v[40:43], v7 offset:9216
    v_smfmac_f32_16x16x64_bf16 v[104:107], v[124:127], a[216:223], v184
    v_smfmac_f32_16x16x64_bf16 v[104:107], v[128:131], a[224:231], v184
    s_branch Ldd_28
LdA_26:
    v_smfmac_f32_16x16x64_bf16 v[96:99], v[108:111], a[48:55], v184
    v_smfmac_f32_16x16x64_bf16 v[100:103], v[108:111], a[128:135], v184
    s_waitcnt lgkmcnt(0)
    s_barrier
    ds_read_b128 v[16:19], v7 offset:0
    ds_read_b128 v[20:23], v7 offset:1024
    v_smfmac_f32_16x16x64_bf16 v[96:99], v[112:115], a[56:63], v184
    ds_read_b128 v[24:27], v7 offset:2048
    v_smfmac_f32_16x16x64_bf16 v[100:103], v[112:115], a[136:143], v184
    ds_read_b128 v[28:31], v7 offset:3072
    v_smfmac_f32_16x16x64_bf16 v[96:99], v[116:119], a[64:71], v184
    ds_read_b128 v[32:35], v7 offset:4096
    v_smfmac_f32_16x16x64_bf16 v[100:103], v[116:119], a[144:151], v184
    ds_read_b128 v[36:39], v7 offset:5120
    v_smfmac_f32_16x16x64_bf16 v[104:107], v[108:111], a[208:215], v184
    ds_read_b128 v[40:43], v7 offset:9216
    v_smfmac_f32_16x16x64_bf16 v[104:107], v[112:115], a[216:223], v184
    v_smfmac_f32_16x16x64_bf16 v[104:107], v[116:119], a[224:231], v184
Ldd_28:
    s_mov_b64 vcc, s[34:35]
    s_waitcnt lgkmcnt(6)
    v_smfmac_f32_16x16x64_bf16 v[96:99], v[16:19], a[0:7], v184
    v_smfmac_f32_16x16x64_bf16 v[100:103], v[16:19], a[80:87], v184
    s_waitcnt lgkmcnt(5)
    v_smfmac_f32_16x16x64_bf16 v[96:99], v[20:23], a[8:15], v184
    v_smfmac_f32_16x16x64_bf16 v[100:103], v[20:23], a[88:95], v184
    s_waitcnt lgkmcnt(4)
    v_smfmac_f32_16x16x64_bf16 v[96:99], v[24:27], a[16:23], v184
    v_smfmac_f32_16x16x64_bf16 v[100:103], v[24:27], a[96:103], v184
    s_waitcnt lgkmcnt(3)
    v_smfmac_f32_16x16x64_bf16 v[96:99], v[28:31], a[24:31], v184
    v_smfmac_f32_16x16x64_bf16 v[100:103], v[28:31], a[104:111], v184
    s_waitcnt lgkmcnt(2)
    v_smfmac_f32_16x16x64_bf16 v[96:99], v[32:35], a[32:39], v184
    v_smfmac_f32_16x16x64_bf16 v[100:103], v[32:35], a[112:119], v184
    s_waitcnt lgkmcnt(1)
    v_smfmac_f32_16x16x64_bf16 v[96:99], v[36:39], a[40:47], v184
    s_waitcnt lgkmcnt(0)
    v_smfmac_f32_16x16x64_bf16 v[96:99], v[40:43], a[72:79], v184
    v_smfmac_f32_16x16x64_bf16 v[100:103], v[36:39], a[120:127], v184
    buffer_store_dword v253, v254, s[4:7], s51 offen
    v_smfmac_f32_16x16x64_bf16 v[100:103], v[40:43], a[152:159], v184
    v_add_f32 v96, v96, v98
    v_add_f32 v97, v97, v99
    v_cvt_pk_bf16_f32 v160, v96, v97
    v_mov_b32 v98, 0
    s_nop 0
    v_mov_b32_dpp v162, v160 quad_perm:[1,0,3,2] row_mask:0xf bank_mask:0xf
    v_perm_b32 v160, v162, v160, v185
    s_nop 0
    v_add_f32 v100, v100, v102
    v_add_f32 v101, v101, v103
    v_cvt_pk_bf16_f32 v161, v100, v101
    v_smfmac_f32_16x16x64_bf16 v[104:107], v[16:19], a[160:167], v184
    s_nop 0
    v_mov_b32_dpp v163, v161 quad_perm:[1,0,3,2] row_mask:0xf bank_mask:0xf
    v_perm_b32 v161, v163, v161, v185
    v_smfmac_f32_16x16x64_bf16 v[104:107], v[20:23], a[168:175], v184
    s_nop 0
    v_cndmask_b32_dpp v176, v161, v160, vcc quad_perm:[2,3,0,1] row_mask:0xf bank_mask:0xf
    s_mov_b64 vcc, s[36:37]
    v_cndmask_b32_dpp v177, v160, v161, vcc quad_perm:[2,3,0,1] row_mask:0xf bank_mask:0xf
    buffer_store_dwordx2 v[176:177], v187, s[4:7], s41 offen
    v_smfmac_f32_16x16x64_bf16 v[104:107], v[24:27], a[176:183], v184
    v_mov_b32 v96, 0
    v_smfmac_f32_16x16x64_bf16 v[104:107], v[28:31], a[184:191], v184
    v_smfmac_f32_16x16x64_bf16 v[104:107], v[32:35], a[192:199], v184
    v_smfmac_f32_16x16x64_bf16 v[104:107], v[36:39], a[200:207], v184
    v_smfmac_f32_16x16x64_bf16 v[104:107], v[40:43], a[232:239], v184
    v_mov_b32 v97, 0
    v_mov_b32 v98, 0
    v_mov_b32 v99, 0
    v_mov_b32 v100, 0
    v_mov_b32 v101, 0
    v_mov_b32 v102, 0
    v_mov_b32 v103, 0
    s_nop 0
    v_add_f32 v104, v104, v106
    v_add_f32 v105, v105, v107
    v_cvt_pk_bf16_f32 v160, v104, v105
    v_mov_b32 v106, 0
    v_mov_b32 v107, 0
    v_mov_b32_dpp v162, v160 quad_perm:[1,0,3,2] row_mask:0xf bank_mask:0xf
    v_perm_b32 v178, v162, v160, v185
    v_mov_b32 v104, 0
    v_mov_b32 v105, 0
    v_mov_b32_dpp v179, v178 quad_perm:[2,3,0,1] row_mask:0xf bank_mask:0xf
    buffer_store_dwordx2 v[178:179], v9, s[4:7], s45 offen
    s_branch Lmj_16
Lmw_15:
    s_mov_b32 s31, 262144
    buffer_load_dwordx4 v[108:111], v3, s[4:7], s40 offen offset:0 sc1
    buffer_load_dwordx4 v[112:115], v3, s[4:7], s40 offen offset:1024 sc1
    buffer_load_dwordx4 v[116:119], v3, s[4:7], s40 offen offset:2048 sc1
Lp_29:
    buffer_load_dwordx4 v[120:123], v3, s[4:7], s40 offen offset:0 sc1
    buffer_load_dwordx4 v[124:127], v3, s[4:7], s40 offen offset:1024 sc1
    buffer_load_dwordx4 v[128:131], v3, s[4:7], s40 offen offset:2048 sc1
    s_waitcnt vmcnt(3)
    ds_write_b128 v5, v[108:111] offset:0
    ds_write_b128 v5, v[112:115] offset:1024
    ds_write_b128 v5, v[116:119] offset:2048
    v_max3_u32 v160, v108, v112, v116
    v_cmp_eq_u32 vcc, -1, v160
    s_cbranch_vccz LdA_30
    buffer_load_dwordx4 v[108:111], v3, s[4:7], s40 offen offset:0 sc1
    buffer_load_dwordx4 v[112:115], v3, s[4:7], s40 offen offset:1024 sc1
    buffer_load_dwordx4 v[116:119], v3, s[4:7], s40 offen offset:2048 sc1
    s_waitcnt vmcnt(3)
    ds_write_b128 v5, v[120:123] offset:0
    ds_write_b128 v5, v[124:127] offset:1024
    ds_write_b128 v5, v[128:131] offset:2048
    v_max3_u32 v160, v120, v124, v128
    v_cmp_eq_u32 vcc, -1, v160
    s_cbranch_vccz LdB_31
    s_sub_u32 s31, s31, 1
    s_cbranch_scc0 Lp_29
    s_mov_b32 s31, 1
    s_branch L_fail
LdB_31:
    v_smfmac_f32_16x16x64_bf16 v[96:99], v[120:123], a[56:63], v184
    v_smfmac_f32_16x16x64_bf16 v[100:103], v[120:123], a[136:143], v184
    s_waitcnt lgkmcnt(0)
    s_barrier
    ds_read_b128 v[16:19], v7 offset:0
    ds_read_b128 v[20:23], v7 offset:1024
    v_smfmac_f32_16x16x64_bf16 v[96:99], v[124:127], a[64:71], v184
    ds_read_b128 v[24:27], v7 offset:2048
    v_smfmac_f32_16x16x64_bf16 v[100:103], v[124:127], a[144:151], v184
    ds_read_b128 v[28:31], v7 offset:3072
    v_smfmac_f32_16x16x64_bf16 v[96:99], v[128:131], a[72:79], v184
    ds_read_b128 v[32:35], v7 offset:4096
    v_smfmac_f32_16x16x64_bf16 v[100:103], v[128:131], a[152:159], v184
    ds_read_b128 v[36:39], v7 offset:5120
    v_smfmac_f32_16x16x64_bf16 v[104:107], v[120:123], a[216:223], v184
    ds_read_b128 v[40:43], v7 offset:6144
    v_smfmac_f32_16x16x64_bf16 v[104:107], v[124:127], a[224:231], v184
    v_smfmac_f32_16x16x64_bf16 v[104:107], v[128:131], a[232:239], v184
    s_branch Ldd_32
LdA_30:
    v_smfmac_f32_16x16x64_bf16 v[96:99], v[108:111], a[56:63], v184
    v_smfmac_f32_16x16x64_bf16 v[100:103], v[108:111], a[136:143], v184
    s_waitcnt lgkmcnt(0)
    s_barrier
    ds_read_b128 v[16:19], v7 offset:0
    ds_read_b128 v[20:23], v7 offset:1024
    v_smfmac_f32_16x16x64_bf16 v[96:99], v[112:115], a[64:71], v184
    ds_read_b128 v[24:27], v7 offset:2048
    v_smfmac_f32_16x16x64_bf16 v[100:103], v[112:115], a[144:151], v184
    ds_read_b128 v[28:31], v7 offset:3072
    v_smfmac_f32_16x16x64_bf16 v[96:99], v[116:119], a[72:79], v184
    ds_read_b128 v[32:35], v7 offset:4096
    v_smfmac_f32_16x16x64_bf16 v[100:103], v[116:119], a[152:159], v184
    ds_read_b128 v[36:39], v7 offset:5120
    v_smfmac_f32_16x16x64_bf16 v[104:107], v[108:111], a[216:223], v184
    ds_read_b128 v[40:43], v7 offset:6144
    v_smfmac_f32_16x16x64_bf16 v[104:107], v[112:115], a[224:231], v184
    v_smfmac_f32_16x16x64_bf16 v[104:107], v[116:119], a[232:239], v184
Ldd_32:
    s_mov_b64 vcc, s[34:35]
    s_waitcnt lgkmcnt(6)
    v_smfmac_f32_16x16x64_bf16 v[96:99], v[16:19], a[0:7], v184
    v_smfmac_f32_16x16x64_bf16 v[100:103], v[16:19], a[80:87], v184
    s_waitcnt lgkmcnt(5)
    v_smfmac_f32_16x16x64_bf16 v[96:99], v[20:23], a[8:15], v184
    v_smfmac_f32_16x16x64_bf16 v[100:103], v[20:23], a[88:95], v184
    s_waitcnt lgkmcnt(4)
    v_smfmac_f32_16x16x64_bf16 v[96:99], v[24:27], a[16:23], v184
    v_smfmac_f32_16x16x64_bf16 v[100:103], v[24:27], a[96:103], v184
    s_waitcnt lgkmcnt(3)
    v_smfmac_f32_16x16x64_bf16 v[96:99], v[28:31], a[24:31], v184
    v_smfmac_f32_16x16x64_bf16 v[100:103], v[28:31], a[104:111], v184
    s_waitcnt lgkmcnt(2)
    v_smfmac_f32_16x16x64_bf16 v[96:99], v[32:35], a[32:39], v184
    v_smfmac_f32_16x16x64_bf16 v[100:103], v[32:35], a[112:119], v184
    s_waitcnt lgkmcnt(1)
    v_smfmac_f32_16x16x64_bf16 v[96:99], v[36:39], a[40:47], v184
    s_waitcnt lgkmcnt(0)
    v_smfmac_f32_16x16x64_bf16 v[96:99], v[40:43], a[48:55], v184
    v_smfmac_f32_16x16x64_bf16 v[100:103], v[36:39], a[120:127], v184
    buffer_store_dword v253, v254, s[4:7], s51 offen
    v_smfmac_f32_16x16x64_bf16 v[100:103], v[40:43], a[128:135], v184
    v_add_f32 v96, v96, v98
    v_add_f32 v97, v97, v99
    v_cvt_pk_bf16_f32 v160, v96, v97
    v_mov_b32 v98, 0
    s_nop 0
    v_mov_b32_dpp v162, v160 quad_perm:[1,0,3,2] row_mask:0xf bank_mask:0xf
    v_perm_b32 v160, v162, v160, v185
    s_nop 0
    v_add_f32 v100, v100, v102
    v_add_f32 v101, v101, v103
    v_cvt_pk_bf16_f32 v161, v100, v101
    v_smfmac_f32_16x16x64_bf16 v[104:107], v[16:19], a[160:167], v184
    s_nop 0
    v_mov_b32_dpp v163, v161 quad_perm:[1,0,3,2] row_mask:0xf bank_mask:0xf
    v_perm_b32 v161, v163, v161, v185
    v_smfmac_f32_16x16x64_bf16 v[104:107], v[20:23], a[168:175], v184
    s_nop 0
    v_cndmask_b32_dpp v176, v161, v160, vcc quad_perm:[2,3,0,1] row_mask:0xf bank_mask:0xf
    s_mov_b64 vcc, s[36:37]
    v_cndmask_b32_dpp v177, v160, v161, vcc quad_perm:[2,3,0,1] row_mask:0xf bank_mask:0xf
    buffer_store_dwordx2 v[176:177], v187, s[4:7], s41 offen
    v_smfmac_f32_16x16x64_bf16 v[104:107], v[24:27], a[176:183], v184
    v_mov_b32 v96, 0
    v_smfmac_f32_16x16x64_bf16 v[104:107], v[28:31], a[184:191], v184
    v_smfmac_f32_16x16x64_bf16 v[104:107], v[32:35], a[192:199], v184
    v_smfmac_f32_16x16x64_bf16 v[104:107], v[36:39], a[200:207], v184
    v_smfmac_f32_16x16x64_bf16 v[104:107], v[40:43], a[208:215], v184
    v_mov_b32 v97, 0
    v_mov_b32 v98, 0
    v_mov_b32 v99, 0
    v_mov_b32 v100, 0
    v_mov_b32 v101, 0
    v_mov_b32 v102, 0
    v_mov_b32 v103, 0
    s_nop 0
    v_add_f32 v104, v104, v106
    v_add_f32 v105, v105, v107
    v_cvt_pk_bf16_f32 v160, v104, v105
    v_mov_b32 v106, 0
    v_mov_b32 v107, 0
    v_mov_b32_dpp v162, v160 quad_perm:[1,0,3,2] row_mask:0xf bank_mask:0xf
    v_perm_b32 v178, v162, v160, v185
    v_mov_b32 v104, 0
    v_mov_b32 v105, 0
    v_mov_b32_dpp v179, v178 quad_perm:[2,3,0,1] row_mask:0xf bank_mask:0xf
    buffer_store_dwordx2 v[178:179], v9, s[4:7], s45 offen
Lmj_16:
    v_xor_b32 v5, 0xc000, v5
    v_xor_b32 v7, 0xc000, v7
    s_cmp_eq_u32 s30, 0
    s_cbranch_scc1 Lq0_8
Lqr_9:
    s_cmp_ge_u32 s64, 64
    s_cbranch_scc1 Lqn_6
    s_and_b32 s65, s64, 1
    s_mul_i32 s66, s65, 40960
    v_add_u32 v12, s66, v2
    s_xor_b32 s65, s65, 1
    s_mul_i32 s65, s65, 40960
    s_add_u32 s65, s65, s62
    s_add_u32 s66, s64, 1
    s_min_u32 s66, s66, 63
    s_mul_i32 s66, s66, 40960
    s_add_u32 s66, s66, s62
    s_add_u32 s66, s66, 4194304
    s_and_b32 s47, s64, 7
    s_mul_i32 s47, s47, 393216
    s_lshl_b32 s48, s58, 1
    s_add_u32 s47, s47, s48
    s_max_u32 s50, s64, 8
    s_sub_u32 s50, s50, 8
    s_lshl_b32 s50, s50, 9
    s_add_u32 s50, s50, s61
    buffer_load_dword v180, v10, s[4:7], s50 offen sc1
    ds_read_b128 v[16:19], v12 offset:0
    ds_read_b128 v[20:23], v12 offset:1024
    ds_read_b128 v[24:27], v12 offset:2048
    ds_read_b128 v[28:31], v12 offset:3072
    ds_read_b128 v[32:35], v12 offset:4096
    ds_read_b128 v[36:39], v12 offset:5120
    ds_read_b128 v[40:43], v12 offset:6144
    ds_read_b128 v[44:47], v12 offset:7168
    ds_read_b128 v[48:51], v12 offset:8192
    ds_read_b128 v[52:55], v12 offset:9216
    s_waitcnt lgkmcnt(9)
    v_mfma_f32_16x16x32_bf16 v[148:151], a[160:163], v[16:19], 0
    v_mfma_f32_16x16x32_bf16 v[140:143], a[80:83], v[16:19], 0
    v_mfma_f32_16x16x32_bf16 v[132:135], a[0:3], v[16:19], 0
    ds_read_b128 v[56:59], v12 offset:10240
    s_waitcnt lgkmcnt(9)
    v_mfma_f32_16x16x32_bf16 v[148:151], a[164:167], v[20:23], v[148:151]
    v_mfma_f32_16x16x32_bf16 v[140:143], a[84:87], v[20:23], v[140:143]
    v_mfma_f32_16x16x32_bf16 v[132:135], a[4:7], v[20:23], v[132:135]
    ds_read_b128 v[60:63], v12 offset:11264
    s_waitcnt lgkmcnt(9)
    v_mfma_f32_16x16x32_bf16 v[148:151], a[168:171], v[24:27], v[148:151]
    v_mfma_f32_16x16x32_bf16 v[140:143], a[88:91], v[24:27], v[140:143]
    v_mfma_f32_16x16x32_bf16 v[132:135], a[8:11], v[24:27], v[132:135]
    ds_read_b128 v[64:67], v12 offset:12288
    s_waitcnt lgkmcnt(9)
    v_mfma_f32_16x16x32_bf16 v[148:151], a[172:175], v[28:31], v[148:151]
    v_mfma_f32_16x16x32_bf16 v[140:143], a[92:95], v[28:31], v[140:143]
    v_mfma_f32_16x16x32_bf16 v[132:135], a[12:15], v[28:31], v[132:135]
    ds_read_b128 v[68:71], v12 offset:13312
    s_waitcnt lgkmcnt(9)
    v_mfma_f32_16x16x32_bf16 v[148:151], a[176:179], v[32:35], v[148:151]
    v_mfma_f32_16x16x32_bf16 v[140:143], a[96:99], v[32:35], v[140:143]
    v_mfma_f32_16x16x32_bf16 v[132:135], a[16:19], v[32:35], v[132:135]
    ds_read_b128 v[72:75], v12 offset:14336
    s_waitcnt lgkmcnt(9)
    v_mfma_f32_16x16x32_bf16 v[148:151], a[180:183], v[36:39], v[148:151]
    v_mfma_f32_16x16x32_bf16 v[140:143], a[100:103], v[36:39], v[140:143]
    v_mfma_f32_16x16x32_bf16 v[132:135], a[20:23], v[36:39], v[132:135]
    ds_read_b128 v[76:79], v12 offset:15360
    s_cmp_lt_u32 s64, 8
    s_cbranch_scc1 Lbp_33
    s_waitcnt vmcnt(0)
    v_cmp_eq_u32 vcc, 0, v180
    s_cbranch_vccz Lbp_33
    s_mov_b32 s31, 262144
    s_mov_b32 exec_lo, 0x1
    s_mov_b32 exec_hi, 0
Lf_34:
    buffer_load_dword v180, v10, s[4:7], s50 offen sc1
    s_waitcnt vmcnt(0)
    v_cmp_eq_u32 vcc, 0, v180
    s_cbranch_vccz Lfd_35
    s_sleep 1
    s_sub_u32 s31, s31, 1
    s_cbranch_scc0 Lf_34
    s_mov_b32 s31, 13
    s_branch L_fail
Lfd_35:
    s_mov_b64 exec, -1
Lbp_33:
    s_waitcnt lgkmcnt(9)
    v_mfma_f32_16x16x32_bf16 v[148:151], a[184:187], v[40:43], v[148:151]
    v_mfma_f32_16x16x32_bf16 v[140:143], a[104:107], v[40:43], v[140:143]
    v_mfma_f32_16x16x32_bf16 v[132:135], a[24:27], v[40:43], v[132:135]
    ds_read_b128 v[80:83], v12 offset:16384
    buffer_store_dwordx2 v[176:177], v182, s[4:7], s43 offen
    s_waitcnt lgkmcnt(9)
    v_mfma_f32_16x16x32_bf16 v[148:151], a[188:191], v[44:47], v[148:151]
    v_mfma_f32_16x16x32_bf16 v[140:143], a[108:111], v[44:47], v[140:143]
    v_mfma_f32_16x16x32_bf16 v[132:135], a[28:31], v[44:47], v[132:135]
    ds_read_b128 v[84:87], v12 offset:17408
    buffer_store_dwordx2 v[248:249], v187, s[4:7], s42 offen
    s_waitcnt lgkmcnt(9)
    v_mfma_f32_16x16x32_bf16 v[148:151], a[192:195], v[48:51], v[148:151]
    v_mfma_f32_16x16x32_bf16 v[140:143], a[112:115], v[48:51], v[140:143]
    v_mfma_f32_16x16x32_bf16 v[132:135], a[32:35], v[48:51], v[132:135]
    ds_read_b128 v[88:91], v12 offset:18432
    buffer_store_dwordx2 v[178:179], v183, s[4:7], s44 offen
    s_waitcnt lgkmcnt(9)
    v_mfma_f32_16x16x32_bf16 v[148:151], a[196:199], v[52:55], v[148:151]
    v_mfma_f32_16x16x32_bf16 v[140:143], a[116:119], v[52:55], v[140:143]
    v_mfma_f32_16x16x32_bf16 v[132:135], a[36:39], v[52:55], v[132:135]
    ds_read_b128 v[92:95], v12 offset:19456
    buffer_store_dwordx2 v[248:249], v9, s[4:7], s46 offen
    s_waitcnt lgkmcnt(9)
    v_mfma_f32_16x16x32_bf16 v[148:151], a[200:203], v[56:59], v[148:151]
    v_mfma_f32_16x16x32_bf16 v[140:143], a[120:123], v[56:59], v[140:143]
    v_mfma_f32_16x16x32_bf16 v[132:135], a[40:43], v[56:59], v[132:135]
    ds_read_b128 v[16:19], v12 offset:20480
    s_add_u32 m0, s65, 0
    s_nop 0
    buffer_load_dwordx4 v2, s[4:7], s66 offen lds
    s_add_u32 s66, s66, 1024
    s_waitcnt lgkmcnt(9)
    v_mfma_f32_16x16x32_bf16 v[148:151], a[204:207], v[60:63], v[148:151]
    v_mfma_f32_16x16x32_bf16 v[140:143], a[124:127], v[60:63], v[140:143]
    v_mfma_f32_16x16x32_bf16 v[132:135], a[44:47], v[60:63], v[132:135]
    ds_read_b128 v[20:23], v12 offset:21504
    s_add_u32 m0, s65, 1024
    s_nop 0
    buffer_load_dwordx4 v2, s[4:7], s66 offen lds
    s_add_u32 s66, s66, 1024
    s_waitcnt lgkmcnt(9)
    v_mfma_f32_16x16x32_bf16 v[148:151], a[208:211], v[64:67], v[148:151]
    v_mfma_f32_16x16x32_bf16 v[140:143], a[128:131], v[64:67], v[140:143]
    v_mfma_f32_16x16x32_bf16 v[132:135], a[48:51], v[64:67], v[132:135]
    ds_read_b128 v[24:27], v12 offset:22528
    s_add_u32 m0, s65, 2048
    s_nop 0
    buffer_load_dwordx4 v2, s[4:7], s66 offen lds
    s_add_u32 s66, s66, 1024
    s_waitcnt lgkmcnt(9)
    v_mfma_f32_16x16x32_bf16 v[148:151], a[212:215], v[68:71], v[148:151]
    v_mfma_f32_16x16x32_bf16 v[140:143], a[132:135], v[68:71], v[140:143]
    v_mfma_f32_16x16x32_bf16 v[132:135], a[52:55], v[68:71], v[132:135]
    ds_read_b128 v[28:31], v12 offset:23552
    s_add_u32 m0, s65, 3072
    s_nop 0
    buffer_load_dwordx4 v2, s[4:7], s66 offen lds
    s_add_u32 s66, s66, 1024
    s_waitcnt lgkmcnt(9)
    v_mfma_f32_16x16x32_bf16 v[148:151], a[216:219], v[72:75], v[148:151]
    v_mfma_f32_16x16x32_bf16 v[140:143], a[136:139], v[72:75], v[140:143]
    v_mfma_f32_16x16x32_bf16 v[132:135], a[56:59], v[72:75], v[132:135]
    ds_read_b128 v[32:35], v12 offset:24576
    s_add_u32 m0, s65, 4096
    s_nop 0
    buffer_load_dwordx4 v2, s[4:7], s66 offen lds
    s_add_u32 s66, s66, 1024
    s_waitcnt lgkmcnt(9)
    v_mfma_f32_16x16x32_bf16 v[148:151], a[220:223], v[76:79], v[148:151]
    v_mfma_f32_16x16x32_bf16 v[140:143], a[140:143], v[76:79], v[140:143]
    v_mfma_f32_16x16x32_bf16 v[132:135], a[60:63], v[76:79], v[132:135]
    ds_read_b128 v[36:39], v12 offset:25600
    s_add_u32 m0, s65, 5120
    s_nop 0
    buffer_load_dwordx4 v2, s[4:7], s66 offen lds
    s_add_u32 s66, s66, 1024
    s_waitcnt lgkmcnt(9)
    v_mfma_f32_16x16x32_bf16 v[148:151], a[224:227], v[80:83], v[148:151]
    v_mfma_f32_16x16x32_bf16 v[140:143], a[144:147], v[80:83], v[140:143]
    v_mfma_f32_16x16x32_bf16 v[132:135], a[64:67], v[80:83], v[132:135]
    ds_read_b128 v[40:43], v12 offset:26624
    s_add_u32 m0, s65, 6144
    s_nop 0
    buffer_load_dwordx4 v2, s[4:7], s66 offen lds
    s_add_u32 s66, s66, 1024
    s_waitcnt lgkmcnt(9)
    v_mfma_f32_16x16x32_bf16 v[148:151], a[228:231], v[84:87], v[148:151]
    v_mfma_f32_16x16x32_bf16 v[140:143], a[148:151], v[84:87], v[140:143]
    v_mfma_f32_16x16x32_bf16 v[132:135], a[68:71], v[84:87], v[132:135]
    ds_read_b128 v[44:47], v12 offset:27648
    s_add_u32 m0, s65, 7168
    s_nop 0
    buffer_load_dwordx4 v2, s[4:7], s66 offen lds
    s_add_u32 s66, s66, 1024
    s_waitcnt lgkmcnt(9)
    v_mfma_f32_16x16x32_bf16 v[148:151], a[232:235], v[88:91], v[148:151]
    v_mfma_f32_16x16x32_bf16 v[140:143], a[152:155], v[88:91], v[140:143]
    v_mfma_f32_16x16x32_bf16 v[132:135], a[72:75], v[88:91], v[132:135]
    ds_read_b128 v[48:51], v12 offset:28672
    s_add_u32 m0, s65, 8192
    s_nop 0
    buffer_load_dwordx4 v2, s[4:7], s66 offen lds
    s_add_u32 s66, s66, 1024
    s_waitcnt lgkmcnt(9)
    v_mfma_f32_16x16x32_bf16 v[148:151], a[236:239], v[92:95], v[148:151]
    v_mfma_f32_16x16x32_bf16 v[140:143], a[156:159], v[92:95], v[140:143]
    v_mfma_f32_16x16x32_bf16 v[132:135], a[76:79], v[92:95], v[132:135]
    ds_read_b128 v[52:55], v12 offset:29696
    s_add_u32 m0, s65, 9216
    s_nop 0
    buffer_load_dwordx4 v2, s[4:7], s66 offen lds
    s_add_u32 s66, s66, 1024
    s_waitcnt lgkmcnt(9)
    v_mfma_f32_16x16x32_bf16 v[152:155], a[160:163], v[16:19], 0
    v_mfma_f32_16x16x32_bf16 v[144:147], a[80:83], v[16:19], 0
    v_mfma_f32_16x16x32_bf16 v[136:139], a[0:3], v[16:19], 0
    ds_read_b128 v[56:59], v12 offset:30720
    s_waitcnt lgkmcnt(9)
    v_mfma_f32_16x16x32_bf16 v[152:155], a[164:167], v[20:23], v[152:155]
    v_mfma_f32_16x16x32_bf16 v[144:147], a[84:87], v[20:23], v[144:147]
    v_mfma_f32_16x16x32_bf16 v[136:139], a[4:7], v[20:23], v[136:139]
    ds_read_b128 v[60:63], v12 offset:31744
    s_waitcnt lgkmcnt(9)
    v_mfma_f32_16x16x32_bf16 v[152:155], a[168:171], v[24:27], v[152:155]
    v_mfma_f32_16x16x32_bf16 v[144:147], a[88:91], v[24:27], v[144:147]
    v_mfma_f32_16x16x32_bf16 v[136:139], a[8:11], v[24:27], v[136:139]
    ds_read_b128 v[64:67], v12 offset:32768
    s_waitcnt lgkmcnt(9)
    v_mfma_f32_16x16x32_bf16 v[152:155], a[172:175], v[28:31], v[152:155]
    v_mfma_f32_16x16x32_bf16 v[144:147], a[92:95], v[28:31], v[144:147]
    v_mfma_f32_16x16x32_bf16 v[136:139], a[12:15], v[28:31], v[136:139]
    ds_read_b128 v[68:71], v12 offset:33792
    v_cvt_pk_bf16_f32 v168, v148, v149
    v_cvt_pk_bf16_f32 v169, v150, v151
    s_add_u32 s48, s47, 67108864
    buffer_store_dwordx2 v[168:169], v8, s[4:7], s48 offen
    s_waitcnt lgkmcnt(9)
    v_mfma_f32_16x16x32_bf16 v[152:155], a[176:179], v[32:35], v[152:155]
    v_mfma_f32_16x16x32_bf16 v[144:147], a[96:99], v[32:35], v[144:147]
    v_mfma_f32_16x16x32_bf16 v[136:139], a[16:19], v[32:35], v[136:139]
    ds_read_b128 v[72:75], v12 offset:34816
    v_cvt_pk_bf16_f32 v164, v140, v141
    v_cvt_pk_bf16_f32 v165, v142, v143
    s_waitcnt lgkmcnt(9)
    v_mfma_f32_16x16x32_bf16 v[152:155], a[180:183], v[36:39], v[152:155]
    v_mfma_f32_16x16x32_bf16 v[144:147], a[100:103], v[36:39], v[144:147]
    v_mfma_f32_16x16x32_bf16 v[136:139], a[20:23], v[36:39], v[136:139]
    ds_read_b128 v[76:79], v12 offset:35840
    v_cvt_pk_bf16_f32 v160, v132, v133
    v_cvt_pk_bf16_f32 v161, v134, v135
    s_waitcnt lgkmcnt(9)
    v_mfma_f32_16x16x32_bf16 v[152:155], a[184:187], v[40:43], v[152:155]
    v_mfma_f32_16x16x32_bf16 v[144:147], a[104:107], v[40:43], v[144:147]
    v_mfma_f32_16x16x32_bf16 v[136:139], a[24:27], v[40:43], v[136:139]
    ds_read_b128 v[80:83], v12 offset:36864
    s_waitcnt lgkmcnt(9)
    v_mfma_f32_16x16x32_bf16 v[152:155], a[188:191], v[44:47], v[152:155]
    v_mfma_f32_16x16x32_bf16 v[144:147], a[108:111], v[44:47], v[144:147]
    v_mfma_f32_16x16x32_bf16 v[136:139], a[28:31], v[44:47], v[136:139]
    ds_read_b128 v[84:87], v12 offset:37888
    s_waitcnt lgkmcnt(9)
    v_mfma_f32_16x16x32_bf16 v[152:155], a[192:195], v[48:51], v[152:155]
    v_mfma_f32_16x16x32_bf16 v[144:147], a[112:115], v[48:51], v[144:147]
    v_mfma_f32_16x16x32_bf16 v[136:139], a[32:35], v[48:51], v[136:139]
    ds_read_b128 v[88:91], v12 offset:38912
    s_waitcnt lgkmcnt(9)
    v_mfma_f32_16x16x32_bf16 v[152:155], a[196:199], v[52:55], v[152:155]
    v_mfma_f32_16x16x32_bf16 v[144:147], a[116:119], v[52:55], v[144:147]
    v_mfma_f32_16x16x32_bf16 v[136:139], a[36:39], v[52:55], v[136:139]
    ds_read_b128 v[92:95], v12 offset:39936
    s_waitcnt lgkmcnt(9)
    v_mfma_f32_16x16x32_bf16 v[152:155], a[200:203], v[56:59], v[152:155]
    v_mfma_f32_16x16x32_bf16 v[144:147], a[120:123], v[56:59], v[144:147]
    v_mfma_f32_16x16x32_bf16 v[136:139], a[40:43], v[56:59], v[136:139]
    s_waitcnt lgkmcnt(8)
    v_mfma_f32_16x16x32_bf16 v[152:155], a[204:207], v[60:63], v[152:155]
    v_mfma_f32_16x16x32_bf16 v[144:147], a[124:127], v[60:63], v[144:147]
    v_mfma_f32_16x16x32_bf16 v[136:139], a[44:47], v[60:63], v[136:139]
    s_waitcnt lgkmcnt(7)
    v_mfma_f32_16x16x32_bf16 v[152:155], a[208:211], v[64:67], v[152:155]
    v_mfma_f32_16x16x32_bf16 v[144:147], a[128:131], v[64:67], v[144:147]
    v_mfma_f32_16x16x32_bf16 v[136:139], a[48:51], v[64:67], v[136:139]
    s_waitcnt lgkmcnt(6)
    v_mfma_f32_16x16x32_bf16 v[152:155], a[212:215], v[68:71], v[152:155]
    v_mfma_f32_16x16x32_bf16 v[144:147], a[132:135], v[68:71], v[144:147]
    v_mfma_f32_16x16x32_bf16 v[136:139], a[52:55], v[68:71], v[136:139]
    s_waitcnt lgkmcnt(5)
    v_mfma_f32_16x16x32_bf16 v[152:155], a[216:219], v[72:75], v[152:155]
    v_mfma_f32_16x16x32_bf16 v[144:147], a[136:139], v[72:75], v[144:147]
    v_mfma_f32_16x16x32_bf16 v[136:139], a[56:59], v[72:75], v[136:139]
    s_waitcnt lgkmcnt(4)
    v_mfma_f32_16x16x32_bf16 v[152:155], a[220:223], v[76:79], v[152:155]
    v_mfma_f32_16x16x32_bf16 v[144:147], a[140:143], v[76:79], v[144:147]
    v_mfma_f32_16x16x32_bf16 v[136:139], a[60:63], v[76:79], v[136:139]
    s_waitcnt lgkmcnt(3)
    v_mfma_f32_16x16x32_bf16 v[152:155], a[224:227], v[80:83], v[152:155]
    v_mfma_f32_16x16x32_bf16 v[144:147], a[144:147], v[80:83], v[144:147]
    v_mfma_f32_16x16x32_bf16 v[136:139], a[64:67], v[80:83], v[136:139]
    s_waitcnt lgkmcnt(2)
    v_mfma_f32_16x16x32_bf16 v[152:155], a[228:231], v[84:87], v[152:155]
    v_mfma_f32_16x16x32_bf16 v[144:147], a[148:151], v[84:87], v[144:147]
    v_mfma_f32_16x16x32_bf16 v[136:139], a[68:71], v[84:87], v[136:139]
    s_waitcnt lgkmcnt(1)
    v_mfma_f32_16x16x32_bf16 v[152:155], a[232:235], v[88:91], v[152:155]
    v_mfma_f32_16x16x32_bf16 v[144:147], a[152:155], v[88:91], v[144:147]
    v_mfma_f32_16x16x32_bf16 v[136:139], a[72:75], v[88:91], v[136:139]
    s_waitcnt lgkmcnt(0)
    v_mfma_f32_16x16x32_bf16 v[152:155], a[236:239], v[92:95], v[152:155]
    v_mfma_f32_16x16x32_bf16 v[144:147], a[156:159], v[92:95], v[144:147]
    v_mfma_f32_16x16x32_bf16 v[136:139], a[76:79], v[92:95], v[136:139]
    v_cvt_pk_bf16_f32 v170, v152, v153
    v_cvt_pk_bf16_f32 v171, v154, v155
    s_add_u32 s48, s47, 67115008
    buffer_store_dwordx2 v[170:171], v8, s[4:7], s48 offen
    v_cvt_pk_bf16_f32 v166, v144, v145
    v_cvt_pk_bf16_f32 v167, v146, v147
    s_add_u32 s48, s47, 41943040
    v_permlane16_swap_b32 v164, v166
    v_permlane16_swap_b32 v165, v167
    buffer_store_dwordx4 v[164:167], v190, s[4:7], s48 offen
    v_cvt_pk_bf16_f32 v162, v136, v137
    v_cvt_pk_bf16_f32 v163, v138, v139
    s_add_u32 s48, s47, 16777216
    v_permlane16_swap_b32 v160, v162
    v_permlane16_swap_b32 v161, v163
    buffer_store_dwordx4 v[160:163], v190, s[4:7], s48 offen
    s_cmp_lg_u32 s64, 63
    s_cbranch_scc1 Lqx_7
    s_sub_u32 s51, s64, 0
    s_lshl_b32 s51, s51, 5
    s_add_u32 s51, s51, s26
    s_lshl_b32 s51, s51, 6
    s_add_u32 s51, s51, 4096
    s_waitcnt vmcnt(0)
    s_mov_b64 exec, 1
    buffer_store_dword v252, v254, s[4:7], s51 offen
    s_mov_b64 exec, -1
    s_branch Lqx_7
Lqn_6:
    buffer_store_dwordx2 v[176:177], v182, s[4:7], s43 offen
    buffer_store_dwordx2 v[178:179], v183, s[4:7], s44 offen
    s_sub_u32 s51, s64, 0
    s_lshl_b32 s51, s51, 5
    s_add_u32 s51, s51, s26
    s_lshl_b32 s51, s51, 6
    s_add_u32 s51, s51, 4096
    s_waitcnt vmcnt(0)
    s_mov_b64 exec, 1
    buffer_store_dword v252, v254, s[4:7], s51 offen
    s_mov_b64 exec, -1
Lqx_7:
    s_add_u32 s64, s64, 1
    s_add_u32 s30, s30, 1
    s_cmp_lt_u32 s30, 64
    s_cbranch_scc1 Lqt_5
    s_lshl_b32 s30, s21, 3
    s_add_u32 s30, s30, s20
    s_add_u32 s30, s30, 1220
    s_mov_b32 s33, 0
    s_cmp_lt_u32 s30, 1280
    s_cselect_b32 s38, s22, 1
    s_cmp_eq_u32 s38, 0
    s_cbranch_scc1 L_cmb2
    s_endpgm
L_qkvs:
    s_mov_b32 s30, 0
    s_mov_b32 s64, 0
    s_add_u32 s57, s28, s55
    s_add_u32 s57, s57, 3932160
    s_add_u32 m0, s56, 81920
    s_nop 0
    buffer_load_dwordx4 v240, s[8:11], s57 offen nt lds
    s_add_u32 s57, s57, 393216
    s_add_u32 m0, s56, 86016
    s_nop 0
    buffer_load_dwordx4 v240, s[8:11], s57 offen nt lds
    s_add_u32 s57, s57, 393216
    s_add_u32 m0, s56, 90112
    s_nop 0
    buffer_load_dwordx4 v240, s[8:11], s57 offen nt lds
    s_add_u32 s57, s57, 393216
    s_add_u32 m0, s56, 94208
    s_nop 0
    buffer_load_dwordx4 v240, s[8:11], s57 offen nt lds
    s_waitcnt vmcnt(4)
    s_barrier
    s_and_b32 s65, s64, 1
    s_mul_i32 s66, s65, 40960
    v_add_u32 v12, s66, v2
    s_xor_b32 s65, s65, 1
    s_mul_i32 s65, s65, 40960
    s_add_u32 s65, s65, s62
    s_add_u32 s66, s64, 1
    s_min_u32 s66, s66, 63
    s_mul_i32 s66, s66, 40960
    s_add_u32 s66, s66, s62
    s_add_u32 s66, s66, 4194304
    s_and_b32 s47, s64, 7
    s_mul_i32 s47, s47, 393216
    s_lshl_b32 s48, s58, 1
    s_add_u32 s47, s47, s48
    ds_read_b128 v[16:19], v12 offset:0
    ds_read_b128 v[20:23], v12 offset:1024
    ds_read_b128 v[24:27], v12 offset:2048
    ds_read_b128 v[28:31], v12 offset:3072
    ds_read_b128 v[32:35], v12 offset:4096
    ds_read_b128 v[36:39], v12 offset:5120
    ds_read_b128 v[40:43], v12 offset:6144
    ds_read_b128 v[44:47], v12 offset:7168
    ds_read_b128 v[48:51], v12 offset:8192
    ds_read_b128 v[52:55], v12 offset:9216
    s_waitcnt lgkmcnt(9)
    v_mfma_f32_16x16x32_bf16 v[148:151], a[160:163], v[16:19], 0
    v_mfma_f32_16x16x32_bf16 v[140:143], a[80:83], v[16:19], 0
    ds_read_b128 v[56:59], v12 offset:10240
    s_add_u32 s57, s57, 393216
    s_add_u32 m0, s56, 98304
    s_nop 0
    buffer_load_dwordx4 v240, s[8:11], s57 offen nt lds
    s_waitcnt lgkmcnt(9)
    v_mfma_f32_16x16x32_bf16 v[148:151], a[164:167], v[20:23], v[148:151]
    v_mfma_f32_16x16x32_bf16 v[140:143], a[84:87], v[20:23], v[140:143]
    ds_read_b128 v[60:63], v12 offset:11264
    s_waitcnt lgkmcnt(9)
    v_mfma_f32_16x16x32_bf16 v[148:151], a[168:171], v[24:27], v[148:151]
    v_mfma_f32_16x16x32_bf16 v[140:143], a[88:91], v[24:27], v[140:143]
    ds_read_b128 v[64:67], v12 offset:12288
    s_add_u32 s57, s57, 393216
    s_add_u32 m0, s56, 102400
    s_nop 0
    buffer_load_dwordx4 v240, s[8:11], s57 offen nt lds
    s_waitcnt lgkmcnt(9)
    v_mfma_f32_16x16x32_bf16 v[148:151], a[172:175], v[28:31], v[148:151]
    v_mfma_f32_16x16x32_bf16 v[140:143], a[92:95], v[28:31], v[140:143]
    ds_read_b128 v[68:71], v12 offset:13312
    s_waitcnt lgkmcnt(9)
    v_mfma_f32_16x16x32_bf16 v[148:151], a[176:179], v[32:35], v[148:151]
    v_mfma_f32_16x16x32_bf16 v[140:143], a[96:99], v[32:35], v[140:143]
    ds_read_b128 v[72:75], v12 offset:14336
    s_add_u32 s57, s57, 393216
    s_add_u32 m0, s56, 106496
    s_nop 0
    buffer_load_dwordx4 v240, s[8:11], s57 offen nt lds
    s_waitcnt lgkmcnt(9)
    v_mfma_f32_16x16x32_bf16 v[148:151], a[180:183], v[36:39], v[148:151]
    v_mfma_f32_16x16x32_bf16 v[140:143], a[100:103], v[36:39], v[140:143]
    ds_read_b128 v[76:79], v12 offset:15360
    s_waitcnt lgkmcnt(9)
    v_mfma_f32_16x16x32_bf16 v[148:151], a[184:187], v[40:43], v[148:151]
    v_mfma_f32_16x16x32_bf16 v[140:143], a[104:107], v[40:43], v[140:143]
    ds_read_b128 v[80:83], v12 offset:16384
    s_add_u32 s57, s57, 393216
    s_add_u32 m0, s56, 110592
    s_nop 0
    buffer_load_dwordx4 v240, s[8:11], s57 offen nt lds
    s_waitcnt lgkmcnt(9)
    v_mfma_f32_16x16x32_bf16 v[148:151], a[188:191], v[44:47], v[148:151]
    v_mfma_f32_16x16x32_bf16 v[140:143], a[108:111], v[44:47], v[140:143]
    ds_read_b128 v[84:87], v12 offset:17408
    s_waitcnt lgkmcnt(9)
    v_mfma_f32_16x16x32_bf16 v[148:151], a[192:195], v[48:51], v[148:151]
    v_mfma_f32_16x16x32_bf16 v[140:143], a[112:115], v[48:51], v[140:143]
    ds_read_b128 v[88:91], v12 offset:18432
    s_add_u32 s57, s57, 393216
    s_add_u32 m0, s56, 114688
    s_nop 0
    buffer_load_dwordx4 v240, s[8:11], s57 offen nt lds
    s_waitcnt lgkmcnt(9)
    v_mfma_f32_16x16x32_bf16 v[148:151], a[196:199], v[52:55], v[148:151]
    v_mfma_f32_16x16x32_bf16 v[140:143], a[116:119], v[52:55], v[140:143]
    ds_read_b128 v[92:95], v12 offset:19456
    s_waitcnt lgkmcnt(9)
    v_mfma_f32_16x16x32_bf16 v[148:151], a[200:203], v[56:59], v[148:151]
    v_mfma_f32_16x16x32_bf16 v[140:143], a[120:123], v[56:59], v[140:143]
    ds_read_b128 v[16:19], v12 offset:20480
    s_add_u32 s57, s57, 393216
    s_add_u32 m0, s56, 118784
    s_nop 0
    buffer_load_dwordx4 v240, s[8:11], s57 offen nt lds
    s_waitcnt lgkmcnt(9)
    v_mfma_f32_16x16x32_bf16 v[148:151], a[204:207], v[60:63], v[148:151]
    v_mfma_f32_16x16x32_bf16 v[140:143], a[124:127], v[60:63], v[140:143]
    ds_read_b128 v[20:23], v12 offset:21504
    s_waitcnt lgkmcnt(9)
    v_mfma_f32_16x16x32_bf16 v[148:151], a[208:211], v[64:67], v[148:151]
    v_mfma_f32_16x16x32_bf16 v[140:143], a[128:131], v[64:67], v[140:143]
    ds_read_b128 v[24:27], v12 offset:22528
    s_add_u32 s63, s62, 4235264
    s_add_u32 m0, s62, 40960
    s_nop 0
    buffer_load_dwordx4 v2, s[4:7], s63 offen lds
    s_waitcnt lgkmcnt(9)
    v_mfma_f32_16x16x32_bf16 v[148:151], a[212:215], v[68:71], v[148:151]
    v_mfma_f32_16x16x32_bf16 v[140:143], a[132:135], v[68:71], v[140:143]
    ds_read_b128 v[28:31], v12 offset:23552
    s_waitcnt lgkmcnt(9)
    v_mfma_f32_16x16x32_bf16 v[148:151], a[216:219], v[72:75], v[148:151]
    v_mfma_f32_16x16x32_bf16 v[140:143], a[136:139], v[72:75], v[140:143]
    ds_read_b128 v[32:35], v12 offset:24576
    s_add_u32 s63, s63, 1024
    s_add_u32 m0, s62, 41984
    s_nop 0
    buffer_load_dwordx4 v2, s[4:7], s63 offen lds
    s_waitcnt lgkmcnt(9)
    v_mfma_f32_16x16x32_bf16 v[148:151], a[220:223], v[76:79], v[148:151]
    v_mfma_f32_16x16x32_bf16 v[140:143], a[140:143], v[76:79], v[140:143]
    ds_read_b128 v[36:39], v12 offset:25600
    s_waitcnt lgkmcnt(9)
    v_mfma_f32_16x16x32_bf16 v[148:151], a[224:227], v[80:83], v[148:151]
    v_mfma_f32_16x16x32_bf16 v[140:143], a[144:147], v[80:83], v[140:143]
    ds_read_b128 v[40:43], v12 offset:26624
    s_add_u32 s63, s63, 1024
    s_add_u32 m0, s62, 43008
    s_nop 0
    buffer_load_dwordx4 v2, s[4:7], s63 offen lds
    s_waitcnt lgkmcnt(9)
    v_mfma_f32_16x16x32_bf16 v[148:151], a[228:231], v[84:87], v[148:151]
    v_mfma_f32_16x16x32_bf16 v[140:143], a[148:151], v[84:87], v[140:143]
    ds_read_b128 v[44:47], v12 offset:27648
    s_waitcnt lgkmcnt(9)
    v_mfma_f32_16x16x32_bf16 v[148:151], a[232:235], v[88:91], v[148:151]
    v_mfma_f32_16x16x32_bf16 v[140:143], a[152:155], v[88:91], v[140:143]
    ds_read_b128 v[48:51], v12 offset:28672
    s_add_u32 s63, s63, 1024
    s_add_u32 m0, s62, 44032
    s_nop 0
    buffer_load_dwordx4 v2, s[4:7], s63 offen lds
    s_waitcnt lgkmcnt(9)
    v_mfma_f32_16x16x32_bf16 v[148:151], a[236:239], v[92:95], v[148:151]
    v_mfma_f32_16x16x32_bf16 v[140:143], a[156:159], v[92:95], v[140:143]
    ds_read_b128 v[52:55], v12 offset:29696
    s_waitcnt lgkmcnt(9)
    v_mfma_f32_16x16x32_bf16 v[152:155], a[160:163], v[16:19], 0
    v_mfma_f32_16x16x32_bf16 v[144:147], a[80:83], v[16:19], 0
    ds_read_b128 v[56:59], v12 offset:30720
    s_add_u32 s63, s63, 1024
    s_add_u32 m0, s62, 45056
    s_nop 0
    buffer_load_dwordx4 v2, s[4:7], s63 offen lds
    s_waitcnt lgkmcnt(9)
    v_mfma_f32_16x16x32_bf16 v[152:155], a[164:167], v[20:23], v[152:155]
    v_mfma_f32_16x16x32_bf16 v[144:147], a[84:87], v[20:23], v[144:147]
    ds_read_b128 v[60:63], v12 offset:31744
    s_waitcnt lgkmcnt(9)
    v_mfma_f32_16x16x32_bf16 v[152:155], a[168:171], v[24:27], v[152:155]
    v_mfma_f32_16x16x32_bf16 v[144:147], a[88:91], v[24:27], v[144:147]
    ds_read_b128 v[64:67], v12 offset:32768
    s_add_u32 s63, s63, 1024
    s_add_u32 m0, s62, 46080
    s_nop 0
    buffer_load_dwordx4 v2, s[4:7], s63 offen lds
    s_waitcnt lgkmcnt(9)
    v_mfma_f32_16x16x32_bf16 v[152:155], a[172:175], v[28:31], v[152:155]
    v_mfma_f32_16x16x32_bf16 v[144:147], a[92:95], v[28:31], v[144:147]
    ds_read_b128 v[68:71], v12 offset:33792
    v_cvt_pk_bf16_f32 v168, v148, v149
    v_cvt_pk_bf16_f32 v169, v150, v151
    s_add_u32 s48, s47, 67108864
    buffer_store_dwordx2 v[168:169], v8, s[4:7], s48 offen sc1
    s_waitcnt lgkmcnt(9)
    v_mfma_f32_16x16x32_bf16 v[152:155], a[176:179], v[32:35], v[152:155]
    v_mfma_f32_16x16x32_bf16 v[144:147], a[96:99], v[32:35], v[144:147]
    ds_read_b128 v[72:75], v12 offset:34816
    s_add_u32 s63, s63, 1024
    s_add_u32 m0, s62, 47104
    s_nop 0
    buffer_load_dwordx4 v2, s[4:7], s63 offen lds
    v_cvt_pk_bf16_f32 v164, v140, v141
    v_cvt_pk_bf16_f32 v165, v142, v143
    s_waitcnt lgkmcnt(9)
    v_mfma_f32_16x16x32_bf16 v[152:155], a[180:183], v[36:39], v[152:155]
    v_mfma_f32_16x16x32_bf16 v[144:147], a[100:103], v[36:39], v[144:147]
    ds_read_b128 v[76:79], v12 offset:35840
    s_waitcnt lgkmcnt(9)
    v_mfma_f32_16x16x32_bf16 v[152:155], a[184:187], v[40:43], v[152:155]
    v_mfma_f32_16x16x32_bf16 v[144:147], a[104:107], v[40:43], v[144:147]
    ds_read_b128 v[80:83], v12 offset:36864
    s_add_u32 s63, s63, 1024
    s_add_u32 m0, s62, 48128
    s_nop 0
    buffer_load_dwordx4 v2, s[4:7], s63 offen lds
    s_waitcnt lgkmcnt(9)
    v_mfma_f32_16x16x32_bf16 v[152:155], a[188:191], v[44:47], v[152:155]
    v_mfma_f32_16x16x32_bf16 v[144:147], a[108:111], v[44:47], v[144:147]
    ds_read_b128 v[84:87], v12 offset:37888
    s_waitcnt lgkmcnt(9)
    v_mfma_f32_16x16x32_bf16 v[152:155], a[192:195], v[48:51], v[152:155]
    v_mfma_f32_16x16x32_bf16 v[144:147], a[112:115], v[48:51], v[144:147]
    ds_read_b128 v[88:91], v12 offset:38912
    s_add_u32 s63, s63, 1024
    s_add_u32 m0, s62, 49152
    s_nop 0
    buffer_load_dwordx4 v2, s[4:7], s63 offen lds
    s_waitcnt lgkmcnt(9)
    v_mfma_f32_16x16x32_bf16 v[152:155], a[196:199], v[52:55], v[152:155]
    v_mfma_f32_16x16x32_bf16 v[144:147], a[116:119], v[52:55], v[144:147]
    ds_read_b128 v[92:95], v12 offset:39936
    s_waitcnt lgkmcnt(9)
    v_mfma_f32_16x16x32_bf16 v[152:155], a[200:203], v[56:59], v[152:155]
    v_mfma_f32_16x16x32_bf16 v[144:147], a[120:123], v[56:59], v[144:147]
    s_add_u32 s63, s63, 1024
    s_add_u32 m0, s62, 50176
    s_nop 0
    buffer_load_dwordx4 v2, s[4:7], s63 offen lds
    s_waitcnt lgkmcnt(8)
    v_mfma_f32_16x16x32_bf16 v[152:155], a[204:207], v[60:63], v[152:155]
    v_mfma_f32_16x16x32_bf16 v[144:147], a[124:127], v[60:63], v[144:147]
    s_waitcnt lgkmcnt(7)
    v_mfma_f32_16x16x32_bf16 v[152:155], a[208:211], v[64:67], v[152:155]
    v_mfma_f32_16x16x32_bf16 v[144:147], a[128:131], v[64:67], v[144:147]
    s_waitcnt lgkmcnt(6)
    v_mfma_f32_16x16x32_bf16 v[152:155], a[212:215], v[68:71], v[152:155]
    v_mfma_f32_16x16x32_bf16 v[144:147], a[132:135], v[68:71], v[144:147]
    s_waitcnt lgkmcnt(5)
    v_mfma_f32_16x16x32_bf16 v[152:155], a[216:219], v[72:75], v[152:155]
    v_mfma_f32_16x16x32_bf16 v[144:147], a[136:139], v[72:75], v[144:147]
    s_waitcnt lgkmcnt(4)
    v_mfma_f32_16x16x32_bf16 v[152:155], a[220:223], v[76:79], v[152:155]
    v_mfma_f32_16x16x32_bf16 v[144:147], a[140:143], v[76:79], v[144:147]
    s_waitcnt lgkmcnt(3)
    v_mfma_f32_16x16x32_bf16 v[152:155], a[224:227], v[80:83], v[152:155]
    v_mfma_f32_16x16x32_bf16 v[144:147], a[144:147], v[80:83], v[144:147]
    s_waitcnt lgkmcnt(2)
    v_mfma_f32_16x16x32_bf16 v[152:155], a[228:231], v[84:87], v[152:155]
    v_mfma_f32_16x16x32_bf16 v[144:147], a[148:151], v[84:87], v[144:147]
    s_waitcnt lgkmcnt(1)
    v_mfma_f32_16x16x32_bf16 v[152:155], a[232:235], v[88:91], v[152:155]
    v_mfma_f32_16x16x32_bf16 v[144:147], a[152:155], v[88:91], v[144:147]
    s_waitcnt lgkmcnt(0)
    v_mfma_f32_16x16x32_bf16 v[152:155], a[236:239], v[92:95], v[152:155]
    v_mfma_f32_16x16x32_bf16 v[144:147], a[156:159], v[92:95], v[144:147]
    s_nop 3
    v_cvt_pk_bf16_f32 v170, v152, v153
    v_cvt_pk_bf16_f32 v171, v154, v155
    s_add_u32 s48, s47, 67115008
    buffer_store_dwordx2 v[170:171], v8, s[4:7], s48 offen sc1
    v_cvt_pk_bf16_f32 v166, v144, v145
    v_cvt_pk_bf16_f32 v167, v146, v147
    s_add_u32 s48, s47, 41943040
    v_permlane16_swap_b32 v164, v166
    v_permlane16_swap_b32 v165, v167
    buffer_store_dwordx4 v[164:167], v190, s[4:7], s48 offen sc1
    s_mov_b32 s64, 1
    s_sub_u32 s51, s64, 1
    s_lshl_b32 s51, s51, 5
    s_add_u32 s51, s51, s26
    s_lshl_b32 s51, s51, 6
    s_add_u32 s51, s51, 4096
    s_waitcnt vmcnt(0)
    s_mov_b64 exec, 1
    buffer_store_dword v252, v254, s[4:7], s51 offen sc1
    s_mov_b64 exec, -1
    s_waitcnt vmcnt(1)
    s_barrier
    ds_read_b64_tr_b16 a[40:41], v241 offset:0
    ds_read_b64_tr_b16 a[42:43], v241 offset:512
    ds_read_b64_tr_b16 a[44:45], v241 offset:4096
    ds_read_b64_tr_b16 a[46:47], v241 offset:4608
    ds_read_b64_tr_b16 a[48:49], v241 offset:8192
    ds_read_b64_tr_b16 a[50:51], v241 offset:8704
    ds_read_b64_tr_b16 a[52:53], v241 offset:12288
    ds_read_b64_tr_b16 a[54:55], v241 offset:12800
    ds_read_b64_tr_b16 a[56:57], v241 offset:16384
    ds_read_b64_tr_b16 a[58:59], v241 offset:16896
    ds_read_b64_tr_b16 a[60:61], v241 offset:20480
    ds_read_b64_tr_b16 a[62:63], v241 offset:20992
    ds_read_b64_tr_b16 a[64:65], v241 offset:24576
    ds_read_b64_tr_b16 a[66:67], v241 offset:25088
    ds_read_b64_tr_b16 a[68:69], v241 offset:28672
    ds_read_b64_tr_b16 a[70:71], v241 offset:29184
    ds_read_b64_tr_b16 a[72:73], v241 offset:32768
    ds_read_b64_tr_b16 a[74:75], v241 offset:33280
    ds_read_b64_tr_b16 a[76:77], v241 offset:36864
    ds_read_b64_tr_b16 a[78:79], v241 offset:37376
    s_waitcnt lgkmcnt(0)
    s_barrier
    s_and_b32 s65, s64, 1
    s_mul_i32 s66, s65, 40960
    v_add_u32 v12, s66, v2
    s_xor_b32 s65, s65, 1
    s_mul_i32 s65, s65, 40960
    s_add_u32 s65, s65, s62
    s_add_u32 s66, s64, 1
    s_min_u32 s66, s66, 63
    s_mul_i32 s66, s66, 40960
    s_add_u32 s66, s66, s62
    s_add_u32 s66, s66, 4194304
    s_and_b32 s47, s64, 7
    s_mul_i32 s47, s47, 393216
    s_lshl_b32 s48, s58, 1
    s_add_u32 s47, s47, s48
    ds_read_b128 v[16:19], v12 offset:0
    ds_read_b128 v[20:23], v12 offset:1024
    ds_read_b128 v[24:27], v12 offset:2048
    ds_read_b128 v[28:31], v12 offset:3072
    ds_read_b128 v[32:35], v12 offset:4096
    ds_read_b128 v[36:39], v12 offset:5120
    ds_read_b128 v[40:43], v12 offset:6144
    ds_read_b128 v[44:47], v12 offset:7168
    ds_read_b128 v[48:51], v12 offset:8192
    ds_read_b128 v[52:55], v12 offset:9216
    s_waitcnt lgkmcnt(9)
    v_mfma_f32_16x16x32_bf16 v[148:151], a[160:163], v[16:19], 0
    v_mfma_f32_16x16x32_bf16 v[140:143], a[80:83], v[16:19], 0
    v_mfma_f32_16x16x32_bf16 v[132:135], a[0:3], v[16:19], 0
    ds_read_b128 v[56:59], v12 offset:10240
    s_waitcnt lgkmcnt(9)
    v_mfma_f32_16x16x32_bf16 v[148:151], a[164:167], v[20:23], v[148:151]
    v_mfma_f32_16x16x32_bf16 v[140:143], a[84:87], v[20:23], v[140:143]
    v_mfma_f32_16x16x32_bf16 v[132:135], a[4:7], v[20:23], v[132:135]
    ds_read_b128 v[60:63], v12 offset:11264
    s_waitcnt lgkmcnt(9)
    v_mfma_f32_16x16x32_bf16 v[148:151], a[168:171], v[24:27], v[148:151]
    v_mfma_f32_16x16x32_bf16 v[140:143], a[88:91], v[24:27], v[140:143]
    v_mfma_f32_16x16x32_bf16 v[132:135], a[8:11], v[24:27], v[132:135]
    ds_read_b128 v[64:67], v12 offset:12288
    s_waitcnt lgkmcnt(9)
    v_mfma_f32_16x16x32_bf16 v[148:151], a[172:175], v[28:31], v[148:151]
    v_mfma_f32_16x16x32_bf16 v[140:143], a[92:95], v[28:31], v[140:143]
    v_mfma_f32_16x16x32_bf16 v[132:135], a[12:15], v[28:31], v[132:135]
    ds_read_b128 v[68:71], v12 offset:13312
    s_waitcnt lgkmcnt(9)
    v_mfma_f32_16x16x32_bf16 v[148:151], a[176:179], v[32:35], v[148:151]
    v_mfma_f32_16x16x32_bf16 v[140:143], a[96:99], v[32:35], v[140:143]
    v_mfma_f32_16x16x32_bf16 v[132:135], a[16:19], v[32:35], v[132:135]
    ds_read_b128 v[72:75], v12 offset:14336
    s_waitcnt lgkmcnt(9)
    v_mfma_f32_16x16x32_bf16 v[148:151], a[180:183], v[36:39], v[148:151]
    v_mfma_f32_16x16x32_bf16 v[140:143], a[100:103], v[36:39], v[140:143]
    v_mfma_f32_16x16x32_bf16 v[132:135], a[20:23], v[36:39], v[132:135]
    ds_read_b128 v[76:79], v12 offset:15360
    s_waitcnt lgkmcnt(9)
    v_mfma_f32_16x16x32_bf16 v[148:151], a[184:187], v[40:43], v[148:151]
    v_mfma_f32_16x16x32_bf16 v[140:143], a[104:107], v[40:43], v[140:143]
    v_mfma_f32_16x16x32_bf16 v[132:135], a[24:27], v[40:43], v[132:135]
    ds_read_b128 v[80:83], v12 offset:16384
    s_waitcnt lgkmcnt(9)
    v_mfma_f32_16x16x32_bf16 v[148:151], a[188:191], v[44:47], v[148:151]
    v_mfma_f32_16x16x32_bf16 v[140:143], a[108:111], v[44:47], v[140:143]
    v_mfma_f32_16x16x32_bf16 v[132:135], a[28:31], v[44:47], v[132:135]
    ds_read_b128 v[84:87], v12 offset:17408
    s_waitcnt lgkmcnt(9)
    v_mfma_f32_16x16x32_bf16 v[148:151], a[192:195], v[48:51], v[148:151]
    v_mfma_f32_16x16x32_bf16 v[140:143], a[112:115], v[48:51], v[140:143]
    v_mfma_f32_16x16x32_bf16 v[132:135], a[32:35], v[48:51], v[132:135]
    ds_read_b128 v[88:91], v12 offset:18432
    s_waitcnt lgkmcnt(9)
    v_mfma_f32_16x16x32_bf16 v[148:151], a[196:199], v[52:55], v[148:151]
    v_mfma_f32_16x16x32_bf16 v[140:143], a[116:119], v[52:55], v[140:143]
    v_mfma_f32_16x16x32_bf16 v[132:135], a[36:39], v[52:55], v[132:135]
    ds_read_b128 v[92:95], v12 offset:19456
    s_waitcnt lgkmcnt(9)
    v_mfma_f32_16x16x32_bf16 v[148:151], a[200:203], v[56:59], v[148:151]
    v_mfma_f32_16x16x32_bf16 v[140:143], a[120:123], v[56:59], v[140:143]
    v_mfma_f32_16x16x32_bf16 v[132:135], a[40:43], v[56:59], v[132:135]
    ds_read_b128 v[16:19], v12 offset:20480
    s_waitcnt lgkmcnt(9)
    v_mfma_f32_16x16x32_bf16 v[148:151], a[204:207], v[60:63], v[148:151]
    v_mfma_f32_16x16x32_bf16 v[140:143], a[124:127], v[60:63], v[140:143]
    v_mfma_f32_16x16x32_bf16 v[132:135], a[44:47], v[60:63], v[132:135]
    ds_read_b128 v[20:23], v12 offset:21504
    s_waitcnt lgkmcnt(9)
    v_mfma_f32_16x16x32_bf16 v[148:151], a[208:211], v[64:67], v[148:151]
    v_mfma_f32_16x16x32_bf16 v[140:143], a[128:131], v[64:67], v[140:143]
    v_mfma_f32_16x16x32_bf16 v[132:135], a[48:51], v[64:67], v[132:135]
    ds_read_b128 v[24:27], v12 offset:22528
    s_waitcnt lgkmcnt(9)
    v_mfma_f32_16x16x32_bf16 v[148:151], a[212:215], v[68:71], v[148:151]
    v_mfma_f32_16x16x32_bf16 v[140:143], a[132:135], v[68:71], v[140:143]
    v_mfma_f32_16x16x32_bf16 v[132:135], a[52:55], v[68:71], v[132:135]
    ds_read_b128 v[28:31], v12 offset:23552
    s_waitcnt lgkmcnt(9)
    v_mfma_f32_16x16x32_bf16 v[148:151], a[216:219], v[72:75], v[148:151]
    v_mfma_f32_16x16x32_bf16 v[140:143], a[136:139], v[72:75], v[140:143]
    v_mfma_f32_16x16x32_bf16 v[132:135], a[56:59], v[72:75], v[132:135]
    ds_read_b128 v[32:35], v12 offset:24576
    s_waitcnt lgkmcnt(9)
    v_mfma_f32_16x16x32_bf16 v[148:151], a[220:223], v[76:79], v[148:151]
    v_mfma_f32_16x16x32_bf16 v[140:143], a[140:143], v[76:79], v[140:143]
    v_mfma_f32_16x16x32_bf16 v[132:135], a[60:63], v[76:79], v[132:135]
    ds_read_b128 v[36:39], v12 offset:25600
    s_waitcnt lgkmcnt(9)
    v_mfma_f32_16x16x32_bf16 v[148:151], a[224:227], v[80:83], v[148:151]
    v_mfma_f32_16x16x32_bf16 v[140:143], a[144:147], v[80:83], v[140:143]
    v_mfma_f32_16x16x32_bf16 v[132:135], a[64:67], v[80:83], v[132:135]
    ds_read_b128 v[40:43], v12 offset:26624
    s_waitcnt lgkmcnt(9)
    v_mfma_f32_16x16x32_bf16 v[148:151], a[228:231], v[84:87], v[148:151]
    v_mfma_f32_16x16x32_bf16 v[140:143], a[148:151], v[84:87], v[140:143]
    v_mfma_f32_16x16x32_bf16 v[132:135], a[68:71], v[84:87], v[132:135]
    ds_read_b128 v[44:47], v12 offset:27648
    s_waitcnt lgkmcnt(9)
    v_mfma_f32_16x16x32_bf16 v[148:151], a[232:235], v[88:91], v[148:151]
    v_mfma_f32_16x16x32_bf16 v[140:143], a[152:155], v[88:91], v[140:143]
    v_mfma_f32_16x16x32_bf16 v[132:135], a[72:75], v[88:91], v[132:135]
    ds_read_b128 v[48:51], v12 offset:28672
    s_waitcnt lgkmcnt(9)
    v_mfma_f32_16x16x32_bf16 v[148:151], a[236:239], v[92:95], v[148:151]
    v_mfma_f32_16x16x32_bf16 v[140:143], a[156:159], v[92:95], v[140:143]
    v_mfma_f32_16x16x32_bf16 v[132:135], a[76:79], v[92:95], v[132:135]
    ds_read_b128 v[52:55], v12 offset:29696
    s_waitcnt lgkmcnt(9)
    v_mfma_f32_16x16x32_bf16 v[152:155], a[160:163], v[16:19], 0
    v_mfma_f32_16x16x32_bf16 v[144:147], a[80:83], v[16:19], 0
    v_mfma_f32_16x16x32_bf16 v[136:139], a[0:3], v[16:19], 0
    ds_read_b128 v[56:59], v12 offset:30720
    s_waitcnt lgkmcnt(9)
    v_mfma_f32_16x16x32_bf16 v[152:155], a[164:167], v[20:23], v[152:155]
    v_mfma_f32_16x16x32_bf16 v[144:147], a[84:87], v[20:23], v[144:147]
    v_mfma_f32_16x16x32_bf16 v[136:139], a[4:7], v[20:23], v[136:139]
    ds_read_b128 v[60:63], v12 offset:31744
    s_waitcnt lgkmcnt(9)
    v_mfma_f32_16x16x32_bf16 v[152:155], a[168:171], v[24:27], v[152:155]
    v_mfma_f32_16x16x32_bf16 v[144:147], a[88:91], v[24:27], v[144:147]
    v_mfma_f32_16x16x32_bf16 v[136:139], a[8:11], v[24:27], v[136:139]
    ds_read_b128 v[64:67], v12 offset:32768
    s_waitcnt lgkmcnt(9)
    v_mfma_f32_16x16x32_bf16 v[152:155], a[172:175], v[28:31], v[152:155]
    v_mfma_f32_16x16x32_bf16 v[144:147], a[92:95], v[28:31], v[144:147]
    v_mfma_f32_16x16x32_bf16 v[136:139], a[12:15], v[28:31], v[136:139]
    ds_read_b128 v[68:71], v12 offset:33792
    v_cvt_pk_bf16_f32 v168, v148, v149
    v_cvt_pk_bf16_f32 v169, v150, v151
    s_add_u32 s48, s47, 67108864
    buffer_store_dwordx2 v[168:169], v8, s[4:7], s48 offen sc1
    s_waitcnt lgkmcnt(9)
    v_mfma_f32_16x16x32_bf16 v[152:155], a[176:179], v[32:35], v[152:155]
    v_mfma_f32_16x16x32_bf16 v[144:147], a[96:99], v[32:35], v[144:147]
    v_mfma_f32_16x16x32_bf16 v[136:139], a[16:19], v[32:35], v[136:139]
    ds_read_b128 v[72:75], v12 offset:34816
    v_cvt_pk_bf16_f32 v164, v140, v141
    v_cvt_pk_bf16_f32 v165, v142, v143
    s_waitcnt lgkmcnt(9)
    v_mfma_f32_16x16x32_bf16 v[152:155], a[180:183], v[36:39], v[152:155]
    v_mfma_f32_16x16x32_bf16 v[144:147], a[100:103], v[36:39], v[144:147]
    v_mfma_f32_16x16x32_bf16 v[136:139], a[20:23], v[36:39], v[136:139]
    ds_read_b128 v[76:79], v12 offset:35840
    v_cvt_pk_bf16_f32 v160, v132, v133
    v_cvt_pk_bf16_f32 v161, v134, v135
    s_waitcnt lgkmcnt(9)
    v_mfma_f32_16x16x32_bf16 v[152:155], a[184:187], v[40:43], v[152:155]
    v_mfma_f32_16x16x32_bf16 v[144:147], a[104:107], v[40:43], v[144:147]
    v_mfma_f32_16x16x32_bf16 v[136:139], a[24:27], v[40:43], v[136:139]
    ds_read_b128 v[80:83], v12 offset:36864
    s_waitcnt lgkmcnt(9)
    v_mfma_f32_16x16x32_bf16 v[152:155], a[188:191], v[44:47], v[152:155]
    v_mfma_f32_16x16x32_bf16 v[144:147], a[108:111], v[44:47], v[144:147]
    v_mfma_f32_16x16x32_bf16 v[136:139], a[28:31], v[44:47], v[136:139]
    ds_read_b128 v[84:87], v12 offset:37888
    s_waitcnt lgkmcnt(9)
    v_mfma_f32_16x16x32_bf16 v[152:155], a[192:195], v[48:51], v[152:155]
    v_mfma_f32_16x16x32_bf16 v[144:147], a[112:115], v[48:51], v[144:147]
    v_mfma_f32_16x16x32_bf16 v[136:139], a[32:35], v[48:51], v[136:139]
    ds_read_b128 v[88:91], v12 offset:38912
    s_waitcnt lgkmcnt(9)
    v_mfma_f32_16x16x32_bf16 v[152:155], a[196:199], v[52:55], v[152:155]
    v_mfma_f32_16x16x32_bf16 v[144:147], a[116:119], v[52:55], v[144:147]
    v_mfma_f32_16x16x32_bf16 v[136:139], a[36:39], v[52:55], v[136:139]
    ds_read_b128 v[92:95], v12 offset:39936
    s_waitcnt lgkmcnt(9)
    v_mfma_f32_16x16x32_bf16 v[152:155], a[200:203], v[56:59], v[152:155]
    v_mfma_f32_16x16x32_bf16 v[144:147], a[120:123], v[56:59], v[144:147]
    v_mfma_f32_16x16x32_bf16 v[136:139], a[40:43], v[56:59], v[136:139]
    s_waitcnt lgkmcnt(8)
    v_mfma_f32_16x16x32_bf16 v[152:155], a[204:207], v[60:63], v[152:155]
    v_mfma_f32_16x16x32_bf16 v[144:147], a[124:127], v[60:63], v[144:147]
    v_mfma_f32_16x16x32_bf16 v[136:139], a[44:47], v[60:63], v[136:139]
    s_waitcnt lgkmcnt(7)
    v_mfma_f32_16x16x32_bf16 v[152:155], a[208:211], v[64:67], v[152:155]
    v_mfma_f32_16x16x32_bf16 v[144:147], a[128:131], v[64:67], v[144:147]
    v_mfma_f32_16x16x32_bf16 v[136:139], a[48:51], v[64:67], v[136:139]
    s_waitcnt lgkmcnt(6)
    v_mfma_f32_16x16x32_bf16 v[152:155], a[212:215], v[68:71], v[152:155]
    v_mfma_f32_16x16x32_bf16 v[144:147], a[132:135], v[68:71], v[144:147]
    v_mfma_f32_16x16x32_bf16 v[136:139], a[52:55], v[68:71], v[136:139]
    s_waitcnt lgkmcnt(5)
    v_mfma_f32_16x16x32_bf16 v[152:155], a[216:219], v[72:75], v[152:155]
    v_mfma_f32_16x16x32_bf16 v[144:147], a[136:139], v[72:75], v[144:147]
    v_mfma_f32_16x16x32_bf16 v[136:139], a[56:59], v[72:75], v[136:139]
    s_waitcnt lgkmcnt(4)
    v_mfma_f32_16x16x32_bf16 v[152:155], a[220:223], v[76:79], v[152:155]
    v_mfma_f32_16x16x32_bf16 v[144:147], a[140:143], v[76:79], v[144:147]
    v_mfma_f32_16x16x32_bf16 v[136:139], a[60:63], v[76:79], v[136:139]
    s_waitcnt lgkmcnt(3)
    v_mfma_f32_16x16x32_bf16 v[152:155], a[224:227], v[80:83], v[152:155]
    v_mfma_f32_16x16x32_bf16 v[144:147], a[144:147], v[80:83], v[144:147]
    v_mfma_f32_16x16x32_bf16 v[136:139], a[64:67], v[80:83], v[136:139]
    s_waitcnt lgkmcnt(2)
    v_mfma_f32_16x16x32_bf16 v[152:155], a[228:231], v[84:87], v[152:155]
    v_mfma_f32_16x16x32_bf16 v[144:147], a[148:151], v[84:87], v[144:147]
    v_mfma_f32_16x16x32_bf16 v[136:139], a[68:71], v[84:87], v[136:139]
    s_waitcnt lgkmcnt(1)
    v_mfma_f32_16x16x32_bf16 v[152:155], a[232:235], v[88:91], v[152:155]
    v_mfma_f32_16x16x32_bf16 v[144:147], a[152:155], v[88:91], v[144:147]
    v_mfma_f32_16x16x32_bf16 v[136:139], a[72:75], v[88:91], v[136:139]
    s_waitcnt lgkmcnt(0)
    v_mfma_f32_16x16x32_bf16 v[152:155], a[236:239], v[92:95], v[152:155]
    v_mfma_f32_16x16x32_bf16 v[144:147], a[156:159], v[92:95], v[144:147]
    v_mfma_f32_16x16x32_bf16 v[136:139], a[76:79], v[92:95], v[136:139]
    v_cvt_pk_bf16_f32 v170, v152, v153
    v_cvt_pk_bf16_f32 v171, v154, v155
    s_add_u32 s48, s47, 67115008
    buffer_store_dwordx2 v[170:171], v8, s[4:7], s48 offen sc1
    v_cvt_pk_bf16_f32 v166, v144, v145
    v_cvt_pk_bf16_f32 v167, v146, v147
    s_add_u32 s48, s47, 41943040
    v_permlane16_swap_b32 v164, v166
    v_permlane16_swap_b32 v165, v167
    buffer_store_dwordx4 v[164:167], v190, s[4:7], s48 offen sc1
    v_cvt_pk_bf16_f32 v162, v136, v137
    v_cvt_pk_bf16_f32 v163, v138, v139
    s_add_u32 s48, s47, 16777216
    v_permlane16_swap_b32 v160, v162
    v_permlane16_swap_b32 v161, v163
    buffer_store_dwordx4 v[160:163], v190, s[4:7], s48 offen sc1
    s_mov_b32 s64, 2
    s_branch Lqt_37
Lq0_40:
    s_mov_b32 s64, 0
    s_and_b32 s65, s64, 1
    s_mul_i32 s66, s65, 40960
    v_add_u32 v12, s66, v2
    s_xor_b32 s65, s65, 1
    s_mul_i32 s65, s65, 40960
    s_add_u32 s65, s65, s62
    s_add_u32 s66, s64, 1
    s_min_u32 s66, s66, 63
    s_mul_i32 s66, s66, 40960
    s_add_u32 s66, s66, s62
    s_add_u32 s66, s66, 4194304
    s_and_b32 s47, s64, 7
    s_mul_i32 s47, s47, 393216
    s_lshl_b32 s48, s58, 1
    s_add_u32 s47, s47, s48
    ds_read_b128 v[16:19], v12 offset:0
    ds_read_b128 v[20:23], v12 offset:1024
    ds_read_b128 v[24:27], v12 offset:2048
    ds_read_b128 v[28:31], v12 offset:3072
    ds_read_b128 v[32:35], v12 offset:4096
    ds_read_b128 v[36:39], v12 offset:5120
    ds_read_b128 v[40:43], v12 offset:6144
    ds_read_b128 v[44:47], v12 offset:7168
    ds_read_b128 v[48:51], v12 offset:8192
    ds_read_b128 v[52:55], v12 offset:9216
    s_waitcnt lgkmcnt(9)
    v_mfma_f32_16x16x32_bf16 v[132:135], a[0:3], v[16:19], 0
    ds_read_b128 v[56:59], v12 offset:10240
    s_waitcnt lgkmcnt(9)
    v_mfma_f32_16x16x32_bf16 v[132:135], a[4:7], v[20:23], v[132:135]
    ds_read_b128 v[60:63], v12 offset:11264
    s_waitcnt lgkmcnt(9)
    v_mfma_f32_16x16x32_bf16 v[132:135], a[8:11], v[24:27], v[132:135]
    ds_read_b128 v[64:67], v12 offset:12288
    s_waitcnt lgkmcnt(9)
    v_mfma_f32_16x16x32_bf16 v[132:135], a[12:15], v[28:31], v[132:135]
    ds_read_b128 v[68:71], v12 offset:13312
    s_waitcnt lgkmcnt(9)
    v_mfma_f32_16x16x32_bf16 v[132:135], a[16:19], v[32:35], v[132:135]
    ds_read_b128 v[72:75], v12 offset:14336
    s_waitcnt lgkmcnt(9)
    v_mfma_f32_16x16x32_bf16 v[132:135], a[20:23], v[36:39], v[132:135]
    ds_read_b128 v[76:79], v12 offset:15360
    s_waitcnt lgkmcnt(9)
    v_mfma_f32_16x16x32_bf16 v[132:135], a[24:27], v[40:43], v[132:135]
    ds_read_b128 v[80:83], v12 offset:16384
    s_waitcnt lgkmcnt(9)
    v_mfma_f32_16x16x32_bf16 v[132:135], a[28:31], v[44:47], v[132:135]
    ds_read_b128 v[84:87], v12 offset:17408
    s_waitcnt lgkmcnt(9)
    v_mfma_f32_16x16x32_bf16 v[132:135], a[32:35], v[48:51], v[132:135]
    ds_read_b128 v[88:91], v12 offset:18432
    s_waitcnt lgkmcnt(9)
    v_mfma_f32_16x16x32_bf16 v[132:135], a[36:39], v[52:55], v[132:135]
    ds_read_b128 v[92:95], v12 offset:19456
    s_waitcnt lgkmcnt(9)
    v_mfma_f32_16x16x32_bf16 v[132:135], a[40:43], v[56:59], v[132:135]
    ds_read_b128 v[16:19], v12 offset:20480
    s_waitcnt lgkmcnt(9)
    v_mfma_f32_16x16x32_bf16 v[132:135], a[44:47], v[60:63], v[132:135]
    ds_read_b128 v[20:23], v12 offset:21504
    s_waitcnt lgkmcnt(9)
    v_mfma_f32_16x16x32_bf16 v[132:135], a[48:51], v[64:67], v[132:135]
    ds_read_b128 v[24:27], v12 offset:22528
    s_waitcnt lgkmcnt(9)
    v_mfma_f32_16x16x32_bf16 v[132:135], a[52:55], v[68:71], v[132:135]
    ds_read_b128 v[28:31], v12 offset:23552
    s_waitcnt lgkmcnt(9)
    v_mfma_f32_16x16x32_bf16 v[132:135], a[56:59], v[72:75], v[132:135]
    ds_read_b128 v[32:35], v12 offset:24576
    s_waitcnt lgkmcnt(9)
    v_mfma_f32_16x16x32_bf16 v[132:135], a[60:63], v[76:79], v[132:135]
    ds_read_b128 v[36:39], v12 offset:25600
    s_waitcnt lgkmcnt(9)
    v_mfma_f32_16x16x32_bf16 v[132:135], a[64:67], v[80:83], v[132:135]
    ds_read_b128 v[40:43], v12 offset:26624
    s_waitcnt lgkmcnt(9)
    v_mfma_f32_16x16x32_bf16 v[132:135], a[68:71], v[84:87], v[132:135]
    ds_read_b128 v[44:47], v12 offset:27648
    s_waitcnt lgkmcnt(9)
    v_mfma_f32_16x16x32_bf16 v[132:135], a[72:75], v[88:91], v[132:135]
    ds_read_b128 v[48:51], v12 offset:28672
    s_waitcnt lgkmcnt(9)
    v_mfma_f32_16x16x32_bf16 v[132:135], a[76:79], v[92:95], v[132:135]
    ds_read_b128 v[52:55], v12 offset:29696
    s_waitcnt lgkmcnt(9)
    v_mfma_f32_16x16x32_bf16 v[136:139], a[0:3], v[16:19], 0
    ds_read_b128 v[56:59], v12 offset:30720
    s_waitcnt lgkmcnt(9)
    v_mfma_f32_16x16x32_bf16 v[136:139], a[4:7], v[20:23], v[136:139]
    ds_read_b128 v[60:63], v12 offset:31744
    s_waitcnt lgkmcnt(9)
    v_mfma_f32_16x16x32_bf16 v[136:139], a[8:11], v[24:27], v[136:139]
    ds_read_b128 v[64:67], v12 offset:32768
    s_waitcnt lgkmcnt(9)
    v_mfma_f32_16x16x32_bf16 v[136:139], a[12:15], v[28:31], v[136:139]
    ds_read_b128 v[68:71], v12 offset:33792
    s_waitcnt lgkmcnt(9)
    v_mfma_f32_16x16x32_bf16 v[136:139], a[16:19], v[32:35], v[136:139]
    ds_read_b128 v[72:75], v12 offset:34816
    s_waitcnt lgkmcnt(9)
    v_mfma_f32_16x16x32_bf16 v[136:139], a[20:23], v[36:39], v[136:139]
    ds_read_b128 v[76:79], v12 offset:35840
    s_waitcnt lgkmcnt(9)
    v_mfma_f32_16x16x32_bf16 v[136:139], a[24:27], v[40:43], v[136:139]
    ds_read_b128 v[80:83], v12 offset:36864
    s_waitcnt lgkmcnt(9)
    v_mfma_f32_16x16x32_bf16 v[136:139], a[28:31], v[44:47], v[136:139]
    ds_read_b128 v[84:87], v12 offset:37888
    s_waitcnt lgkmcnt(9)
    v_mfma_f32_16x16x32_bf16 v[136:139], a[32:35], v[48:51], v[136:139]
    ds_read_b128 v[88:91], v12 offset:38912
    v_cvt_pk_bf16_f32 v160, v132, v133
    v_cvt_pk_bf16_f32 v161, v134, v135
    s_waitcnt lgkmcnt(9)
    v_mfma_f32_16x16x32_bf16 v[136:139], a[36:39], v[52:55], v[136:139]
    ds_read_b128 v[92:95], v12 offset:39936
    s_waitcnt lgkmcnt(9)
    v_mfma_f32_16x16x32_bf16 v[136:139], a[40:43], v[56:59], v[136:139]
    s_waitcnt lgkmcnt(8)
    v_mfma_f32_16x16x32_bf16 v[136:139], a[44:47], v[60:63], v[136:139]
    s_waitcnt lgkmcnt(7)
    v_mfma_f32_16x16x32_bf16 v[136:139], a[48:51], v[64:67], v[136:139]
    s_waitcnt lgkmcnt(6)
    v_mfma_f32_16x16x32_bf16 v[136:139], a[52:55], v[68:71], v[136:139]
    s_waitcnt lgkmcnt(5)
    v_mfma_f32_16x16x32_bf16 v[136:139], a[56:59], v[72:75], v[136:139]
    s_waitcnt lgkmcnt(4)
    v_mfma_f32_16x16x32_bf16 v[136:139], a[60:63], v[76:79], v[136:139]
    s_waitcnt lgkmcnt(3)
    v_mfma_f32_16x16x32_bf16 v[136:139], a[64:67], v[80:83], v[136:139]
    s_waitcnt lgkmcnt(2)
    v_mfma_f32_16x16x32_bf16 v[136:139], a[68:71], v[84:87], v[136:139]
    s_waitcnt lgkmcnt(1)
    v_mfma_f32_16x16x32_bf16 v[136:139], a[72:75], v[88:91], v[136:139]
    s_waitcnt lgkmcnt(0)
    v_mfma_f32_16x16x32_bf16 v[136:139], a[76:79], v[92:95], v[136:139]
    s_nop 7
    v_cvt_pk_bf16_f32 v162, v136, v137
    v_cvt_pk_bf16_f32 v163, v138, v139
    s_add_u32 s48, s47, 16777216
    v_permlane16_swap_b32 v160, v162
    v_permlane16_swap_b32 v161, v163
    buffer_store_dwordx4 v[160:163], v190, s[4:7], s48 offen sc1
    s_barrier
    s_add_u32 s63, s62, 4276224
    s_add_u32 m0, s62, 0
    s_nop 0
    buffer_load_dwordx4 v2, s[4:7], s63 offen lds
    s_add_u32 s63, s63, 1024
    s_add_u32 m0, s62, 1024
    s_nop 0
    buffer_load_dwordx4 v2, s[4:7], s63 offen lds
    s_add_u32 s63, s63, 1024
    s_add_u32 m0, s62, 2048
    s_nop 0
    buffer_load_dwordx4 v2, s[4:7], s63 offen lds
    s_add_u32 s63, s63, 1024
    s_add_u32 m0, s62, 3072
    s_nop 0
    buffer_load_dwordx4 v2, s[4:7], s63 offen lds
    s_add_u32 s63, s63, 1024
    s_add_u32 m0, s62, 4096
    s_nop 0
    buffer_load_dwordx4 v2, s[4:7], s63 offen lds
    s_add_u32 s63, s63, 1024
    s_add_u32 m0, s62, 5120
    s_nop 0
    buffer_load_dwordx4 v2, s[4:7], s63 offen lds
    s_add_u32 s63, s63, 1024
    s_add_u32 m0, s62, 6144
    s_nop 0
    buffer_load_dwordx4 v2, s[4:7], s63 offen lds
    s_add_u32 s63, s63, 1024
    s_add_u32 m0, s62, 7168
    s_nop 0
    buffer_load_dwordx4 v2, s[4:7], s63 offen lds
    s_add_u32 s63, s63, 1024
    s_add_u32 m0, s62, 8192
    s_nop 0
    buffer_load_dwordx4 v2, s[4:7], s63 offen lds
    s_add_u32 s63, s63, 1024
    s_add_u32 m0, s62, 9216
    s_nop 0
    buffer_load_dwordx4 v2, s[4:7], s63 offen lds
    s_add_u32 s63, s63, 1024
    s_mov_b32 s64, 2
    s_waitcnt vmcnt(0)
    s_barrier
    s_branch Lqr_41
Lqt_37:
    s_and_b32 s38, s30, 3
    s_xor_b32 s39, s38, 2
    s_mul_i32 s40, s38, 81920
    s_add_u32 s40, s40, s59
    s_mul_i32 s41, s38, 196608
    s_add_u32 s41, s41, s58
    s_add_u32 s41, s41, 589824
    s_mul_i32 s42, s39, 196608
    s_add_u32 s42, s42, s58
    s_add_u32 s42, s42, 589824
    s_and_b32 s44, s30, 7
    s_mul_i32 s43, s44, 196608
    s_add_u32 s43, s43, s58
    s_add_u32 s43, s43, 117440512
    s_mul_i32 s44, s44, 98304
    s_add_u32 s44, s44, s60
    s_add_u32 s44, s44, 130023424
    s_mul_i32 s45, s38, 98304
    s_add_u32 s45, s45, s60
    s_add_u32 s45, s45, 1376256
    s_mul_i32 s46, s39, 98304
    s_add_u32 s46, s46, s60
    s_add_u32 s46, s46, 1376256
    s_sub_u32 s51, s64, 1
    s_lshl_b32 s51, s51, 5
    s_add_u32 s51, s51, s26
    s_lshl_b32 s51, s51, 6
    s_add_u32 s51, s51, 4096
    s_cmp_eq_u32 s22, 1
    s_cbranch_scc1 Lmw_45
    s_cmp_eq_u32 s22, 2
    s_cbranch_scc1 Lmw_46
    s_cmp_eq_u32 s22, 3
    s_cbranch_scc1 Lmw_47
Lmw_44:
    s_mov_b32 s31, 262144
    buffer_load_dwordx4 v[108:111], v3, s[4:7], s40 offen offset:0 sc1
    buffer_load_dwordx4 v[112:115], v3, s[4:7], s40 offen offset:1024 sc1
    buffer_load_dwordx4 v[116:119], v3, s[4:7], s40 offen offset:2048 sc1
Lp_49:
    buffer_load_dwordx4 v[120:123], v3, s[4:7], s40 offen offset:0 sc1
    buffer_load_dwordx4 v[124:127], v3, s[4:7], s40 offen offset:1024 sc1
    buffer_load_dwordx4 v[128:131], v3, s[4:7], s40 offen offset:2048 sc1
    s_waitcnt vmcnt(3)
    ds_write_b128 v5, v[108:111] offset:0
    ds_write_b128 v5, v[112:115] offset:1024
    ds_write_b128 v5, v[116:119] offset:2048
    v_max3_u32 v160, v108, v112, v116
    v_cmp_eq_u32 vcc, -1, v160
    s_cbranch_vccz LdA_50
    buffer_load_dwordx4 v[108:111], v3, s[4:7], s40 offen offset:0 sc1
    buffer_load_dwordx4 v[112:115], v3, s[4:7], s40 offen offset:1024 sc1
    buffer_load_dwordx4 v[116:119], v3, s[4:7], s40 offen offset:2048 sc1
    s_waitcnt vmcnt(3)
    ds_write_b128 v5, v[120:123] offset:0
    ds_write_b128 v5, v[124:127] offset:1024
    ds_write_b128 v5, v[128:131] offset:2048
    v_max3_u32 v160, v120, v124, v128
    v_cmp_eq_u32 vcc, -1, v160
    s_cbranch_vccz LdB_51
    s_sub_u32 s31, s31, 1
    s_cbranch_scc0 Lp_49
    s_mov_b32 s31, 1
    s_branch L_fail
LdB_51:
    v_smfmac_f32_16x16x64_bf16 v[96:99], v[120:123], a[0:7], v184
    v_smfmac_f32_16x16x64_bf16 v[100:103], v[120:123], a[80:87], v184
    s_waitcnt lgkmcnt(0)
    s_barrier
    ds_read_b128 v[16:19], v7 offset:3072
    ds_read_b128 v[20:23], v7 offset:4096
    v_smfmac_f32_16x16x64_bf16 v[96:99], v[124:127], a[8:15], v184
    ds_read_b128 v[24:27], v7 offset:5120
    v_smfmac_f32_16x16x64_bf16 v[100:103], v[124:127], a[88:95], v184
    ds_read_b128 v[28:31], v7 offset:6144
    v_smfmac_f32_16x16x64_bf16 v[96:99], v[128:131], a[16:23], v184
    ds_read_b128 v[32:35], v7 offset:7168
    v_smfmac_f32_16x16x64_bf16 v[100:103], v[128:131], a[96:103], v184
    ds_read_b128 v[36:39], v7 offset:8192
    v_smfmac_f32_16x16x64_bf16 v[104:107], v[120:123], a[160:167], v184
    ds_read_b128 v[40:43], v7 offset:9216
    v_smfmac_f32_16x16x64_bf16 v[104:107], v[124:127], a[168:175], v184
    v_smfmac_f32_16x16x64_bf16 v[104:107], v[128:131], a[176:183], v184
    s_branch Ldd_52
LdA_50:
    v_smfmac_f32_16x16x64_bf16 v[96:99], v[108:111], a[0:7], v184
    v_smfmac_f32_16x16x64_bf16 v[100:103], v[108:111], a[80:87], v184
    s_waitcnt lgkmcnt(0)
    s_barrier
    ds_read_b128 v[16:19], v7 offset:3072
    ds_read_b128 v[20:23], v7 offset:4096
    v_smfmac_f32_16x16x64_bf16 v[96:99], v[112:115], a[8:15], v184
    ds_read_b128 v[24:27], v7 offset:5120
    v_smfmac_f32_16x16x64_bf16 v[100:103], v[112:115], a[88:95], v184
    ds_read_b128 v[28:31], v7 offset:6144
    v_smfmac_f32_16x16x64_bf16 v[96:99], v[116:119], a[16:23], v184
    ds_read_b128 v[32:35], v7 offset:7168
    v_smfmac_f32_16x16x64_bf16 v[100:103], v[116:119], a[96:103], v184
    ds_read_b128 v[36:39], v7 offset:8192
    v_smfmac_f32_16x16x64_bf16 v[104:107], v[108:111], a[160:167], v184
    ds_read_b128 v[40:43], v7 offset:9216
    v_smfmac_f32_16x16x64_bf16 v[104:107], v[112:115], a[168:175], v184
    v_smfmac_f32_16x16x64_bf16 v[104:107], v[116:119], a[176:183], v184
Ldd_52:
    s_mov_b64 vcc, s[34:35]
    s_waitcnt lgkmcnt(6)
    v_smfmac_f32_16x16x64_bf16 v[96:99], v[16:19], a[24:31], v184
    v_smfmac_f32_16x16x64_bf16 v[100:103], v[16:19], a[104:111], v184
    s_waitcnt lgkmcnt(5)
    v_smfmac_f32_16x16x64_bf16 v[96:99], v[20:23], a[32:39], v184
    v_smfmac_f32_16x16x64_bf16 v[100:103], v[20:23], a[112:119], v184
    s_waitcnt lgkmcnt(4)
    v_smfmac_f32_16x16x64_bf16 v[96:99], v[24:27], a[40:47], v184
    v_smfmac_f32_16x16x64_bf16 v[100:103], v[24:27], a[120:127], v184
    s_waitcnt lgkmcnt(3)
    v_smfmac_f32_16x16x64_bf16 v[96:99], v[28:31], a[48:55], v184
    v_smfmac_f32_16x16x64_bf16 v[100:103], v[28:31], a[128:135], v184
    s_waitcnt lgkmcnt(2)
    v_smfmac_f32_16x16x64_bf16 v[96:99], v[32:35], a[56:63], v184
    v_smfmac_f32_16x16x64_bf16 v[100:103], v[32:35], a[136:143], v184
    s_waitcnt lgkmcnt(1)
    v_smfmac_f32_16x16x64_bf16 v[96:99], v[36:39], a[64:71], v184
    s_waitcnt lgkmcnt(0)
    v_smfmac_f32_16x16x64_bf16 v[96:99], v[40:43], a[72:79], v184
    v_smfmac_f32_16x16x64_bf16 v[100:103], v[36:39], a[144:151], v184
    buffer_store_dword v253, v254, s[4:7], s51 offen sc1
    v_smfmac_f32_16x16x64_bf16 v[100:103], v[40:43], a[152:159], v184
    v_add_f32 v96, v96, v98
    v_add_f32 v97, v97, v99
    v_cvt_pk_bf16_f32 v160, v96, v97
    v_mov_b32 v98, 0
    s_nop 0
    v_mov_b32_dpp v162, v160 quad_perm:[1,0,3,2] row_mask:0xf bank_mask:0xf
    v_perm_b32 v160, v162, v160, v185
    s_nop 0
    v_add_f32 v100, v100, v102
    v_add_f32 v101, v101, v103
    v_cvt_pk_bf16_f32 v161, v100, v101
    v_smfmac_f32_16x16x64_bf16 v[104:107], v[16:19], a[184:191], v184
    s_nop 0
    v_mov_b32_dpp v163, v161 quad_perm:[1,0,3,2] row_mask:0xf bank_mask:0xf
    v_perm_b32 v161, v163, v161, v185
    v_smfmac_f32_16x16x64_bf16 v[104:107], v[20:23], a[192:199], v184
    s_nop 0
    v_cndmask_b32_dpp v176, v161, v160, vcc quad_perm:[2,3,0,1] row_mask:0xf bank_mask:0xf
    s_mov_b64 vcc, s[36:37]
    v_cndmask_b32_dpp v177, v160, v161, vcc quad_perm:[2,3,0,1] row_mask:0xf bank_mask:0xf
    buffer_store_dwordx2 v[176:177], v187, s[4:7], s41 offen sc1
    v_smfmac_f32_16x16x64_bf16 v[104:107], v[24:27], a[200:207], v184
    v_mov_b32 v96, 0
    v_smfmac_f32_16x16x64_bf16 v[104:107], v[28:31], a[208:215], v184
    v_smfmac_f32_16x16x64_bf16 v[104:107], v[32:35], a[216:223], v184
    v_smfmac_f32_16x16x64_bf16 v[104:107], v[36:39], a[224:231], v184
    v_smfmac_f32_16x16x64_bf16 v[104:107], v[40:43], a[232:239], v184
    v_mov_b32 v97, 0
    v_mov_b32 v98, 0
    v_mov_b32 v99, 0
    v_mov_b32 v100, 0
    v_mov_b32 v101, 0
    v_mov_b32 v102, 0
    v_mov_b32 v103, 0
    s_nop 0
    v_add_f32 v104, v104, v106
    v_add_f32 v105, v105, v107
    v_cvt_pk_bf16_f32 v160, v104, v105
    v_mov_b32 v106, 0
    v_mov_b32 v107, 0
    v_mov_b32_dpp v162, v160 quad_perm:[1,0,3,2] row_mask:0xf bank_mask:0xf
    v_perm_b32 v178, v162, v160, v185
    v_mov_b32 v104, 0
    v_mov_b32 v105, 0
    v_mov_b32_dpp v179, v178 quad_perm:[2,3,0,1] row_mask:0xf bank_mask:0xf
    buffer_store_dwordx2 v[178:179], v9, s[4:7], s45 offen sc1
    s_branch Lmj_48
Lmw_45:
    s_mov_b32 s31, 262144
    buffer_load_dwordx4 v[108:111], v3, s[4:7], s40 offen offset:0 sc1
    buffer_load_dwordx4 v[112:115], v3, s[4:7], s40 offen offset:1024 sc1
    buffer_load_dwordx4 v[116:119], v3, s[4:7], s40 offen offset:2048 sc1
Lp_53:
    buffer_load_dwordx4 v[120:123], v3, s[4:7], s40 offen offset:0 sc1
    buffer_load_dwordx4 v[124:127], v3, s[4:7], s40 offen offset:1024 sc1
    buffer_load_dwordx4 v[128:131], v3, s[4:7], s40 offen offset:2048 sc1
    s_waitcnt vmcnt(3)
    ds_write_b128 v5, v[108:111] offset:0
    ds_write_b128 v5, v[112:115] offset:1024
    ds_write_b128 v5, v[116:119] offset:2048
    v_max3_u32 v160, v108, v112, v116
    v_cmp_eq_u32 vcc, -1, v160
    s_cbranch_vccz LdA_54
    buffer_load_dwordx4 v[108:111], v3, s[4:7], s40 offen offset:0 sc1
    buffer_load_dwordx4 v[112:115], v3, s[4:7], s40 offen offset:1024 sc1
    buffer_load_dwordx4 v[116:119], v3, s[4:7], s40 offen offset:2048 sc1
    s_waitcnt vmcnt(3)
    ds_write_b128 v5, v[120:123] offset:0
    ds_write_b128 v5, v[124:127] offset:1024
    ds_write_b128 v5, v[128:131] offset:2048
    v_max3_u32 v160, v120, v124, v128
    v_cmp_eq_u32 vcc, -1, v160
    s_cbranch_vccz LdB_55
    s_sub_u32 s31, s31, 1
    s_cbranch_scc0 Lp_53
    s_mov_b32 s31, 1
    s_branch L_fail
LdB_55:
    v_smfmac_f32_16x16x64_bf16 v[96:99], v[120:123], a[24:31], v184
    v_smfmac_f32_16x16x64_bf16 v[100:103], v[120:123], a[104:111], v184
    s_waitcnt lgkmcnt(0)
    s_barrier
    ds_read_b128 v[16:19], v7 offset:0
    ds_read_b128 v[20:23], v7 offset:1024
    v_smfmac_f32_16x16x64_bf16 v[96:99], v[124:127], a[32:39], v184
    ds_read_b128 v[24:27], v7 offset:2048
    v_smfmac_f32_16x16x64_bf16 v[100:103], v[124:127], a[112:119], v184
    ds_read_b128 v[28:31], v7 offset:6144
    v_smfmac_f32_16x16x64_bf16 v[96:99], v[128:131], a[40:47], v184
    ds_read_b128 v[32:35], v7 offset:7168
    v_smfmac_f32_16x16x64_bf16 v[100:103], v[128:131], a[120:127], v184
    ds_read_b128 v[36:39], v7 offset:8192
    v_smfmac_f32_16x16x64_bf16 v[104:107], v[120:123], a[184:191], v184
    ds_read_b128 v[40:43], v7 offset:9216
    v_smfmac_f32_16x16x64_bf16 v[104:107], v[124:127], a[192:199], v184
    v_smfmac_f32_16x16x64_bf16 v[104:107], v[128:131], a[200:207], v184
    s_branch Ldd_56
LdA_54:
    v_smfmac_f32_16x16x64_bf16 v[96:99], v[108:111], a[24:31], v184
    v_smfmac_f32_16x16x64_bf16 v[100:103], v[108:111], a[104:111], v184
    s_waitcnt lgkmcnt(0)
    s_barrier
    ds_read_b128 v[16:19], v7 offset:0
    ds_read_b128 v[20:23], v7 offset:1024
    v_smfmac_f32_16x16x64_bf16 v[96:99], v[112:115], a[32:39], v184
    ds_read_b128 v[24:27], v7 offset:2048
    v_smfmac_f32_16x16x64_bf16 v[100:103], v[112:115], a[112:119], v184
    ds_read_b128 v[28:31], v7 offset:6144
    v_smfmac_f32_16x16x64_bf16 v[96:99], v[116:119], a[40:47], v184
    ds_read_b128 v[32:35], v7 offset:7168
    v_smfmac_f32_16x16x64_bf16 v[100:103], v[116:119], a[120:127], v184
    ds_read_b128 v[36:39], v7 offset:8192
    v_smfmac_f32_16x16x64_bf16 v[104:107], v[108:111], a[184:191], v184
    ds_read_b128 v[40:43], v7 offset:9216
    v_smfmac_f32_16x16x64_bf16 v[104:107], v[112:115], a[192:199], v184
    v_smfmac_f32_16x16x64_bf16 v[104:107], v[116:119], a[200:207], v184
Ldd_56:
    s_mov_b64 vcc, s[34:35]
    s_waitcnt lgkmcnt(6)
    v_smfmac_f32_16x16x64_bf16 v[96:99], v[16:19], a[0:7], v184
    v_smfmac_f32_16x16x64_bf16 v[100:103], v[16:19], a[80:87], v184
    s_waitcnt lgkmcnt(5)
    v_smfmac_f32_16x16x64_bf16 v[96:99], v[20:23], a[8:15], v184
    v_smfmac_f32_16x16x64_bf16 v[100:103], v[20:23], a[88:95], v184
    s_waitcnt lgkmcnt(4)
    v_smfmac_f32_16x16x64_bf16 v[96:99], v[24:27], a[16:23], v184
    v_smfmac_f32_16x16x64_bf16 v[100:103], v[24:27], a[96:103], v184
    s_waitcnt lgkmcnt(3)
    v_smfmac_f32_16x16x64_bf16 v[96:99], v[28:31], a[48:55], v184
    v_smfmac_f32_16x16x64_bf16 v[100:103], v[28:31], a[128:135], v184
    s_waitcnt lgkmcnt(2)
    v_smfmac_f32_16x16x64_bf16 v[96:99], v[32:35], a[56:63], v184
    v_smfmac_f32_16x16x64_bf16 v[100:103], v[32:35], a[136:143], v184
    s_waitcnt lgkmcnt(1)
    v_smfmac_f32_16x16x64_bf16 v[96:99], v[36:39], a[64:71], v184
    s_waitcnt lgkmcnt(0)
    v_smfmac_f32_16x16x64_bf16 v[96:99], v[40:43], a[72:79], v184
    v_smfmac_f32_16x16x64_bf16 v[100:103], v[36:39], a[144:151], v184
    buffer_store_dword v253, v254, s[4:7], s51 offen sc1
    v_smfmac_f32_16x16x64_bf16 v[100:103], v[40:43], a[152:159], v184
    v_add_f32 v96, v96, v98
    v_add_f32 v97, v97, v99
    v_cvt_pk_bf16_f32 v160, v96, v97
    v_mov_b32 v98, 0
    s_nop 0
    v_mov_b32_dpp v162, v160 quad_perm:[1,0,3,2] row_mask:0xf bank_mask:0xf
    v_perm_b32 v160, v162, v160, v185
    s_nop 0
    v_add_f32 v100, v100, v102
    v_add_f32 v101, v101, v103
    v_cvt_pk_bf16_f32 v161, v100, v101
    v_smfmac_f32_16x16x64_bf16 v[104:107], v[16:19], a[160:167], v184
    s_nop 0
    v_mov_b32_dpp v163, v161 quad_perm:[1,0,3,2] row_mask:0xf bank_mask:0xf
    v_perm_b32 v161, v163, v161, v185
    v_smfmac_f32_16x16x64_bf16 v[104:107], v[20:23], a[168:175], v184
    s_nop 0
    v_cndmask_b32_dpp v176, v161, v160, vcc quad_perm:[2,3,0,1] row_mask:0xf bank_mask:0xf
    s_mov_b64 vcc, s[36:37]
    v_cndmask_b32_dpp v177, v160, v161, vcc quad_perm:[2,3,0,1] row_mask:0xf bank_mask:0xf
    buffer_store_dwordx2 v[176:177], v187, s[4:7], s41 offen sc1
    v_smfmac_f32_16x16x64_bf16 v[104:107], v[24:27], a[176:183], v184
    v_mov_b32 v96, 0
    v_smfmac_f32_16x16x64_bf16 v[104:107], v[28:31], a[208:215], v184
    v_smfmac_f32_16x16x64_bf16 v[104:107], v[32:35], a[216:223], v184
    v_smfmac_f32_16x16x64_bf16 v[104:107], v[36:39], a[224:231], v184
    v_smfmac_f32_16x16x64_bf16 v[104:107], v[40:43], a[232:239], v184
    v_mov_b32 v97, 0
    v_mov_b32 v98, 0
    v_mov_b32 v99, 0
    v_mov_b32 v100, 0
    v_mov_b32 v101, 0
    v_mov_b32 v102, 0
    v_mov_b32 v103, 0
    s_nop 0
    v_add_f32 v104, v104, v106
    v_add_f32 v105, v105, v107
    v_cvt_pk_bf16_f32 v160, v104, v105
    v_mov_b32 v106, 0
    v_mov_b32 v107, 0
    v_mov_b32_dpp v162, v160 quad_perm:[1,0,3,2] row_mask:0xf bank_mask:0xf
    v_perm_b32 v178, v162, v160, v185
    v_mov_b32 v104, 0
    v_mov_b32 v105, 0
    v_mov_b32_dpp v179, v178 quad_perm:[2,3,0,1] row_mask:0xf bank_mask:0xf
    buffer_store_dwordx2 v[178:179], v9, s[4:7], s45 offen sc1
    s_branch Lmj_48
Lmw_46:
    s_mov_b32 s31, 262144
    buffer_load_dwordx4 v[108:111], v3, s[4:7], s40 offen offset:0 sc1
    buffer_load_dwordx4 v[112:115], v3, s[4:7], s40 offen offset:1024 sc1
    buffer_load_dwordx4 v[116:119], v3, s[4:7], s40 offen offset:2048 sc1
Lp_57:
    buffer_load_dwordx4 v[120:123], v3, s[4:7], s40 offen offset:0 sc1
    buffer_load_dwordx4 v[124:127], v3, s[4:7], s40 offen offset:1024 sc1
    buffer_load_dwordx4 v[128:131], v3, s[4:7], s40 offen offset:2048 sc1
    s_waitcnt vmcnt(3)
    ds_write_b128 v5, v[108:111] offset:0
    ds_write_b128 v5, v[112:115] offset:1024
    ds_write_b128 v5, v[116:119] offset:2048
    v_max3_u32 v160, v108, v112, v116
    v_cmp_eq_u32 vcc, -1, v160
    s_cbranch_vccz LdA_58
    buffer_load_dwordx4 v[108:111], v3, s[4:7], s40 offen offset:0 sc1
    buffer_load_dwordx4 v[112:115], v3, s[4:7], s40 offen offset:1024 sc1
    buffer_load_dwordx4 v[116:119], v3, s[4:7], s40 offen offset:2048 sc1
    s_waitcnt vmcnt(3)
    ds_write_b128 v5, v[120:123] offset:0
    ds_write_b128 v5, v[124:127] offset:1024
    ds_write_b128 v5, v[128:131] offset:2048
    v_max3_u32 v160, v120, v124, v128
    v_cmp_eq_u32 vcc, -1, v160
    s_cbranch_vccz LdB_59
    s_sub_u32 s31, s31, 1
    s_cbranch_scc0 Lp_57
    s_mov_b32 s31, 1
    s_branch L_fail
LdB_59:
    v_smfmac_f32_16x16x64_bf16 v[96:99], v[120:123], a[48:55], v184
    v_smfmac_f32_16x16x64_bf16 v[100:103], v[120:123], a[128:135], v184
    s_waitcnt lgkmcnt(0)
    s_barrier
    ds_read_b128 v[16:19], v7 offset:0
    ds_read_b128 v[20:23], v7 offset:1024
    v_smfmac_f32_16x16x64_bf16 v[96:99], v[124:127], a[56:63], v184
    ds_read_b128 v[24:27], v7 offset:2048
    v_smfmac_f32_16x16x64_bf16 v[100:103], v[124:127], a[136:143], v184
    ds_read_b128 v[28:31], v7 offset:3072
    v_smfmac_f32_16x16x64_bf16 v[96:99], v[128:131], a[64:71], v184
    ds_read_b128 v[32:35], v7 offset:4096
    v_smfmac_f32_16x16x64_bf16 v[100:103], v[128:131], a[144:151], v184
    ds_read_b128 v[36:39], v7 offset:5120
    v_smfmac_f32_16x16x64_bf16 v[104:107], v[120:123], a[208:215], v184
    ds_read_b128 v[40:43], v7 offset:9216
    v_smfmac_f32_16x16x64_bf16 v[104:107], v[124:127], a[216:223], v184
    v_smfmac_f32_16x16x64_bf16 v[104:107], v[128:131], a[224:231], v184
    s_branch Ldd_60
LdA_58:
    v_smfmac_f32_16x16x64_bf16 v[96:99], v[108:111], a[48:55], v184
    v_smfmac_f32_16x16x64_bf16 v[100:103], v[108:111], a[128:135], v184
    s_waitcnt lgkmcnt(0)
    s_barrier
    ds_read_b128 v[16:19], v7 offset:0
    ds_read_b128 v[20:23], v7 offset:1024
    v_smfmac_f32_16x16x64_bf16 v[96:99], v[112:115], a[56:63], v184
    ds_read_b128 v[24:27], v7 offset:2048
    v_smfmac_f32_16x16x64_bf16 v[100:103], v[112:115], a[136:143], v184
    ds_read_b128 v[28:31], v7 offset:3072
    v_smfmac_f32_16x16x64_bf16 v[96:99], v[116:119], a[64:71], v184
    ds_read_b128 v[32:35], v7 offset:4096
    v_smfmac_f32_16x16x64_bf16 v[100:103], v[116:119], a[144:151], v184
    ds_read_b128 v[36:39], v7 offset:5120
    v_smfmac_f32_16x16x64_bf16 v[104:107], v[108:111], a[208:215], v184
    ds_read_b128 v[40:43], v7 offset:9216
    v_smfmac_f32_16x16x64_bf16 v[104:107], v[112:115], a[216:223], v184
    v_smfmac_f32_16x16x64_bf16 v[104:107], v[116:119], a[224:231], v184
Ldd_60:
    s_mov_b64 vcc, s[34:35]
    s_waitcnt lgkmcnt(6)
    v_smfmac_f32_16x16x64_bf16 v[96:99], v[16:19], a[0:7], v184
    v_smfmac_f32_16x16x64_bf16 v[100:103], v[16:19], a[80:87], v184
    s_waitcnt lgkmcnt(5)
    v_smfmac_f32_16x16x64_bf16 v[96:99], v[20:23], a[8:15], v184
    v_smfmac_f32_16x16x64_bf16 v[100:103], v[20:23], a[88:95], v184
    s_waitcnt lgkmcnt(4)
    v_smfmac_f32_16x16x64_bf16 v[96:99], v[24:27], a[16:23], v184
    v_smfmac_f32_16x16x64_bf16 v[100:103], v[24:27], a[96:103], v184
    s_waitcnt lgkmcnt(3)
    v_smfmac_f32_16x16x64_bf16 v[96:99], v[28:31], a[24:31], v184
    v_smfmac_f32_16x16x64_bf16 v[100:103], v[28:31], a[104:111], v184
    s_waitcnt lgkmcnt(2)
    v_smfmac_f32_16x16x64_bf16 v[96:99], v[32:35], a[32:39], v184
    v_smfmac_f32_16x16x64_bf16 v[100:103], v[32:35], a[112:119], v184
    s_waitcnt lgkmcnt(1)
    v_smfmac_f32_16x16x64_bf16 v[96:99], v[36:39], a[40:47], v184
    s_waitcnt lgkmcnt(0)
    v_smfmac_f32_16x16x64_bf16 v[96:99], v[40:43], a[72:79], v184
    v_smfmac_f32_16x16x64_bf16 v[100:103], v[36:39], a[120:127], v184
    buffer_store_dword v253, v254, s[4:7], s51 offen sc1
    v_smfmac_f32_16x16x64_bf16 v[100:103], v[40:43], a[152:159], v184
    v_add_f32 v96, v96, v98
    v_add_f32 v97, v97, v99
    v_cvt_pk_bf16_f32 v160, v96, v97
    v_mov_b32 v98, 0
    s_nop 0
    v_mov_b32_dpp v162, v160 quad_perm:[1,0,3,2] row_mask:0xf bank_mask:0xf
    v_perm_b32 v160, v162, v160, v185
    s_nop 0
    v_add_f32 v100, v100, v102
    v_add_f32 v101, v101, v103
    v_cvt_pk_bf16_f32 v161, v100, v101
    v_smfmac_f32_16x16x64_bf16 v[104:107], v[16:19], a[160:167], v184
    s_nop 0
    v_mov_b32_dpp v163, v161 quad_perm:[1,0,3,2] row_mask:0xf bank_mask:0xf
    v_perm_b32 v161, v163, v161, v185
    v_smfmac_f32_16x16x64_bf16 v[104:107], v[20:23], a[168:175], v184
    s_nop 0
    v_cndmask_b32_dpp v176, v161, v160, vcc quad_perm:[2,3,0,1] row_mask:0xf bank_mask:0xf
    s_mov_b64 vcc, s[36:37]
    v_cndmask_b32_dpp v177, v160, v161, vcc quad_perm:[2,3,0,1] row_mask:0xf bank_mask:0xf
    buffer_store_dwordx2 v[176:177], v187, s[4:7], s41 offen sc1
    v_smfmac_f32_16x16x64_bf16 v[104:107], v[24:27], a[176:183], v184
    v_mov_b32 v96, 0
    v_smfmac_f32_16x16x64_bf16 v[104:107], v[28:31], a[184:191], v184
    v_smfmac_f32_16x16x64_bf16 v[104:107], v[32:35], a[192:199], v184
    v_smfmac_f32_16x16x64_bf16 v[104:107], v[36:39], a[200:207], v184
    v_smfmac_f32_16x16x64_bf16 v[104:107], v[40:43], a[232:239], v184
    v_mov_b32 v97, 0
    v_mov_b32 v98, 0
    v_mov_b32 v99, 0
    v_mov_b32 v100, 0
    v_mov_b32 v101, 0
    v_mov_b32 v102, 0
    v_mov_b32 v103, 0
    s_nop 0
    v_add_f32 v104, v104, v106
    v_add_f32 v105, v105, v107
    v_cvt_pk_bf16_f32 v160, v104, v105
    v_mov_b32 v106, 0
    v_mov_b32 v107, 0
    v_mov_b32_dpp v162, v160 quad_perm:[1,0,3,2] row_mask:0xf bank_mask:0xf
    v_perm_b32 v178, v162, v160, v185
    v_mov_b32 v104, 0
    v_mov_b32 v105, 0
    v_mov_b32_dpp v179, v178 quad_perm:[2,3,0,1] row_mask:0xf bank_mask:0xf
    buffer_store_dwordx2 v[178:179], v9, s[4:7], s45 offen sc1
    s_branch Lmj_48
Lmw_47:
    s_mov_b32 s31, 262144
    buffer_load_dwordx4 v[108:111], v3, s[4:7], s40 offen offset:0 sc1
    buffer_load_dwordx4 v[112:115], v3, s[4:7], s40 offen offset:1024 sc1
    buffer_load_dwordx4 v[116:119], v3, s[4:7], s40 offen offset:2048 sc1
Lp_61:
    buffer_load_dwordx4 v[120:123], v3, s[4:7], s40 offen offset:0 sc1
    buffer_load_dwordx4 v[124:127], v3, s[4:7], s40 offen offset:1024 sc1
    buffer_load_dwordx4 v[128:131], v3, s[4:7], s40 offen offset:2048 sc1
    s_waitcnt vmcnt(3)
    ds_write_b128 v5, v[108:111] offset:0
    ds_write_b128 v5, v[112:115] offset:1024
    ds_write_b128 v5, v[116:119] offset:2048
    v_max3_u32 v160, v108, v112, v116
    v_cmp_eq_u32 vcc, -1, v160
    s_cbranch_vccz LdA_62
    buffer_load_dwordx4 v[108:111], v3, s[4:7], s40 offen offset:0 sc1
    buffer_load_dwordx4 v[112:115], v3, s[4:7], s40 offen offset:1024 sc1
    buffer_load_dwordx4 v[116:119], v3, s[4:7], s40 offen offset:2048 sc1
    s_waitcnt vmcnt(3)
    ds_write_b128 v5, v[120:123] offset:0
    ds_write_b128 v5, v[124:127] offset:1024
    ds_write_b128 v5, v[128:131] offset:2048
    v_max3_u32 v160, v120, v124, v128
    v_cmp_eq_u32 vcc, -1, v160
    s_cbranch_vccz LdB_63
    s_sub_u32 s31, s31, 1
    s_cbranch_scc0 Lp_61
    s_mov_b32 s31, 1
    s_branch L_fail
LdB_63:
    v_smfmac_f32_16x16x64_bf16 v[96:99], v[120:123], a[56:63], v184
    v_smfmac_f32_16x16x64_bf16 v[100:103], v[120:123], a[136:143], v184
    s_waitcnt lgkmcnt(0)
    s_barrier
    ds_read_b128 v[16:19], v7 offset:0
    ds_read_b128 v[20:23], v7 offset:1024
    v_smfmac_f32_16x16x64_bf16 v[96:99], v[124:127], a[64:71], v184
    ds_read_b128 v[24:27], v7 offset:2048
    v_smfmac_f32_16x16x64_bf16 v[100:103], v[124:127], a[144:151], v184
    ds_read_b128 v[28:31], v7 offset:3072
    v_smfmac_f32_16x16x64_bf16 v[96:99], v[128:131], a[72:79], v184
    ds_read_b128 v[32:35], v7 offset:4096
    v_smfmac_f32_16x16x64_bf16 v[100:103], v[128:131], a[152:159], v184
    ds_read_b128 v[36:39], v7 offset:5120
    v_smfmac_f32_16x16x64_bf16 v[104:107], v[120:123], a[216:223], v184
    ds_read_b128 v[40:43], v7 offset:6144
    v_smfmac_f32_16x16x64_bf16 v[104:107], v[124:127], a[224:231], v184
    v_smfmac_f32_16x16x64_bf16 v[104:107], v[128:131], a[232:239], v184
    s_branch Ldd_64
LdA_62:
    v_smfmac_f32_16x16x64_bf16 v[96:99], v[108:111], a[56:63], v184
    v_smfmac_f32_16x16x64_bf16 v[100:103], v[108:111], a[136:143], v184
    s_waitcnt lgkmcnt(0)
    s_barrier
    ds_read_b128 v[16:19], v7 offset:0
    ds_read_b128 v[20:23], v7 offset:1024
    v_smfmac_f32_16x16x64_bf16 v[96:99], v[112:115], a[64:71], v184
    ds_read_b128 v[24:27], v7 offset:2048
    v_smfmac_f32_16x16x64_bf16 v[100:103], v[112:115], a[144:151], v184
    ds_read_b128 v[28:31], v7 offset:3072
    v_smfmac_f32_16x16x64_bf16 v[96:99], v[116:119], a[72:79], v184
    ds_read_b128 v[32:35], v7 offset:4096
    v_smfmac_f32_16x16x64_bf16 v[100:103], v[116:119], a[152:159], v184
    ds_read_b128 v[36:39], v7 offset:5120
    v_smfmac_f32_16x16x64_bf16 v[104:107], v[108:111], a[216:223], v184
    ds_read_b128 v[40:43], v7 offset:6144
    v_smfmac_f32_16x16x64_bf16 v[104:107], v[112:115], a[224:231], v184
    v_smfmac_f32_16x16x64_bf16 v[104:107], v[116:119], a[232:239], v184
Ldd_64:
    s_mov_b64 vcc, s[34:35]
    s_waitcnt lgkmcnt(6)
    v_smfmac_f32_16x16x64_bf16 v[96:99], v[16:19], a[0:7], v184
    v_smfmac_f32_16x16x64_bf16 v[100:103], v[16:19], a[80:87], v184
    s_waitcnt lgkmcnt(5)
    v_smfmac_f32_16x16x64_bf16 v[96:99], v[20:23], a[8:15], v184
    v_smfmac_f32_16x16x64_bf16 v[100:103], v[20:23], a[88:95], v184
    s_waitcnt lgkmcnt(4)
    v_smfmac_f32_16x16x64_bf16 v[96:99], v[24:27], a[16:23], v184
    v_smfmac_f32_16x16x64_bf16 v[100:103], v[24:27], a[96:103], v184
    s_waitcnt lgkmcnt(3)
    v_smfmac_f32_16x16x64_bf16 v[96:99], v[28:31], a[24:31], v184
    v_smfmac_f32_16x16x64_bf16 v[100:103], v[28:31], a[104:111], v184
    s_waitcnt lgkmcnt(2)
    v_smfmac_f32_16x16x64_bf16 v[96:99], v[32:35], a[32:39], v184
    v_smfmac_f32_16x16x64_bf16 v[100:103], v[32:35], a[112:119], v184
    s_waitcnt lgkmcnt(1)
    v_smfmac_f32_16x16x64_bf16 v[96:99], v[36:39], a[40:47], v184
    s_waitcnt lgkmcnt(0)
    v_smfmac_f32_16x16x64_bf16 v[96:99], v[40:43], a[48:55], v184
    v_smfmac_f32_16x16x64_bf16 v[100:103], v[36:39], a[120:127], v184
    buffer_store_dword v253, v254, s[4:7], s51 offen sc1
    v_smfmac_f32_16x16x64_bf16 v[100:103], v[40:43], a[128:135], v184
    v_add_f32 v96, v96, v98
    v_add_f32 v97, v97, v99
    v_cvt_pk_bf16_f32 v160, v96, v97
    v_mov_b32 v98, 0
    s_nop 0
    v_mov_b32_dpp v162, v160 quad_perm:[1,0,3,2] row_mask:0xf bank_mask:0xf
    v_perm_b32 v160, v162, v160, v185
    s_nop 0
    v_add_f32 v100, v100, v102
    v_add_f32 v101, v101, v103
    v_cvt_pk_bf16_f32 v161, v100, v101
    v_smfmac_f32_16x16x64_bf16 v[104:107], v[16:19], a[160:167], v184
    s_nop 0
    v_mov_b32_dpp v163, v161 quad_perm:[1,0,3,2] row_mask:0xf bank_mask:0xf
    v_perm_b32 v161, v163, v161, v185
    v_smfmac_f32_16x16x64_bf16 v[104:107], v[20:23], a[168:175], v184
    s_nop 0
    v_cndmask_b32_dpp v176, v161, v160, vcc quad_perm:[2,3,0,1] row_mask:0xf bank_mask:0xf
    s_mov_b64 vcc, s[36:37]
    v_cndmask_b32_dpp v177, v160, v161, vcc quad_perm:[2,3,0,1] row_mask:0xf bank_mask:0xf
    buffer_store_dwordx2 v[176:177], v187, s[4:7], s41 offen sc1
    v_smfmac_f32_16x16x64_bf16 v[104:107], v[24:27], a[176:183], v184
    v_mov_b32 v96, 0
    v_smfmac_f32_16x16x64_bf16 v[104:107], v[28:31], a[184:191], v184
    v_smfmac_f32_16x16x64_bf16 v[104:107], v[32:35], a[192:199], v184
    v_smfmac_f32_16x16x64_bf16 v[104:107], v[36:39], a[200:207], v184
    v_smfmac_f32_16x16x64_bf16 v[104:107], v[40:43], a[208:215], v184
    v_mov_b32 v97, 0
    v_mov_b32 v98, 0
    v_mov_b32 v99, 0
    v_mov_b32 v100, 0
    v_mov_b32 v101, 0
    v_mov_b32 v102, 0
    v_mov_b32 v103, 0
    s_nop 0
    v_add_f32 v104, v104, v106
    v_add_f32 v105, v105, v107
    v_cvt_pk_bf16_f32 v160, v104, v105
    v_mov_b32 v106, 0
    v_mov_b32 v107, 0
    v_mov_b32_dpp v162, v160 quad_perm:[1,0,3,2] row_mask:0xf bank_mask:0xf
    v_perm_b32 v178, v162, v160, v185
    v_mov_b32 v104, 0
    v_mov_b32 v105, 0
    v_mov_b32_dpp v179, v178 quad_perm:[2,3,0,1] row_mask:0xf bank_mask:0xf
    buffer_store_dwordx2 v[178:179], v9, s[4:7], s45 offen sc1
Lmj_48:
    v_xor_b32 v5, 0xc000, v5
    v_xor_b32 v7, 0xc000, v7
    s_cmp_eq_u32 s30, 0
    s_cbranch_scc1 Lq0_40
Lqr_41:
    s_cmp_ge_u32 s64, 64
    s_cbranch_scc1 Lqn_38
    s_and_b32 s65, s64, 1
    s_mul_i32 s66, s65, 40960
    v_add_u32 v12, s66, v2
    s_xor_b32 s65, s65, 1
    s_mul_i32 s65, s65, 40960
    s_add_u32 s65, s65, s62
    s_add_u32 s66, s64, 1
    s_min_u32 s66, s66, 63
    s_mul_i32 s66, s66, 40960
    s_add_u32 s66, s66, s62
    s_add_u32 s66, s66, 4194304
    s_and_b32 s47, s64, 7
    s_mul_i32 s47, s47, 393216
    s_lshl_b32 s48, s58, 1
    s_add_u32 s47, s47, s48
    s_max_u32 s50, s64, 8
    s_sub_u32 s50, s50, 8
    s_lshl_b32 s50, s50, 9
    s_add_u32 s50, s50, s61
    buffer_load_dword v180, v10, s[4:7], s50 offen sc1
    ds_read_b128 v[16:19], v12 offset:0
    ds_read_b128 v[20:23], v12 offset:1024
    ds_read_b128 v[24:27], v12 offset:2048
    ds_read_b128 v[28:31], v12 offset:3072
    ds_read_b128 v[32:35], v12 offset:4096
    ds_read_b128 v[36:39], v12 offset:5120
    ds_read_b128 v[40:43], v12 offset:6144
    ds_read_b128 v[44:47], v12 offset:7168
    ds_read_b128 v[48:51], v12 offset:8192
    ds_read_b128 v[52:55], v12 offset:9216
    s_waitcnt lgkmcnt(9)
    v_mfma_f32_16x16x32_bf16 v[148:151], a[160:163], v[16:19], 0
    v_mfma_f32_16x16x32_bf16 v[140:143], a[80:83], v[16:19], 0
    v_mfma_f32_16x16x32_bf16 v[132:135], a[0:3], v[16:19], 0
    ds_read_b128 v[56:59], v12 offset:10240
    s_waitcnt lgkmcnt(9)
    v_mfma_f32_16x16x32_bf16 v[148:151], a[164:167], v[20:23], v[148:151]
    v_mfma_f32_16x16x32_bf16 v[140:143], a[84:87], v[20:23], v[140:143]
    v_mfma_f32_16x16x32_bf16 v[132:135], a[4:7], v[20:23], v[132:135]
    ds_read_b128 v[60:63], v12 offset:11264
    s_waitcnt lgkmcnt(9)
    v_mfma_f32_16x16x32_bf16 v[148:151], a[168:171], v[24:27], v[148:151]
    v_mfma_f32_16x16x32_bf16 v[140:143], a[88:91], v[24:27], v[140:143]
    v_mfma_f32_16x16x32_bf16 v[132:135], a[8:11], v[24:27], v[132:135]
    ds_read_b128 v[64:67], v12 offset:12288
    s_waitcnt lgkmcnt(9)
    v_mfma_f32_16x16x32_bf16 v[148:151], a[172:175], v[28:31], v[148:151]
    v_mfma_f32_16x16x32_bf16 v[140:143], a[92:95], v[28:31], v[140:143]
    v_mfma_f32_16x16x32_bf16 v[132:135], a[12:15], v[28:31], v[132:135]
    ds_read_b128 v[68:71], v12 offset:13312
    s_waitcnt lgkmcnt(9)
    v_mfma_f32_16x16x32_bf16 v[148:151], a[176:179], v[32:35], v[148:151]
    v_mfma_f32_16x16x32_bf16 v[140:143], a[96:99], v[32:35], v[140:143]
    v_mfma_f32_16x16x32_bf16 v[132:135], a[16:19], v[32:35], v[132:135]
    ds_read_b128 v[72:75], v12 offset:14336
    s_waitcnt lgkmcnt(9)
    v_mfma_f32_16x16x32_bf16 v[148:151], a[180:183], v[36:39], v[148:151]
    v_mfma_f32_16x16x32_bf16 v[140:143], a[100:103], v[36:39], v[140:143]
    v_mfma_f32_16x16x32_bf16 v[132:135], a[20:23], v[36:39], v[132:135]
    ds_read_b128 v[76:79], v12 offset:15360
    s_cmp_lt_u32 s64, 8
    s_cbranch_scc1 Lbp_65
    s_waitcnt vmcnt(0)
    v_cmp_eq_u32 vcc, 0, v180
    s_cbranch_vccz Lbp_65
    s_mov_b32 s31, 262144
    s_mov_b32 exec_lo, 0x1
    s_mov_b32 exec_hi, 0
Lf_66:
    buffer_load_dword v180, v10, s[4:7], s50 offen sc1
    s_waitcnt vmcnt(0)
    v_cmp_eq_u32 vcc, 0, v180
    s_cbranch_vccz Lfd_67
    s_sleep 1
    s_sub_u32 s31, s31, 1
    s_cbranch_scc0 Lf_66
    s_mov_b32 s31, 13
    s_branch L_fail
Lfd_67:
    s_mov_b64 exec, -1
Lbp_65:
    s_waitcnt lgkmcnt(9)
    v_mfma_f32_16x16x32_bf16 v[148:151], a[184:187], v[40:43], v[148:151]
    v_mfma_f32_16x16x32_bf16 v[140:143], a[104:107], v[40:43], v[140:143]
    v_mfma_f32_16x16x32_bf16 v[132:135], a[24:27], v[40:43], v[132:135]
    ds_read_b128 v[80:83], v12 offset:16384
    buffer_store_dwordx2 v[176:177], v182, s[4:7], s43 offen sc1
    s_waitcnt lgkmcnt(9)
    v_mfma_f32_16x16x32_bf16 v[148:151], a[188:191], v[44:47], v[148:151]
    v_mfma_f32_16x16x32_bf16 v[140:143], a[108:111], v[44:47], v[140:143]
    v_mfma_f32_16x16x32_bf16 v[132:135], a[28:31], v[44:47], v[132:135]
    ds_read_b128 v[84:87], v12 offset:17408
    buffer_store_dwordx2 v[248:249], v187, s[4:7], s42 offen sc1
    s_waitcnt lgkmcnt(9)
    v_mfma_f32_16x16x32_bf16 v[148:151], a[192:195], v[48:51], v[148:151]
    v_mfma_f32_16x16x32_bf16 v[140:143], a[112:115], v[48:51], v[140:143]
    v_mfma_f32_16x16x32_bf16 v[132:135], a[32:35], v[48:51], v[132:135]
    ds_read_b128 v[88:91], v12 offset:18432
    buffer_store_dwordx2 v[178:179], v183, s[4:7], s44 offen sc1
    s_waitcnt lgkmcnt(9)
    v_mfma_f32_16x16x32_bf16 v[148:151], a[196:199], v[52:55], v[148:151]
    v_mfma_f32_16x16x32_bf16 v[140:143], a[116:119], v[52:55], v[140:143]
    v_mfma_f32_16x16x32_bf16 v[132:135], a[36:39], v[52:55], v[132:135]
    ds_read_b128 v[92:95], v12 offset:19456
    buffer_store_dwordx2 v[248:249], v9, s[4:7], s46 offen sc1
    s_waitcnt lgkmcnt(9)
    v_mfma_f32_16x16x32_bf16 v[148:151], a[200:203], v[56:59], v[148:151]
    v_mfma_f32_16x16x32_bf16 v[140:143], a[120:123], v[56:59], v[140:143]
    v_mfma_f32_16x16x32_bf16 v[132:135], a[40:43], v[56:59], v[132:135]
    ds_read_b128 v[16:19], v12 offset:20480
    s_add_u32 m0, s65, 0
    s_nop 0
    buffer_load_dwordx4 v2, s[4:7], s66 offen lds
    s_add_u32 s66, s66, 1024
    s_waitcnt lgkmcnt(9)
    v_mfma_f32_16x16x32_bf16 v[148:151], a[204:207], v[60:63], v[148:151]
    v_mfma_f32_16x16x32_bf16 v[140:143], a[124:127], v[60:63], v[140:143]
    v_mfma_f32_16x16x32_bf16 v[132:135], a[44:47], v[60:63], v[132:135]
    ds_read_b128 v[20:23], v12 offset:21504
    s_add_u32 m0, s65, 1024
    s_nop 0
    buffer_load_dwordx4 v2, s[4:7], s66 offen lds
    s_add_u32 s66, s66, 1024
    s_waitcnt lgkmcnt(9)
    v_mfma_f32_16x16x32_bf16 v[148:151], a[208:211], v[64:67], v[148:151]
    v_mfma_f32_16x16x32_bf16 v[140:143], a[128:131], v[64:67], v[140:143]
    v_mfma_f32_16x16x32_bf16 v[132:135], a[48:51], v[64:67], v[132:135]
    ds_read_b128 v[24:27], v12 offset:22528
    s_add_u32 m0, s65, 2048
    s_nop 0
    buffer_load_dwordx4 v2, s[4:7], s66 offen lds
    s_add_u32 s66, s66, 1024
    s_waitcnt lgkmcnt(9)
    v_mfma_f32_16x16x32_bf16 v[148:151], a[212:215], v[68:71], v[148:151]
    v_mfma_f32_16x16x32_bf16 v[140:143], a[132:135], v[68:71], v[140:143]
    v_mfma_f32_16x16x32_bf16 v[132:135], a[52:55], v[68:71], v[132:135]
    ds_read_b128 v[28:31], v12 offset:23552
    s_add_u32 m0, s65, 3072
    s_nop 0
    buffer_load_dwordx4 v2, s[4:7], s66 offen lds
    s_add_u32 s66, s66, 1024
    s_waitcnt lgkmcnt(9)
    v_mfma_f32_16x16x32_bf16 v[148:151], a[216:219], v[72:75], v[148:151]
    v_mfma_f32_16x16x32_bf16 v[140:143], a[136:139], v[72:75], v[140:143]
    v_mfma_f32_16x16x32_bf16 v[132:135], a[56:59], v[72:75], v[132:135]
    ds_read_b128 v[32:35], v12 offset:24576
    s_add_u32 m0, s65, 4096
    s_nop 0
    buffer_load_dwordx4 v2, s[4:7], s66 offen lds
    s_add_u32 s66, s66, 1024
    s_waitcnt lgkmcnt(9)
    v_mfma_f32_16x16x32_bf16 v[148:151], a[220:223], v[76:79], v[148:151]
    v_mfma_f32_16x16x32_bf16 v[140:143], a[140:143], v[76:79], v[140:143]
    v_mfma_f32_16x16x32_bf16 v[132:135], a[60:63], v[76:79], v[132:135]
    ds_read_b128 v[36:39], v12 offset:25600
    s_add_u32 m0, s65, 5120
    s_nop 0
    buffer_load_dwordx4 v2, s[4:7], s66 offen lds
    s_add_u32 s66, s66, 1024
    s_waitcnt lgkmcnt(9)
    v_mfma_f32_16x16x32_bf16 v[148:151], a[224:227], v[80:83], v[148:151]
    v_mfma_f32_16x16x32_bf16 v[140:143], a[144:147], v[80:83], v[140:143]
    v_mfma_f32_16x16x32_bf16 v[132:135], a[64:67], v[80:83], v[132:135]
    ds_read_b128 v[40:43], v12 offset:26624
    s_add_u32 m0, s65, 6144
    s_nop 0
    buffer_load_dwordx4 v2, s[4:7], s66 offen lds
    s_add_u32 s66, s66, 1024
    s_waitcnt lgkmcnt(9)
    v_mfma_f32_16x16x32_bf16 v[148:151], a[228:231], v[84:87], v[148:151]
    v_mfma_f32_16x16x32_bf16 v[140:143], a[148:151], v[84:87], v[140:143]
    v_mfma_f32_16x16x32_bf16 v[132:135], a[68:71], v[84:87], v[132:135]
    ds_read_b128 v[44:47], v12 offset:27648
    s_add_u32 m0, s65, 7168
    s_nop 0
    buffer_load_dwordx4 v2, s[4:7], s66 offen lds
    s_add_u32 s66, s66, 1024
    s_waitcnt lgkmcnt(9)
    v_mfma_f32_16x16x32_bf16 v[148:151], a[232:235], v[88:91], v[148:151]
    v_mfma_f32_16x16x32_bf16 v[140:143], a[152:155], v[88:91], v[140:143]
    v_mfma_f32_16x16x32_bf16 v[132:135], a[72:75], v[88:91], v[132:135]
    ds_read_b128 v[48:51], v12 offset:28672
    s_add_u32 m0, s65, 8192
    s_nop 0
    buffer_load_dwordx4 v2, s[4:7], s66 offen lds
    s_add_u32 s66, s66, 1024
    s_waitcnt lgkmcnt(9)
    v_mfma_f32_16x16x32_bf16 v[148:151], a[236:239], v[92:95], v[148:151]
    v_mfma_f32_16x16x32_bf16 v[140:143], a[156:159], v[92:95], v[140:143]
    v_mfma_f32_16x16x32_bf16 v[132:135], a[76:79], v[92:95], v[132:135]
    ds_read_b128 v[52:55], v12 offset:29696
    s_add_u32 m0, s65, 9216
    s_nop 0
    buffer_load_dwordx4 v2, s[4:7], s66 offen lds
    s_add_u32 s66, s66, 1024
    s_waitcnt lgkmcnt(9)
    v_mfma_f32_16x16x32_bf16 v[152:155], a[160:163], v[16:19], 0
    v_mfma_f32_16x16x32_bf16 v[144:147], a[80:83], v[16:19], 0
    v_mfma_f32_16x16x32_bf16 v[136:139], a[0:3], v[16:19], 0
    ds_read_b128 v[56:59], v12 offset:30720
    s_waitcnt lgkmcnt(9)
    v_mfma_f32_16x16x32_bf16 v[152:155], a[164:167], v[20:23], v[152:155]
    v_mfma_f32_16x16x32_bf16 v[144:147], a[84:87], v[20:23], v[144:147]
    v_mfma_f32_16x16x32_bf16 v[136:139], a[4:7], v[20:23], v[136:139]
    ds_read_b128 v[60:63], v12 offset:31744
    s_waitcnt lgkmcnt(9)
    v_mfma_f32_16x16x32_bf16 v[152:155], a[168:171], v[24:27], v[152:155]
    v_mfma_f32_16x16x32_bf16 v[144:147], a[88:91], v[24:27], v[144:147]
    v_mfma_f32_16x16x32_bf16 v[136:139], a[8:11], v[24:27], v[136:139]
    ds_read_b128 v[64:67], v12 offset:32768
    s_waitcnt lgkmcnt(9)
    v_mfma_f32_16x16x32_bf16 v[152:155], a[172:175], v[28:31], v[152:155]
    v_mfma_f32_16x16x32_bf16 v[144:147], a[92:95], v[28:31], v[144:147]
    v_mfma_f32_16x16x32_bf16 v[136:139], a[12:15], v[28:31], v[136:139]
    ds_read_b128 v[68:71], v12 offset:33792
    v_cvt_pk_bf16_f32 v168, v148, v149
    v_cvt_pk_bf16_f32 v169, v150, v151
    s_add_u32 s48, s47, 67108864
    buffer_store_dwordx2 v[168:169], v8, s[4:7], s48 offen sc1
    s_waitcnt lgkmcnt(9)
    v_mfma_f32_16x16x32_bf16 v[152:155], a[176:179], v[32:35], v[152:155]
    v_mfma_f32_16x16x32_bf16 v[144:147], a[96:99], v[32:35], v[144:147]
    v_mfma_f32_16x16x32_bf16 v[136:139], a[16:19], v[32:35], v[136:139]
    ds_read_b128 v[72:75], v12 offset:34816
    v_cvt_pk_bf16_f32 v164, v140, v141
    v_cvt_pk_bf16_f32 v165, v142, v143
    s_waitcnt lgkmcnt(9)
    v_mfma_f32_16x16x32_bf16 v[152:155], a[180:183], v[36:39], v[152:155]
    v_mfma_f32_16x16x32_bf16 v[144:147], a[100:103], v[36:39], v[144:147]
    v_mfma_f32_16x16x32_bf16 v[136:139], a[20:23], v[36:39], v[136:139]
    ds_read_b128 v[76:79], v12 offset:35840
    v_cvt_pk_bf16_f32 v160, v132, v133
    v_cvt_pk_bf16_f32 v161, v134, v135
    s_waitcnt lgkmcnt(9)
    v_mfma_f32_16x16x32_bf16 v[152:155], a[184:187], v[40:43], v[152:155]
    v_mfma_f32_16x16x32_bf16 v[144:147], a[104:107], v[40:43], v[144:147]
    v_mfma_f32_16x16x32_bf16 v[136:139], a[24:27], v[40:43], v[136:139]
    ds_read_b128 v[80:83], v12 offset:36864
    s_waitcnt lgkmcnt(9)
    v_mfma_f32_16x16x32_bf16 v[152:155], a[188:191], v[44:47], v[152:155]
    v_mfma_f32_16x16x32_bf16 v[144:147], a[108:111], v[44:47], v[144:147]
    v_mfma_f32_16x16x32_bf16 v[136:139], a[28:31], v[44:47], v[136:139]
    ds_read_b128 v[84:87], v12 offset:37888
    s_waitcnt lgkmcnt(9)
    v_mfma_f32_16x16x32_bf16 v[152:155], a[192:195], v[48:51], v[152:155]
    v_mfma_f32_16x16x32_bf16 v[144:147], a[112:115], v[48:51], v[144:147]
    v_mfma_f32_16x16x32_bf16 v[136:139], a[32:35], v[48:51], v[136:139]
    ds_read_b128 v[88:91], v12 offset:38912
    s_waitcnt lgkmcnt(9)
    v_mfma_f32_16x16x32_bf16 v[152:155], a[196:199], v[52:55], v[152:155]
    v_mfma_f32_16x16x32_bf16 v[144:147], a[116:119], v[52:55], v[144:147]
    v_mfma_f32_16x16x32_bf16 v[136:139], a[36:39], v[52:55], v[136:139]
    ds_read_b128 v[92:95], v12 offset:39936
    s_waitcnt lgkmcnt(9)
    v_mfma_f32_16x16x32_bf16 v[152:155], a[200:203], v[56:59], v[152:155]
    v_mfma_f32_16x16x32_bf16 v[144:147], a[120:123], v[56:59], v[144:147]
    v_mfma_f32_16x16x32_bf16 v[136:139], a[40:43], v[56:59], v[136:139]
    s_waitcnt lgkmcnt(8)
    v_mfma_f32_16x16x32_bf16 v[152:155], a[204:207], v[60:63], v[152:155]
    v_mfma_f32_16x16x32_bf16 v[144:147], a[124:127], v[60:63], v[144:147]
    v_mfma_f32_16x16x32_bf16 v[136:139], a[44:47], v[60:63], v[136:139]
    s_waitcnt lgkmcnt(7)
    v_mfma_f32_16x16x32_bf16 v[152:155], a[208:211], v[64:67], v[152:155]
    v_mfma_f32_16x16x32_bf16 v[144:147], a[128:131], v[64:67], v[144:147]
    v_mfma_f32_16x16x32_bf16 v[136:139], a[48:51], v[64:67], v[136:139]
    s_waitcnt lgkmcnt(6)
    v_mfma_f32_16x16x32_bf16 v[152:155], a[212:215], v[68:71], v[152:155]
    v_mfma_f32_16x16x32_bf16 v[144:147], a[132:135], v[68:71], v[144:147]
    v_mfma_f32_16x16x32_bf16 v[136:139], a[52:55], v[68:71], v[136:139]
    s_waitcnt lgkmcnt(5)
    v_mfma_f32_16x16x32_bf16 v[152:155], a[216:219], v[72:75], v[152:155]
    v_mfma_f32_16x16x32_bf16 v[144:147], a[136:139], v[72:75], v[144:147]
    v_mfma_f32_16x16x32_bf16 v[136:139], a[56:59], v[72:75], v[136:139]
    s_waitcnt lgkmcnt(4)
    v_mfma_f32_16x16x32_bf16 v[152:155], a[220:223], v[76:79], v[152:155]
    v_mfma_f32_16x16x32_bf16 v[144:147], a[140:143], v[76:79], v[144:147]
    v_mfma_f32_16x16x32_bf16 v[136:139], a[60:63], v[76:79], v[136:139]
    s_waitcnt lgkmcnt(3)
    v_mfma_f32_16x16x32_bf16 v[152:155], a[224:227], v[80:83], v[152:155]
    v_mfma_f32_16x16x32_bf16 v[144:147], a[144:147], v[80:83], v[144:147]
    v_mfma_f32_16x16x32_bf16 v[136:139], a[64:67], v[80:83], v[136:139]
    s_waitcnt lgkmcnt(2)
    v_mfma_f32_16x16x32_bf16 v[152:155], a[228:231], v[84:87], v[152:155]
    v_mfma_f32_16x16x32_bf16 v[144:147], a[148:151], v[84:87], v[144:147]
    v_mfma_f32_16x16x32_bf16 v[136:139], a[68:71], v[84:87], v[136:139]
    s_waitcnt lgkmcnt(1)
    v_mfma_f32_16x16x32_bf16 v[152:155], a[232:235], v[88:91], v[152:155]
    v_mfma_f32_16x16x32_bf16 v[144:147], a[152:155], v[88:91], v[144:147]
    v_mfma_f32_16x16x32_bf16 v[136:139], a[72:75], v[88:91], v[136:139]
    s_waitcnt lgkmcnt(0)
    v_mfma_f32_16x16x32_bf16 v[152:155], a[236:239], v[92:95], v[152:155]
    v_mfma_f32_16x16x32_bf16 v[144:147], a[156:159], v[92:95], v[144:147]
    v_mfma_f32_16x16x32_bf16 v[136:139], a[76:79], v[92:95], v[136:139]
    v_cvt_pk_bf16_f32 v170, v152, v153
    v_cvt_pk_bf16_f32 v171, v154, v155
    s_add_u32 s48, s47, 67115008
    buffer_store_dwordx2 v[170:171], v8, s[4:7], s48 offen sc1
    v_cvt_pk_bf16_f32 v166, v144, v145
    v_cvt_pk_bf16_f32 v167, v146, v147
    s_add_u32 s48, s47, 41943040
    v_permlane16_swap_b32 v164, v166
    v_permlane16_swap_b32 v165, v167
    buffer_store_dwordx4 v[164:167], v190, s[4:7], s48 offen sc1
    v_cvt_pk_bf16_f32 v162, v136, v137
    v_cvt_pk_bf16_f32 v163, v138, v139
    s_add_u32 s48, s47, 16777216
    v_permlane16_swap_b32 v160, v162
    v_permlane16_swap_b32 v161, v163
    buffer_store_dwordx4 v[160:163], v190, s[4:7], s48 offen sc1
    s_cmp_lg_u32 s64, 63
    s_cbranch_scc1 Lqx_39
    s_sub_u32 s51, s64, 0
    s_lshl_b32 s51, s51, 5
    s_add_u32 s51, s51, s26
    s_lshl_b32 s51, s51, 6
    s_add_u32 s51, s51, 4096
    s_waitcnt vmcnt(0)
    s_mov_b64 exec, 1
    buffer_store_dword v252, v254, s[4:7], s51 offen sc1
    s_mov_b64 exec, -1
    s_branch Lqx_39
Lqn_38:
    buffer_store_dwordx2 v[176:177], v182, s[4:7], s43 offen sc1
    buffer_store_dwordx2 v[178:179], v183, s[4:7], s44 offen sc1
    s_sub_u32 s51, s64, 0
    s_lshl_b32 s51, s51, 5
    s_add_u32 s51, s51, s26
    s_lshl_b32 s51, s51, 6
    s_add_u32 s51, s51, 4096
    s_waitcnt vmcnt(0)
    s_mov_b64 exec, 1
    buffer_store_dword v252, v254, s[4:7], s51 offen sc1
    s_mov_b64 exec, -1
Lqx_39:
    s_add_u32 s64, s64, 1
    s_add_u32 s30, s30, 1
    s_cmp_lt_u32 s30, 64
    s_cbranch_scc1 Lqt_37
    s_lshl_b32 s30, s21, 3
    s_add_u32 s30, s30, s20
    s_add_u32 s30, s30, 1220
    s_mov_b32 s33, 0
    s_cmp_lt_u32 s30, 1280
    s_cselect_b32 s38, s22, 1
    s_cmp_eq_u32 s38, 0
    s_cbranch_scc1 L_cmb2
    s_endpgm
L_urg:
    s_mov_b32 s8, s52
    s_and_b32 s9, s53, 0xffff
    s_mov_b32 s10, 0x280000
    s_mov_b32 s11, 0x00020000
    s_mov_b32 s12, s54
    s_and_b32 s13, s55, 0xffff
    s_mov_b32 s14, 0x2800
    s_mov_b32 s15, 0x00020000
    s_cmp_lg_u32 s24, 0
    s_cbranch_scc1 L_um
    v_and_b32 v3, 3, v1
    v_lshrrev_b32 v4, 2, v1
    s_lshl_b32 s40, s22, 2
    v_add_u32 v3, s40, v3
    v_mul_u32_u24 v5, 1280, v3
    v_lshl_add_u32 v5, v4, 4, v5
    v_lshrrev_b32 v6, 2, v4
    v_lshlrev_b32 v6, 10, v6
    v_and_b32 v7, 3, v4
    v_lshl_add_u32 v6, v7, 8, v6
    v_lshl_add_u32 v6, v3, 4, v6
    s_mul_i32 s25, s20, 20480
    buffer_load_dwordx4 v[16:19], v5, s[8:11], s25 offen offset:0 nt
    buffer_load_dwordx4 v[20:23], v5, s[8:11], s25 offen offset:256 nt
    buffer_load_dwordx4 v[24:27], v5, s[8:11], s25 offen offset:512 nt
    buffer_load_dwordx4 v[28:31], v5, s[8:11], s25 offen offset:768 nt
    buffer_load_dwordx4 v[32:35], v5, s[8:11], s25 offen offset:1024 nt
    s_waitcnt vmcnt(0)
    v_lshlrev_b32 v64, 16, v16
    v_and_b32 v65, 0xffff0000, v16
    v_lshlrev_b32 v66, 16, v17
    v_and_b32 v67, 0xffff0000, v17
    v_lshlrev_b32 v68, 16, v18
    v_and_b32 v69, 0xffff0000, v18
    v_lshlrev_b32 v70, 16, v19
    v_and_b32 v71, 0xffff0000, v19
    v_lshlrev_b32 v72, 16, v20
    v_and_b32 v73, 0xffff0000, v20
    v_lshlrev_b32 v74, 16, v21
    v_and_b32 v75, 0xffff0000, v21
    v_lshlrev_b32 v76, 16, v22
    v_and_b32 v77, 0xffff0000, v22
    v_lshlrev_b32 v78, 16, v23
    v_and_b32 v79, 0xffff0000, v23
    v_lshlrev_b32 v80, 16, v24
    v_and_b32 v81, 0xffff0000, v24
    v_lshlrev_b32 v82, 16, v25
    v_and_b32 v83, 0xffff0000, v25
    v_lshlrev_b32 v84, 16, v26
    v_and_b32 v85, 0xffff0000, v26
    v_lshlrev_b32 v86, 16, v27
    v_and_b32 v87, 0xffff0000, v27
    v_lshlrev_b32 v88, 16, v28
    v_and_b32 v89, 0xffff0000, v28
    v_lshlrev_b32 v90, 16, v29
    v_and_b32 v91, 0xffff0000, v29
    v_lshlrev_b32 v92, 16, v30
    v_and_b32 v93, 0xffff0000, v30
    v_lshlrev_b32 v94, 16, v31
    v_and_b32 v95, 0xffff0000, v31
    v_lshlrev_b32 v96, 16, v32
    v_and_b32 v97, 0xffff0000, v32
    v_lshlrev_b32 v98, 16, v33
    v_and_b32 v99, 0xffff0000, v33
    v_lshlrev_b32 v100, 16, v34
    v_and_b32 v101, 0xffff0000, v34
    v_lshlrev_b32 v102, 16, v35
    v_and_b32 v103, 0xffff0000, v35
    v_add_f32 v104, v64, v65
    v_add_f32 v105, v66, v67
    v_add_f32 v104, v104, v68
    v_add_f32 v105, v105, v69
    v_add_f32 v104, v104, v70
    v_add_f32 v105, v105, v71
    v_add_f32 v104, v104, v72
    v_add_f32 v105, v105, v73
    v_add_f32 v104, v104, v74
    v_add_f32 v105, v105, v75
    v_add_f32 v104, v104, v76
    v_add_f32 v105, v105, v77
    v_add_f32 v104, v104, v78
    v_add_f32 v105, v105, v79
    v_add_f32 v104, v104, v80
    v_add_f32 v105, v105, v81
    v_add_f32 v104, v104, v82
    v_add_f32 v105, v105, v83
    v_add_f32 v104, v104, v84
    v_add_f32 v105, v105, v85
    v_add_f32 v104, v104, v86
    v_add_f32 v105, v105, v87
    v_add_f32 v104, v104, v88
    v_add_f32 v105, v105, v89
    v_add_f32 v104, v104, v90
    v_add_f32 v105, v105, v91
    v_add_f32 v104, v104, v92
    v_add_f32 v105, v105, v93
    v_add_f32 v104, v104, v94
    v_add_f32 v105, v105, v95
    v_add_f32 v104, v104, v96
    v_add_f32 v105, v105, v97
    v_add_f32 v104, v104, v98
    v_add_f32 v105, v105, v99
    v_add_f32 v104, v104, v100
    v_add_f32 v105, v105, v101
    v_add_f32 v104, v104, v102
    v_add_f32 v105, v105, v103
    v_add_f32 v104, v104, v105
    s_nop 1
    v_add_f32_dpp v104, v104, v104 row_ror:8 row_mask:0xf bank_mask:0xf
    s_nop 1
    v_add_f32_dpp v104, v104, v104 row_ror:4 row_mask:0xf bank_mask:0xf
    v_mov_b32 v105, v104
    s_nop 1
    v_permlane16_swap_b32 v104, v105
    v_add_f32 v104, v104, v105
    v_mov_b32 v105, v104
    s_nop 1
    v_permlane32_swap_b32 v104, v105
    v_add_f32 v104, v104, v105
    v_mul_f32 v104, 0x3acccccd, v104
    v_mov_b32 v106, 0
    v_mov_b32 v107, 0
    v_sub_f32 v108, v64, v104
    v_sub_f32 v109, v65, v104
    v_fmac_f32 v106, v108, v108
    v_fmac_f32 v107, v109, v109
    v_sub_f32 v108, v66, v104
    v_sub_f32 v109, v67, v104
    v_fmac_f32 v106, v108, v108
    v_fmac_f32 v107, v109, v109
    v_sub_f32 v108, v68, v104
    v_sub_f32 v109, v69, v104
    v_fmac_f32 v106, v108, v108
    v_fmac_f32 v107, v109, v109
    v_sub_f32 v108, v70, v104
    v_sub_f32 v109, v71, v104
    v_fmac_f32 v106, v108, v108
    v_fmac_f32 v107, v109, v109
    v_sub_f32 v108, v72, v104
    v_sub_f32 v109, v73, v104
    v_fmac_f32 v106, v108, v108
    v_fmac_f32 v107, v109, v109
    v_sub_f32 v108, v74, v104
    v_sub_f32 v109, v75, v104
    v_fmac_f32 v106, v108, v108
    v_fmac_f32 v107, v109, v109
    v_sub_f32 v108, v76, v104
    v_sub_f32 v109, v77, v104
    v_fmac_f32 v106, v108, v108
    v_fmac_f32 v107, v109, v109
    v_sub_f32 v108, v78, v104
    v_sub_f32 v109, v79, v104
    v_fmac_f32 v106, v108, v108
    v_fmac_f32 v107, v109, v109
    v_sub_f32 v108, v80, v104
    v_sub_f32 v109, v81, v104
    v_fmac_f32 v106, v108, v108
    v_fmac_f32 v107, v109, v109
    v_sub_f32 v108, v82, v104
    v_sub_f32 v109, v83, v104
    v_fmac_f32 v106, v108, v108
    v_fmac_f32 v107, v109, v109
    v_sub_f32 v108, v84, v104
    v_sub_f32 v109, v85, v104
    v_fmac_f32 v106, v108, v108
    v_fmac_f32 v107, v109, v109
    v_sub_f32 v108, v86, v104
    v_sub_f32 v109, v87, v104
    v_fmac_f32 v106, v108, v108
    v_fmac_f32 v107, v109, v109
    v_sub_f32 v108, v88, v104
    v_sub_f32 v109, v89, v104
    v_fmac_f32 v106, v108, v108
    v_fmac_f32 v107, v109, v109
    v_sub_f32 v108, v90, v104
    v_sub_f32 v109, v91, v104
    v_fmac_f32 v106, v108, v108
    v_fmac_f32 v107, v109, v109
    v_sub_f32 v108, v92, v104
    v_sub_f32 v109, v93, v104
    v_fmac_f32 v106, v108, v108
    v_fmac_f32 v107, v109, v109
    v_sub_f32 v108, v94, v104
    v_sub_f32 v109, v95, v104
    v_fmac_f32 v106, v108, v108
    v_fmac_f32 v107, v109, v109
    v_sub_f32 v108, v96, v104
    v_sub_f32 v109, v97, v104
    v_fmac_f32 v106, v108, v108
    v_fmac_f32 v107, v109, v109
    v_sub_f32 v108, v98, v104
    v_sub_f32 v109, v99, v104
    v_fmac_f32 v106, v108, v108
    v_fmac_f32 v107, v109, v109
    v_sub_f32 v108, v100, v104
    v_sub_f32 v109, v101, v104
    v_fmac_f32 v106, v108, v108
    v_fmac_f32 v107, v109, v109
    v_sub_f32 v108, v102, v104
    v_sub_f32 v109, v103, v104
    v_fmac_f32 v106, v108, v108
    v_fmac_f32 v107, v109, v109
    v_add_f32 v106, v106, v107
    s_nop 1
    v_add_f32_dpp v106, v106, v106 row_ror:8 row_mask:0xf bank_mask:0xf
    s_nop 1
    v_add_f32_dpp v106, v106, v106 row_ror:4 row_mask:0xf bank_mask:0xf
    v_mov_b32 v105, v106
    s_nop 1
    v_permlane16_swap_b32 v106, v105
    v_add_f32 v106, v106, v105
    v_mov_b32 v105, v106
    s_nop 1
    v_permlane32_swap_b32 v106, v105
    v_add_f32 v106, v106, v105
    v_mul_f32 v106, 0x3acccccd, v106
    v_cvt_pk_bf16_f32 v106, v106, v106
    v_and_b32 v106, 0xffff0000, v106
    v_add_f32 v106, 0x3727c5ac, v106
    v_cvt_pk_bf16_f32 v106, v106, v106
    v_and_b32 v106, 0xffff0000, v106
    v_sqrt_f32 v106, v106
    s_nop 0
    v_cvt_pk_bf16_f32 v106, v106, v106
    v_and_b32 v106, 0xffff0000, v106
    v_rcp_f32 v106, v106
    v_cvt_pk_bf16_f32 v104, v104, v104
    v_and_b32 v104, 0xffff0000, v104
    v_sub_f32 v64, v64, v104
    v_sub_f32 v65, v65, v104
    v_cvt_pk_bf16_f32 v16, v64, v65
    v_lshlrev_b32 v64, 16, v16
    v_and_b32 v65, 0xffff0000, v16
    v_mul_f32 v64, v64, v106
    v_mul_f32 v65, v65, v106
    v_cvt_pk_bf16_f32 v16, v64, v65
    v_sub_f32 v66, v66, v104
    v_sub_f32 v67, v67, v104
    v_cvt_pk_bf16_f32 v17, v66, v67
    v_lshlrev_b32 v66, 16, v17
    v_and_b32 v67, 0xffff0000, v17
    v_mul_f32 v66, v66, v106
    v_mul_f32 v67, v67, v106
    v_cvt_pk_bf16_f32 v17, v66, v67
    v_sub_f32 v68, v68, v104
    v_sub_f32 v69, v69, v104
    v_cvt_pk_bf16_f32 v18, v68, v69
    v_lshlrev_b32 v68, 16, v18
    v_and_b32 v69, 0xffff0000, v18
    v_mul_f32 v68, v68, v106
    v_mul_f32 v69, v69, v106
    v_cvt_pk_bf16_f32 v18, v68, v69
    v_sub_f32 v70, v70, v104
    v_sub_f32 v71, v71, v104
    v_cvt_pk_bf16_f32 v19, v70, v71
    v_lshlrev_b32 v70, 16, v19
    v_and_b32 v71, 0xffff0000, v19
    v_mul_f32 v70, v70, v106
    v_mul_f32 v71, v71, v106
    v_cvt_pk_bf16_f32 v19, v70, v71
    v_sub_f32 v72, v72, v104
    v_sub_f32 v73, v73, v104
    v_cvt_pk_bf16_f32 v20, v72, v73
    v_lshlrev_b32 v72, 16, v20
    v_and_b32 v73, 0xffff0000, v20
    v_mul_f32 v72, v72, v106
    v_mul_f32 v73, v73, v106
    v_cvt_pk_bf16_f32 v20, v72, v73
    v_sub_f32 v74, v74, v104
    v_sub_f32 v75, v75, v104
    v_cvt_pk_bf16_f32 v21, v74, v75
    v_lshlrev_b32 v74, 16, v21
    v_and_b32 v75, 0xffff0000, v21
    v_mul_f32 v74, v74, v106
    v_mul_f32 v75, v75, v106
    v_cvt_pk_bf16_f32 v21, v74, v75
    v_sub_f32 v76, v76, v104
    v_sub_f32 v77, v77, v104
    v_cvt_pk_bf16_f32 v22, v76, v77
    v_lshlrev_b32 v76, 16, v22
    v_and_b32 v77, 0xffff0000, v22
    v_mul_f32 v76, v76, v106
    v_mul_f32 v77, v77, v106
    v_cvt_pk_bf16_f32 v22, v76, v77
    v_sub_f32 v78, v78, v104
    v_sub_f32 v79, v79, v104
    v_cvt_pk_bf16_f32 v23, v78, v79
    v_lshlrev_b32 v78, 16, v23
    v_and_b32 v79, 0xffff0000, v23
    v_mul_f32 v78, v78, v106
    v_mul_f32 v79, v79, v106
    v_cvt_pk_bf16_f32 v23, v78, v79
    v_sub_f32 v80, v80, v104
    v_sub_f32 v81, v81, v104
    v_cvt_pk_bf16_f32 v24, v80, v81
    v_lshlrev_b32 v80, 16, v24
    v_and_b32 v81, 0xffff0000, v24
    v_mul_f32 v80, v80, v106
    v_mul_f32 v81, v81, v106
    v_cvt_pk_bf16_f32 v24, v80, v81
    v_sub_f32 v82, v82, v104
    v_sub_f32 v83, v83, v104
    v_cvt_pk_bf16_f32 v25, v82, v83
    v_lshlrev_b32 v82, 16, v25
    v_and_b32 v83, 0xffff0000, v25
    v_mul_f32 v82, v82, v106
    v_mul_f32 v83, v83, v106
    v_cvt_pk_bf16_f32 v25, v82, v83
    v_sub_f32 v84, v84, v104
    v_sub_f32 v85, v85, v104
    v_cvt_pk_bf16_f32 v26, v84, v85
    v_lshlrev_b32 v84, 16, v26
    v_and_b32 v85, 0xffff0000, v26
    v_mul_f32 v84, v84, v106
    v_mul_f32 v85, v85, v106
    v_cvt_pk_bf16_f32 v26, v84, v85
    v_sub_f32 v86, v86, v104
    v_sub_f32 v87, v87, v104
    v_cvt_pk_bf16_f32 v27, v86, v87
    v_lshlrev_b32 v86, 16, v27
    v_and_b32 v87, 0xffff0000, v27
    v_mul_f32 v86, v86, v106
    v_mul_f32 v87, v87, v106
    v_cvt_pk_bf16_f32 v27, v86, v87
    v_sub_f32 v88, v88, v104
    v_sub_f32 v89, v89, v104
    v_cvt_pk_bf16_f32 v28, v88, v89
    v_lshlrev_b32 v88, 16, v28
    v_and_b32 v89, 0xffff0000, v28
    v_mul_f32 v88, v88, v106
    v_mul_f32 v89, v89, v106
    v_cvt_pk_bf16_f32 v28, v88, v89
    v_sub_f32 v90, v90, v104
    v_sub_f32 v91, v91, v104
    v_cvt_pk_bf16_f32 v29, v90, v91
    v_lshlrev_b32 v90, 16, v29
    v_and_b32 v91, 0xffff0000, v29
    v_mul_f32 v90, v90, v106
    v_mul_f32 v91, v91, v106
    v_cvt_pk_bf16_f32 v29, v90, v91
    v_sub_f32 v92, v92, v104
    v_sub_f32 v93, v93, v104
    v_cvt_pk_bf16_f32 v30, v92, v93
    v_lshlrev_b32 v92, 16, v30
    v_and_b32 v93, 0xffff0000, v30
    v_mul_f32 v92, v92, v106
    v_mul_f32 v93, v93, v106
    v_cvt_pk_bf16_f32 v30, v92, v93
    v_sub_f32 v94, v94, v104
    v_sub_f32 v95, v95, v104
    v_cvt_pk_bf16_f32 v31, v94, v95
    v_lshlrev_b32 v94, 16, v31
    v_and_b32 v95, 0xffff0000, v31
    v_mul_f32 v94, v94, v106
    v_mul_f32 v95, v95, v106
    v_cvt_pk_bf16_f32 v31, v94, v95
    v_sub_f32 v96, v96, v104
    v_sub_f32 v97, v97, v104
    v_cvt_pk_bf16_f32 v32, v96, v97
    v_lshlrev_b32 v96, 16, v32
    v_and_b32 v97, 0xffff0000, v32
    v_mul_f32 v96, v96, v106
    v_mul_f32 v97, v97, v106
    v_cvt_pk_bf16_f32 v32, v96, v97
    v_sub_f32 v98, v98, v104
    v_sub_f32 v99, v99, v104
    v_cvt_pk_bf16_f32 v33, v98, v99
    v_lshlrev_b32 v98, 16, v33
    v_and_b32 v99, 0xffff0000, v33
    v_mul_f32 v98, v98, v106
    v_mul_f32 v99, v99, v106
    v_cvt_pk_bf16_f32 v33, v98, v99
    v_sub_f32 v100, v100, v104
    v_sub_f32 v101, v101, v104
    v_cvt_pk_bf16_f32 v34, v100, v101
    v_lshlrev_b32 v100, 16, v34
    v_and_b32 v101, 0xffff0000, v34
    v_mul_f32 v100, v100, v106
    v_mul_f32 v101, v101, v106
    v_cvt_pk_bf16_f32 v34, v100, v101
    v_sub_f32 v102, v102, v104
    v_sub_f32 v103, v103, v104
    v_cvt_pk_bf16_f32 v35, v102, v103
    v_lshlrev_b32 v102, 16, v35
    v_and_b32 v103, 0xffff0000, v35
    v_mul_f32 v102, v102, v106
    v_mul_f32 v103, v103, v106
    v_cvt_pk_bf16_f32 v35, v102, v103
    s_add_u32 s43, s25, 4194304
    buffer_store_dwordx4 v[16:19], v6, s[4:7], s43 offen sc1
    s_add_u32 s43, s25, 4198400
    buffer_store_dwordx4 v[20:23], v6, s[4:7], s43 offen sc1
    s_add_u32 s43, s25, 4202496
    buffer_store_dwordx4 v[24:27], v6, s[4:7], s43 offen sc1
    s_add_u32 s43, s25, 4206592
    buffer_store_dwordx4 v[28:31], v6, s[4:7], s43 offen sc1
    s_add_u32 s43, s25, 4210688
    buffer_store_dwordx4 v[32:35], v6, s[4:7], s43 offen sc1
    s_branch L_ur
L_um:
    v_bfe_u32 v3, v0, 2, 3
    v_bfe_u32 v3, v0, 4, 2
    v_bfe_u32 v4, v0, 2, 1
    v_lshl_add_u32 v3, v3, 1, v4
    v_mul_u32_u24 v4, 1280, v3
    v_lshrrev_b32 v3, 6, v0
    v_lshl_add_u32 v4, v3, 5, v4
    v_and_b32 v3, 3, v0
    v_lshl_add_u32 v4, v3, 3, v4
    v_bfe_u32 v3, v0, 3, 1
    v_lshl_add_u32 v4, v3, 2, v4
    buffer_load_dword v112, v4, s[12:15], 0 offen offset:0
    buffer_load_dword v113, v4, s[12:15], 0 offen offset:128
    buffer_load_dword v114, v4, s[12:15], 0 offen offset:256
    buffer_load_dword v115, v4, s[12:15], 0 offen offset:384
    buffer_load_dword v116, v4, s[12:15], 0 offen offset:512
    buffer_load_dword v117, v4, s[12:15], 0 offen offset:640
    buffer_load_dword v118, v4, s[12:15], 0 offen offset:768
    buffer_load_dword v119, v4, s[12:15], 0 offen offset:896
    buffer_load_dword v120, v4, s[12:15], 0 offen offset:1024
    buffer_load_dword v121, v4, s[12:15], 0 offen offset:1152
    s_mul_i32 s41, s20, 10240
    s_add_u32 s41, s41, 262144
    s_waitcnt vmcnt(0)
    v_lshlrev_b32 v7, 2, v0
    v_min_u32 v112, -2, v112
    s_add_u32 s42, s41, 0
    buffer_store_dword v112, v7, s[4:7], s42 offen offset:0 sc1
    v_min_u32 v113, -2, v113
    s_add_u32 s42, s41, 0
    buffer_store_dword v113, v7, s[4:7], s42 offen offset:1024 sc1
    v_min_u32 v114, -2, v114
    s_add_u32 s42, s41, 0
    buffer_store_dword v114, v7, s[4:7], s42 offen offset:2048 sc1
    v_min_u32 v115, -2, v115
    s_add_u32 s42, s41, 0
    buffer_store_dword v115, v7, s[4:7], s42 offen offset:3072 sc1
    v_min_u32 v116, -2, v116
    s_add_u32 s42, s41, 4096
    buffer_store_dword v116, v7, s[4:7], s42 offen offset:0 sc1
    v_min_u32 v117, -2, v117
    s_add_u32 s42, s41, 4096
    buffer_store_dword v117, v7, s[4:7], s42 offen offset:1024 sc1
    v_min_u32 v118, -2, v118
    s_add_u32 s42, s41, 4096
    buffer_store_dword v118, v7, s[4:7], s42 offen offset:2048 sc1
    v_min_u32 v119, -2, v119
    s_add_u32 s42, s41, 4096
    buffer_store_dword v119, v7, s[4:7], s42 offen offset:3072 sc1
    v_min_u32 v120, -2, v120
    s_add_u32 s42, s41, 8192
    buffer_store_dword v120, v7, s[4:7], s42 offen offset:0 sc1
    v_min_u32 v121, -2, v121
    s_add_u32 s42, s41, 8192
    buffer_store_dword v121, v7, s[4:7], s42 offen offset:1024 sc1
L_ur:
    s_waitcnt vmcnt(0)
    s_barrier
    s_cmp_lg_u32 s22, 0
    s_cbranch_scc1 Lrg_68
    v_mov_b32 v3, s96
    v_mov_b32 v4, s97
    s_mov_b64 exec, 1
    global_atomic_add v3, v4, s[74:75] offset:128 sc1
    s_mov_b64 exec, -1
Lrg_68:
L_wo:
    s_sub_u32 s24, s21, 12
    s_lshl_b32 s25, s24, 2
    s_add_u32 s25, s25, s22
    s_lshl_b32 s26, s20, 2
    s_add_u32 s26, s26, s22
    s_mov_b32 s8, s66
    s_and_b32 s9, s67, 0xffff
    s_mov_b32 s10, 0x780000
    s_mov_b32 s11, 0x00020000
    s_cmp_lg_u32 s25, 8
    s_cbranch_scc1 Lnc_69
    s_lshl_b32 s38, s20, 7
    s_add_u32 s38, s38, 3424256
    s_add_u32 s39, s38, 8192
    s_mov_b32 s40, -1
    s_mov_b32 s41, -1
    s_mov_b32 s42, 4
    v_mov_b32 v10, 0
    s_mov_b64 exec, 1
Lcal_70:
    buffer_store_dword v10, v10, s[4:7], s38 offen sc1
    s_waitcnt vmcnt(0)
    s_memtime s[44:45]
    s_waitcnt lgkmcnt(0)
    buffer_load_dword v11, v10, s[4:7], s38 offen sc1
    s_waitcnt vmcnt(0)
    s_memtime s[46:47]
    s_waitcnt lgkmcnt(0)
    s_sub_u32 s46, s46, s44
    s_min_u32 s40, s40, s46
    buffer_store_dword v10, v10, s[4:7], s39 offen sc1
    s_waitcnt vmcnt(0)
    s_memtime s[44:45]
    s_waitcnt lgkmcnt(0)
    buffer_load_dword v11, v10, s[4:7], s39 offen sc1
    s_waitcnt vmcnt(0)
    s_memtime s[46:47]
    s_waitcnt lgkmcnt(0)
    s_sub_u32 s46, s46, s44
    s_min_u32 s41, s41, s46
    s_sub_u32 s42, s42, 1
    s_cmp_lg_u32 s42, 0
    s_cbranch_scc1 Lcal_70
    s_cmp_lt_u32 s41, s40
    s_cselect_b32 s38, 2, 1
    v_mov_b32 v11, s38
    s_lshl_b32 s38, s20, 2
    v_mov_b32 v10, s38
    global_store_dword v10, v11, s[74:75] offset:96 sc1
    s_mov_b64 exec, -1
Lnc_69:
    v_min_u32 v25, 23, v1
    v_lshlrev_b32 v25, 7, v25
    v_min_u32 v26, 31, v1
    v_lshlrev_b32 v26, 7, v26
    v_min_u32 v27, 47, v1
    v_lshlrev_b32 v27, 7, v27
    v_min_u32 v28, 63, v1
    v_lshlrev_b32 v28, 7, v28
    s_cmp_lg_u32 s24, 0
    s_cbranch_scc1 Ltj_71
    s_mul_i32 s38, s26, 12288
    s_add_u32 s38, s38, 41943040
    buffer_load_dword v24, v28, s[4:7], s38 offen sc1
    s_mul_i32 s38, s26, 6144
    s_add_u32 s38, s38, 117440512
    buffer_load_dword v24, v27, s[4:7], s38 offen sc1
Ltj_71:
    s_cmp_lg_u32 s24, 1
    s_cbranch_scc1 Ltj_72
    s_mul_i32 s38, s26, 12288
    s_add_u32 s38, s38, 41951232
    buffer_load_dword v24, v26, s[4:7], s38 offen sc1
    s_mul_i32 s38, s26, 3072
    s_add_u32 s38, s38, 130023424
    buffer_load_dword v24, v25, s[4:7], s38 offen sc1
Ltj_72:
    s_cmp_lg_u32 s24, 2
    s_cbranch_scc1 Ltj_73
    s_mul_i32 s38, s26, 12288
    s_add_u32 s38, s38, 67108864
    buffer_load_dword v24, v28, s[4:7], s38 offen sc1
    s_mul_i32 s38, s26, 12288
    s_add_u32 s38, s38, 17170432
    buffer_load_dword v24, v28, s[4:7], s38 offen sc1
Ltj_73:
    s_cmp_lg_u32 s24, 3
    s_cbranch_scc1 Ltj_74
    s_mul_i32 s38, s26, 12288
    s_add_u32 s38, s38, 67117056
    buffer_load_dword v24, v26, s[4:7], s38 offen sc1
    s_mul_i32 s38, s26, 12288
    s_add_u32 s38, s38, 17178624
    buffer_load_dword v24, v26, s[4:7], s38 offen sc1
Ltj_74:
    s_cmp_lg_u32 s24, 4
    s_cbranch_scc1 Ltj_75
    s_mul_i32 s38, s26, 12288
    s_add_u32 s38, s38, 42336256
    buffer_load_dword v24, v28, s[4:7], s38 offen sc1
    s_mul_i32 s38, s26, 6144
    s_add_u32 s38, s38, 117637120
    buffer_load_dword v24, v27, s[4:7], s38 offen sc1
Ltj_75:
    s_cmp_lg_u32 s24, 5
    s_cbranch_scc1 Ltj_76
    s_mul_i32 s38, s26, 12288
    s_add_u32 s38, s38, 42344448
    buffer_load_dword v24, v26, s[4:7], s38 offen sc1
    s_mul_i32 s38, s26, 3072
    s_add_u32 s38, s38, 130121728
    buffer_load_dword v24, v25, s[4:7], s38 offen sc1
Ltj_76:
    s_cmp_lg_u32 s24, 6
    s_cbranch_scc1 Ltj_77
    s_mul_i32 s38, s26, 12288
    s_add_u32 s38, s38, 67502080
    buffer_load_dword v24, v28, s[4:7], s38 offen sc1
Ltj_77:
    s_cmp_lg_u32 s24, 7
    s_cbranch_scc1 Ltj_78
    s_mul_i32 s38, s26, 12288
    s_add_u32 s38, s38, 67510272
    buffer_load_dword v24, v26, s[4:7], s38 offen sc1
Ltj_78:
    s_cmp_lg_u32 s24, 8
    s_cbranch_scc1 Ltj_79
    s_mul_i32 s38, s26, 12288
    s_add_u32 s38, s38, 16777216
    buffer_load_dword v24, v28, s[4:7], s38 offen sc1
Ltj_79:
    s_cmp_lg_u32 s24, 9
    s_cbranch_scc1 Ltj_80
    s_mul_i32 s38, s26, 12288
    s_add_u32 s38, s38, 16785408
    buffer_load_dword v24, v26, s[4:7], s38 offen sc1
Ltj_80:
    s_mov_b32 s52, 0x3dd53b95
    s_mov_b32 s53, 0xbdd53b95
    v_and_b32 v14, 15, v1
    v_lshrrev_b32 v15, 4, v1
    v_and_b32 v13, 7, v14
    v_lshlrev_b32 v13, 4, v13
    v_lshl_add_u32 v13, v15, 7, v13
    v_bfe_u32 v5, v1, 3, 1
    s_lshl_b32 s38, s22, 9
    s_add_u32 s38, s38, 98304
    v_add_u32 v6, s38, v13
    v_lshl_add_u32 v6, v5, 14, v6
    s_lshl_b32 s38, s22, 11
    s_add_u32 s38, s38, 98304
    v_add_u32 v7, s38, v13
    v_lshl_add_u32 v7, v5, 10, v7
    v_bfe_u32 v8, v1, 1, 2
    v_add_u32 v8, v8, v15
    v_and_b32 v8, 3, v8
    v_and_b32 v9, 7, v1
    v_lshlrev_b32 v9, 6, v9
    v_lshl_add_u32 v9, v8, 4, v9
    v_sub_u32 v9, v9, v13
    v_add_u32 v6, v6, v9
    v_add_u32 v8, v1, v15
    v_and_b32 v8, 3, v8
    v_bfe_u32 v9, v1, 2, 1
    v_lshl_add_u32 v9, v15, 1, v9
    v_lshlrev_b32 v9, 6, v9
    v_lshl_add_u32 v9, v8, 4, v9
    v_sub_u32 v9, v9, v13
    v_add_u32 v7, v7, v9
    v_lshrrev_b32 v13, 1, v13
    v_lshl_add_u32 v13, v5, 13, v13
    v_and_b32 v4, 0x1fff, v13
    v_lshlrev_b32 v9, 2, v5
    v_xor_b32 v9, s20, v9
    v_xor_b32 v8, 0, v9
    v_lshl_add_u32 v240, v8, 9, v4
    v_xor_b32 v8, 1, v9
    v_lshl_add_u32 v241, v8, 9, v4
    v_xor_b32 v8, 2, v9
    v_lshl_add_u32 v242, v8, 9, v4
    v_xor_b32 v8, 3, v9
    v_lshl_add_u32 v243, v8, 9, v4
    v_and_b32 v9, 7, v1
    v_lshlrev_b32 v8, 4, v9
    v_lshl_add_u32 v8, v5, 7, v8
    v_lshl_add_u32 v8, v15, 2, v8
    v_bfe_u32 v9, v1, 2, 1
    v_lshl_add_u32 v9, v15, 1, v9
    v_lshlrev_b32 v8, 4, v9
    v_lshl_add_u32 v8, v5, 7, v8
    v_and_b32 v9, 3, v1
    v_lshl_add_u32 v8, v9, 2, v8
    v_bfe_u32 v8, v1, 2, 1
    v_lshl_add_u32 v8, v5, 1, v8
    v_lshl_add_u32 v8, v15, 2, v8
    v_lshlrev_b32 v8, 4, v8
    v_lshl_add_u32 v8, v9, 2, v8
    s_lshl_b32 s38, s25, 8
    v_add_u32 v8, s38, v8
    v_lshrrev_b32 v9, 1, v1
    v_cmp_lt_u32 vcc, 2, v9
    v_lshlrev_b32 v9, 10, v9
    v_add_u32 v10, -2944, v9
    v_cndmask_b32 v9, v9, v10, vcc
    v_and_b32 v10, 1, v1
    v_lshl_add_u32 v9, v10, 9, v9
    v_lshlrev_b32 v253, 2, v1
    v_mov_b32 v248, -1
    v_mov_b32 v249, -1
    v_mov_b32 v250, -1
    v_mov_b32 v251, -1
    s_mov_b32 s68, 0xff00ff00
    s_mov_b32 s69, 0xff00ff00
    s_mov_b32 s70, 0x3f80
    s_mov_b32 s71, 0x3f800000
    v_mov_b32 v224, 0xf149f2ca
    s_mov_b32 vcc_lo, 0
    s_mov_b32 vcc_hi, 0x00ff00ff
    v_cndmask_b32 v224, v224, 0, vcc
    v_mov_b32 v225, v224
    v_mov_b32 v226, v224
    v_mov_b32 v227, v224
    v_mov_b32 v246, 0x44444444
    v_mov_b32 v11, 0xeeeeeeee
    v_and_b32 v12, 2, v1
    v_cmp_lt_u32 vcc, 0, v12
    s_nop 1
    v_cndmask_b32 v246, v246, v11, vcc
    v_mov_b32 v11, 0x3f803f80
    v_accvgpr_write_b32 a96, v11
    v_accvgpr_write_b32 a97, v11
    v_accvgpr_write_b32 a98, v11
    v_accvgpr_write_b32 a99, v11
    v_mov_b32 v11, 0x3f003f00
    v_accvgpr_write_b32 a100, v11
    v_accvgpr_write_b32 a101, v11
    s_mul_i32 s58, s26, 6144
    s_add_u32 s58, s58, 589824
    s_mul_i32 s57, s26, 3072
    s_add_u32 s57, s57, 1376256
    s_lshr_b32 s59, s25, 1
    s_lshl_b32 s59, s59, 14
    s_and_b32 s38, s25, 1
    s_lshl_b32 s38, s38, 12
    s_add_u32 s59, s59, s38
    s_add_u32 s59, s59, 2097152
    s_lshl_b32 s60, s20, 9
    s_add_u32 s60, s60, s59
    s_mul_i32 s61, s20, 10240
    s_add_u32 s61, s61, 262144
    s_mul_i32 s62, s26, 12288
    s_lshl_b32 s63, s26, 6
    s_add_u32 s63, s63, 4096
    s_lshl_b32 s38, s20, 2
    v_mov_b32 v10, s38
    s_mov_b32 s31, 262144
    s_mov_b32 exec_lo, 0x1
    s_mov_b32 exec_hi, 0
Lf_81:
    global_load_dword v228, v10, s[74:75] offset:96 sc1
    s_waitcnt vmcnt(0)
    v_cmp_eq_u32 vcc, 0, v228
    s_cbranch_vccz Lfd_82
    s_sleep 4
    s_sub_u32 s31, s31, 1
    s_cbranch_scc0 Lf_81
    s_mov_b32 s31, 12
    s_branch L_fail
Lfd_82:
    s_mov_b64 exec, -1
    v_readfirstlane_b32 s38, v228
    s_nop 3
    s_and_b32 s38, s38, 2
    s_lshl_b32 s38, s38, 12
    s_add_u32 s59, s59, s38
    s_lshl_b32 s38, s22, 2
    s_add_u32 s38, s38, 106496
    v_lshlrev_b32 v10, 4, v14
    v_add_u32 v10, s38, v10
    v_and_b32 v11, 7, v14
    v_bfe_u32 v11, v1, 2, 1
    v_lshl_add_u32 v11, v15, 1, v11
    v_lshlrev_b32 v11, 4, v11
    v_bfe_u32 v12, v1, 3, 1
    v_lshl_add_u32 v11, v12, 3, v11
    v_add_u32 v11, 106496, v11
    v_min_u32 v12, 12, v1
    v_lshlrev_b32 v12, 2, v12
    v_bfe_u32 v15, v1, 3, 1
    v_mul_u32_u24 v14, 1016, v15
    v_sub_u32 v7, v7, v14
    v_lshlrev_b32 v14, 3, v15
    v_sub_u32 v11, v11, v14
    v_lshlrev_b32 v15, 2, v1
    s_xor_b32 s38, s20, 1
    s_lshl_b32 s38, s38, 9
    v_add_u32 v240, s38, v15
    s_xor_b32 s38, s20, 2
    s_lshl_b32 s38, s38, 9
    v_add_u32 v241, s38, v15
    s_xor_b32 s38, s20, 3
    s_lshl_b32 s38, s38, 9
    v_add_u32 v242, s38, v15
    s_xor_b32 s38, s20, 4
    s_lshl_b32 s38, s38, 9
    v_add_u32 v243, s38, v15
    s_xor_b32 s38, s20, 5
    s_lshl_b32 s38, s38, 9
    v_add_u32 v4, s38, v15
    s_xor_b32 s38, s20, 6
    s_lshl_b32 s38, s38, 9
    v_add_u32 v5, s38, v15
    s_xor_b32 s38, s20, 7
    s_lshl_b32 s38, s38, 9
    v_add_u32 v14, s38, v15
    s_mov_b32 s31, 262144
    v_lshlrev_b32 v230, 2, v1
    s_mov_b32 exec_hi, 0
Lwr_83:
    global_load_dword v228, v230, s[74:75] offset:128 sc1
    s_mov_b32 s23, 0
    s_mov_b32 s38, 0
    s_waitcnt vmcnt(0)
    v_cmp_eq_u32 vcc, 0x20, v228
    s_nop 0
    s_or_b32 s38, s38, vcc_lo
    v_cmp_eq_u32 vcc, 0x2000, v228
    s_nop 0
    s_or_b32 s38, s38, vcc_lo
    v_cmp_eq_u32 vcc, 0x200000, v228
    s_nop 0
    s_or_b32 s38, s38, vcc_lo
    v_cmp_eq_u32 vcc, 0x20000000, v228
    s_nop 0
    s_or_b32 s38, s38, vcc_lo
    v_sad_u8 v229, v228, 0, 0
    s_bcnt1_i32_b32 s38, s38
    s_cmp_eq_u32 s38, 8
    s_cbranch_scc1 Lwd_84
    v_add_u32_dpp v229, v229, v229 row_shr:1 row_mask:0xf bank_mask:0xf bound_ctrl:0
    s_nop 1
    v_add_u32_dpp v229, v229, v229 row_shr:2 row_mask:0xf bank_mask:0xf bound_ctrl:0
    s_nop 1
    v_add_u32_dpp v229, v229, v229 row_shr:4 row_mask:0xf bank_mask:0xf bound_ctrl:0
    s_nop 1
    v_add_u32_dpp v229, v229, v229 row_shr:8 row_mask:0xf bank_mask:0xf bound_ctrl:0
    s_nop 0
    v_readlane_b32 s38, v229, 15
    v_readlane_b32 s39, v229, 31
    s_mov_b32 s23, 1
    s_add_u32 s38, s38, s39
    s_cmp_eq_u32 s38, 256
    s_cbranch_scc1 Lwd_84
    s_sleep 16
    s_sub_u32 s31, s31, 1
    s_cbranch_scc0 Lwr_83
    s_mov_b32 s31, 10
    s_branch L_fail
Lwd_84:
    s_mov_b64 exec, -1
    s_mul_i32 s28, s26, 245760
    s_lshl_b32 s29, s24, 7
    s_add_u32 s28, s28, s29
    v_lshrrev_b32 v17, 3, v1
    v_bfe_u32 v18, v1, 4, 2
    v_lshlrev_b32 v18, 1, v18
    v_and_b32 v19, 7, v1
    v_xor_b32 v19, v19, v18
    v_mul_u32_u24 v16, 1280, v17
    v_lshl_add_u32 v16, v19, 4, v16
    s_mul_i32 s46, s22, 24576
    s_add_u32 m0, s46, 0
    s_nop 0
    buffer_load_dwordx4 v16, s[8:11], s28 offen nt lds
    s_add_u32 s28, s28, 10240
    s_add_u32 m0, s46, 1024
    s_nop 0
    buffer_load_dwordx4 v16, s[8:11], s28 offen nt lds
    s_add_u32 s28, s28, 10240
    s_add_u32 m0, s46, 2048
    s_nop 0
    buffer_load_dwordx4 v16, s[8:11], s28 offen nt lds
    s_add_u32 s28, s28, 10240
    s_add_u32 m0, s46, 3072
    s_nop 0
    buffer_load_dwordx4 v16, s[8:11], s28 offen nt lds
    s_add_u32 s28, s28, 10240
    s_add_u32 m0, s46, 4096
    s_nop 0
    buffer_load_dwordx4 v16, s[8:11], s28 offen nt lds
    s_add_u32 s28, s28, 10240
    s_add_u32 m0, s46, 5120
    s_nop 0
    buffer_load_dwordx4 v16, s[8:11], s28 offen nt lds
    s_add_u32 s28, s28, 10240
    s_add_u32 m0, s46, 6144
    s_nop 0
    buffer_load_dwordx4 v16, s[8:11], s28 offen nt lds
    s_add_u32 s28, s28, 10240
    s_add_u32 m0, s46, 7168
    s_nop 0
    buffer_load_dwordx4 v16, s[8:11], s28 offen nt lds
    s_add_u32 s28, s28, 10240
    s_add_u32 m0, s46, 8192
    s_nop 0
    buffer_load_dwordx4 v16, s[8:11], s28 offen nt lds
    s_add_u32 s28, s28, 10240
    s_add_u32 m0, s46, 9216
    s_nop 0
    buffer_load_dwordx4 v16, s[8:11], s28 offen nt lds
    s_add_u32 s28, s28, 10240
    s_add_u32 m0, s46, 10240
    s_nop 0
    buffer_load_dwordx4 v16, s[8:11], s28 offen nt lds
    s_add_u32 s28, s28, 10240
    s_add_u32 m0, s46, 11264
    s_nop 0
    buffer_load_dwordx4 v16, s[8:11], s28 offen nt lds
    s_add_u32 s28, s28, 10240
    s_add_u32 m0, s46, 12288
    s_nop 0
    buffer_load_dwordx4 v16, s[8:11], s28 offen nt lds
    s_add_u32 s28, s28, 10240
    s_add_u32 m0, s46, 13312
    s_nop 0
    buffer_load_dwordx4 v16, s[8:11], s28 offen nt lds
    s_add_u32 s28, s28, 10240
    s_add_u32 m0, s46, 14336
    s_nop 0
    buffer_load_dwordx4 v16, s[8:11], s28 offen nt lds
    s_add_u32 s28, s28, 10240
    s_add_u32 m0, s46, 15360
    s_nop 0
    buffer_load_dwordx4 v16, s[8:11], s28 offen nt lds
    s_add_u32 s28, s28, 10240
    s_add_u32 m0, s46, 16384
    s_nop 0
    buffer_load_dwordx4 v16, s[8:11], s28 offen nt lds
    s_add_u32 s28, s28, 10240
    s_add_u32 m0, s46, 17408
    s_nop 0
    buffer_load_dwordx4 v16, s[8:11], s28 offen nt lds
    s_add_u32 s28, s28, 10240
    s_add_u32 m0, s46, 18432
    s_nop 0
    buffer_load_dwordx4 v16, s[8:11], s28 offen nt lds
    s_add_u32 s28, s28, 10240
    s_add_u32 m0, s46, 19456
    s_nop 0
    buffer_load_dwordx4 v16, s[8:11], s28 offen nt lds
    s_add_u32 s28, s28, 10240
    s_add_u32 m0, s46, 20480
    s_nop 0
    buffer_load_dwordx4 v16, s[8:11], s28 offen nt lds
    s_add_u32 s28, s28, 10240
    s_add_u32 m0, s46, 21504
    s_nop 0
    buffer_load_dwordx4 v16, s[8:11], s28 offen nt lds
    s_add_u32 s28, s28, 10240
    s_add_u32 m0, s46, 22528
    s_nop 0
    buffer_load_dwordx4 v16, s[8:11], s28 offen nt lds
    s_add_u32 s28, s28, 10240
    s_add_u32 m0, s46, 23552
    s_nop 0
    buffer_load_dwordx4 v16, s[8:11], s28 offen nt lds
    v_lshrrev_b32 v17, 2, v1
    v_bfe_u32 v18, v17, 1, 2
    v_lshlrev_b32 v17, 7, v17
    v_and_b32 v19, 3, v1
    v_lshl_add_u32 v17, v19, 3, v17
    v_add_u32 v17, s46, v17
    v_xor_b32 v19, 0, v18
    v_lshl_add_u32 v20, v19, 5, v17
    v_xor_b32 v19, 1, v18
    v_lshl_add_u32 v21, v19, 5, v17
    v_xor_b32 v19, 2, v18
    v_lshl_add_u32 v22, v19, 5, v17
    v_xor_b32 v19, 3, v18
    v_lshl_add_u32 v23, v19, 5, v17
    s_waitcnt vmcnt(20)
    ds_read_b64_tr_b16 a[0:1], v20 offset:0
    ds_read_b64_tr_b16 a[2:3], v20 offset:2048
    ds_read_b64_tr_b16 a[24:25], v21 offset:0
    ds_read_b64_tr_b16 a[26:27], v21 offset:2048
    ds_read_b64_tr_b16 a[48:49], v22 offset:0
    ds_read_b64_tr_b16 a[50:51], v22 offset:2048
    ds_read_b64_tr_b16 a[72:73], v23 offset:0
    ds_read_b64_tr_b16 a[74:75], v23 offset:2048
    s_waitcnt vmcnt(16)
    ds_read_b64_tr_b16 a[4:5], v20 offset:4096
    ds_read_b64_tr_b16 a[6:7], v20 offset:6144
    ds_read_b64_tr_b16 a[28:29], v21 offset:4096
    ds_read_b64_tr_b16 a[30:31], v21 offset:6144
    ds_read_b64_tr_b16 a[52:53], v22 offset:4096
    ds_read_b64_tr_b16 a[54:55], v22 offset:6144
    ds_read_b64_tr_b16 a[76:77], v23 offset:4096
    ds_read_b64_tr_b16 a[78:79], v23 offset:6144
    s_waitcnt vmcnt(12)
    ds_read_b64_tr_b16 a[8:9], v20 offset:8192
    ds_read_b64_tr_b16 a[10:11], v20 offset:10240
    ds_read_b64_tr_b16 a[32:33], v21 offset:8192
    ds_read_b64_tr_b16 a[34:35], v21 offset:10240
    ds_read_b64_tr_b16 a[56:57], v22 offset:8192
    ds_read_b64_tr_b16 a[58:59], v22 offset:10240
    ds_read_b64_tr_b16 a[80:81], v23 offset:8192
    ds_read_b64_tr_b16 a[82:83], v23 offset:10240
    s_waitcnt vmcnt(8)
    ds_read_b64_tr_b16 a[12:13], v20 offset:12288
    ds_read_b64_tr_b16 a[14:15], v20 offset:14336
    ds_read_b64_tr_b16 a[36:37], v21 offset:12288
    ds_read_b64_tr_b16 a[38:39], v21 offset:14336
    ds_read_b64_tr_b16 a[60:61], v22 offset:12288
    ds_read_b64_tr_b16 a[62:63], v22 offset:14336
    ds_read_b64_tr_b16 a[84:85], v23 offset:12288
    ds_read_b64_tr_b16 a[86:87], v23 offset:14336
    s_waitcnt vmcnt(4)
    ds_read_b64_tr_b16 a[16:17], v20 offset:16384
    ds_read_b64_tr_b16 a[18:19], v20 offset:18432
    ds_read_b64_tr_b16 a[40:41], v21 offset:16384
    ds_read_b64_tr_b16 a[42:43], v21 offset:18432
    ds_read_b64_tr_b16 a[64:65], v22 offset:16384
    ds_read_b64_tr_b16 a[66:67], v22 offset:18432
    ds_read_b64_tr_b16 a[88:89], v23 offset:16384
    ds_read_b64_tr_b16 a[90:91], v23 offset:18432
    s_waitcnt vmcnt(0)
    ds_read_b64_tr_b16 a[20:21], v20 offset:20480
    ds_read_b64_tr_b16 a[22:23], v20 offset:22528
    ds_read_b64_tr_b16 a[44:45], v21 offset:20480
    ds_read_b64_tr_b16 a[46:47], v21 offset:22528
    ds_read_b64_tr_b16 a[68:69], v22 offset:20480
    ds_read_b64_tr_b16 a[70:71], v22 offset:22528
    ds_read_b64_tr_b16 a[92:93], v23 offset:20480
    ds_read_b64_tr_b16 a[94:95], v23 offset:22528
    s_waitcnt lgkmcnt(0)
    v_accvgpr_mov_b32 a104, a0
    v_accvgpr_mov_b32 a105, a2
    v_accvgpr_mov_b32 a106, a1
    v_accvgpr_mov_b32 a107, a3
    v_accvgpr_mov_b32 a108, a4
    v_accvgpr_mov_b32 a109, a6
    v_accvgpr_mov_b32 a110, a5
    v_accvgpr_mov_b32 a111, a7
    v_accvgpr_mov_b32 a112, a8
    v_accvgpr_mov_b32 a113, a10
    v_accvgpr_mov_b32 a114, a9
    v_accvgpr_mov_b32 a115, a11
    v_accvgpr_mov_b32 a116, a12
    v_accvgpr_mov_b32 a117, a14
    v_accvgpr_mov_b32 a118, a13
    v_accvgpr_mov_b32 a119, a15
    v_accvgpr_mov_b32 a120, a16
    v_accvgpr_mov_b32 a121, a18
    v_accvgpr_mov_b32 a122, a17
    v_accvgpr_mov_b32 a123, a19
    v_accvgpr_mov_b32 a124, a20
    v_accvgpr_mov_b32 a125, a22
    v_accvgpr_mov_b32 a126, a21
    v_accvgpr_mov_b32 a127, a23
    v_accvgpr_mov_b32 a128, a24
    v_accvgpr_mov_b32 a129, a26
    v_accvgpr_mov_b32 a130, a25
    v_accvgpr_mov_b32 a131, a27
    v_accvgpr_mov_b32 a132, a28
    v_accvgpr_mov_b32 a133, a30
    v_accvgpr_mov_b32 a134, a29
    v_accvgpr_mov_b32 a135, a31
    v_accvgpr_mov_b32 a136, a32
    v_accvgpr_mov_b32 a137, a34
    v_accvgpr_mov_b32 a138, a33
    v_accvgpr_mov_b32 a139, a35
    v_accvgpr_mov_b32 a140, a36
    v_accvgpr_mov_b32 a141, a38
    v_accvgpr_mov_b32 a142, a37
    v_accvgpr_mov_b32 a143, a39
    v_accvgpr_mov_b32 a144, a40
    v_accvgpr_mov_b32 a145, a42
    v_accvgpr_mov_b32 a146, a41
    v_accvgpr_mov_b32 a147, a43
    v_accvgpr_mov_b32 a148, a44
    v_accvgpr_mov_b32 a149, a46
    v_accvgpr_mov_b32 a150, a45
    v_accvgpr_mov_b32 a151, a47
    v_accvgpr_mov_b32 a152, a48
    v_accvgpr_mov_b32 a153, a50
    v_accvgpr_mov_b32 a154, a49
    v_accvgpr_mov_b32 a155, a51
    v_accvgpr_mov_b32 a156, a52
    v_accvgpr_mov_b32 a157, a54
    v_accvgpr_mov_b32 a158, a53
    v_accvgpr_mov_b32 a159, a55
    v_accvgpr_mov_b32 a160, a56
    v_accvgpr_mov_b32 a161, a58
    v_accvgpr_mov_b32 a162, a57
    v_accvgpr_mov_b32 a163, a59
    v_accvgpr_mov_b32 a164, a60
    v_accvgpr_mov_b32 a165, a62
    v_accvgpr_mov_b32 a166, a61
    v_accvgpr_mov_b32 a167, a63
    v_accvgpr_mov_b32 a168, a64
    v_accvgpr_mov_b32 a169, a66
    v_accvgpr_mov_b32 a170, a65
    v_accvgpr_mov_b32 a171, a67
    v_accvgpr_mov_b32 a172, a68
    v_accvgpr_mov_b32 a173, a70
    v_accvgpr_mov_b32 a174, a69
    v_accvgpr_mov_b32 a175, a71
    v_accvgpr_mov_b32 a176, a72
    v_accvgpr_mov_b32 a177, a74
    v_accvgpr_mov_b32 a178, a73
    v_accvgpr_mov_b32 a179, a75
    v_accvgpr_mov_b32 a180, a76
    v_accvgpr_mov_b32 a181, a78
    v_accvgpr_mov_b32 a182, a77
    v_accvgpr_mov_b32 a183, a79
    v_accvgpr_mov_b32 a184, a80
    v_accvgpr_mov_b32 a185, a82
    v_accvgpr_mov_b32 a186, a81
    v_accvgpr_mov_b32 a187, a83
    v_accvgpr_mov_b32 a188, a84
    v_accvgpr_mov_b32 a189, a86
    v_accvgpr_mov_b32 a190, a85
    v_accvgpr_mov_b32 a191, a87
    v_accvgpr_mov_b32 a192, a88
    v_accvgpr_mov_b32 a193, a90
    v_accvgpr_mov_b32 a194, a89
    v_accvgpr_mov_b32 a195, a91
    v_accvgpr_mov_b32 a196, a92
    v_accvgpr_mov_b32 a197, a94
    v_accvgpr_mov_b32 a198, a93
    v_accvgpr_mov_b32 a199, a95
    v_lshrrev_b32 v16, 4, v1
    s_mov_b32 s38, 327680
    v_mul_lo_u32 v16, s38, v16
    v_bfe_u32 v17, v1, 1, 3
    v_lshl_add_u32 v16, v17, 9, v16
    v_and_b32 v17, 1, v1
    v_lshl_add_u32 v16, v17, 7, v16
    buffer_load_dword v17, v16, s[4:7], s59 offen sc1
    s_mov_b64 exec, -1
    s_mov_b32 s31, 262144
    s_mov_b32 exec_lo, 0xfff
    s_mov_b32 exec_hi, 0
Lf_85:
    buffer_load_dword v228, v253, s[4:7], s63 offen sc1
    s_waitcnt vmcnt(0)
    v_cmp_eq_u32 vcc, 0, v228
    s_cbranch_vccz Lfd_86
    s_sleep 2
    s_sub_u32 s31, s31, 1
    s_cbranch_scc0 Lf_85
    s_mov_b32 s31, 11
    s_branch L_fail
Lfd_86:
    s_mov_b64 exec, -1
    s_mov_b32 s49, 0
    s_and_b32 s48, s49, 7
    s_mul_i32 s48, s48, 393216
    s_add_u32 s48, s48, s62
    s_add_u32 s48, s48, 67108864
    s_add_u32 s46, s48, 4096
    s_add_u32 s56, s48, 8192
    buffer_load_dwordx4 v[88:91], v2, s[4:7], s48 offen offset:0 sc1
    buffer_load_dwordx4 v[112:115], v2, s[4:7], s46 offen offset:2048 sc1
    buffer_load_dwordx4 v[92:95], v2, s[4:7], s48 offen offset:1024 sc1
    buffer_load_dwordx4 v[116:119], v2, s[4:7], s46 offen offset:3072 sc1
    buffer_load_dwordx4 v[96:99], v2, s[4:7], s48 offen offset:2048 sc1
    buffer_load_dwordx4 v[120:123], v2, s[4:7], s56 offen offset:0 sc1
    buffer_load_dwordx4 v[100:103], v2, s[4:7], s48 offen offset:3072 sc1
    buffer_load_dwordx4 v[124:127], v2, s[4:7], s56 offen offset:1024 sc1
    buffer_load_dwordx4 v[104:107], v2, s[4:7], s46 offen offset:0 sc1
    buffer_load_dwordx4 v[128:131], v2, s[4:7], s56 offen offset:2048 sc1
    buffer_load_dwordx4 v[108:111], v2, s[4:7], s46 offen offset:1024 sc1
    buffer_load_dwordx4 v[132:135], v2, s[4:7], s56 offen offset:3072 sc1
    s_and_b32 s48, s49, 7
    s_mul_i32 s48, s48, 393216
    s_add_u32 s48, s48, s62
    s_add_u32 s48, s48, 41943040
    buffer_load_dwordx4 v[40:43], v2, s[4:7], s48 offen offset:0 sc1
    buffer_load_dwordx4 v[44:47], v2, s[4:7], s48 offen offset:1024 sc1
    buffer_load_dwordx4 v[48:51], v2, s[4:7], s48 offen offset:2048 sc1
    buffer_load_dwordx4 v[52:55], v2, s[4:7], s48 offen offset:3072 sc1
    s_add_u32 s48, s48, 4096
    buffer_load_dwordx4 v[56:59], v2, s[4:7], s48 offen offset:0 sc1
    buffer_load_dwordx4 v[60:63], v2, s[4:7], s48 offen offset:1024 sc1
    buffer_load_dwordx4 v[64:67], v2, s[4:7], s48 offen offset:2048 sc1
    buffer_load_dwordx4 v[68:71], v2, s[4:7], s48 offen offset:3072 sc1
    s_add_u32 s48, s48, 4096
    buffer_load_dwordx4 v[72:75], v2, s[4:7], s48 offen offset:0 sc1
    buffer_load_dwordx4 v[76:79], v2, s[4:7], s48 offen offset:1024 sc1
    buffer_load_dwordx4 v[80:83], v2, s[4:7], s48 offen offset:2048 sc1
    buffer_load_dwordx4 v[84:87], v2, s[4:7], s48 offen offset:3072 sc1
    s_waitcnt vmcnt(23)
    v_mfma_f32_16x16x32_bf16 v[168:171], v[88:91], a[0:3], 0
    v_mfma_f32_16x16x32_bf16 v[176:179], v[88:91], a[24:27], 0
    v_mfma_f32_16x16x32_bf16 v[184:187], v[88:91], a[48:51], 0
    v_mfma_f32_16x16x32_bf16 v[192:195], v[88:91], a[72:75], 0
    s_waitcnt vmcnt(22)
    v_mfma_f32_16x16x32_bf16 v[172:175], v[112:115], a[0:3], 0
    v_mfma_f32_16x16x32_bf16 v[180:183], v[112:115], a[24:27], 0
    v_mfma_f32_16x16x32_bf16 v[188:191], v[112:115], a[48:51], 0
    v_mfma_f32_16x16x32_bf16 v[196:199], v[112:115], a[72:75], 0
    s_waitcnt vmcnt(21)
    v_mfma_f32_16x16x32_bf16 v[168:171], v[92:95], a[4:7], v[168:171]
    v_mfma_f32_16x16x32_bf16 v[176:179], v[92:95], a[28:31], v[176:179]
    v_mfma_f32_16x16x32_bf16 v[184:187], v[92:95], a[52:55], v[184:187]
    v_mfma_f32_16x16x32_bf16 v[192:195], v[92:95], a[76:79], v[192:195]
    s_waitcnt vmcnt(20)
    v_mfma_f32_16x16x32_bf16 v[172:175], v[116:119], a[4:7], v[172:175]
    v_mfma_f32_16x16x32_bf16 v[180:183], v[116:119], a[28:31], v[180:183]
    v_mfma_f32_16x16x32_bf16 v[188:191], v[116:119], a[52:55], v[188:191]
    v_mfma_f32_16x16x32_bf16 v[196:199], v[116:119], a[76:79], v[196:199]
    s_waitcnt vmcnt(19)
    v_mfma_f32_16x16x32_bf16 v[168:171], v[96:99], a[8:11], v[168:171]
    v_mfma_f32_16x16x32_bf16 v[176:179], v[96:99], a[32:35], v[176:179]
    v_mfma_f32_16x16x32_bf16 v[184:187], v[96:99], a[56:59], v[184:187]
    v_mfma_f32_16x16x32_bf16 v[192:195], v[96:99], a[80:83], v[192:195]
    s_waitcnt vmcnt(18)
    v_mfma_f32_16x16x32_bf16 v[172:175], v[120:123], a[8:11], v[172:175]
    v_mfma_f32_16x16x32_bf16 v[180:183], v[120:123], a[32:35], v[180:183]
    v_mfma_f32_16x16x32_bf16 v[188:191], v[120:123], a[56:59], v[188:191]
    v_mfma_f32_16x16x32_bf16 v[196:199], v[120:123], a[80:83], v[196:199]
    s_waitcnt vmcnt(17)
    v_mfma_f32_16x16x32_bf16 v[168:171], v[100:103], a[12:15], v[168:171]
    v_mfma_f32_16x16x32_bf16 v[176:179], v[100:103], a[36:39], v[176:179]
    v_mfma_f32_16x16x32_bf16 v[184:187], v[100:103], a[60:63], v[184:187]
    v_mfma_f32_16x16x32_bf16 v[192:195], v[100:103], a[84:87], v[192:195]
    s_waitcnt vmcnt(16)
    v_mfma_f32_16x16x32_bf16 v[172:175], v[124:127], a[12:15], v[172:175]
    v_mfma_f32_16x16x32_bf16 v[180:183], v[124:127], a[36:39], v[180:183]
    v_mfma_f32_16x16x32_bf16 v[188:191], v[124:127], a[60:63], v[188:191]
    v_mfma_f32_16x16x32_bf16 v[196:199], v[124:127], a[84:87], v[196:199]
    s_waitcnt vmcnt(15)
    v_mfma_f32_16x16x32_bf16 v[168:171], v[104:107], a[16:19], v[168:171]
    v_mfma_f32_16x16x32_bf16 v[176:179], v[104:107], a[40:43], v[176:179]
    v_mfma_f32_16x16x32_bf16 v[184:187], v[104:107], a[64:67], v[184:187]
    v_mfma_f32_16x16x32_bf16 v[192:195], v[104:107], a[88:91], v[192:195]
    s_waitcnt vmcnt(14)
    v_mfma_f32_16x16x32_bf16 v[172:175], v[128:131], a[16:19], v[172:175]
    v_mfma_f32_16x16x32_bf16 v[180:183], v[128:131], a[40:43], v[180:183]
    v_mfma_f32_16x16x32_bf16 v[188:191], v[128:131], a[64:67], v[188:191]
    v_mfma_f32_16x16x32_bf16 v[196:199], v[128:131], a[88:91], v[196:199]
    s_waitcnt vmcnt(13)
    v_mfma_f32_16x16x32_bf16 v[168:171], v[108:111], a[20:23], v[168:171]
    v_mfma_f32_16x16x32_bf16 v[176:179], v[108:111], a[44:47], v[176:179]
    v_mfma_f32_16x16x32_bf16 v[184:187], v[108:111], a[68:71], v[184:187]
    v_mfma_f32_16x16x32_bf16 v[192:195], v[108:111], a[92:95], v[192:195]
    s_waitcnt vmcnt(12)
    v_mfma_f32_16x16x32_bf16 v[172:175], v[132:135], a[20:23], v[172:175]
    v_mfma_f32_16x16x32_bf16 v[180:183], v[132:135], a[44:47], v[180:183]
    v_mfma_f32_16x16x32_bf16 v[188:191], v[132:135], a[68:71], v[188:191]
    v_mfma_f32_16x16x32_bf16 v[196:199], v[132:135], a[92:95], v[196:199]
    v_cvt_pk_bf16_f32 v200, v168, v169
    v_cvt_pk_bf16_f32 v201, v170, v171
    v_cvt_pk_bf16_f32 v202, v172, v173
    v_cvt_pk_bf16_f32 v203, v174, v175
    v_cvt_pk_bf16_f32 v204, v176, v177
    v_cvt_pk_bf16_f32 v205, v178, v179
    v_cvt_pk_bf16_f32 v206, v180, v181
    v_cvt_pk_bf16_f32 v207, v182, v183
    s_cmp_lg_u32 s23, 0
    s_cbranch_scc1 L_sws
    s_mov_b32 s30, 0
Lwt_87:
    s_and_b32 s38, s30, 3
    s_xor_b32 s39, s38, 2
    s_mul_i32 s40, s38, 196608
    s_add_u32 s40, s40, s58
    s_add_u32 s54, s40, 4096
    s_mul_i32 s55, s38, 98304
    s_add_u32 s55, s55, s57
    s_mul_i32 s41, s38, 327680
    s_add_u32 s42, s41, s60
    s_add_u32 s41, s41, s59
    s_xor_b32 s47, s41, 8192
    s_mul_i32 s43, s39, 327680
    s_add_u32 s43, s43, s60
    s_add_u32 s49, s30, 1
    s_and_b32 s44, s49, 3
    s_xor_b32 s45, s44, 2
    s_mul_i32 s44, s44, 81920
    s_add_u32 s44, s44, s61
    s_mul_i32 s45, s45, 81920
    s_add_u32 s45, s45, s61
    s_and_b32 s46, s49, 7
    s_mul_i32 s46, s46, 393216
    s_add_u32 s46, s46, s62
    s_add_u32 s65, s46, 41943040
    s_add_u32 s46, s46, 67108864
    s_add_u32 s56, s46, 4096
    s_add_u32 s64, s46, 8192
    s_add_u32 s66, s65, 4096
    s_add_u32 s67, s65, 8192
    s_lshl_b32 s50, s49, 11
    s_add_u32 s50, s50, s63
    s_mov_b32 s31, 262144
    s_mov_b64 exec, 0x1fff
    buffer_load_dword v228, v12, s[4:7], s50 offen sc1
Lhp_91:
    buffer_load_dword v229, v12, s[4:7], s50 offen sc1
    s_waitcnt vmcnt(1)
    v_cmp_gt_u32 vcc, 2, v228
    s_cbranch_vccz Lhd_92
    buffer_load_dword v228, v12, s[4:7], s50 offen sc1
    s_waitcnt vmcnt(1)
    v_cmp_gt_u32 vcc, 2, v229
    s_cbranch_vccz Lhd_92
    s_sub_u32 s31, s31, 1
    s_cbranch_scc0 Lhp_91
    s_mov_b32 s31, 2
    s_branch L_fail
Lsqf_94:
    s_sub_u32 s31, s31, 1
    s_cbranch_scc1 L_fail
    s_mov_b64 exec, 0xfff
    buffer_load_dword v228, v9, s[4:7], s40 offen sc1
Lxp_88:
    buffer_load_dword v229, v9, s[4:7], s40 offen sc1
    s_waitcnt vmcnt(1)
    v_cmp_eq_u32 vcc, -1, v228
    s_cbranch_vccz Lsqd_95
    buffer_load_dword v228, v9, s[4:7], s40 offen sc1
    s_waitcnt vmcnt(1)
    v_cmp_eq_u32 vcc, -1, v229
    s_cbranch_vccz Lsqd_95
    s_sub_u32 s31, s31, 1
    s_cbranch_scc0 Lxp_88
    s_mov_b32 s31, 2
    s_branch L_fail
Lsqd_95:
    s_mov_b64 exec, -1
    buffer_load_dwordx4 v[16:19], v2, s[4:7], s40 offen offset:0 sc1
    buffer_load_dwordx4 v[20:23], v2, s[4:7], s40 offen offset:1024 sc1
    buffer_load_dwordx4 v[24:27], v2, s[4:7], s40 offen offset:2048 sc1
    s_waitcnt vmcnt(0)
    s_branch Lsq_93
Lskf_96:
    s_sub_u32 s31, s31, 1
    s_cbranch_scc1 L_fail
    s_add_u32 s48, s40, 3072
    v_and_b32 v236, 128, v9
    v_lshrrev_b32 v237, 2, v236
    v_sub_u32 v236, v9, v236
    v_add_u32 v236, v236, v237
    s_mov_b64 exec, 0xfff
    buffer_load_dword v228, v236, s[4:7], s48 offen sc1
Lskp_99:
    buffer_load_dword v229, v236, s[4:7], s48 offen sc1
    s_waitcnt vmcnt(1)
    v_cmp_eq_u32 vcc, -1, v228
    s_cbranch_vccz Lskd_97
    buffer_load_dword v228, v236, s[4:7], s48 offen sc1
    s_waitcnt vmcnt(1)
    v_cmp_eq_u32 vcc, -1, v229
    s_cbranch_vccz Lskd_97
    s_sub_u32 s31, s31, 1
    s_cbranch_scc0 Lskp_99
    s_mov_b32 s31, 2
    s_branch L_fail
Lskd_97:
    s_mov_b64 exec, -1
    buffer_load_dwordx4 v[28:31], v2, s[4:7], s40 offen offset:3072 sc1
    buffer_load_dwordx4 v[32:35], v2, s[4:7], s54 offen offset:0 sc1
    buffer_load_dwordx4 v[36:39], v2, s[4:7], s54 offen offset:1024 sc1
    s_waitcnt vmcnt(0)
    v_mfma_f32_16x16x32_bf16 v[224:227], v[28:31], v[16:19], 0
    v_mfma_f32_16x16x32_bf16 v[224:227], v[32:35], v[20:23], v[224:227]
    v_mfma_f32_16x16x32_bf16 v[224:227], v[36:39], v[24:27], v[224:227]
    v_max3_u32 v230, v28, v32, v36
    v_cmp_eq_u32 vcc, -1, v230
    s_cbranch_vccnz Lskf_96
    s_nop 7
    s_branch Lsko_98
Lhd_92:
    s_mov_b64 exec, -1
    buffer_load_dwordx4 v[16:19], v2, s[4:7], s40 offen offset:0 sc1
    buffer_load_dwordx4 v[20:23], v2, s[4:7], s40 offen offset:1024 sc1
    buffer_load_dwordx4 v[24:27], v2, s[4:7], s40 offen offset:2048 sc1
    buffer_load_dwordx4 v[28:31], v2, s[4:7], s40 offen offset:3072 sc1
    buffer_load_dwordx4 v[32:35], v2, s[4:7], s54 offen offset:0 sc1
    buffer_load_dwordx4 v[36:39], v2, s[4:7], s54 offen offset:1024 sc1
    v_cvt_pk_bf16_f32 v208, v184, v185
    v_cvt_pk_bf16_f32 v209, v186, v187
    v_cvt_pk_bf16_f32 v210, v188, v189
    v_cvt_pk_bf16_f32 v211, v190, v191
    v_cvt_pk_bf16_f32 v212, v192, v193
    v_cvt_pk_bf16_f32 v213, v194, v195
    v_cvt_pk_bf16_f32 v214, v196, v197
    v_cvt_pk_bf16_f32 v215, v198, v199
    v_mov_b32 v184, 0
    v_mov_b32 v185, 0
    v_mov_b32 v186, 0
    v_mov_b32 v187, 0
    v_mov_b32 v188, 0
    v_mov_b32 v189, 0
    v_mov_b32 v190, 0
    v_mov_b32 v191, 0
    v_mov_b32 v192, 0
    v_mov_b32 v193, 0
    v_mov_b32 v194, 0
    v_mov_b32 v195, 0
    v_mov_b32 v196, 0
    v_mov_b32 v197, 0
    v_mov_b32 v198, 0
    v_mov_b32 v199, 0
    buffer_load_dwordx4 v[136:139], v2, s[4:7], s55 offen offset:0 sc1
    buffer_load_dwordx4 v[140:143], v2, s[4:7], s55 offen offset:1024 sc1
    buffer_load_dwordx4 v[144:147], v2, s[4:7], s55 offen offset:2048 sc1
Lsq_93:
    s_waitcnt vmcnt(8)
    v_mfma_f32_16x16x32_bf16 v[152:155], v[40:43], v[16:19], 0
    v_mfma_f32_16x16x32_bf16 v[148:151], v[52:55], v[16:19], 0
    s_waitcnt vmcnt(7)
    v_mfma_f32_16x16x32_bf16 v[152:155], v[44:47], v[20:23], v[152:155]
    v_mfma_f32_16x16x32_bf16 v[148:151], v[56:59], v[20:23], v[148:151]
    s_waitcnt vmcnt(6)
    v_mfma_f32_16x16x32_bf16 v[152:155], v[48:51], v[24:27], v[152:155]
    v_max3_u32 v230, v16, v20, v24
    v_mfma_f32_16x16x32_bf16 v[148:151], v[60:63], v[24:27], v[148:151]
    v_cmp_eq_u32 vcc, -1, v230
    v_mfma_f32_16x16x32_bf16 v[156:159], v[64:67], v[16:19], 0
    s_cbranch_vccnz Lsqf_94
    v_mfma_f32_16x16x32_bf16 v[232:235], v[76:79], v[16:19], 0
    v_mfma_f32_16x16x32_bf16 v[156:159], v[68:71], v[20:23], v[156:159]
    v_add_f32_dpp v152, v148, v152 row_ror:8 row_mask:0xf bank_mask:0x3
    v_add_f32_dpp v153, v149, v153 row_ror:8 row_mask:0xf bank_mask:0x3
    v_mfma_f32_16x16x32_bf16 v[232:235], v[80:83], v[20:23], v[232:235]
    v_add_f32_dpp v154, v150, v154 row_ror:8 row_mask:0xf bank_mask:0x3
    v_add_f32_dpp v155, v151, v155 row_ror:8 row_mask:0xf bank_mask:0x3
    v_mfma_f32_16x16x32_bf16 v[156:159], v[72:75], v[24:27], v[156:159]
    v_mfma_f32_16x16x32_bf16 v[232:235], v[84:87], v[24:27], v[232:235]
    s_waitcnt vmcnt(5)
    v_mfma_f32_16x16x32_bf16 v[224:227], v[28:31], v[16:19], 0
    s_waitcnt vmcnt(4)
    v_mfma_f32_16x16x32_bf16 v[224:227], v[32:35], v[20:23], v[224:227]
    v_add_f32_dpp v152, v156, v232 row_ror:8 row_mask:0xf bank_mask:0xc
    s_waitcnt vmcnt(3)
    v_mfma_f32_16x16x32_bf16 v[224:227], v[36:39], v[24:27], v[224:227]
    v_max3_u32 v230, v28, v32, v36
    v_cmp_eq_u32 vcc, -1, v230
    v_add_f32_dpp v153, v157, v233 row_ror:8 row_mask:0xf bank_mask:0xc
    v_add_f32_dpp v154, v158, v234 row_ror:8 row_mask:0xf bank_mask:0xc
    v_add_f32_dpp v155, v159, v235 row_ror:8 row_mask:0xf bank_mask:0xc
    v_max3_f32 v231, v152, v153, v154
    s_cbranch_vccnz Lskf_96
Lsko_98:
    s_nop 0
    v_add_f32_dpp v148, v226, v224 row_ror:8 row_mask:0xf bank_mask:0x3
    v_add_f32_dpp v148, v225, v227 row_ror:8 row_mask:0xf bank_mask:0xc
    v_max3_f32 v230, v231, v155, v148
    buffer_load_dwordx4 v[88:91], v2, s[4:7], s46 offen offset:0 sc1
    buffer_load_dwordx4 v[112:115], v2, s[4:7], s56 offen offset:2048 sc1
    v_max_f32_dpp v230, v230, v230 row_ror:8 row_mask:0xf bank_mask:0xf
    v_mov_b32 v231, v230
    s_waitcnt vmcnt(2)
Lv2_101:
    v_max3_u32 v228, v136, v140, v144
    v_cmp_eq_u32 vcc, -1, v228
    s_cbranch_vccz Lvd_102
    buffer_load_dwordx4 v[136:139], v2, s[4:7], s55 offen offset:0 sc1
    buffer_load_dwordx4 v[140:143], v2, s[4:7], s55 offen offset:1024 sc1
    buffer_load_dwordx4 v[144:147], v2, s[4:7], s55 offen offset:2048 sc1
    s_waitcnt vmcnt(0)
    s_sub_u32 s31, s31, 1
    s_cbranch_scc0 Lv2_101
    s_mov_b32 s31, 3
    s_branch L_fail
Lvd_102:
    v_smfmac_f32_16x16x64_bf16 v[184:187], v[136:139], a[104:111], v246
    buffer_load_dwordx4 v[92:95], v2, s[4:7], s46 offen offset:1024 sc1
    buffer_load_dwordx4 v[116:119], v2, s[4:7], s56 offen offset:3072 sc1
    v_permlane16_swap_b32 v230, v231
    v_max_f32 v230, v230, v231
    v_mov_b32 v231, v230
    v_smfmac_f32_16x16x64_bf16 v[188:191], v[136:139], a[128:135], v246
    buffer_load_dwordx4 v[96:99], v2, s[4:7], s46 offen offset:2048 sc1
    v_permlane32_swap_b32 v230, v231
    v_max_f32 v230, v230, v231
    v_mul_f32 v230, s53, v230
    v_smfmac_f32_16x16x64_bf16 v[192:195], v[136:139], a[152:159], v246
    v_fma_f32 v152, v152, s52, v230
    v_fma_f32 v153, v153, s52, v230
    v_fma_f32 v154, v154, s52, v230
    v_smfmac_f32_16x16x64_bf16 v[196:199], v[136:139], a[176:183], v246
    v_fma_f32 v155, v155, s52, v230
    v_fma_f32 v148, v148, s52, v230
    v_exp_f32 v152, v152
    v_smfmac_f32_16x16x64_bf16 v[184:187], v[140:143], a[112:119], v246
    v_exp_f32 v153, v153
    v_exp_f32 v154, v154
    v_smfmac_f32_16x16x64_bf16 v[188:191], v[140:143], a[136:143], v246
    v_exp_f32 v155, v155
    v_exp_f32 v148, v148
    v_smfmac_f32_16x16x64_bf16 v[192:195], v[140:143], a[160:167], v246
    v_cvt_pk_bf16_f32 v160, v152, v153
    v_cvt_pk_bf16_f32 v161, v154, v155
    v_mov_b32_dpp v230, v148 row_ror:8 row_mask:0xf bank_mask:0xf
    v_smfmac_f32_16x16x64_bf16 v[196:199], v[140:143], a[184:191], v246
    v_mov_b32_dpp v162, v160 row_ror:8 row_mask:0xf bank_mask:0xf
    v_mov_b32_dpp v163, v161 row_ror:8 row_mask:0xf bank_mask:0xf
    v_smfmac_f32_16x16x64_bf16 v[184:187], v[144:147], a[120:127], v246
    v_smfmac_f32_16x16x64_bf16 v[188:191], v[144:147], a[144:151], v246
    v_smfmac_f32_16x16x64_bf16 v[192:195], v[144:147], a[168:175], v246
    v_smfmac_f32_16x16x64_bf16 v[196:199], v[144:147], a[192:199], v246
    v_mfma_f32_16x16x32_bf16 v[168:171], v[200:203], v[160:163], 0
    v_cvt_pk_bf16_f32 v164, v148, v230
    v_cvt_pk_bf16_f32 v165, v148, v230
    v_mfma_f32_16x16x32_bf16 v[156:159], a[96:99], v[160:163], 0
    v_cvt_pk_bf16_f32 v216, v184, v185
    v_cvt_pk_bf16_f32 v217, v186, v187
    v_mfma_f32_16x16x32_bf16 v[172:175], v[204:207], v[160:163], 0
    v_cvt_pk_bf16_f32 v218, v188, v189
    v_cvt_pk_bf16_f32 v219, v190, v191
    v_mfma_f32_16x16x32_bf16 v[176:179], v[208:211], v[160:163], 0
    v_cvt_pk_bf16_f32 v220, v192, v193
    v_cvt_pk_bf16_f32 v221, v194, v195
    v_mfma_f32_16x16x32_bf16 v[180:183], v[212:215], v[160:163], 0
    v_cvt_pk_bf16_f32 v222, v196, v197
    v_cvt_pk_bf16_f32 v223, v198, v199
    v_mfma_f32_16x16x16_bf16 v[168:171], v[216:217], v[164:165], v[168:171]
    buffer_load_dwordx4 v[120:123], v2, s[4:7], s64 offen offset:0 sc1
    v_mfma_f32_16x16x16_bf16 v[156:159], a[100:101], v[164:165], v[156:159]
    buffer_load_dwordx4 v[100:103], v2, s[4:7], s46 offen offset:3072 sc1
    v_mfma_f32_16x16x16_bf16 v[172:175], v[218:219], v[164:165], v[172:175]
    buffer_load_dwordx4 v[124:127], v2, s[4:7], s64 offen offset:1024 sc1
    v_mfma_f32_16x16x16_bf16 v[176:179], v[220:221], v[164:165], v[176:179]
    buffer_load_dwordx4 v[104:107], v2, s[4:7], s56 offen offset:0 sc1
    v_mfma_f32_16x16x16_bf16 v[180:183], v[222:223], v[164:165], v[180:183]
    buffer_load_dwordx4 v[128:131], v2, s[4:7], s64 offen offset:2048 sc1
    buffer_load_dwordx4 v[108:111], v2, s[4:7], s56 offen offset:1024 sc1
    buffer_load_dwordx4 v[132:135], v2, s[4:7], s64 offen offset:3072 sc1
    s_not_b64 exec, s[68:69]
    ds_write_b128 v6, v[168:171]
    v_rcp_f32 v230, v156
    ds_write_b128 v6, v[172:175] offset:2048
    ds_write_b32 v10, v230
    ds_write_b128 v6, v[176:179] offset:4096
    ds_write_b128 v6, v[180:183] offset:6144
    s_mov_b64 exec, -1
    s_waitcnt lgkmcnt(0)
    s_barrier
    ds_read_b128 v[232:235], v11
    ds_read2_b64 v[148:151], v7 offset0:0 offset1:64
    ds_read2_b64 v[152:155], v7 offset0:128 offset1:192
    s_add_u32 s48, s42, 8192
    s_waitcnt lgkmcnt(1)
    v_pk_mul_f32 v[148:149], v[148:149], v[232:233] op_sel_hi:[1,0]
    v_pk_fma_f32 v[148:149], v[150:151], v[232:233], v[148:149] op_sel:[0,1,0]
    s_waitcnt lgkmcnt(0)
    v_pk_fma_f32 v[148:149], v[152:153], v[234:235], v[148:149] op_sel_hi:[1,0,1]
    v_pk_fma_f32 v[148:149], v[154:155], v[234:235], v[148:149] op_sel:[0,1,0]
    v_cvt_pk_bf16_f32 v152, v148, v149
    buffer_store_dword v152, v15, s[4:7], s42 offen sc1
    buffer_store_dword v152, v15, s[4:7], s48 offen sc1
    s_waitcnt vmcnt(2)
    v_mfma_f32_16x16x32_bf16 v[168:171], v[88:91], a[0:3], 0
    v_mfma_f32_16x16x32_bf16 v[176:179], v[88:91], a[24:27], 0
    v_mfma_f32_16x16x32_bf16 v[184:187], v[88:91], a[48:51], 0
    v_mfma_f32_16x16x32_bf16 v[192:195], v[88:91], a[72:75], 0
    v_mfma_f32_16x16x32_bf16 v[172:175], v[112:115], a[0:3], 0
    v_mfma_f32_16x16x32_bf16 v[180:183], v[112:115], a[24:27], 0
    v_mfma_f32_16x16x32_bf16 v[188:191], v[112:115], a[48:51], 0
    v_mfma_f32_16x16x32_bf16 v[196:199], v[112:115], a[72:75], 0
    v_mfma_f32_16x16x32_bf16 v[168:171], v[92:95], a[4:7], v[168:171]
    v_mfma_f32_16x16x32_bf16 v[176:179], v[92:95], a[28:31], v[176:179]
    v_mfma_f32_16x16x32_bf16 v[184:187], v[92:95], a[52:55], v[184:187]
    v_mfma_f32_16x16x32_bf16 v[192:195], v[92:95], a[76:79], v[192:195]
    v_mfma_f32_16x16x32_bf16 v[172:175], v[116:119], a[4:7], v[172:175]
    v_mfma_f32_16x16x32_bf16 v[180:183], v[116:119], a[28:31], v[180:183]
    v_mfma_f32_16x16x32_bf16 v[188:191], v[116:119], a[52:55], v[188:191]
    v_mfma_f32_16x16x32_bf16 v[196:199], v[116:119], a[76:79], v[196:199]
    v_mfma_f32_16x16x32_bf16 v[168:171], v[96:99], a[8:11], v[168:171]
    v_mfma_f32_16x16x32_bf16 v[176:179], v[96:99], a[32:35], v[176:179]
    v_mfma_f32_16x16x32_bf16 v[184:187], v[96:99], a[56:59], v[184:187]
    v_mfma_f32_16x16x32_bf16 v[192:195], v[96:99], a[80:83], v[192:195]
    v_mfma_f32_16x16x32_bf16 v[172:175], v[120:123], a[8:11], v[172:175]
    v_mfma_f32_16x16x32_bf16 v[180:183], v[120:123], a[32:35], v[180:183]
    v_mfma_f32_16x16x32_bf16 v[188:191], v[120:123], a[56:59], v[188:191]
    v_mfma_f32_16x16x32_bf16 v[196:199], v[120:123], a[80:83], v[196:199]
    buffer_load_dword v16, v240, s[4:7], s41 offen offset:0 sc1
    buffer_load_dword v17, v241, s[4:7], s41 offen offset:0 sc1
    buffer_load_dword v18, v242, s[4:7], s41 offen offset:0 sc1
    buffer_load_dword v19, v243, s[4:7], s41 offen offset:0 sc1
    buffer_load_dword v20, v4, s[4:7], s41 offen offset:0 sc1
    buffer_load_dword v21, v5, s[4:7], s41 offen offset:0 sc1
    buffer_load_dword v22, v14, s[4:7], s41 offen offset:0 sc1
    v_mov_b32 v232, v148
    v_mov_b32 v233, v149
    v_mfma_f32_16x16x32_bf16 v[168:171], v[100:103], a[12:15], v[168:171]
    v_mfma_f32_16x16x32_bf16 v[176:179], v[100:103], a[36:39], v[176:179]
    v_mfma_f32_16x16x32_bf16 v[184:187], v[100:103], a[60:63], v[184:187]
    v_mfma_f32_16x16x32_bf16 v[192:195], v[100:103], a[84:87], v[192:195]
    v_mfma_f32_16x16x32_bf16 v[172:175], v[124:127], a[12:15], v[172:175]
    v_mfma_f32_16x16x32_bf16 v[180:183], v[124:127], a[36:39], v[180:183]
    v_mfma_f32_16x16x32_bf16 v[188:191], v[124:127], a[60:63], v[188:191]
    v_mfma_f32_16x16x32_bf16 v[196:199], v[124:127], a[84:87], v[196:199]
    v_mfma_f32_16x16x32_bf16 v[168:171], v[104:107], a[16:19], v[168:171]
    v_mfma_f32_16x16x32_bf16 v[176:179], v[104:107], a[40:43], v[176:179]
    v_mfma_f32_16x16x32_bf16 v[184:187], v[104:107], a[64:67], v[184:187]
    v_mfma_f32_16x16x32_bf16 v[192:195], v[104:107], a[88:91], v[192:195]
    v_mfma_f32_16x16x32_bf16 v[172:175], v[128:131], a[16:19], v[172:175]
    v_mfma_f32_16x16x32_bf16 v[180:183], v[128:131], a[40:43], v[180:183]
    v_mfma_f32_16x16x32_bf16 v[188:191], v[128:131], a[64:67], v[188:191]
    v_mfma_f32_16x16x32_bf16 v[196:199], v[128:131], a[88:91], v[196:199]
    s_branch Lpf_105
Lpp_103:
    buffer_load_dword v16, v240, s[4:7], s41 offen offset:0 sc1
    buffer_load_dword v17, v241, s[4:7], s41 offen offset:0 sc1
    buffer_load_dword v18, v242, s[4:7], s41 offen offset:0 sc1
    buffer_load_dword v19, v243, s[4:7], s41 offen offset:0 sc1
    buffer_load_dword v20, v4, s[4:7], s41 offen offset:0 sc1
    buffer_load_dword v21, v5, s[4:7], s41 offen offset:0 sc1
    buffer_load_dword v22, v14, s[4:7], s41 offen offset:0 sc1
    v_mov_b32 v232, v148
    v_mov_b32 v233, v149
Lpf_105:
    s_waitcnt vmcnt(4)
    v_max3_u32 v228, v16, v17, v18
    v_dot2c_f32_bf16 v232, s70, v16
    v_dot2c_f32_bf16 v233, s71, v16
    v_dot2c_f32_bf16 v232, s70, v17
    v_dot2c_f32_bf16 v233, s71, v17
    v_dot2c_f32_bf16 v232, s70, v18
    v_dot2c_f32_bf16 v233, s71, v18
    s_waitcnt vmcnt(2)
    v_max3_u32 v228, v228, v19, v20
    v_dot2c_f32_bf16 v232, s70, v19
    v_dot2c_f32_bf16 v233, s71, v19
    v_dot2c_f32_bf16 v232, s70, v20
    v_dot2c_f32_bf16 v233, s71, v20
    s_waitcnt vmcnt(1)
    v_dot2c_f32_bf16 v232, s70, v21
    v_dot2c_f32_bf16 v233, s71, v21
    s_waitcnt vmcnt(0)
    v_max3_u32 v228, v228, v21, v22
    v_cmp_eq_u32 vcc, -1, v228
    v_dot2c_f32_bf16 v232, s70, v22
    v_dot2c_f32_bf16 v233, s71, v22
    s_cbranch_vccz Lpd_104
    s_sub_u32 s31, s31, 1
    s_cbranch_scc0 Lpp_103
    s_mov_b32 s31, 4
    s_branch L_fail
Lpd_104:
    v_cvt_pk_bf16_f32 v232, v232, v233
    buffer_store_dword v232, v8, s[4:7], s44 offen
    buffer_store_dword v248, v8, s[4:7], s45 offen
    s_barrier
    buffer_load_dwordx4 v[40:43], v2, s[4:7], s65 offen offset:0 sc1
    buffer_load_dwordx4 v[44:47], v2, s[4:7], s65 offen offset:1024 sc1
    buffer_load_dwordx4 v[48:51], v2, s[4:7], s65 offen offset:2048 sc1
    buffer_load_dwordx4 v[52:55], v2, s[4:7], s65 offen offset:3072 sc1
    buffer_load_dwordx4 v[56:59], v2, s[4:7], s66 offen offset:0 sc1
    buffer_load_dwordx4 v[60:63], v2, s[4:7], s66 offen offset:1024 sc1
    v_mfma_f32_16x16x32_bf16 v[168:171], v[108:111], a[20:23], v[168:171]
    v_mfma_f32_16x16x32_bf16 v[176:179], v[108:111], a[44:47], v[176:179]
    v_mfma_f32_16x16x32_bf16 v[184:187], v[108:111], a[68:71], v[184:187]
    v_mfma_f32_16x16x32_bf16 v[192:195], v[108:111], a[92:95], v[192:195]
    buffer_load_dwordx4 v[64:67], v2, s[4:7], s66 offen offset:2048 sc1
    buffer_load_dwordx4 v[68:71], v2, s[4:7], s66 offen offset:3072 sc1
    buffer_load_dwordx4 v[72:75], v2, s[4:7], s67 offen offset:0 sc1
    buffer_load_dwordx4 v[76:79], v2, s[4:7], s67 offen offset:1024 sc1
    buffer_load_dwordx4 v[80:83], v2, s[4:7], s67 offen offset:2048 sc1
    buffer_load_dwordx4 v[84:87], v2, s[4:7], s67 offen offset:3072 sc1
    v_mfma_f32_16x16x32_bf16 v[172:175], v[132:135], a[20:23], v[172:175]
    v_mfma_f32_16x16x32_bf16 v[180:183], v[132:135], a[44:47], v[180:183]
    v_mfma_f32_16x16x32_bf16 v[188:191], v[132:135], a[68:71], v[188:191]
    v_mfma_f32_16x16x32_bf16 v[196:199], v[132:135], a[92:95], v[196:199]
    v_cvt_pk_bf16_f32 v200, v168, v169
    v_cvt_pk_bf16_f32 v201, v170, v171
    v_cvt_pk_bf16_f32 v202, v172, v173
    v_cvt_pk_bf16_f32 v203, v174, v175
    v_cvt_pk_bf16_f32 v204, v176, v177
    v_cvt_pk_bf16_f32 v205, v178, v179
    v_cvt_pk_bf16_f32 v206, v180, v181
    v_cvt_pk_bf16_f32 v207, v182, v183
    s_add_u32 s30, s30, 1
    s_cmp_lt_u32 s30, 63
    s_cbranch_scc1 Lwt_87
    s_branch L_swend
L_sws:
    s_mov_b32 s30, 0
Lwt_106:
    s_and_b32 s38, s30, 3
    s_xor_b32 s39, s38, 2
    s_mul_i32 s40, s38, 196608
    s_add_u32 s40, s40, s58
    s_add_u32 s54, s40, 4096
    s_mul_i32 s55, s38, 98304
    s_add_u32 s55, s55, s57
    s_mul_i32 s41, s38, 327680
    s_add_u32 s42, s41, s60
    s_add_u32 s41, s41, s59
    s_xor_b32 s47, s41, 8192
    s_mul_i32 s43, s39, 327680
    s_add_u32 s43, s43, s60
    s_add_u32 s49, s30, 1
    s_and_b32 s44, s49, 3
    s_xor_b32 s45, s44, 2
    s_mul_i32 s44, s44, 81920
    s_add_u32 s44, s44, s61
    s_mul_i32 s45, s45, 81920
    s_add_u32 s45, s45, s61
    s_and_b32 s46, s49, 7
    s_mul_i32 s46, s46, 393216
    s_add_u32 s46, s46, s62
    s_add_u32 s65, s46, 41943040
    s_add_u32 s46, s46, 67108864
    s_add_u32 s56, s46, 4096
    s_add_u32 s64, s46, 8192
    s_add_u32 s66, s65, 4096
    s_add_u32 s67, s65, 8192
    s_lshl_b32 s50, s49, 11
    s_add_u32 s50, s50, s63
    s_mov_b32 s31, 262144
    s_mov_b64 exec, 0x1fff
    buffer_load_dword v228, v12, s[4:7], s50 offen sc1
Lhp_110:
    buffer_load_dword v229, v12, s[4:7], s50 offen sc1
    s_waitcnt vmcnt(1)
    v_cmp_gt_u32 vcc, 2, v228
    s_cbranch_vccz Lhd_111
    buffer_load_dword v228, v12, s[4:7], s50 offen sc1
    s_waitcnt vmcnt(1)
    v_cmp_gt_u32 vcc, 2, v229
    s_cbranch_vccz Lhd_111
    s_sub_u32 s31, s31, 1
    s_cbranch_scc0 Lhp_110
    s_mov_b32 s31, 2
    s_branch L_fail
Lsqf_113:
    s_sub_u32 s31, s31, 1
    s_cbranch_scc1 L_fail
    s_mov_b64 exec, 0xfff
    buffer_load_dword v228, v9, s[4:7], s40 offen sc1
Lxp_107:
    buffer_load_dword v229, v9, s[4:7], s40 offen sc1
    s_waitcnt vmcnt(1)
    v_cmp_eq_u32 vcc, -1, v228
    s_cbranch_vccz Lsqd_114
    buffer_load_dword v228, v9, s[4:7], s40 offen sc1
    s_waitcnt vmcnt(1)
    v_cmp_eq_u32 vcc, -1, v229
    s_cbranch_vccz Lsqd_114
    s_sub_u32 s31, s31, 1
    s_cbranch_scc0 Lxp_107
    s_mov_b32 s31, 2
    s_branch L_fail
Lsqd_114:
    s_mov_b64 exec, -1
    buffer_load_dwordx4 v[16:19], v2, s[4:7], s40 offen offset:0 sc1
    buffer_load_dwordx4 v[20:23], v2, s[4:7], s40 offen offset:1024 sc1
    buffer_load_dwordx4 v[24:27], v2, s[4:7], s40 offen offset:2048 sc1
    s_waitcnt vmcnt(0)
    s_branch Lsq_112
Lskf_115:
    s_sub_u32 s31, s31, 1
    s_cbranch_scc1 L_fail
    s_add_u32 s48, s40, 3072
    v_and_b32 v236, 128, v9
    v_lshrrev_b32 v237, 2, v236
    v_sub_u32 v236, v9, v236
    v_add_u32 v236, v236, v237
    s_mov_b64 exec, 0xfff
    buffer_load_dword v228, v236, s[4:7], s48 offen sc1
Lskp_118:
    buffer_load_dword v229, v236, s[4:7], s48 offen sc1
    s_waitcnt vmcnt(1)
    v_cmp_eq_u32 vcc, -1, v228
    s_cbranch_vccz Lskd_116
    buffer_load_dword v228, v236, s[4:7], s48 offen sc1
    s_waitcnt vmcnt(1)
    v_cmp_eq_u32 vcc, -1, v229
    s_cbranch_vccz Lskd_116
    s_sub_u32 s31, s31, 1
    s_cbranch_scc0 Lskp_118
    s_mov_b32 s31, 2
    s_branch L_fail
Lskd_116:
    s_mov_b64 exec, -1
    buffer_load_dwordx4 v[28:31], v2, s[4:7], s40 offen offset:3072 sc1
    buffer_load_dwordx4 v[32:35], v2, s[4:7], s54 offen offset:0 sc1
    buffer_load_dwordx4 v[36:39], v2, s[4:7], s54 offen offset:1024 sc1
    s_waitcnt vmcnt(0)
    v_mfma_f32_16x16x32_bf16 v[224:227], v[28:31], v[16:19], 0
    v_mfma_f32_16x16x32_bf16 v[224:227], v[32:35], v[20:23], v[224:227]
    v_mfma_f32_16x16x32_bf16 v[224:227], v[36:39], v[24:27], v[224:227]
    v_max3_u32 v230, v28, v32, v36
    v_cmp_eq_u32 vcc, -1, v230
    s_cbranch_vccnz Lskf_115
    s_nop 7
    s_branch Lsko_117
Lhd_111:
    s_mov_b64 exec, -1
    buffer_load_dwordx4 v[16:19], v2, s[4:7], s40 offen offset:0 sc1
    buffer_load_dwordx4 v[20:23], v2, s[4:7], s40 offen offset:1024 sc1
    buffer_load_dwordx4 v[24:27], v2, s[4:7], s40 offen offset:2048 sc1
    buffer_load_dwordx4 v[28:31], v2, s[4:7], s40 offen offset:3072 sc1
    buffer_load_dwordx4 v[32:35], v2, s[4:7], s54 offen offset:0 sc1
    buffer_load_dwordx4 v[36:39], v2, s[4:7], s54 offen offset:1024 sc1
    v_cvt_pk_bf16_f32 v208, v184, v185
    v_cvt_pk_bf16_f32 v209, v186, v187
    v_cvt_pk_bf16_f32 v210, v188, v189
    v_cvt_pk_bf16_f32 v211, v190, v191
    v_cvt_pk_bf16_f32 v212, v192, v193
    v_cvt_pk_bf16_f32 v213, v194, v195
    v_cvt_pk_bf16_f32 v214, v196, v197
    v_cvt_pk_bf16_f32 v215, v198, v199
    v_mov_b32 v184, 0
    v_mov_b32 v185, 0
    v_mov_b32 v186, 0
    v_mov_b32 v187, 0
    v_mov_b32 v188, 0
    v_mov_b32 v189, 0
    v_mov_b32 v190, 0
    v_mov_b32 v191, 0
    v_mov_b32 v192, 0
    v_mov_b32 v193, 0
    v_mov_b32 v194, 0
    v_mov_b32 v195, 0
    v_mov_b32 v196, 0
    v_mov_b32 v197, 0
    v_mov_b32 v198, 0
    v_mov_b32 v199, 0
    buffer_load_dwordx4 v[136:139], v2, s[4:7], s55 offen offset:0 sc1
    buffer_load_dwordx4 v[140:143], v2, s[4:7], s55 offen offset:1024 sc1
    buffer_load_dwordx4 v[144:147], v2, s[4:7], s55 offen offset:2048 sc1
Lsq_112:
    s_waitcnt vmcnt(8)
    v_mfma_f32_16x16x32_bf16 v[152:155], v[40:43], v[16:19], 0
    v_mfma_f32_16x16x32_bf16 v[148:151], v[52:55], v[16:19], 0
    s_waitcnt vmcnt(7)
    v_mfma_f32_16x16x32_bf16 v[152:155], v[44:47], v[20:23], v[152:155]
    v_mfma_f32_16x16x32_bf16 v[148:151], v[56:59], v[20:23], v[148:151]
    s_waitcnt vmcnt(6)
    v_mfma_f32_16x16x32_bf16 v[152:155], v[48:51], v[24:27], v[152:155]
    v_max3_u32 v230, v16, v20, v24
    v_mfma_f32_16x16x32_bf16 v[148:151], v[60:63], v[24:27], v[148:151]
    v_cmp_eq_u32 vcc, -1, v230
    v_mfma_f32_16x16x32_bf16 v[156:159], v[64:67], v[16:19], 0
    s_cbranch_vccnz Lsqf_113
    v_mfma_f32_16x16x32_bf16 v[232:235], v[76:79], v[16:19], 0
    v_mfma_f32_16x16x32_bf16 v[156:159], v[68:71], v[20:23], v[156:159]
    v_add_f32_dpp v152, v148, v152 row_ror:8 row_mask:0xf bank_mask:0x3
    v_add_f32_dpp v153, v149, v153 row_ror:8 row_mask:0xf bank_mask:0x3
    v_mfma_f32_16x16x32_bf16 v[232:235], v[80:83], v[20:23], v[232:235]
    v_add_f32_dpp v154, v150, v154 row_ror:8 row_mask:0xf bank_mask:0x3
    v_add_f32_dpp v155, v151, v155 row_ror:8 row_mask:0xf bank_mask:0x3
    v_mfma_f32_16x16x32_bf16 v[156:159], v[72:75], v[24:27], v[156:159]
    v_mfma_f32_16x16x32_bf16 v[232:235], v[84:87], v[24:27], v[232:235]
    s_waitcnt vmcnt(5)
    v_mfma_f32_16x16x32_bf16 v[224:227], v[28:31], v[16:19], 0
    s_waitcnt vmcnt(4)
    v_mfma_f32_16x16x32_bf16 v[224:227], v[32:35], v[20:23], v[224:227]
    v_add_f32_dpp v152, v156, v232 row_ror:8 row_mask:0xf bank_mask:0xc
    s_waitcnt vmcnt(3)
    v_mfma_f32_16x16x32_bf16 v[224:227], v[36:39], v[24:27], v[224:227]
    v_max3_u32 v230, v28, v32, v36
    v_cmp_eq_u32 vcc, -1, v230
    v_add_f32_dpp v153, v157, v233 row_ror:8 row_mask:0xf bank_mask:0xc
    v_add_f32_dpp v154, v158, v234 row_ror:8 row_mask:0xf bank_mask:0xc
    v_add_f32_dpp v155, v159, v235 row_ror:8 row_mask:0xf bank_mask:0xc
    v_max3_f32 v231, v152, v153, v154
    s_cbranch_vccnz Lskf_115
Lsko_117:
    s_nop 0
    v_add_f32_dpp v148, v226, v224 row_ror:8 row_mask:0xf bank_mask:0x3
    v_add_f32_dpp v148, v225, v227 row_ror:8 row_mask:0xf bank_mask:0xc
    v_max3_f32 v230, v231, v155, v148
    buffer_load_dwordx4 v[88:91], v2, s[4:7], s46 offen offset:0 sc1
    buffer_load_dwordx4 v[112:115], v2, s[4:7], s56 offen offset:2048 sc1
    v_max_f32_dpp v230, v230, v230 row_ror:8 row_mask:0xf bank_mask:0xf
    v_mov_b32 v231, v230
    s_waitcnt vmcnt(2)
Lv2_120:
    v_max3_u32 v228, v136, v140, v144
    v_cmp_eq_u32 vcc, -1, v228
    s_cbranch_vccz Lvd_121
    buffer_load_dwordx4 v[136:139], v2, s[4:7], s55 offen offset:0 sc1
    buffer_load_dwordx4 v[140:143], v2, s[4:7], s55 offen offset:1024 sc1
    buffer_load_dwordx4 v[144:147], v2, s[4:7], s55 offen offset:2048 sc1
    s_waitcnt vmcnt(0)
    s_sub_u32 s31, s31, 1
    s_cbranch_scc0 Lv2_120
    s_mov_b32 s31, 3
    s_branch L_fail
Lvd_121:
    v_smfmac_f32_16x16x64_bf16 v[184:187], v[136:139], a[104:111], v246
    buffer_load_dwordx4 v[92:95], v2, s[4:7], s46 offen offset:1024 sc1
    buffer_load_dwordx4 v[116:119], v2, s[4:7], s56 offen offset:3072 sc1
    v_permlane16_swap_b32 v230, v231
    v_max_f32 v230, v230, v231
    v_mov_b32 v231, v230
    v_smfmac_f32_16x16x64_bf16 v[188:191], v[136:139], a[128:135], v246
    buffer_load_dwordx4 v[96:99], v2, s[4:7], s46 offen offset:2048 sc1
    v_permlane32_swap_b32 v230, v231
    v_max_f32 v230, v230, v231
    v_mul_f32 v230, s53, v230
    v_smfmac_f32_16x16x64_bf16 v[192:195], v[136:139], a[152:159], v246
    v_fma_f32 v152, v152, s52, v230
    v_fma_f32 v153, v153, s52, v230
    v_fma_f32 v154, v154, s52, v230
    v_smfmac_f32_16x16x64_bf16 v[196:199], v[136:139], a[176:183], v246
    v_fma_f32 v155, v155, s52, v230
    v_fma_f32 v148, v148, s52, v230
    v_exp_f32 v152, v152
    v_smfmac_f32_16x16x64_bf16 v[184:187], v[140:143], a[112:119], v246
    v_exp_f32 v153, v153
    v_exp_f32 v154, v154
    v_smfmac_f32_16x16x64_bf16 v[188:191], v[140:143], a[136:143], v246
    v_exp_f32 v155, v155
    v_exp_f32 v148, v148
    v_smfmac_f32_16x16x64_bf16 v[192:195], v[140:143], a[160:167], v246
    v_cvt_pk_bf16_f32 v160, v152, v153
    v_cvt_pk_bf16_f32 v161, v154, v155
    v_mov_b32_dpp v230, v148 row_ror:8 row_mask:0xf bank_mask:0xf
    v_smfmac_f32_16x16x64_bf16 v[196:199], v[140:143], a[184:191], v246
    v_mov_b32_dpp v162, v160 row_ror:8 row_mask:0xf bank_mask:0xf
    v_mov_b32_dpp v163, v161 row_ror:8 row_mask:0xf bank_mask:0xf
    v_smfmac_f32_16x16x64_bf16 v[184:187], v[144:147], a[120:127], v246
    v_smfmac_f32_16x16x64_bf16 v[188:191], v[144:147], a[144:151], v246
    v_smfmac_f32_16x16x64_bf16 v[192:195], v[144:147], a[168:175], v246
    v_smfmac_f32_16x16x64_bf16 v[196:199], v[144:147], a[192:199], v246
    v_mfma_f32_16x16x32_bf16 v[168:171], v[200:203], v[160:163], 0
    v_cvt_pk_bf16_f32 v164, v148, v230
    v_cvt_pk_bf16_f32 v165, v148, v230
    v_mfma_f32_16x16x32_bf16 v[156:159], a[96:99], v[160:163], 0
    v_cvt_pk_bf16_f32 v216, v184, v185
    v_cvt_pk_bf16_f32 v217, v186, v187
    v_mfma_f32_16x16x32_bf16 v[172:175], v[204:207], v[160:163], 0
    v_cvt_pk_bf16_f32 v218, v188, v189
    v_cvt_pk_bf16_f32 v219, v190, v191
    v_mfma_f32_16x16x32_bf16 v[176:179], v[208:211], v[160:163], 0
    v_cvt_pk_bf16_f32 v220, v192, v193
    v_cvt_pk_bf16_f32 v221, v194, v195
    v_mfma_f32_16x16x32_bf16 v[180:183], v[212:215], v[160:163], 0
    v_cvt_pk_bf16_f32 v222, v196, v197
    v_cvt_pk_bf16_f32 v223, v198, v199
    v_mfma_f32_16x16x16_bf16 v[168:171], v[216:217], v[164:165], v[168:171]
    buffer_load_dwordx4 v[120:123], v2, s[4:7], s64 offen offset:0 sc1
    v_mfma_f32_16x16x16_bf16 v[156:159], a[100:101], v[164:165], v[156:159]
    buffer_load_dwordx4 v[100:103], v2, s[4:7], s46 offen offset:3072 sc1
    v_mfma_f32_16x16x16_bf16 v[172:175], v[218:219], v[164:165], v[172:175]
    buffer_load_dwordx4 v[124:127], v2, s[4:7], s64 offen offset:1024 sc1
    v_mfma_f32_16x16x16_bf16 v[176:179], v[220:221], v[164:165], v[176:179]
    buffer_load_dwordx4 v[104:107], v2, s[4:7], s56 offen offset:0 sc1
    v_mfma_f32_16x16x16_bf16 v[180:183], v[222:223], v[164:165], v[180:183]
    buffer_load_dwordx4 v[128:131], v2, s[4:7], s64 offen offset:2048 sc1
    buffer_load_dwordx4 v[108:111], v2, s[4:7], s56 offen offset:1024 sc1
    buffer_load_dwordx4 v[132:135], v2, s[4:7], s64 offen offset:3072 sc1
    s_not_b64 exec, s[68:69]
    ds_write_b128 v6, v[168:171]
    v_rcp_f32 v230, v156
    ds_write_b128 v6, v[172:175] offset:2048
    ds_write_b32 v10, v230
    ds_write_b128 v6, v[176:179] offset:4096
    ds_write_b128 v6, v[180:183] offset:6144
    s_mov_b64 exec, -1
    s_waitcnt lgkmcnt(0)
    s_barrier
    ds_read_b128 v[232:235], v11
    ds_read2_b64 v[148:151], v7 offset0:0 offset1:64
    ds_read2_b64 v[152:155], v7 offset0:128 offset1:192
    s_add_u32 s48, s42, 8192
    s_waitcnt lgkmcnt(1)
    v_pk_mul_f32 v[148:149], v[148:149], v[232:233] op_sel_hi:[1,0]
    v_pk_fma_f32 v[148:149], v[150:151], v[232:233], v[148:149] op_sel:[0,1,0]
    s_waitcnt lgkmcnt(0)
    v_pk_fma_f32 v[148:149], v[152:153], v[234:235], v[148:149] op_sel_hi:[1,0,1]
    v_pk_fma_f32 v[148:149], v[154:155], v[234:235], v[148:149] op_sel:[0,1,0]
    v_cvt_pk_bf16_f32 v152, v148, v149
    buffer_store_dword v152, v15, s[4:7], s42 offen sc1
    buffer_store_dword v152, v15, s[4:7], s48 offen sc1
    s_waitcnt vmcnt(2)
    v_mfma_f32_16x16x32_bf16 v[168:171], v[88:91], a[0:3], 0
    v_mfma_f32_16x16x32_bf16 v[176:179], v[88:91], a[24:27], 0
    v_mfma_f32_16x16x32_bf16 v[184:187], v[88:91], a[48:51], 0
    v_mfma_f32_16x16x32_bf16 v[192:195], v[88:91], a[72:75], 0
    v_mfma_f32_16x16x32_bf16 v[172:175], v[112:115], a[0:3], 0
    v_mfma_f32_16x16x32_bf16 v[180:183], v[112:115], a[24:27], 0
    v_mfma_f32_16x16x32_bf16 v[188:191], v[112:115], a[48:51], 0
    v_mfma_f32_16x16x32_bf16 v[196:199], v[112:115], a[72:75], 0
    v_mfma_f32_16x16x32_bf16 v[168:171], v[92:95], a[4:7], v[168:171]
    v_mfma_f32_16x16x32_bf16 v[176:179], v[92:95], a[28:31], v[176:179]
    v_mfma_f32_16x16x32_bf16 v[184:187], v[92:95], a[52:55], v[184:187]
    v_mfma_f32_16x16x32_bf16 v[192:195], v[92:95], a[76:79], v[192:195]
    v_mfma_f32_16x16x32_bf16 v[172:175], v[116:119], a[4:7], v[172:175]
    v_mfma_f32_16x16x32_bf16 v[180:183], v[116:119], a[28:31], v[180:183]
    v_mfma_f32_16x16x32_bf16 v[188:191], v[116:119], a[52:55], v[188:191]
    v_mfma_f32_16x16x32_bf16 v[196:199], v[116:119], a[76:79], v[196:199]
    v_mfma_f32_16x16x32_bf16 v[168:171], v[96:99], a[8:11], v[168:171]
    v_mfma_f32_16x16x32_bf16 v[176:179], v[96:99], a[32:35], v[176:179]
    v_mfma_f32_16x16x32_bf16 v[184:187], v[96:99], a[56:59], v[184:187]
    v_mfma_f32_16x16x32_bf16 v[192:195], v[96:99], a[80:83], v[192:195]
    v_mfma_f32_16x16x32_bf16 v[172:175], v[120:123], a[8:11], v[172:175]
    v_mfma_f32_16x16x32_bf16 v[180:183], v[120:123], a[32:35], v[180:183]
    v_mfma_f32_16x16x32_bf16 v[188:191], v[120:123], a[56:59], v[188:191]
    v_mfma_f32_16x16x32_bf16 v[196:199], v[120:123], a[80:83], v[196:199]
    buffer_load_dword v16, v240, s[4:7], s41 offen offset:0 sc1
    buffer_load_dword v17, v241, s[4:7], s41 offen offset:0 sc1
    buffer_load_dword v18, v242, s[4:7], s41 offen offset:0 sc1
    buffer_load_dword v19, v243, s[4:7], s41 offen offset:0 sc1
    buffer_load_dword v20, v4, s[4:7], s41 offen offset:0 sc1
    buffer_load_dword v21, v5, s[4:7], s41 offen offset:0 sc1
    buffer_load_dword v22, v14, s[4:7], s41 offen offset:0 sc1
    v_mov_b32 v232, v148
    v_mov_b32 v233, v149
    v_mfma_f32_16x16x32_bf16 v[168:171], v[100:103], a[12:15], v[168:171]
    v_mfma_f32_16x16x32_bf16 v[176:179], v[100:103], a[36:39], v[176:179]
    v_mfma_f32_16x16x32_bf16 v[184:187], v[100:103], a[60:63], v[184:187]
    v_mfma_f32_16x16x32_bf16 v[192:195], v[100:103], a[84:87], v[192:195]
    v_mfma_f32_16x16x32_bf16 v[172:175], v[124:127], a[12:15], v[172:175]
    v_mfma_f32_16x16x32_bf16 v[180:183], v[124:127], a[36:39], v[180:183]
    v_mfma_f32_16x16x32_bf16 v[188:191], v[124:127], a[60:63], v[188:191]
    v_mfma_f32_16x16x32_bf16 v[196:199], v[124:127], a[84:87], v[196:199]
    v_mfma_f32_16x16x32_bf16 v[168:171], v[104:107], a[16:19], v[168:171]
    v_mfma_f32_16x16x32_bf16 v[176:179], v[104:107], a[40:43], v[176:179]
    v_mfma_f32_16x16x32_bf16 v[184:187], v[104:107], a[64:67], v[184:187]
    v_mfma_f32_16x16x32_bf16 v[192:195], v[104:107], a[88:91], v[192:195]
    v_mfma_f32_16x16x32_bf16 v[172:175], v[128:131], a[16:19], v[172:175]
    v_mfma_f32_16x16x32_bf16 v[180:183], v[128:131], a[40:43], v[180:183]
    v_mfma_f32_16x16x32_bf16 v[188:191], v[128:131], a[64:67], v[188:191]
    v_mfma_f32_16x16x32_bf16 v[196:199], v[128:131], a[88:91], v[196:199]
    s_branch Lpf_124
Lpp_122:
    buffer_load_dword v16, v240, s[4:7], s41 offen offset:0 sc1
    buffer_load_dword v17, v241, s[4:7], s41 offen offset:0 sc1
    buffer_load_dword v18, v242, s[4:7], s41 offen offset:0 sc1
    buffer_load_dword v19, v243, s[4:7], s41 offen offset:0 sc1
    buffer_load_dword v20, v4, s[4:7], s41 offen offset:0 sc1
    buffer_load_dword v21, v5, s[4:7], s41 offen offset:0 sc1
    buffer_load_dword v22, v14, s[4:7], s41 offen offset:0 sc1
    v_mov_b32 v232, v148
    v_mov_b32 v233, v149
Lpf_124:
    s_waitcnt vmcnt(4)
    v_max3_u32 v228, v16, v17, v18
    v_dot2c_f32_bf16 v232, s70, v16
    v_dot2c_f32_bf16 v233, s71, v16
    v_dot2c_f32_bf16 v232, s70, v17
    v_dot2c_f32_bf16 v233, s71, v17
    v_dot2c_f32_bf16 v232, s70, v18
    v_dot2c_f32_bf16 v233, s71, v18
    s_waitcnt vmcnt(2)
    v_max3_u32 v228, v228, v19, v20
    v_dot2c_f32_bf16 v232, s70, v19
    v_dot2c_f32_bf16 v233, s71, v19
    v_dot2c_f32_bf16 v232, s70, v20
    v_dot2c_f32_bf16 v233, s71, v20
    s_waitcnt vmcnt(1)
    v_dot2c_f32_bf16 v232, s70, v21
    v_dot2c_f32_bf16 v233, s71, v21
    s_waitcnt vmcnt(0)
    v_max3_u32 v228, v228, v21, v22
    v_cmp_eq_u32 vcc, -1, v228
    v_dot2c_f32_bf16 v232, s70, v22
    v_dot2c_f32_bf16 v233, s71, v22
    s_cbranch_vccz Lpd_123
    s_sub_u32 s31, s31, 1
    s_cbranch_scc0 Lpp_122
    s_mov_b32 s31, 4
    s_branch L_fail
Lpd_123:
    v_cvt_pk_bf16_f32 v232, v232, v233
    buffer_store_dword v232, v8, s[4:7], s44 offen sc1
    buffer_store_dword v248, v8, s[4:7], s45 offen sc1
    s_barrier
    buffer_load_dwordx4 v[40:43], v2, s[4:7], s65 offen offset:0 sc1
    buffer_load_dwordx4 v[44:47], v2, s[4:7], s65 offen offset:1024 sc1
    buffer_load_dwordx4 v[48:51], v2, s[4:7], s65 offen offset:2048 sc1
    buffer_load_dwordx4 v[52:55], v2, s[4:7], s65 offen offset:3072 sc1
    buffer_load_dwordx4 v[56:59], v2, s[4:7], s66 offen offset:0 sc1
    buffer_load_dwordx4 v[60:63], v2, s[4:7], s66 offen offset:1024 sc1
    v_mfma_f32_16x16x32_bf16 v[168:171], v[108:111], a[20:23], v[168:171]
    v_mfma_f32_16x16x32_bf16 v[176:179], v[108:111], a[44:47], v[176:179]
    v_mfma_f32_16x16x32_bf16 v[184:187], v[108:111], a[68:71], v[184:187]
    v_mfma_f32_16x16x32_bf16 v[192:195], v[108:111], a[92:95], v[192:195]
    buffer_load_dwordx4 v[64:67], v2, s[4:7], s66 offen offset:2048 sc1
    buffer_load_dwordx4 v[68:71], v2, s[4:7], s66 offen offset:3072 sc1
    buffer_load_dwordx4 v[72:75], v2, s[4:7], s67 offen offset:0 sc1
    buffer_load_dwordx4 v[76:79], v2, s[4:7], s67 offen offset:1024 sc1
    buffer_load_dwordx4 v[80:83], v2, s[4:7], s67 offen offset:2048 sc1
    buffer_load_dwordx4 v[84:87], v2, s[4:7], s67 offen offset:3072 sc1
    v_mfma_f32_16x16x32_bf16 v[172:175], v[132:135], a[20:23], v[172:175]
    v_mfma_f32_16x16x32_bf16 v[180:183], v[132:135], a[44:47], v[180:183]
    v_mfma_f32_16x16x32_bf16 v[188:191], v[132:135], a[68:71], v[188:191]
    v_mfma_f32_16x16x32_bf16 v[196:199], v[132:135], a[92:95], v[196:199]
    v_cvt_pk_bf16_f32 v200, v168, v169
    v_cvt_pk_bf16_f32 v201, v170, v171
    v_cvt_pk_bf16_f32 v202, v172, v173
    v_cvt_pk_bf16_f32 v203, v174, v175
    v_cvt_pk_bf16_f32 v204, v176, v177
    v_cvt_pk_bf16_f32 v205, v178, v179
    v_cvt_pk_bf16_f32 v206, v180, v181
    v_cvt_pk_bf16_f32 v207, v182, v183
    s_add_u32 s30, s30, 1
    s_cmp_lt_u32 s30, 63
    s_cbranch_scc1 Lwt_106
L_swend:
    s_lshl_b32 s38, s20, 6
    s_lshl_b32 s39, s22, 2
    s_add_u32 s38, s38, s39
    s_add_u32 s38, s38, 171008
    s_add_u32 s46, s62, 94633984
    s_add_u32 s56, s46, 4096
    s_add_u32 s64, s46, 8192
    s_lshl_b32 s39, s22, 10
    v_add_u32 v6, s39, v2
    s_lshl_b32 s39, s22, 12
    v_add_u32 v7, s39, v2
    s_lshr_b32 s40, s24, 1
    s_lshl_b32 s40, s40, 2
    s_add_u32 s40, s40, s22
    s_lshl_b32 s40, s40, 10
    s_and_b32 s41, s24, 1
    s_lshl_b32 s41, s41, 3
    s_add_u32 s40, s40, s41
    s_mul_i32 s41, s20, 40960
    s_add_u32 s40, s40, s41
    s_add_u32 s40, s40, 162922496
    s_add_u32 s41, s40, 20480
    s_mul_i32 s43, s20, 5
    s_lshr_b32 s44, s24, 1
    s_add_u32 s43, s43, s44
    s_lshl_b32 s43, s43, 7
    s_add_u32 s43, s43, 1769472
    v_mov_b32 v3, 0
    v_mov_b32 v252, 1
    s_waitcnt vmcnt(0)
    s_mov_b32 s31, 262144
    s_mov_b32 exec_lo, 0x1
    s_mov_b32 exec_hi, 0
Lf_125:
    buffer_load_dword v228, v3, s[4:7], s38 offen sc1
    s_waitcnt vmcnt(0)
    v_cmp_eq_u32 vcc, 0, v228
    s_cbranch_vccz Lfd_126
    s_sleep 1
    s_sub_u32 s31, s31, 1
    s_cbranch_scc0 Lf_125
    s_mov_b32 s31, 5
    s_branch L_fail
Lfd_126:
    s_mov_b64 exec, -1
    buffer_load_dwordx4 v[88:91], v2, s[4:7], s46 offen offset:0 sc1
    buffer_load_dwordx4 v[112:115], v2, s[4:7], s56 offen offset:2048 sc1
    buffer_load_dwordx4 v[92:95], v2, s[4:7], s46 offen offset:1024 sc1
    buffer_load_dwordx4 v[116:119], v2, s[4:7], s56 offen offset:3072 sc1
    buffer_load_dwordx4 v[96:99], v2, s[4:7], s46 offen offset:2048 sc1
    buffer_load_dwordx4 v[120:123], v2, s[4:7], s64 offen offset:0 sc1
    buffer_load_dwordx4 v[100:103], v2, s[4:7], s46 offen offset:3072 sc1
    buffer_load_dwordx4 v[124:127], v2, s[4:7], s64 offen offset:1024 sc1
    buffer_load_dwordx4 v[104:107], v2, s[4:7], s56 offen offset:0 sc1
    buffer_load_dwordx4 v[128:131], v2, s[4:7], s64 offen offset:2048 sc1
    buffer_load_dwordx4 v[108:111], v2, s[4:7], s56 offen offset:1024 sc1
    buffer_load_dwordx4 v[132:135], v2, s[4:7], s64 offen offset:3072 sc1
    s_waitcnt vmcnt(11)
    v_mfma_f32_16x16x32_bf16 v[168:171], a[0:3], v[88:91], 0
    v_mfma_f32_16x16x32_bf16 v[172:175], a[24:27], v[88:91], 0
    v_mfma_f32_16x16x32_bf16 v[176:179], a[48:51], v[88:91], 0
    v_mfma_f32_16x16x32_bf16 v[180:183], a[72:75], v[88:91], 0
    s_waitcnt vmcnt(10)
    v_mfma_f32_16x16x32_bf16 v[184:187], a[0:3], v[112:115], 0
    v_mfma_f32_16x16x32_bf16 v[188:191], a[24:27], v[112:115], 0
    v_mfma_f32_16x16x32_bf16 v[192:195], a[48:51], v[112:115], 0
    v_mfma_f32_16x16x32_bf16 v[196:199], a[72:75], v[112:115], 0
    s_waitcnt vmcnt(9)
    v_mfma_f32_16x16x32_bf16 v[168:171], a[4:7], v[92:95], v[168:171]
    v_mfma_f32_16x16x32_bf16 v[172:175], a[28:31], v[92:95], v[172:175]
    v_mfma_f32_16x16x32_bf16 v[176:179], a[52:55], v[92:95], v[176:179]
    v_mfma_f32_16x16x32_bf16 v[180:183], a[76:79], v[92:95], v[180:183]
    s_waitcnt vmcnt(8)
    v_mfma_f32_16x16x32_bf16 v[184:187], a[4:7], v[116:119], v[184:187]
    v_mfma_f32_16x16x32_bf16 v[188:191], a[28:31], v[116:119], v[188:191]
    v_mfma_f32_16x16x32_bf16 v[192:195], a[52:55], v[116:119], v[192:195]
    v_mfma_f32_16x16x32_bf16 v[196:199], a[76:79], v[116:119], v[196:199]
    s_waitcnt vmcnt(7)
    v_mfma_f32_16x16x32_bf16 v[168:171], a[8:11], v[96:99], v[168:171]
    v_mfma_f32_16x16x32_bf16 v[172:175], a[32:35], v[96:99], v[172:175]
    v_mfma_f32_16x16x32_bf16 v[176:179], a[56:59], v[96:99], v[176:179]
    v_mfma_f32_16x16x32_bf16 v[180:183], a[80:83], v[96:99], v[180:183]
    s_waitcnt vmcnt(6)
    v_mfma_f32_16x16x32_bf16 v[184:187], a[8:11], v[120:123], v[184:187]
    v_mfma_f32_16x16x32_bf16 v[188:191], a[32:35], v[120:123], v[188:191]
    v_mfma_f32_16x16x32_bf16 v[192:195], a[56:59], v[120:123], v[192:195]
    v_mfma_f32_16x16x32_bf16 v[196:199], a[80:83], v[120:123], v[196:199]
    s_waitcnt vmcnt(5)
    v_mfma_f32_16x16x32_bf16 v[168:171], a[12:15], v[100:103], v[168:171]
    v_mfma_f32_16x16x32_bf16 v[172:175], a[36:39], v[100:103], v[172:175]
    v_mfma_f32_16x16x32_bf16 v[176:179], a[60:63], v[100:103], v[176:179]
    v_mfma_f32_16x16x32_bf16 v[180:183], a[84:87], v[100:103], v[180:183]
    s_waitcnt vmcnt(4)
    v_mfma_f32_16x16x32_bf16 v[184:187], a[12:15], v[124:127], v[184:187]
    v_mfma_f32_16x16x32_bf16 v[188:191], a[36:39], v[124:127], v[188:191]
    v_mfma_f32_16x16x32_bf16 v[192:195], a[60:63], v[124:127], v[192:195]
    v_mfma_f32_16x16x32_bf16 v[196:199], a[84:87], v[124:127], v[196:199]
    s_waitcnt vmcnt(3)
    v_mfma_f32_16x16x32_bf16 v[168:171], a[16:19], v[104:107], v[168:171]
    v_mfma_f32_16x16x32_bf16 v[172:175], a[40:43], v[104:107], v[172:175]
    v_mfma_f32_16x16x32_bf16 v[176:179], a[64:67], v[104:107], v[176:179]
    v_mfma_f32_16x16x32_bf16 v[180:183], a[88:91], v[104:107], v[180:183]
    s_waitcnt vmcnt(2)
    v_mfma_f32_16x16x32_bf16 v[184:187], a[16:19], v[128:131], v[184:187]
    v_mfma_f32_16x16x32_bf16 v[188:191], a[40:43], v[128:131], v[188:191]
    v_mfma_f32_16x16x32_bf16 v[192:195], a[64:67], v[128:131], v[192:195]
    v_mfma_f32_16x16x32_bf16 v[196:199], a[88:91], v[128:131], v[196:199]
    s_waitcnt vmcnt(1)
    v_mfma_f32_16x16x32_bf16 v[168:171], a[20:23], v[108:111], v[168:171]
    v_mfma_f32_16x16x32_bf16 v[172:175], a[44:47], v[108:111], v[172:175]
    v_mfma_f32_16x16x32_bf16 v[176:179], a[68:71], v[108:111], v[176:179]
    v_mfma_f32_16x16x32_bf16 v[180:183], a[92:95], v[108:111], v[180:183]
    s_waitcnt vmcnt(0)
    v_mfma_f32_16x16x32_bf16 v[184:187], a[20:23], v[132:135], v[184:187]
    v_mfma_f32_16x16x32_bf16 v[188:191], a[44:47], v[132:135], v[188:191]
    v_mfma_f32_16x16x32_bf16 v[192:195], a[68:71], v[132:135], v[192:195]
    v_mfma_f32_16x16x32_bf16 v[196:199], a[92:95], v[132:135], v[196:199]
    ds_write_b128 v6, v[168:171] offset:0
    ds_write_b128 v6, v[172:175] offset:4096
    ds_write_b128 v6, v[176:179] offset:8192
    ds_write_b128 v6, v[180:183] offset:12288
    ds_write_b128 v6, v[184:187] offset:16384
    ds_write_b128 v6, v[188:191] offset:20480
    ds_write_b128 v6, v[192:195] offset:24576
    s_nop 0
    ds_write_b128 v6, v[196:199] offset:28672
    s_waitcnt lgkmcnt(0)
    s_barrier
    ds_read_b128 v[40:43], v7 offset:0
    ds_read_b128 v[44:47], v7 offset:1024
    ds_read_b128 v[48:51], v7 offset:2048
    ds_read_b128 v[52:55], v7 offset:3072
    ds_read_b128 v[56:59], v7 offset:16384
    ds_read_b128 v[60:63], v7 offset:17408
    ds_read_b128 v[64:67], v7 offset:18432
    ds_read_b128 v[68:71], v7 offset:19456
    s_and_b32 s38, s25, 7
    s_cmp_eq_u32 s38, 7
    s_cselect_b64 exec, 1, 0
    buffer_store_dword v252, v3, s[4:7], s43 offen sc1
    s_mov_b64 exec, -1
    s_waitcnt lgkmcnt(4)
    v_add_f32 v40, v40, v44
    v_add_f32 v48, v48, v52
    v_add_f32 v41, v41, v45
    v_add_f32 v49, v49, v53
    v_add_f32 v42, v42, v46
    v_add_f32 v50, v50, v54
    v_add_f32 v43, v43, v47
    v_add_f32 v51, v51, v55
    v_add_f32 v40, v40, v48
    v_add_f32 v41, v41, v49
    v_add_f32 v42, v42, v50
    v_add_f32 v43, v43, v51
    v_cvt_pk_bf16_f32 v44, v40, v41
    v_cvt_pk_bf16_f32 v45, v42, v43
    buffer_store_dwordx2 v[44:45], v2, s[4:7], s40 offen sc1
    s_waitcnt lgkmcnt(0)
    v_add_f32 v56, v56, v60
    v_add_f32 v64, v64, v68
    v_add_f32 v57, v57, v61
    v_add_f32 v65, v65, v69
    v_add_f32 v58, v58, v62
    v_add_f32 v66, v66, v70
    v_add_f32 v59, v59, v63
    v_add_f32 v67, v67, v71
    v_add_f32 v56, v56, v64
    v_add_f32 v57, v57, v65
    v_add_f32 v58, v58, v66
    v_add_f32 v59, v59, v67
    v_cvt_pk_bf16_f32 v60, v56, v57
    v_cvt_pk_bf16_f32 v61, v58, v59
    buffer_store_dwordx2 v[60:61], v2, s[4:7], s41 offen sc1
    s_lshl_b32 s38, s20, 6
    s_lshl_b32 s39, s22, 2
    s_add_u32 s38, s38, s39
    s_add_u32 s38, s38, 171520
    s_add_u32 s46, s62, 95027200
    s_add_u32 s56, s46, 4096
    s_add_u32 s64, s46, 8192
    s_lshl_b32 s39, s22, 10
    v_add_u32 v6, s39, v2
    s_lshl_b32 s39, s22, 12
    v_add_u32 v7, s39, v2
    s_lshr_b32 s40, s24, 1
    s_lshl_b32 s40, s40, 2
    s_add_u32 s40, s40, s22
    s_lshl_b32 s40, s40, 10
    s_and_b32 s41, s24, 1
    s_lshl_b32 s41, s41, 3
    s_add_u32 s40, s40, s41
    s_mul_i32 s41, s20, 40960
    s_add_u32 s40, s40, s41
    s_add_u32 s40, s40, 163250176
    s_add_u32 s41, s40, 20480
    s_mul_i32 s43, s20, 5
    s_lshr_b32 s44, s24, 1
    s_add_u32 s43, s43, s44
    s_lshl_b32 s43, s43, 7
    s_add_u32 s43, s43, 1769476
    v_mov_b32 v3, 0
    v_mov_b32 v252, 1
    s_mov_b32 s31, 262144
    s_mov_b32 exec_lo, 0x1
    s_mov_b32 exec_hi, 0
Lf_127:
    buffer_load_dword v228, v3, s[4:7], s38 offen sc1
    s_waitcnt vmcnt(0)
    v_cmp_eq_u32 vcc, 0, v228
    s_cbranch_vccz Lfd_128
    s_sleep 1
    s_sub_u32 s31, s31, 1
    s_cbranch_scc0 Lf_127
    s_mov_b32 s31, 5
    s_branch L_fail
Lfd_128:
    s_mov_b64 exec, -1
    buffer_load_dwordx4 v[88:91], v2, s[4:7], s46 offen offset:0 sc1
    buffer_load_dwordx4 v[112:115], v2, s[4:7], s56 offen offset:2048 sc1
    buffer_load_dwordx4 v[92:95], v2, s[4:7], s46 offen offset:1024 sc1
    buffer_load_dwordx4 v[116:119], v2, s[4:7], s56 offen offset:3072 sc1
    buffer_load_dwordx4 v[96:99], v2, s[4:7], s46 offen offset:2048 sc1
    buffer_load_dwordx4 v[120:123], v2, s[4:7], s64 offen offset:0 sc1
    buffer_load_dwordx4 v[100:103], v2, s[4:7], s46 offen offset:3072 sc1
    buffer_load_dwordx4 v[124:127], v2, s[4:7], s64 offen offset:1024 sc1
    buffer_load_dwordx4 v[104:107], v2, s[4:7], s56 offen offset:0 sc1
    buffer_load_dwordx4 v[128:131], v2, s[4:7], s64 offen offset:2048 sc1
    buffer_load_dwordx4 v[108:111], v2, s[4:7], s56 offen offset:1024 sc1
    buffer_load_dwordx4 v[132:135], v2, s[4:7], s64 offen offset:3072 sc1
    s_waitcnt vmcnt(11)
    v_mfma_f32_16x16x32_bf16 v[168:171], a[0:3], v[88:91], 0
    v_mfma_f32_16x16x32_bf16 v[172:175], a[24:27], v[88:91], 0
    v_mfma_f32_16x16x32_bf16 v[176:179], a[48:51], v[88:91], 0
    v_mfma_f32_16x16x32_bf16 v[180:183], a[72:75], v[88:91], 0
    s_waitcnt vmcnt(10)
    v_mfma_f32_16x16x32_bf16 v[184:187], a[0:3], v[112:115], 0
    v_mfma_f32_16x16x32_bf16 v[188:191], a[24:27], v[112:115], 0
    v_mfma_f32_16x16x32_bf16 v[192:195], a[48:51], v[112:115], 0
    v_mfma_f32_16x16x32_bf16 v[196:199], a[72:75], v[112:115], 0
    s_waitcnt vmcnt(9)
    v_mfma_f32_16x16x32_bf16 v[168:171], a[4:7], v[92:95], v[168:171]
    v_mfma_f32_16x16x32_bf16 v[172:175], a[28:31], v[92:95], v[172:175]
    v_mfma_f32_16x16x32_bf16 v[176:179], a[52:55], v[92:95], v[176:179]
    v_mfma_f32_16x16x32_bf16 v[180:183], a[76:79], v[92:95], v[180:183]
    s_waitcnt vmcnt(8)
    v_mfma_f32_16x16x32_bf16 v[184:187], a[4:7], v[116:119], v[184:187]
    v_mfma_f32_16x16x32_bf16 v[188:191], a[28:31], v[116:119], v[188:191]
    v_mfma_f32_16x16x32_bf16 v[192:195], a[52:55], v[116:119], v[192:195]
    v_mfma_f32_16x16x32_bf16 v[196:199], a[76:79], v[116:119], v[196:199]
    s_waitcnt vmcnt(7)
    v_mfma_f32_16x16x32_bf16 v[168:171], a[8:11], v[96:99], v[168:171]
    v_mfma_f32_16x16x32_bf16 v[172:175], a[32:35], v[96:99], v[172:175]
    v_mfma_f32_16x16x32_bf16 v[176:179], a[56:59], v[96:99], v[176:179]
    v_mfma_f32_16x16x32_bf16 v[180:183], a[80:83], v[96:99], v[180:183]
    s_waitcnt vmcnt(6)
    v_mfma_f32_16x16x32_bf16 v[184:187], a[8:11], v[120:123], v[184:187]
    v_mfma_f32_16x16x32_bf16 v[188:191], a[32:35], v[120:123], v[188:191]
    v_mfma_f32_16x16x32_bf16 v[192:195], a[56:59], v[120:123], v[192:195]
    v_mfma_f32_16x16x32_bf16 v[196:199], a[80:83], v[120:123], v[196:199]
    s_waitcnt vmcnt(5)
    v_mfma_f32_16x16x32_bf16 v[168:171], a[12:15], v[100:103], v[168:171]
    v_mfma_f32_16x16x32_bf16 v[172:175], a[36:39], v[100:103], v[172:175]
    v_mfma_f32_16x16x32_bf16 v[176:179], a[60:63], v[100:103], v[176:179]
    v_mfma_f32_16x16x32_bf16 v[180:183], a[84:87], v[100:103], v[180:183]
    s_waitcnt vmcnt(4)
    v_mfma_f32_16x16x32_bf16 v[184:187], a[12:15], v[124:127], v[184:187]
    v_mfma_f32_16x16x32_bf16 v[188:191], a[36:39], v[124:127], v[188:191]
    v_mfma_f32_16x16x32_bf16 v[192:195], a[60:63], v[124:127], v[192:195]
    v_mfma_f32_16x16x32_bf16 v[196:199], a[84:87], v[124:127], v[196:199]
    s_waitcnt vmcnt(3)
    v_mfma_f32_16x16x32_bf16 v[168:171], a[16:19], v[104:107], v[168:171]
    v_mfma_f32_16x16x32_bf16 v[172:175], a[40:43], v[104:107], v[172:175]
    v_mfma_f32_16x16x32_bf16 v[176:179], a[64:67], v[104:107], v[176:179]
    v_mfma_f32_16x16x32_bf16 v[180:183], a[88:91], v[104:107], v[180:183]
    s_waitcnt vmcnt(2)
    v_mfma_f32_16x16x32_bf16 v[184:187], a[16:19], v[128:131], v[184:187]
    v_mfma_f32_16x16x32_bf16 v[188:191], a[40:43], v[128:131], v[188:191]
    v_mfma_f32_16x16x32_bf16 v[192:195], a[64:67], v[128:131], v[192:195]
    v_mfma_f32_16x16x32_bf16 v[196:199], a[88:91], v[128:131], v[196:199]
    s_waitcnt vmcnt(1)
    v_mfma_f32_16x16x32_bf16 v[168:171], a[20:23], v[108:111], v[168:171]
    v_mfma_f32_16x16x32_bf16 v[172:175], a[44:47], v[108:111], v[172:175]
    v_mfma_f32_16x16x32_bf16 v[176:179], a[68:71], v[108:111], v[176:179]
    v_mfma_f32_16x16x32_bf16 v[180:183], a[92:95], v[108:111], v[180:183]
    s_waitcnt vmcnt(0)
    v_mfma_f32_16x16x32_bf16 v[184:187], a[20:23], v[132:135], v[184:187]
    v_mfma_f32_16x16x32_bf16 v[188:191], a[44:47], v[132:135], v[188:191]
    v_mfma_f32_16x16x32_bf16 v[192:195], a[68:71], v[132:135], v[192:195]
    v_mfma_f32_16x16x32_bf16 v[196:199], a[92:95], v[132:135], v[196:199]
    s_barrier
    ds_write_b128 v6, v[168:171] offset:0
    ds_write_b128 v6, v[172:175] offset:4096
    ds_write_b128 v6, v[176:179] offset:8192
    ds_write_b128 v6, v[180:183] offset:12288
    ds_write_b128 v6, v[184:187] offset:16384
    ds_write_b128 v6, v[188:191] offset:20480
    ds_write_b128 v6, v[192:195] offset:24576
    ds_write_b128 v6, v[196:199] offset:28672
    s_waitcnt lgkmcnt(0)
    s_barrier
    ds_read_b128 v[40:43], v7 offset:0
    ds_read_b128 v[44:47], v7 offset:1024
    ds_read_b128 v[48:51], v7 offset:2048
    ds_read_b128 v[52:55], v7 offset:3072
    ds_read_b128 v[56:59], v7 offset:16384
    ds_read_b128 v[60:63], v7 offset:17408
    ds_read_b128 v[64:67], v7 offset:18432
    ds_read_b128 v[68:71], v7 offset:19456
    s_and_b32 s38, s25, 7
    s_cmp_eq_u32 s38, 7
    s_cselect_b64 exec, 1, 0
    buffer_store_dword v252, v3, s[4:7], s43 offen sc1
    s_mov_b64 exec, -1
    s_waitcnt lgkmcnt(4)
    v_add_f32 v40, v40, v44
    v_add_f32 v48, v48, v52
    v_add_f32 v41, v41, v45
    v_add_f32 v49, v49, v53
    v_add_f32 v42, v42, v46
    v_add_f32 v50, v50, v54
    v_add_f32 v43, v43, v47
    v_add_f32 v51, v51, v55
    v_add_f32 v40, v40, v48
    v_add_f32 v41, v41, v49
    v_add_f32 v42, v42, v50
    v_add_f32 v43, v43, v51
    v_cvt_pk_bf16_f32 v44, v40, v41
    v_cvt_pk_bf16_f32 v45, v42, v43
    buffer_store_dwordx2 v[44:45], v2, s[4:7], s40 offen sc1
    s_waitcnt lgkmcnt(0)
    v_add_f32 v56, v56, v60
    v_add_f32 v64, v64, v68
    v_add_f32 v57, v57, v61
    v_add_f32 v65, v65, v69
    v_add_f32 v58, v58, v62
    v_add_f32 v66, v66, v70
    v_add_f32 v59, v59, v63
    v_add_f32 v67, v67, v71
    v_add_f32 v56, v56, v64
    v_add_f32 v57, v57, v65
    v_add_f32 v58, v58, v66
    v_add_f32 v59, v59, v67
    v_cvt_pk_bf16_f32 v60, v56, v57
    v_cvt_pk_bf16_f32 v61, v58, v59
    buffer_store_dwordx2 v[60:61], v2, s[4:7], s41 offen sc1
    s_endpgm
L_help:
    s_mov_b32 s8, s52
    s_and_b32 s9, s53, 0xffff
    s_mov_b32 s10, 0x280000
    s_mov_b32 s11, 0x00020000
    s_mul_i32 s24, s20, 10
    s_add_u32 s24, s24, s21
    s_sub_u32 s24, s24, 22
    v_and_b32 v3, 3, v1
    v_lshrrev_b32 v4, 2, v1
    s_lshl_b32 s40, s22, 2
    v_add_u32 v3, s40, v3
    v_mul_u32_u24 v5, 1280, v3
    v_lshl_add_u32 v5, v4, 4, v5
    v_lshrrev_b32 v6, 2, v4
    v_lshlrev_b32 v6, 10, v6
    v_and_b32 v7, 3, v4
    v_lshl_add_u32 v6, v7, 8, v6
    v_lshl_add_u32 v6, v3, 4, v6
    s_mul_i32 s25, s24, 20480
    s_add_u32 s26, s25, 1638400
    buffer_load_dwordx4 v[16:19], v5, s[8:11], s25 offen offset:0 nt
    buffer_load_dwordx4 v[20:23], v5, s[8:11], s25 offen offset:256 nt
    buffer_load_dwordx4 v[24:27], v5, s[8:11], s25 offen offset:512 nt
    buffer_load_dwordx4 v[28:31], v5, s[8:11], s25 offen offset:768 nt
    buffer_load_dwordx4 v[32:35], v5, s[8:11], s25 offen offset:1024 nt
    buffer_load_dwordx4 v[36:39], v5, s[8:11], s26 offen offset:0 nt
    buffer_load_dwordx4 v[40:43], v5, s[8:11], s26 offen offset:256 nt
    buffer_load_dwordx4 v[44:47], v5, s[8:11], s26 offen offset:512 nt
    buffer_load_dwordx4 v[48:51], v5, s[8:11], s26 offen offset:768 nt
    buffer_load_dwordx4 v[52:55], v5, s[8:11], s26 offen offset:1024 nt
    v_mov_b32 v56, 0
    v_mov_b32 v60, -1
    v_mov_b32 v57, 0
    v_mov_b32 v61, -1
    v_mov_b32 v58, 0
    v_mov_b32 v62, -1
    v_mov_b32 v59, 0
    v_mov_b32 v63, -1
    v_lshlrev_b32 v8, 4, v0
    s_add_u32 s44, s24, 0
    s_mov_b32 s45, 0
    s_cmp_ge_u32 s44, 0
    s_cselect_b32 s45, 0x0, s45
    s_cmp_ge_u32 s44, 64
    s_cselect_b32 s45, 0x170000, s45
    s_cmp_ge_u32 s44, 66
    s_cselect_b32 s45, 0x12000, s45
    s_lshl_b32 s46, s44, 12
    s_add_u32 s45, s45, s46
    s_cmp_ge_u32 s44, 66
    s_cbranch_scc1 Liz_130
    buffer_store_dwordx4 v[56:59], v8, s[4:7], s45 offen sc1
    s_branch Lif_129
Liz_130:
    buffer_store_dwordx4 v[60:63], v8, s[4:7], s45 offen sc1
Lif_129:
    s_add_u32 s44, s24, 80
    s_mov_b32 s45, 0
    s_cmp_ge_u32 s44, 66
    s_cselect_b32 s45, 0x12000, s45
    s_cmp_ge_u32 s44, 106
    s_cselect_b32 s45, 0x26000, s45
    s_lshl_b32 s46, s44, 12
    s_add_u32 s45, s45, s46
    buffer_store_dwordx4 v[60:63], v8, s[4:7], s45 offen sc1
Lif_131:
    s_add_u32 s44, s24, 160
    s_mov_b32 s45, 0
    s_cmp_ge_u32 s44, 106
    s_cselect_b32 s45, 0x26000, s45
    s_cmp_ge_u32 s44, 202
    s_cselect_b32 s45, 0x86000, s45
    s_lshl_b32 s46, s44, 12
    s_add_u32 s45, s45, s46
    buffer_store_dwordx4 v[60:63], v8, s[4:7], s45 offen sc1
Lif_132:
    s_add_u32 s44, s24, 240
    s_mov_b32 s45, 0
    s_cmp_ge_u32 s44, 202
    s_cselect_b32 s45, 0x86000, s45
    s_cmp_ge_u32 s44, 250
    s_cselect_b32 s45, 0x106000, s45
    s_lshl_b32 s46, s44, 12
    s_add_u32 s45, s45, s46
    buffer_store_dwordx4 v[60:63], v8, s[4:7], s45 offen sc1
Lif_133:
    s_add_u32 s44, s24, 320
    s_mov_b32 s45, 0
    s_cmp_ge_u32 s44, 250
    s_cselect_b32 s45, 0x106000, s45
    s_cmp_ge_u32 s44, 330
    s_cselect_b32 s45, 0x9a16000, s45
    s_lshl_b32 s46, s44, 12
    s_add_u32 s45, s45, s46
    buffer_store_dwordx4 v[60:63], v8, s[4:7], s45 offen sc1
Lif_134:
    s_add_u32 s44, s24, 400
    s_mov_b32 s45, 0
    s_cmp_ge_u32 s44, 330
    s_cselect_b32 s45, 0x9a16000, s45
    s_lshl_b32 s46, s44, 12
    s_add_u32 s45, s45, s46
    buffer_store_dwordx4 v[60:63], v8, s[4:7], s45 offen sc1
Lif_135:
    s_add_u32 s44, s24, 480
    s_cmp_ge_u32 s44, 490
    s_cbranch_scc1 Lif_136
    s_mov_b32 s45, 0
    s_cmp_ge_u32 s44, 330
    s_cselect_b32 s45, 0x9a16000, s45
    s_lshl_b32 s46, s44, 12
    s_add_u32 s45, s45, s46
    buffer_store_dwordx4 v[60:63], v8, s[4:7], s45 offen sc1
Lif_136:
    s_waitcnt vmcnt(0)
    v_lshlrev_b32 v64, 16, v16
    v_and_b32 v65, 0xffff0000, v16
    v_lshlrev_b32 v66, 16, v17
    v_and_b32 v67, 0xffff0000, v17
    v_lshlrev_b32 v68, 16, v18
    v_and_b32 v69, 0xffff0000, v18
    v_lshlrev_b32 v70, 16, v19
    v_and_b32 v71, 0xffff0000, v19
    v_lshlrev_b32 v72, 16, v20
    v_and_b32 v73, 0xffff0000, v20
    v_lshlrev_b32 v74, 16, v21
    v_and_b32 v75, 0xffff0000, v21
    v_lshlrev_b32 v76, 16, v22
    v_and_b32 v77, 0xffff0000, v22
    v_lshlrev_b32 v78, 16, v23
    v_and_b32 v79, 0xffff0000, v23
    v_lshlrev_b32 v80, 16, v24
    v_and_b32 v81, 0xffff0000, v24
    v_lshlrev_b32 v82, 16, v25
    v_and_b32 v83, 0xffff0000, v25
    v_lshlrev_b32 v84, 16, v26
    v_and_b32 v85, 0xffff0000, v26
    v_lshlrev_b32 v86, 16, v27
    v_and_b32 v87, 0xffff0000, v27
    v_lshlrev_b32 v88, 16, v28
    v_and_b32 v89, 0xffff0000, v28
    v_lshlrev_b32 v90, 16, v29
    v_and_b32 v91, 0xffff0000, v29
    v_lshlrev_b32 v92, 16, v30
    v_and_b32 v93, 0xffff0000, v30
    v_lshlrev_b32 v94, 16, v31
    v_and_b32 v95, 0xffff0000, v31
    v_lshlrev_b32 v96, 16, v32
    v_and_b32 v97, 0xffff0000, v32
    v_lshlrev_b32 v98, 16, v33
    v_and_b32 v99, 0xffff0000, v33
    v_lshlrev_b32 v100, 16, v34
    v_and_b32 v101, 0xffff0000, v34
    v_lshlrev_b32 v102, 16, v35
    v_and_b32 v103, 0xffff0000, v35
    v_add_f32 v104, v64, v65
    v_add_f32 v105, v66, v67
    v_add_f32 v104, v104, v68
    v_add_f32 v105, v105, v69
    v_add_f32 v104, v104, v70
    v_add_f32 v105, v105, v71
    v_add_f32 v104, v104, v72
    v_add_f32 v105, v105, v73
    v_add_f32 v104, v104, v74
    v_add_f32 v105, v105, v75
    v_add_f32 v104, v104, v76
    v_add_f32 v105, v105, v77
    v_add_f32 v104, v104, v78
    v_add_f32 v105, v105, v79
    v_add_f32 v104, v104, v80
    v_add_f32 v105, v105, v81
    v_add_f32 v104, v104, v82
    v_add_f32 v105, v105, v83
    v_add_f32 v104, v104, v84
    v_add_f32 v105, v105, v85
    v_add_f32 v104, v104, v86
    v_add_f32 v105, v105, v87
    v_add_f32 v104, v104, v88
    v_add_f32 v105, v105, v89
    v_add_f32 v104, v104, v90
    v_add_f32 v105, v105, v91
    v_add_f32 v104, v104, v92
    v_add_f32 v105, v105, v93
    v_add_f32 v104, v104, v94
    v_add_f32 v105, v105, v95
    v_add_f32 v104, v104, v96
    v_add_f32 v105, v105, v97
    v_add_f32 v104, v104, v98
    v_add_f32 v105, v105, v99
    v_add_f32 v104, v104, v100
    v_add_f32 v105, v105, v101
    v_add_f32 v104, v104, v102
    v_add_f32 v105, v105, v103
    v_add_f32 v104, v104, v105
    s_nop 1
    v_add_f32_dpp v104, v104, v104 row_ror:8 row_mask:0xf bank_mask:0xf
    s_nop 1
    v_add_f32_dpp v104, v104, v104 row_ror:4 row_mask:0xf bank_mask:0xf
    v_mov_b32 v105, v104
    s_nop 1
    v_permlane16_swap_b32 v104, v105
    v_add_f32 v104, v104, v105
    v_mov_b32 v105, v104
    s_nop 1
    v_permlane32_swap_b32 v104, v105
    v_add_f32 v104, v104, v105
    v_mul_f32 v104, 0x3acccccd, v104
    v_mov_b32 v106, 0
    v_mov_b32 v107, 0
    v_sub_f32 v108, v64, v104
    v_sub_f32 v109, v65, v104
    v_fmac_f32 v106, v108, v108
    v_fmac_f32 v107, v109, v109
    v_sub_f32 v108, v66, v104
    v_sub_f32 v109, v67, v104
    v_fmac_f32 v106, v108, v108
    v_fmac_f32 v107, v109, v109
    v_sub_f32 v108, v68, v104
    v_sub_f32 v109, v69, v104
    v_fmac_f32 v106, v108, v108
    v_fmac_f32 v107, v109, v109
    v_sub_f32 v108, v70, v104
    v_sub_f32 v109, v71, v104
    v_fmac_f32 v106, v108, v108
    v_fmac_f32 v107, v109, v109
    v_sub_f32 v108, v72, v104
    v_sub_f32 v109, v73, v104
    v_fmac_f32 v106, v108, v108
    v_fmac_f32 v107, v109, v109
    v_sub_f32 v108, v74, v104
    v_sub_f32 v109, v75, v104
    v_fmac_f32 v106, v108, v108
    v_fmac_f32 v107, v109, v109
    v_sub_f32 v108, v76, v104
    v_sub_f32 v109, v77, v104
    v_fmac_f32 v106, v108, v108
    v_fmac_f32 v107, v109, v109
    v_sub_f32 v108, v78, v104
    v_sub_f32 v109, v79, v104
    v_fmac_f32 v106, v108, v108
    v_fmac_f32 v107, v109, v109
    v_sub_f32 v108, v80, v104
    v_sub_f32 v109, v81, v104
    v_fmac_f32 v106, v108, v108
    v_fmac_f32 v107, v109, v109
    v_sub_f32 v108, v82, v104
    v_sub_f32 v109, v83, v104
    v_fmac_f32 v106, v108, v108
    v_fmac_f32 v107, v109, v109
    v_sub_f32 v108, v84, v104
    v_sub_f32 v109, v85, v104
    v_fmac_f32 v106, v108, v108
    v_fmac_f32 v107, v109, v109
    v_sub_f32 v108, v86, v104
    v_sub_f32 v109, v87, v104
    v_fmac_f32 v106, v108, v108
    v_fmac_f32 v107, v109, v109
    v_sub_f32 v108, v88, v104
    v_sub_f32 v109, v89, v104
    v_fmac_f32 v106, v108, v108
    v_fmac_f32 v107, v109, v109
    v_sub_f32 v108, v90, v104
    v_sub_f32 v109, v91, v104
    v_fmac_f32 v106, v108, v108
    v_fmac_f32 v107, v109, v109
    v_sub_f32 v108, v92, v104
    v_sub_f32 v109, v93, v104
    v_fmac_f32 v106, v108, v108
    v_fmac_f32 v107, v109, v109
    v_sub_f32 v108, v94, v104
    v_sub_f32 v109, v95, v104
    v_fmac_f32 v106, v108, v108
    v_fmac_f32 v107, v109, v109
    v_sub_f32 v108, v96, v104
    v_sub_f32 v109, v97, v104
    v_fmac_f32 v106, v108, v108
    v_fmac_f32 v107, v109, v109
    v_sub_f32 v108, v98, v104
    v_sub_f32 v109, v99, v104
    v_fmac_f32 v106, v108, v108
    v_fmac_f32 v107, v109, v109
    v_sub_f32 v108, v100, v104
    v_sub_f32 v109, v101, v104
    v_fmac_f32 v106, v108, v108
    v_fmac_f32 v107, v109, v109
    v_sub_f32 v108, v102, v104
    v_sub_f32 v109, v103, v104
    v_fmac_f32 v106, v108, v108
    v_fmac_f32 v107, v109, v109
    v_add_f32 v106, v106, v107
    s_nop 1
    v_add_f32_dpp v106, v106, v106 row_ror:8 row_mask:0xf bank_mask:0xf
    s_nop 1
    v_add_f32_dpp v106, v106, v106 row_ror:4 row_mask:0xf bank_mask:0xf
    v_mov_b32 v105, v106
    s_nop 1
    v_permlane16_swap_b32 v106, v105
    v_add_f32 v106, v106, v105
    v_mov_b32 v105, v106
    s_nop 1
    v_permlane32_swap_b32 v106, v105
    v_add_f32 v106, v106, v105
    v_mul_f32 v106, 0x3acccccd, v106
    v_cvt_pk_bf16_f32 v106, v106, v106
    v_and_b32 v106, 0xffff0000, v106
    v_add_f32 v106, 0x3727c5ac, v106
    v_cvt_pk_bf16_f32 v106, v106, v106
    v_and_b32 v106, 0xffff0000, v106
    v_sqrt_f32 v106, v106
    s_nop 0
    v_cvt_pk_bf16_f32 v106, v106, v106
    v_and_b32 v106, 0xffff0000, v106
    v_rcp_f32 v106, v106
    v_cvt_pk_bf16_f32 v104, v104, v104
    v_and_b32 v104, 0xffff0000, v104
    v_sub_f32 v64, v64, v104
    v_sub_f32 v65, v65, v104
    v_cvt_pk_bf16_f32 v16, v64, v65
    v_lshlrev_b32 v64, 16, v16
    v_and_b32 v65, 0xffff0000, v16
    v_mul_f32 v64, v64, v106
    v_mul_f32 v65, v65, v106
    v_cvt_pk_bf16_f32 v16, v64, v65
    v_sub_f32 v66, v66, v104
    v_sub_f32 v67, v67, v104
    v_cvt_pk_bf16_f32 v17, v66, v67
    v_lshlrev_b32 v66, 16, v17
    v_and_b32 v67, 0xffff0000, v17
    v_mul_f32 v66, v66, v106
    v_mul_f32 v67, v67, v106
    v_cvt_pk_bf16_f32 v17, v66, v67
    v_sub_f32 v68, v68, v104
    v_sub_f32 v69, v69, v104
    v_cvt_pk_bf16_f32 v18, v68, v69
    v_lshlrev_b32 v68, 16, v18
    v_and_b32 v69, 0xffff0000, v18
    v_mul_f32 v68, v68, v106
    v_mul_f32 v69, v69, v106
    v_cvt_pk_bf16_f32 v18, v68, v69
    v_sub_f32 v70, v70, v104
    v_sub_f32 v71, v71, v104
    v_cvt_pk_bf16_f32 v19, v70, v71
    v_lshlrev_b32 v70, 16, v19
    v_and_b32 v71, 0xffff0000, v19
    v_mul_f32 v70, v70, v106
    v_mul_f32 v71, v71, v106
    v_cvt_pk_bf16_f32 v19, v70, v71
    v_sub_f32 v72, v72, v104
    v_sub_f32 v73, v73, v104
    v_cvt_pk_bf16_f32 v20, v72, v73
    v_lshlrev_b32 v72, 16, v20
    v_and_b32 v73, 0xffff0000, v20
    v_mul_f32 v72, v72, v106
    v_mul_f32 v73, v73, v106
    v_cvt_pk_bf16_f32 v20, v72, v73
    v_sub_f32 v74, v74, v104
    v_sub_f32 v75, v75, v104
    v_cvt_pk_bf16_f32 v21, v74, v75
    v_lshlrev_b32 v74, 16, v21
    v_and_b32 v75, 0xffff0000, v21
    v_mul_f32 v74, v74, v106
    v_mul_f32 v75, v75, v106
    v_cvt_pk_bf16_f32 v21, v74, v75
    v_sub_f32 v76, v76, v104
    v_sub_f32 v77, v77, v104
    v_cvt_pk_bf16_f32 v22, v76, v77
    v_lshlrev_b32 v76, 16, v22
    v_and_b32 v77, 0xffff0000, v22
    v_mul_f32 v76, v76, v106
    v_mul_f32 v77, v77, v106
    v_cvt_pk_bf16_f32 v22, v76, v77
    v_sub_f32 v78, v78, v104
    v_sub_f32 v79, v79, v104
    v_cvt_pk_bf16_f32 v23, v78, v79
    v_lshlrev_b32 v78, 16, v23
    v_and_b32 v79, 0xffff0000, v23
    v_mul_f32 v78, v78, v106
    v_mul_f32 v79, v79, v106
    v_cvt_pk_bf16_f32 v23, v78, v79
    v_sub_f32 v80, v80, v104
    v_sub_f32 v81, v81, v104
    v_cvt_pk_bf16_f32 v24, v80, v81
    v_lshlrev_b32 v80, 16, v24
    v_and_b32 v81, 0xffff0000, v24
    v_mul_f32 v80, v80, v106
    v_mul_f32 v81, v81, v106
    v_cvt_pk_bf16_f32 v24, v80, v81
    v_sub_f32 v82, v82, v104
    v_sub_f32 v83, v83, v104
    v_cvt_pk_bf16_f32 v25, v82, v83
    v_lshlrev_b32 v82, 16, v25
    v_and_b32 v83, 0xffff0000, v25
    v_mul_f32 v82, v82, v106
    v_mul_f32 v83, v83, v106
    v_cvt_pk_bf16_f32 v25, v82, v83
    v_sub_f32 v84, v84, v104
    v_sub_f32 v85, v85, v104
    v_cvt_pk_bf16_f32 v26, v84, v85
    v_lshlrev_b32 v84, 16, v26
    v_and_b32 v85, 0xffff0000, v26
    v_mul_f32 v84, v84, v106
    v_mul_f32 v85, v85, v106
    v_cvt_pk_bf16_f32 v26, v84, v85
    v_sub_f32 v86, v86, v104
    v_sub_f32 v87, v87, v104
    v_cvt_pk_bf16_f32 v27, v86, v87
    v_lshlrev_b32 v86, 16, v27
    v_and_b32 v87, 0xffff0000, v27
    v_mul_f32 v86, v86, v106
    v_mul_f32 v87, v87, v106
    v_cvt_pk_bf16_f32 v27, v86, v87
    v_sub_f32 v88, v88, v104
    v_sub_f32 v89, v89, v104
    v_cvt_pk_bf16_f32 v28, v88, v89
    v_lshlrev_b32 v88, 16, v28
    v_and_b32 v89, 0xffff0000, v28
    v_mul_f32 v88, v88, v106
    v_mul_f32 v89, v89, v106
    v_cvt_pk_bf16_f32 v28, v88, v89
    v_sub_f32 v90, v90, v104
    v_sub_f32 v91, v91, v104
    v_cvt_pk_bf16_f32 v29, v90, v91
    v_lshlrev_b32 v90, 16, v29
    v_and_b32 v91, 0xffff0000, v29
    v_mul_f32 v90, v90, v106
    v_mul_f32 v91, v91, v106
    v_cvt_pk_bf16_f32 v29, v90, v91
    v_sub_f32 v92, v92, v104
    v_sub_f32 v93, v93, v104
    v_cvt_pk_bf16_f32 v30, v92, v93
    v_lshlrev_b32 v92, 16, v30
    v_and_b32 v93, 0xffff0000, v30
    v_mul_f32 v92, v92, v106
    v_mul_f32 v93, v93, v106
    v_cvt_pk_bf16_f32 v30, v92, v93
    v_sub_f32 v94, v94, v104
    v_sub_f32 v95, v95, v104
    v_cvt_pk_bf16_f32 v31, v94, v95
    v_lshlrev_b32 v94, 16, v31
    v_and_b32 v95, 0xffff0000, v31
    v_mul_f32 v94, v94, v106
    v_mul_f32 v95, v95, v106
    v_cvt_pk_bf16_f32 v31, v94, v95
    v_sub_f32 v96, v96, v104
    v_sub_f32 v97, v97, v104
    v_cvt_pk_bf16_f32 v32, v96, v97
    v_lshlrev_b32 v96, 16, v32
    v_and_b32 v97, 0xffff0000, v32
    v_mul_f32 v96, v96, v106
    v_mul_f32 v97, v97, v106
    v_cvt_pk_bf16_f32 v32, v96, v97
    v_sub_f32 v98, v98, v104
    v_sub_f32 v99, v99, v104
    v_cvt_pk_bf16_f32 v33, v98, v99
    v_lshlrev_b32 v98, 16, v33
    v_and_b32 v99, 0xffff0000, v33
    v_mul_f32 v98, v98, v106
    v_mul_f32 v99, v99, v106
    v_cvt_pk_bf16_f32 v33, v98, v99
    v_sub_f32 v100, v100, v104
    v_sub_f32 v101, v101, v104
    v_cvt_pk_bf16_f32 v34, v100, v101
    v_lshlrev_b32 v100, 16, v34
    v_and_b32 v101, 0xffff0000, v34
    v_mul_f32 v100, v100, v106
    v_mul_f32 v101, v101, v106
    v_cvt_pk_bf16_f32 v34, v100, v101
    v_sub_f32 v102, v102, v104
    v_sub_f32 v103, v103, v104
    v_cvt_pk_bf16_f32 v35, v102, v103
    v_lshlrev_b32 v102, 16, v35
    v_and_b32 v103, 0xffff0000, v35
    v_mul_f32 v102, v102, v106
    v_mul_f32 v103, v103, v106
    v_cvt_pk_bf16_f32 v35, v102, v103
    s_add_u32 s43, s25, 4194304
    buffer_store_dwordx4 v[16:19], v6, s[4:7], s43 offen sc1
    s_add_u32 s43, s25, 4198400
    buffer_store_dwordx4 v[20:23], v6, s[4:7], s43 offen sc1
    s_add_u32 s43, s25, 4202496
    buffer_store_dwordx4 v[24:27], v6, s[4:7], s43 offen sc1
    s_add_u32 s43, s25, 4206592
    buffer_store_dwordx4 v[28:31], v6, s[4:7], s43 offen sc1
    s_add_u32 s43, s25, 4210688
    buffer_store_dwordx4 v[32:35], v6, s[4:7], s43 offen sc1
    s_cmp_ge_u32 s24, 48
    s_cbranch_scc1 L_hl
    v_lshlrev_b32 v64, 16, v36
    v_and_b32 v65, 0xffff0000, v36
    v_lshlrev_b32 v66, 16, v37
    v_and_b32 v67, 0xffff0000, v37
    v_lshlrev_b32 v68, 16, v38
    v_and_b32 v69, 0xffff0000, v38
    v_lshlrev_b32 v70, 16, v39
    v_and_b32 v71, 0xffff0000, v39
    v_lshlrev_b32 v72, 16, v40
    v_and_b32 v73, 0xffff0000, v40
    v_lshlrev_b32 v74, 16, v41
    v_and_b32 v75, 0xffff0000, v41
    v_lshlrev_b32 v76, 16, v42
    v_and_b32 v77, 0xffff0000, v42
    v_lshlrev_b32 v78, 16, v43
    v_and_b32 v79, 0xffff0000, v43
    v_lshlrev_b32 v80, 16, v44
    v_and_b32 v81, 0xffff0000, v44
    v_lshlrev_b32 v82, 16, v45
    v_and_b32 v83, 0xffff0000, v45
    v_lshlrev_b32 v84, 16, v46
    v_and_b32 v85, 0xffff0000, v46
    v_lshlrev_b32 v86, 16, v47
    v_and_b32 v87, 0xffff0000, v47
    v_lshlrev_b32 v88, 16, v48
    v_and_b32 v89, 0xffff0000, v48
    v_lshlrev_b32 v90, 16, v49
    v_and_b32 v91, 0xffff0000, v49
    v_lshlrev_b32 v92, 16, v50
    v_and_b32 v93, 0xffff0000, v50
    v_lshlrev_b32 v94, 16, v51
    v_and_b32 v95, 0xffff0000, v51
    v_lshlrev_b32 v96, 16, v52
    v_and_b32 v97, 0xffff0000, v52
    v_lshlrev_b32 v98, 16, v53
    v_and_b32 v99, 0xffff0000, v53
    v_lshlrev_b32 v100, 16, v54
    v_and_b32 v101, 0xffff0000, v54
    v_lshlrev_b32 v102, 16, v55
    v_and_b32 v103, 0xffff0000, v55
    v_add_f32 v104, v64, v65
    v_add_f32 v105, v66, v67
    v_add_f32 v104, v104, v68
    v_add_f32 v105, v105, v69
    v_add_f32 v104, v104, v70
    v_add_f32 v105, v105, v71
    v_add_f32 v104, v104, v72
    v_add_f32 v105, v105, v73
    v_add_f32 v104, v104, v74
    v_add_f32 v105, v105, v75
    v_add_f32 v104, v104, v76
    v_add_f32 v105, v105, v77
    v_add_f32 v104, v104, v78
    v_add_f32 v105, v105, v79
    v_add_f32 v104, v104, v80
    v_add_f32 v105, v105, v81
    v_add_f32 v104, v104, v82
    v_add_f32 v105, v105, v83
    v_add_f32 v104, v104, v84
    v_add_f32 v105, v105, v85
    v_add_f32 v104, v104, v86
    v_add_f32 v105, v105, v87
    v_add_f32 v104, v104, v88
    v_add_f32 v105, v105, v89
    v_add_f32 v104, v104, v90
    v_add_f32 v105, v105, v91
    v_add_f32 v104, v104, v92
    v_add_f32 v105, v105, v93
    v_add_f32 v104, v104, v94
    v_add_f32 v105, v105, v95
    v_add_f32 v104, v104, v96
    v_add_f32 v105, v105, v97
    v_add_f32 v104, v104, v98
    v_add_f32 v105, v105, v99
    v_add_f32 v104, v104, v100
    v_add_f32 v105, v105, v101
    v_add_f32 v104, v104, v102
    v_add_f32 v105, v105, v103
    v_add_f32 v104, v104, v105
    s_nop 1
    v_add_f32_dpp v104, v104, v104 row_ror:8 row_mask:0xf bank_mask:0xf
    s_nop 1
    v_add_f32_dpp v104, v104, v104 row_ror:4 row_mask:0xf bank_mask:0xf
    v_mov_b32 v105, v104
    s_nop 1
    v_permlane16_swap_b32 v104, v105
    v_add_f32 v104, v104, v105
    v_mov_b32 v105, v104
    s_nop 1
    v_permlane32_swap_b32 v104, v105
    v_add_f32 v104, v104, v105
    v_mul_f32 v104, 0x3acccccd, v104
    v_mov_b32 v106, 0
    v_mov_b32 v107, 0
    v_sub_f32 v108, v64, v104
    v_sub_f32 v109, v65, v104
    v_fmac_f32 v106, v108, v108
    v_fmac_f32 v107, v109, v109
    v_sub_f32 v108, v66, v104
    v_sub_f32 v109, v67, v104
    v_fmac_f32 v106, v108, v108
    v_fmac_f32 v107, v109, v109
    v_sub_f32 v108, v68, v104
    v_sub_f32 v109, v69, v104
    v_fmac_f32 v106, v108, v108
    v_fmac_f32 v107, v109, v109
    v_sub_f32 v108, v70, v104
    v_sub_f32 v109, v71, v104
    v_fmac_f32 v106, v108, v108
    v_fmac_f32 v107, v109, v109
    v_sub_f32 v108, v72, v104
    v_sub_f32 v109, v73, v104
    v_fmac_f32 v106, v108, v108
    v_fmac_f32 v107, v109, v109
    v_sub_f32 v108, v74, v104
    v_sub_f32 v109, v75, v104
    v_fmac_f32 v106, v108, v108
    v_fmac_f32 v107, v109, v109
    v_sub_f32 v108, v76, v104
    v_sub_f32 v109, v77, v104
    v_fmac_f32 v106, v108, v108
    v_fmac_f32 v107, v109, v109
    v_sub_f32 v108, v78, v104
    v_sub_f32 v109, v79, v104
    v_fmac_f32 v106, v108, v108
    v_fmac_f32 v107, v109, v109
    v_sub_f32 v108, v80, v104
    v_sub_f32 v109, v81, v104
    v_fmac_f32 v106, v108, v108
    v_fmac_f32 v107, v109, v109
    v_sub_f32 v108, v82, v104
    v_sub_f32 v109, v83, v104
    v_fmac_f32 v106, v108, v108
    v_fmac_f32 v107, v109, v109
    v_sub_f32 v108, v84, v104
    v_sub_f32 v109, v85, v104
    v_fmac_f32 v106, v108, v108
    v_fmac_f32 v107, v109, v109
    v_sub_f32 v108, v86, v104
    v_sub_f32 v109, v87, v104
    v_fmac_f32 v106, v108, v108
    v_fmac_f32 v107, v109, v109
    v_sub_f32 v108, v88, v104
    v_sub_f32 v109, v89, v104
    v_fmac_f32 v106, v108, v108
    v_fmac_f32 v107, v109, v109
    v_sub_f32 v108, v90, v104
    v_sub_f32 v109, v91, v104
    v_fmac_f32 v106, v108, v108
    v_fmac_f32 v107, v109, v109
    v_sub_f32 v108, v92, v104
    v_sub_f32 v109, v93, v104
    v_fmac_f32 v106, v108, v108
    v_fmac_f32 v107, v109, v109
    v_sub_f32 v108, v94, v104
    v_sub_f32 v109, v95, v104
    v_fmac_f32 v106, v108, v108
    v_fmac_f32 v107, v109, v109
    v_sub_f32 v108, v96, v104
    v_sub_f32 v109, v97, v104
    v_fmac_f32 v106, v108, v108
    v_fmac_f32 v107, v109, v109
    v_sub_f32 v108, v98, v104
    v_sub_f32 v109, v99, v104
    v_fmac_f32 v106, v108, v108
    v_fmac_f32 v107, v109, v109
    v_sub_f32 v108, v100, v104
    v_sub_f32 v109, v101, v104
    v_fmac_f32 v106, v108, v108
    v_fmac_f32 v107, v109, v109
    v_sub_f32 v108, v102, v104
    v_sub_f32 v109, v103, v104
    v_fmac_f32 v106, v108, v108
    v_fmac_f32 v107, v109, v109
    v_add_f32 v106, v106, v107
    s_nop 1
    v_add_f32_dpp v106, v106, v106 row_ror:8 row_mask:0xf bank_mask:0xf
    s_nop 1
    v_add_f32_dpp v106, v106, v106 row_ror:4 row_mask:0xf bank_mask:0xf
    v_mov_b32 v105, v106
    s_nop 1
    v_permlane16_swap_b32 v106, v105
    v_add_f32 v106, v106, v105
    v_mov_b32 v105, v106
    s_nop 1
    v_permlane32_swap_b32 v106, v105
    v_add_f32 v106, v106, v105
    v_mul_f32 v106, 0x3acccccd, v106
    v_cvt_pk_bf16_f32 v106, v106, v106
    v_and_b32 v106, 0xffff0000, v106
    v_add_f32 v106, 0x3727c5ac, v106
    v_cvt_pk_bf16_f32 v106, v106, v106
    v_and_b32 v106, 0xffff0000, v106
    v_sqrt_f32 v106, v106
    s_nop 0
    v_cvt_pk_bf16_f32 v106, v106, v106
    v_and_b32 v106, 0xffff0000, v106
    v_rcp_f32 v106, v106
    v_cvt_pk_bf16_f32 v104, v104, v104
    v_and_b32 v104, 0xffff0000, v104
    v_sub_f32 v64, v64, v104
    v_sub_f32 v65, v65, v104
    v_cvt_pk_bf16_f32 v36, v64, v65
    v_lshlrev_b32 v64, 16, v36
    v_and_b32 v65, 0xffff0000, v36
    v_mul_f32 v64, v64, v106
    v_mul_f32 v65, v65, v106
    v_cvt_pk_bf16_f32 v36, v64, v65
    v_sub_f32 v66, v66, v104
    v_sub_f32 v67, v67, v104
    v_cvt_pk_bf16_f32 v37, v66, v67
    v_lshlrev_b32 v66, 16, v37
    v_and_b32 v67, 0xffff0000, v37
    v_mul_f32 v66, v66, v106
    v_mul_f32 v67, v67, v106
    v_cvt_pk_bf16_f32 v37, v66, v67
    v_sub_f32 v68, v68, v104
    v_sub_f32 v69, v69, v104
    v_cvt_pk_bf16_f32 v38, v68, v69
    v_lshlrev_b32 v68, 16, v38
    v_and_b32 v69, 0xffff0000, v38
    v_mul_f32 v68, v68, v106
    v_mul_f32 v69, v69, v106
    v_cvt_pk_bf16_f32 v38, v68, v69
    v_sub_f32 v70, v70, v104
    v_sub_f32 v71, v71, v104
    v_cvt_pk_bf16_f32 v39, v70, v71
    v_lshlrev_b32 v70, 16, v39
    v_and_b32 v71, 0xffff0000, v39
    v_mul_f32 v70, v70, v106
    v_mul_f32 v71, v71, v106
    v_cvt_pk_bf16_f32 v39, v70, v71
    v_sub_f32 v72, v72, v104
    v_sub_f32 v73, v73, v104
    v_cvt_pk_bf16_f32 v40, v72, v73
    v_lshlrev_b32 v72, 16, v40
    v_and_b32 v73, 0xffff0000, v40
    v_mul_f32 v72, v72, v106
    v_mul_f32 v73, v73, v106
    v_cvt_pk_bf16_f32 v40, v72, v73
    v_sub_f32 v74, v74, v104
    v_sub_f32 v75, v75, v104
    v_cvt_pk_bf16_f32 v41, v74, v75
    v_lshlrev_b32 v74, 16, v41
    v_and_b32 v75, 0xffff0000, v41
    v_mul_f32 v74, v74, v106
    v_mul_f32 v75, v75, v106
    v_cvt_pk_bf16_f32 v41, v74, v75
    v_sub_f32 v76, v76, v104
    v_sub_f32 v77, v77, v104
    v_cvt_pk_bf16_f32 v42, v76, v77
    v_lshlrev_b32 v76, 16, v42
    v_and_b32 v77, 0xffff0000, v42
    v_mul_f32 v76, v76, v106
    v_mul_f32 v77, v77, v106
    v_cvt_pk_bf16_f32 v42, v76, v77
    v_sub_f32 v78, v78, v104
    v_sub_f32 v79, v79, v104
    v_cvt_pk_bf16_f32 v43, v78, v79
    v_lshlrev_b32 v78, 16, v43
    v_and_b32 v79, 0xffff0000, v43
    v_mul_f32 v78, v78, v106
    v_mul_f32 v79, v79, v106
    v_cvt_pk_bf16_f32 v43, v78, v79
    v_sub_f32 v80, v80, v104
    v_sub_f32 v81, v81, v104
    v_cvt_pk_bf16_f32 v44, v80, v81
    v_lshlrev_b32 v80, 16, v44
    v_and_b32 v81, 0xffff0000, v44
    v_mul_f32 v80, v80, v106
    v_mul_f32 v81, v81, v106
    v_cvt_pk_bf16_f32 v44, v80, v81
    v_sub_f32 v82, v82, v104
    v_sub_f32 v83, v83, v104
    v_cvt_pk_bf16_f32 v45, v82, v83
    v_lshlrev_b32 v82, 16, v45
    v_and_b32 v83, 0xffff0000, v45
    v_mul_f32 v82, v82, v106
    v_mul_f32 v83, v83, v106
    v_cvt_pk_bf16_f32 v45, v82, v83
    v_sub_f32 v84, v84, v104
    v_sub_f32 v85, v85, v104
    v_cvt_pk_bf16_f32 v46, v84, v85
    v_lshlrev_b32 v84, 16, v46
    v_and_b32 v85, 0xffff0000, v46
    v_mul_f32 v84, v84, v106
    v_mul_f32 v85, v85, v106
    v_cvt_pk_bf16_f32 v46, v84, v85
    v_sub_f32 v86, v86, v104
    v_sub_f32 v87, v87, v104
    v_cvt_pk_bf16_f32 v47, v86, v87
    v_lshlrev_b32 v86, 16, v47
    v_and_b32 v87, 0xffff0000, v47
    v_mul_f32 v86, v86, v106
    v_mul_f32 v87, v87, v106
    v_cvt_pk_bf16_f32 v47, v86, v87
    v_sub_f32 v88, v88, v104
    v_sub_f32 v89, v89, v104
    v_cvt_pk_bf16_f32 v48, v88, v89
    v_lshlrev_b32 v88, 16, v48
    v_and_b32 v89, 0xffff0000, v48
    v_mul_f32 v88, v88, v106
    v_mul_f32 v89, v89, v106
    v_cvt_pk_bf16_f32 v48, v88, v89
    v_sub_f32 v90, v90, v104
    v_sub_f32 v91, v91, v104
    v_cvt_pk_bf16_f32 v49, v90, v91
    v_lshlrev_b32 v90, 16, v49
    v_and_b32 v91, 0xffff0000, v49
    v_mul_f32 v90, v90, v106
    v_mul_f32 v91, v91, v106
    v_cvt_pk_bf16_f32 v49, v90, v91
    v_sub_f32 v92, v92, v104
    v_sub_f32 v93, v93, v104
    v_cvt_pk_bf16_f32 v50, v92, v93
    v_lshlrev_b32 v92, 16, v50
    v_and_b32 v93, 0xffff0000, v50
    v_mul_f32 v92, v92, v106
    v_mul_f32 v93, v93, v106
    v_cvt_pk_bf16_f32 v50, v92, v93
    v_sub_f32 v94, v94, v104
    v_sub_f32 v95, v95, v104
    v_cvt_pk_bf16_f32 v51, v94, v95
    v_lshlrev_b32 v94, 16, v51
    v_and_b32 v95, 0xffff0000, v51
    v_mul_f32 v94, v94, v106
    v_mul_f32 v95, v95, v106
    v_cvt_pk_bf16_f32 v51, v94, v95
    v_sub_f32 v96, v96, v104
    v_sub_f32 v97, v97, v104
    v_cvt_pk_bf16_f32 v52, v96, v97
    v_lshlrev_b32 v96, 16, v52
    v_and_b32 v97, 0xffff0000, v52
    v_mul_f32 v96, v96, v106
    v_mul_f32 v97, v97, v106
    v_cvt_pk_bf16_f32 v52, v96, v97
    v_sub_f32 v98, v98, v104
    v_sub_f32 v99, v99, v104
    v_cvt_pk_bf16_f32 v53, v98, v99
    v_lshlrev_b32 v98, 16, v53
    v_and_b32 v99, 0xffff0000, v53
    v_mul_f32 v98, v98, v106
    v_mul_f32 v99, v99, v106
    v_cvt_pk_bf16_f32 v53, v98, v99
    v_sub_f32 v100, v100, v104
    v_sub_f32 v101, v101, v104
    v_cvt_pk_bf16_f32 v54, v100, v101
    v_lshlrev_b32 v100, 16, v54
    v_and_b32 v101, 0xffff0000, v54
    v_mul_f32 v100, v100, v106
    v_mul_f32 v101, v101, v106
    v_cvt_pk_bf16_f32 v54, v100, v101
    v_sub_f32 v102, v102, v104
    v_sub_f32 v103, v103, v104
    v_cvt_pk_bf16_f32 v55, v102, v103
    v_lshlrev_b32 v102, 16, v55
    v_and_b32 v103, 0xffff0000, v55
    v_mul_f32 v102, v102, v106
    v_mul_f32 v103, v103, v106
    v_cvt_pk_bf16_f32 v55, v102, v103
    s_add_u32 s43, s26, 4194304
    buffer_store_dwordx4 v[36:39], v6, s[4:7], s43 offen sc1
    s_add_u32 s43, s26, 4198400
    buffer_store_dwordx4 v[40:43], v6, s[4:7], s43 offen sc1
    s_add_u32 s43, s26, 4202496
    buffer_store_dwordx4 v[44:47], v6, s[4:7], s43 offen sc1
    s_add_u32 s43, s26, 4206592
    buffer_store_dwordx4 v[48:51], v6, s[4:7], s43 offen sc1
    s_add_u32 s43, s26, 4210688
    buffer_store_dwordx4 v[52:55], v6, s[4:7], s43 offen sc1
L_hl:
    s_waitcnt vmcnt(0)
    s_barrier
    s_cmp_lg_u32 s22, 0
    s_cbranch_scc1 Lrg_137
    v_mov_b32 v3, s96
    v_mov_b32 v4, s97
    s_mov_b64 exec, 1
    global_atomic_add v3, v4, s[74:75] offset:128 sc1
    s_mov_b64 exec, -1
Lrg_137:
    s_mov_b32 s31, 262144
    v_lshlrev_b32 v18, 2, v1
    s_mov_b32 exec_hi, 0
Lwr_138:
    global_load_dword v16, v18, s[74:75] offset:128 sc1
    s_mov_b32 s23, 0
    s_mov_b32 s38, 0
    s_waitcnt vmcnt(0)
    v_cmp_eq_u32 vcc, 0x20, v16
    s_nop 0
    s_or_b32 s38, s38, vcc_lo
    v_cmp_eq_u32 vcc, 0x2000, v16
    s_nop 0
    s_or_b32 s38, s38, vcc_lo
    v_cmp_eq_u32 vcc, 0x200000, v16
    s_nop 0
    s_or_b32 s38, s38, vcc_lo
    v_cmp_eq_u32 vcc, 0x20000000, v16
    s_nop 0
    s_or_b32 s38, s38, vcc_lo
    v_sad_u8 v17, v16, 0, 0
    s_bcnt1_i32_b32 s38, s38
    s_cmp_eq_u32 s38, 8
    s_cbranch_scc1 Lwd_139
    v_add_u32_dpp v17, v17, v17 row_shr:1 row_mask:0xf bank_mask:0xf bound_ctrl:0
    s_nop 1
    v_add_u32_dpp v17, v17, v17 row_shr:2 row_mask:0xf bank_mask:0xf bound_ctrl:0
    s_nop 1
    v_add_u32_dpp v17, v17, v17 row_shr:4 row_mask:0xf bank_mask:0xf bound_ctrl:0
    s_nop 1
    v_add_u32_dpp v17, v17, v17 row_shr:8 row_mask:0xf bank_mask:0xf bound_ctrl:0
    s_nop 0
    v_readlane_b32 s38, v17, 15
    v_readlane_b32 s39, v17, 31
    s_mov_b32 s23, 1
    s_add_u32 s38, s38, s39
    s_cmp_eq_u32 s38, 256
    s_cbranch_scc1 Lwd_139
    s_sleep 16
    s_sub_u32 s31, s31, 1
    s_cbranch_scc0 Lwr_138
    s_mov_b32 s31, 10
    s_branch L_fail
Lwd_139:
    s_mov_b64 exec, -1
    s_sub_u32 s24, s21, 22
    s_lshl_b32 s25, s20, 2
    s_add_u32 s25, s25, s22
    v_min_u32 v19, 39, v1
    v_lshlrev_b32 v19, 7, v19
    s_cmp_lg_u32 s24, 0
    s_cbranch_scc1 Ltj_140
    s_mul_i32 s38, s22, 10240
    s_add_u32 s38, s38, 4194304
    buffer_load_dword v18, v19, s[4:7], s38 offen sc1
Ltj_140:
    s_cmp_lg_u32 s24, 1
    s_cbranch_scc1 Ltj_141
    s_mul_i32 s38, s22, 10240
    s_add_u32 s38, s38, 4235264
    buffer_load_dword v18, v19, s[4:7], s38 offen sc1
Ltj_141:
    s_cmp_lg_u32 s24, 2
    s_cbranch_scc1 Ltj_142
    s_mul_i32 s38, s22, 10240
    s_add_u32 s38, s38, 4276224
    buffer_load_dword v18, v19, s[4:7], s38 offen sc1
Ltj_142:
    s_cmp_lg_u32 s24, 3
    s_cbranch_scc1 Ltj_143
    s_mul_i32 s38, s22, 10240
    s_add_u32 s38, s38, 4199424
    buffer_load_dword v18, v19, s[4:7], s38 offen sc1
Ltj_143:
    s_cmp_lg_u32 s24, 4
    s_cbranch_scc1 Ltj_144
    s_mul_i32 s38, s22, 10240
    s_add_u32 s38, s38, 4240384
    buffer_load_dword v18, v19, s[4:7], s38 offen sc1
Ltj_144:
    s_cmp_lg_u32 s24, 5
    s_cbranch_scc1 Ltj_145
    s_mul_i32 s38, s22, 10240
    s_add_u32 s38, s38, 4281344
    buffer_load_dword v18, v19, s[4:7], s38 offen sc1
Ltj_145:
    s_cmp_lg_u32 s24, 6
    s_cbranch_scc1 Ltj_146
Ltj_146:
    s_cmp_lg_u32 s24, 7
    s_cbranch_scc1 Ltj_147
Ltj_147:
    s_cmp_lg_u32 s24, 8
    s_cbranch_scc1 Ltj_148
Ltj_148:
    s_cmp_lg_u32 s24, 9
    s_cbranch_scc1 Ltj_149
Ltj_149:
    v_min_u32 v25, 19, v1
    v_lshlrev_b32 v25, 7, v25
    v_min_u32 v26, 23, v1
    v_lshlrev_b32 v26, 7, v26
    v_min_u32 v27, 47, v1
    v_lshlrev_b32 v27, 7, v27
    s_cmp_lg_u32 s24, 0
    s_cbranch_scc1 Ltj_150
    s_mul_i32 s38, s25, 2560
    s_add_u32 s38, s38, 262144
    buffer_load_dword v24, v25, s[4:7], s38 offen sc1
Ltj_150:
    s_cmp_lg_u32 s24, 1
    s_cbranch_scc1 Ltj_151
    s_mul_i32 s38, s25, 6144
    s_add_u32 s38, s38, 589824
    buffer_load_dword v24, v27, s[4:7], s38 offen sc1
Ltj_151:
    s_cmp_lg_u32 s24, 2
    s_cbranch_scc1 Ltj_152
    s_mul_i32 s38, s25, 3072
    s_add_u32 s38, s38, 1376256
    buffer_load_dword v24, v26, s[4:7], s38 offen sc1
Ltj_152:
    s_cmp_lg_u32 s24, 3
    s_cbranch_scc1 Ltj_153
    s_mul_i32 s38, s25, 2560
    s_add_u32 s38, s38, 344064
    buffer_load_dword v24, v25, s[4:7], s38 offen sc1
Ltj_153:
    s_cmp_lg_u32 s24, 4
    s_cbranch_scc1 Ltj_154
    s_mul_i32 s38, s25, 6144
    s_add_u32 s38, s38, 786432
    buffer_load_dword v24, v27, s[4:7], s38 offen sc1
Ltj_154:
    s_cmp_lg_u32 s24, 5
    s_cbranch_scc1 Ltj_155
    s_mul_i32 s38, s25, 3072
    s_add_u32 s38, s38, 1474560
    buffer_load_dword v24, v26, s[4:7], s38 offen sc1
Ltj_155:
    s_cmp_lg_u32 s24, 6
    s_cbranch_scc1 Ltj_156
    s_mul_i32 s38, s25, 3072
    s_add_u32 s38, s38, 1671168
    buffer_load_dword v24, v26, s[4:7], s38 offen sc1
    s_mul_i32 s38, s25, 2560
    s_add_u32 s38, s38, 425984
    buffer_load_dword v24, v25, s[4:7], s38 offen sc1
Ltj_156:
    s_cmp_lg_u32 s24, 7
    s_cbranch_scc1 Ltj_157
    s_mul_i32 s38, s25, 6144
    s_add_u32 s38, s38, 1179648
    buffer_load_dword v24, v27, s[4:7], s38 offen sc1
    s_mul_i32 s38, s25, 6144
    s_add_u32 s38, s38, 983040
    buffer_load_dword v24, v27, s[4:7], s38 offen sc1
Ltj_157:
    s_cmp_lg_u32 s24, 8
    s_cbranch_scc1 Ltj_158
    s_mul_i32 s38, s25, 2560
    s_add_u32 s38, s38, 507904
    buffer_load_dword v24, v25, s[4:7], s38 offen sc1
Ltj_158:
    s_cmp_lg_u32 s24, 9
    s_cbranch_scc1 Ltj_159
    s_mul_i32 s38, s25, 3072
    s_add_u32 s38, s38, 1572864
    buffer_load_dword v24, v26, s[4:7], s38 offen sc1
Ltj_159:
    s_cmp_ge_u32 s21, 29
    s_cbranch_scc1 L_ffn
    s_cmp_lt_u32 s21, 27
    s_cbranch_scc1 L_xw
    s_sub_u32 s25, s21, 27
    s_lshl_b32 s26, s20, 2
    s_add_u32 s26, s26, s22
    s_mov_b32 s52, 0x3dd53b95
    s_mov_b32 s53, 0xbdd53b95
    v_lshlrev_b32 v253, 2, v1
    s_lshl_b32 s38, s22, 2
    v_mov_b32 v254, s38
    v_mov_b32 v252, 1
    v_and_b32 v14, 15, v1
    v_lshrrev_b32 v15, 4, v1
    v_mov_b32 v3, 0xf149f2ca
    v_cmp_gt_u32 vcc, 32, v1
    s_nop 1
    v_cndmask_b32 v232, 0, v3, vcc
    v_mov_b32 v233, v232
    v_mov_b32 v234, v232
    v_mov_b32 v235, v232
    v_lshlrev_b32 v5, 2, v15
    v_add_u32 v6, 0, v5
    v_cmp_gt_u32 vcc, v6, v14
    s_nop 1
    v_cndmask_b32 v236, 0, v3, vcc
    v_add_u32 v6, 1, v5
    v_cmp_gt_u32 vcc, v6, v14
    s_nop 1
    v_cndmask_b32 v237, 0, v3, vcc
    v_add_u32 v6, 2, v5
    v_cmp_gt_u32 vcc, v6, v14
    s_nop 1
    v_cndmask_b32 v238, 0, v3, vcc
    v_add_u32 v6, 3, v5
    v_cmp_gt_u32 vcc, v6, v14
    s_nop 1
    v_cndmask_b32 v239, 0, v3, vcc
    s_mul_i32 s58, s26, 6144
    s_lshl_b32 s59, s22, 14
    v_and_b32 v4, 3, v1
    v_lshlrev_b32 v4, 8, v4
    v_bfe_u32 v5, v1, 2, 3
    v_lshl_add_u32 v5, v5, 4, v4
    v_add_u32 v5, s59, v5
    v_lshrrev_b32 v6, 2, v1
    v_lshl_add_u32 v4, v6, 4, v4
    v_add_u32 v4, s59, v4
    s_mov_b32 s31, 262144
    v_lshlrev_b32 v228, 2, v1
    s_mov_b32 exec_hi, 0
Lwr_160:
    global_load_dword v226, v228, s[74:75] offset:128 sc1
    s_mov_b32 s23, 0
    s_mov_b32 s38, 0
    s_waitcnt vmcnt(0)
    v_cmp_eq_u32 vcc, 0x20, v226
    s_nop 0
    s_or_b32 s38, s38, vcc_lo
    v_cmp_eq_u32 vcc, 0x2000, v226
    s_nop 0
    s_or_b32 s38, s38, vcc_lo
    v_cmp_eq_u32 vcc, 0x200000, v226
    s_nop 0
    s_or_b32 s38, s38, vcc_lo
    v_cmp_eq_u32 vcc, 0x20000000, v226
    s_nop 0
    s_or_b32 s38, s38, vcc_lo
    v_sad_u8 v227, v226, 0, 0
    s_bcnt1_i32_b32 s38, s38
    s_cmp_eq_u32 s38, 8
    s_cbranch_scc1 Lwd_161
    v_add_u32_dpp v227, v227, v227 row_shr:1 row_mask:0xf bank_mask:0xf bound_ctrl:0
    s_nop 1
    v_add_u32_dpp v227, v227, v227 row_shr:2 row_mask:0xf bank_mask:0xf bound_ctrl:0
    s_nop 1
    v_add_u32_dpp v227, v227, v227 row_shr:4 row_mask:0xf bank_mask:0xf bound_ctrl:0
    s_nop 1
    v_add_u32_dpp v227, v227, v227 row_shr:8 row_mask:0xf bank_mask:0xf bound_ctrl:0
    s_nop 0
    v_readlane_b32 s38, v227, 15
    v_readlane_b32 s39, v227, 31
    s_mov_b32 s23, 1
    s_add_u32 s38, s38, s39
    s_cmp_eq_u32 s38, 256
    s_cbranch_scc1 Lwd_161
    s_sleep 4
    s_sub_u32 s31, s31, 1
    s_cbranch_scc0 Lwr_160
    s_mov_b32 s31, 10
    s_branch L_fail
Lwd_161:
    s_mov_b64 exec, -1
    v_lshrrev_b32 v12, 2, v1
    v_lshlrev_b32 v12, 8, v12
    v_and_b32 v13, 3, v1
    v_lshl_add_u32 v12, v13, 2, v12
    s_lshl_b32 s38, s20, 4
    v_add_u32 v12, s38, v12
    s_lshl_b32 s60, s26, 6
    s_add_u32 s60, s60, 4096
    v_and_b32 v7, 15, v1
    v_lshlrev_b32 v7, 4, v7
    v_bfe_u32 v8, v1, 4, 1
    v_lshl_add_u32 v7, v8, 13, v7
    v_lshrrev_b32 v8, 5, v1
    v_lshl_add_u32 v7, v8, 15, v7
    s_lshr_b32 s61, s22, 1
    s_lshl_b32 s61, s61, 14
    s_and_b32 s38, s22, 1
    s_lshl_b32 s38, s38, 12
    s_add_u32 s61, s61, s38
    s_lshl_b32 s38, s20, 9
    s_add_u32 s61, s61, s38
    s_add_u32 s61, s61, 2097152
    v_mov_b32 v240, -1
    v_mov_b32 v241, -1
    v_mov_b32 v242, -1
    v_mov_b32 v243, -1
    v_mov_b32 v8, 48
    v_mov_b32 v9, 2
    s_add_u32 s38, s25, 1
    s_mul_i32 s48, s38, 327680
    s_add_u32 s48, s48, s61
    buffer_store_dwordx4 v[240:243], v7, s[4:7], s48 offen sc1
    s_add_u32 s48, s48, 65536
    buffer_store_dwordx4 v[240:243], v7, s[4:7], s48 offen sc1
    s_add_u32 s48, s48, 65536
    buffer_store_dwordx4 v[240:243], v7, s[4:7], s48 offen sc1
    s_add_u32 s48, s48, 65536
    buffer_store_dwordx4 v[240:243], v7, s[4:7], s48 offen sc1
    s_add_u32 s48, s48, 65536
    buffer_store_dwordx4 v[240:243], v7, s[4:7], s48 offen sc1
    s_waitcnt vmcnt(0)
    s_lshl_b32 s38, s38, 11
    s_add_u32 s38, s38, s60
    s_mov_b64 exec, 1
    buffer_store_dword v9, v8, s[4:7], s38 offen sc1
    s_mov_b64 exec, -1
    s_cmp_lg_u32 s23, 0
    s_cbranch_scc1 L_atts
    s_mov_b32 s30, s25
Lat_162:
    s_max_u32 s51, s30, 2
    s_lshl_b32 s51, s51, 11
    s_add_u32 s51, s51, s60
    s_and_b32 s42, s30, 7
    s_mul_i32 s40, s42, 393216
    s_lshl_b32 s41, s58, 1
    s_add_u32 s40, s40, s41
    s_mul_i32 s41, s42, 196608
    s_add_u32 s41, s41, s58
    s_mov_b32 s31, 262144
    s_mov_b32 exec_lo, 0xfff
    s_mov_b32 exec_hi, 0
Lf_163:
    buffer_load_dword v226, v253, s[4:7], s51 offen sc1
    s_waitcnt vmcnt(0)
    v_cmp_eq_u32 vcc, 0, v226
    s_cbranch_vccz Lfd_164
    s_sleep 2
    s_sub_u32 s31, s31, 1
    s_cbranch_scc0 Lf_163
    s_mov_b32 s31, 6
    s_branch L_fail
Lfd_164:
    s_mov_b64 exec, -1
    s_add_u32 s48, s40, 67108864
    s_add_u32 m0, s59, 0
    s_nop 0
    buffer_load_dwordx4 v2, s[4:7], s48 offen sc1 lds
    s_add_u32 s48, s48, 1024
    s_add_u32 m0, s59, 1024
    s_nop 0
    buffer_load_dwordx4 v2, s[4:7], s48 offen sc1 lds
    s_add_u32 s48, s48, 1024
    s_add_u32 m0, s59, 2048
    s_nop 0
    buffer_load_dwordx4 v2, s[4:7], s48 offen sc1 lds
    s_add_u32 s48, s48, 1024
    s_add_u32 m0, s59, 3072
    s_nop 0
    buffer_load_dwordx4 v2, s[4:7], s48 offen sc1 lds
    s_add_u32 s48, s48, 1024
    s_add_u32 m0, s59, 4096
    s_nop 0
    buffer_load_dwordx4 v2, s[4:7], s48 offen sc1 lds
    s_add_u32 s48, s48, 1024
    s_add_u32 m0, s59, 5120
    s_nop 0
    buffer_load_dwordx4 v2, s[4:7], s48 offen sc1 lds
    s_add_u32 s48, s48, 1024
    s_add_u32 m0, s59, 6144
    s_nop 0
    buffer_load_dwordx4 v2, s[4:7], s48 offen sc1 lds
    s_add_u32 s48, s48, 1024
    s_add_u32 m0, s59, 7168
    s_nop 0
    buffer_load_dwordx4 v2, s[4:7], s48 offen sc1 lds
    s_add_u32 s48, s48, 1024
    s_add_u32 m0, s59, 8192
    s_nop 0
    buffer_load_dwordx4 v2, s[4:7], s48 offen sc1 lds
    s_add_u32 s48, s48, 1024
    s_add_u32 m0, s59, 9216
    s_nop 0
    buffer_load_dwordx4 v2, s[4:7], s48 offen sc1 lds
    s_add_u32 s48, s48, 1024
    s_add_u32 m0, s59, 10240
    s_nop 0
    buffer_load_dwordx4 v2, s[4:7], s48 offen sc1 lds
    s_add_u32 s48, s48, 1024
    s_add_u32 m0, s59, 11264
    s_nop 0
    buffer_load_dwordx4 v2, s[4:7], s48 offen sc1 lds
    s_add_u32 s48, s48, 1024
    s_add_u32 s48, s40, 41943040
    buffer_load_dwordx4 a[0:3], v2, s[4:7], s48 offen offset:0 sc1
    buffer_load_dwordx4 a[4:7], v2, s[4:7], s48 offen offset:1024 sc1
    buffer_load_dwordx4 a[8:11], v2, s[4:7], s48 offen offset:2048 sc1
    buffer_load_dwordx4 a[12:15], v2, s[4:7], s48 offen offset:3072 sc1
    s_add_u32 s48, s48, 4096
    buffer_load_dwordx4 a[16:19], v2, s[4:7], s48 offen offset:0 sc1
    buffer_load_dwordx4 a[20:23], v2, s[4:7], s48 offen offset:1024 sc1
    buffer_load_dwordx4 a[24:27], v2, s[4:7], s48 offen offset:2048 sc1
    buffer_load_dwordx4 a[28:31], v2, s[4:7], s48 offen offset:3072 sc1
    s_add_u32 s48, s48, 4096
    buffer_load_dwordx4 a[32:35], v2, s[4:7], s48 offen offset:0 sc1
    buffer_load_dwordx4 a[36:39], v2, s[4:7], s48 offen offset:1024 sc1
    buffer_load_dwordx4 a[40:43], v2, s[4:7], s48 offen offset:2048 sc1
    buffer_load_dwordx4 a[44:47], v2, s[4:7], s48 offen offset:3072 sc1
    s_add_u32 s48, s40, 16777216
    buffer_load_dwordx4 a[48:51], v2, s[4:7], s48 offen offset:0 sc1
    buffer_load_dwordx4 a[52:55], v2, s[4:7], s48 offen offset:1024 sc1
    buffer_load_dwordx4 a[56:59], v2, s[4:7], s48 offen offset:2048 sc1
    buffer_load_dwordx4 a[60:63], v2, s[4:7], s48 offen offset:3072 sc1
    s_add_u32 s48, s48, 4096
    buffer_load_dwordx4 a[64:67], v2, s[4:7], s48 offen offset:0 sc1
    buffer_load_dwordx4 a[68:71], v2, s[4:7], s48 offen offset:1024 sc1
    buffer_load_dwordx4 a[72:75], v2, s[4:7], s48 offen offset:2048 sc1
    buffer_load_dwordx4 a[76:79], v2, s[4:7], s48 offen offset:3072 sc1
    s_add_u32 s48, s48, 4096
    buffer_load_dwordx4 a[80:83], v2, s[4:7], s48 offen offset:0 sc1
    buffer_load_dwordx4 a[84:87], v2, s[4:7], s48 offen offset:1024 sc1
    buffer_load_dwordx4 a[88:91], v2, s[4:7], s48 offen offset:2048 sc1
    buffer_load_dwordx4 a[92:95], v2, s[4:7], s48 offen offset:3072 sc1
    s_add_u32 s51, s30, 2
    s_lshl_b32 s51, s51, 11
    s_add_u32 s51, s51, s60
    s_waitcnt vmcnt(24)
    ds_read_b64_tr_b16 a[98:99], v4 offset:0
    ds_read_b64_tr_b16 a[100:101], v4 offset:6144
    ds_read_b64_tr_b16 a[104:105], v4 offset:8
    ds_read_b64_tr_b16 a[106:107], v4 offset:6152
    ds_read_b64_tr_b16 a[110:111], v4 offset:1024
    ds_read_b64_tr_b16 a[112:113], v4 offset:7168
    ds_read_b64_tr_b16 a[116:117], v4 offset:1032
    ds_read_b64_tr_b16 a[118:119], v4 offset:7176
    ds_read_b64_tr_b16 a[122:123], v4 offset:2048
    ds_read_b64_tr_b16 a[124:125], v4 offset:8192
    ds_read_b64_tr_b16 a[128:129], v4 offset:2056
    ds_read_b64_tr_b16 a[130:131], v4 offset:8200
    ds_read_b64_tr_b16 a[134:135], v4 offset:3072
    ds_read_b64_tr_b16 a[136:137], v4 offset:9216
    ds_read_b64_tr_b16 a[140:141], v4 offset:3080
    ds_read_b64_tr_b16 a[142:143], v4 offset:9224
    ds_read_b64_tr_b16 a[146:147], v4 offset:4096
    ds_read_b64_tr_b16 a[148:149], v4 offset:10240
    ds_read_b64_tr_b16 a[152:153], v4 offset:4104
    ds_read_b64_tr_b16 a[154:155], v4 offset:10248
    ds_read_b64_tr_b16 a[158:159], v4 offset:5120
    ds_read_b64_tr_b16 a[160:161], v4 offset:11264
    ds_read_b64_tr_b16 a[164:165], v4 offset:5128
    ds_read_b64_tr_b16 a[166:167], v4 offset:11272
    s_cmp_lt_u32 s30, 8
    s_cbranch_scc1 Lab_165
    s_sub_u32 s50, s30, 8
    s_mul_i32 s50, s50, 1280
    s_add_u32 s50, s50, 172032
    s_mov_b32 s31, 262144
    s_mov_b32 exec_lo, 0xfffff
    s_mov_b32 exec_hi, 0
Lf_166:
    buffer_load_dword v226, v12, s[4:7], s50 offen sc1
    s_waitcnt vmcnt(0)
    v_cmp_eq_u32 vcc, 0, v226
    s_cbranch_vccz Lfd_167
    s_sleep 16
    s_sub_u32 s31, s31, 1
    s_cbranch_scc0 Lf_166
    s_mov_b32 s31, 14
    s_branch L_fail
Lfd_167:
    s_mov_b64 exec, -1
Lab_165:
    s_waitcnt vmcnt(0)
    v_mfma_f32_16x16x32_bf16 v[44:47], a[0:3], a[48:51], v[236:239]
    v_mfma_f32_16x16x32_bf16 v[52:55], a[0:3], a[72:75], 0
    v_mfma_f32_16x16x32_bf16 v[56:59], a[24:27], a[72:75], v[236:239]
    v_mfma_f32_16x16x32_bf16 v[44:47], a[4:7], a[52:55], v[44:47]
    v_mfma_f32_16x16x32_bf16 v[52:55], a[4:7], a[76:79], v[52:55]
    v_mfma_f32_16x16x32_bf16 v[56:59], a[28:31], a[76:79], v[56:59]
    v_mfma_f32_16x16x32_bf16 v[44:47], a[8:11], a[56:59], v[44:47]
    v_mfma_f32_16x16x32_bf16 v[52:55], a[8:11], a[80:83], v[52:55]
    v_mfma_f32_16x16x32_bf16 v[56:59], a[32:35], a[80:83], v[56:59]
    v_mfma_f32_16x16x32_bf16 v[44:47], a[12:15], a[60:63], v[44:47]
    v_mfma_f32_16x16x32_bf16 v[52:55], a[12:15], a[84:87], v[52:55]
    v_mfma_f32_16x16x32_bf16 v[56:59], a[36:39], a[84:87], v[56:59]
    v_mfma_f32_16x16x32_bf16 v[44:47], a[16:19], a[64:67], v[44:47]
    v_mfma_f32_16x16x32_bf16 v[52:55], a[16:19], a[88:91], v[52:55]
    v_mfma_f32_16x16x32_bf16 v[56:59], a[40:43], a[88:91], v[56:59]
    v_mfma_f32_16x16x32_bf16 v[44:47], a[20:23], a[68:71], v[44:47]
    v_mfma_f32_16x16x32_bf16 v[52:55], a[20:23], a[92:95], v[52:55]
    v_mfma_f32_16x16x32_bf16 v[56:59], a[44:47], a[92:95], v[56:59]
    s_mov_b32 s31, 262144
    s_mov_b32 exec_lo, 0xfff
    s_mov_b32 exec_hi, 0
Lf_168:
    buffer_load_dword v226, v253, s[4:7], s51 offen sc1
    s_waitcnt vmcnt(0)
    v_cmp_eq_u32 vcc, 0, v226
    s_cbranch_vccz Lfd_169
    s_sleep 2
    s_sub_u32 s31, s31, 1
    s_cbranch_scc0 Lf_168
    s_mov_b32 s31, 6
    s_branch L_fail
Lfd_169:
    s_mov_b64 exec, -1
    s_add_u32 s48, s41, 117440512
    buffer_load_dwordx4 v[16:19], v2, s[4:7], s48 offen offset:0 sc1
    buffer_load_dwordx4 v[20:23], v2, s[4:7], s48 offen offset:1024 sc1
    buffer_load_dwordx4 v[24:27], v2, s[4:7], s48 offen offset:2048 sc1
    buffer_load_dwordx4 v[28:31], v2, s[4:7], s48 offen offset:3072 sc1
    s_add_u32 s48, s48, 4096
    buffer_load_dwordx4 v[32:35], v2, s[4:7], s48 offen offset:0 sc1
    buffer_load_dwordx4 v[36:39], v2, s[4:7], s48 offen offset:1024 sc1
    s_lshr_b32 s42, s41, 1
    s_add_u32 s48, s42, 130023424
    s_add_u32 m0, s59, 12288
    s_nop 0
    buffer_load_dwordx4 v2, s[4:7], s48 offen sc1 lds
    s_add_u32 s48, s48, 1024
    s_add_u32 m0, s59, 13312
    s_nop 0
    buffer_load_dwordx4 v2, s[4:7], s48 offen sc1 lds
    s_add_u32 s48, s48, 1024
    s_add_u32 m0, s59, 14336
    s_nop 0
    buffer_load_dwordx4 v2, s[4:7], s48 offen sc1 lds
    s_add_u32 s48, s48, 1024
    s_add_u32 s48, s30, 3
    s_and_b32 s48, s48, 3
    s_mul_i32 s48, s48, 327680
    s_add_u32 s48, s48, s61
    s_cmp_lt_u32 s30, 60
    s_cselect_b64 exec, -1, 0
    buffer_store_dwordx4 v[240:243], v7, s[4:7], s48 offen sc1
    s_add_u32 s48, s48, 65536
    buffer_store_dwordx4 v[240:243], v7, s[4:7], s48 offen sc1
    s_add_u32 s48, s48, 65536
    buffer_store_dwordx4 v[240:243], v7, s[4:7], s48 offen sc1
    s_add_u32 s48, s48, 65536
    buffer_store_dwordx4 v[240:243], v7, s[4:7], s48 offen sc1
    s_add_u32 s48, s48, 65536
    buffer_store_dwordx4 v[240:243], v7, s[4:7], s48 offen sc1
    s_mov_b64 exec, -1
    s_waitcnt vmcnt(13)
    v_mfma_f32_16x16x32_bf16 v[40:43], v[16:19], a[48:51], v[232:235]
    v_mfma_f32_16x16x32_bf16 v[48:51], v[16:19], a[72:75], v[232:235]
    s_waitcnt vmcnt(12)
    v_mfma_f32_16x16x32_bf16 v[40:43], v[20:23], a[52:55], v[40:43]
    v_mfma_f32_16x16x32_bf16 v[48:51], v[20:23], a[76:79], v[48:51]
    s_waitcnt vmcnt(11)
    v_mfma_f32_16x16x32_bf16 v[40:43], v[24:27], a[56:59], v[40:43]
    v_mfma_f32_16x16x32_bf16 v[48:51], v[24:27], a[80:83], v[48:51]
    s_waitcnt vmcnt(10)
    v_mfma_f32_16x16x32_bf16 v[40:43], v[28:31], a[60:63], v[40:43]
    v_mfma_f32_16x16x32_bf16 v[48:51], v[28:31], a[84:87], v[48:51]
    s_waitcnt vmcnt(9)
    v_mfma_f32_16x16x32_bf16 v[40:43], v[32:35], a[64:67], v[40:43]
    v_mfma_f32_16x16x32_bf16 v[48:51], v[32:35], a[88:91], v[48:51]
    s_waitcnt vmcnt(8)
    v_mfma_f32_16x16x32_bf16 v[40:43], v[36:39], a[68:71], v[40:43]
    v_mfma_f32_16x16x32_bf16 v[48:51], v[36:39], a[92:95], v[48:51]
    s_waitcnt vmcnt(0)
    s_add_u32 s48, s51, 2048
    s_cmp_lt_u32 s30, 61
    s_cselect_b64 exec, 1, 0
    buffer_store_dword v9, v8, s[4:7], s48 offen
    s_mov_b64 exec, -1
    ds_read_b64_tr_b16 a[96:97], v5 offset:12288
    ds_read_b64_tr_b16 a[102:103], v5 offset:12296
    ds_read_b64_tr_b16 a[108:109], v5 offset:13312
    ds_read_b64_tr_b16 a[114:115], v5 offset:13320
    ds_read_b64_tr_b16 a[120:121], v5 offset:14336
    ds_read_b64_tr_b16 a[126:127], v5 offset:14344
    ds_read_b64_tr_b16 a[132:133], v5 offset:12416
    ds_read_b64_tr_b16 a[138:139], v5 offset:12424
    ds_read_b64_tr_b16 a[144:145], v5 offset:13440
    ds_read_b64_tr_b16 a[150:151], v5 offset:13448
    ds_read_b64_tr_b16 a[156:157], v5 offset:14464
    ds_read_b64_tr_b16 a[162:163], v5 offset:14472
    v_max3_f32 v226, v40, v41, v42
    v_max3_f32 v226, v226, v43, v44
    v_max3_f32 v226, v226, v45, v46
    v_max_f32 v226, v226, v47
    v_mov_b32 v227, v226
    s_nop 1
    v_permlane16_swap_b32 v226, v227
    v_max_f32 v226, v226, v227
    v_mov_b32 v227, v226
    s_nop 1
    v_permlane32_swap_b32 v226, v227
    v_max_f32 v226, v226, v227
    v_mul_f32 v226, s53, v226
    v_fma_f32 v40, v40, s52, v226
    v_fma_f32 v41, v41, s52, v226
    v_fma_f32 v42, v42, s52, v226
    v_fma_f32 v43, v43, s52, v226
    v_fma_f32 v44, v44, s52, v226
    v_fma_f32 v45, v45, s52, v226
    v_fma_f32 v46, v46, s52, v226
    v_fma_f32 v47, v47, s52, v226
    v_exp_f32 v40, v40
    v_exp_f32 v41, v41
    v_exp_f32 v42, v42
    v_exp_f32 v43, v43
    v_exp_f32 v44, v44
    v_exp_f32 v45, v45
    v_exp_f32 v46, v46
    v_exp_f32 v47, v47
    v_add_f32 v228, v40, v41
    v_add_f32 v229, v42, v43
    v_add_f32 v228, v228, v44
    v_add_f32 v229, v229, v45
    v_add_f32 v228, v228, v46
    v_add_f32 v229, v229, v47
    v_add_f32 v228, v228, v229
    v_mov_b32 v229, v228
    s_nop 1
    v_permlane16_swap_b32 v228, v229
    v_add_f32 v228, v228, v229
    v_mov_b32 v229, v228
    s_nop 1
    v_permlane32_swap_b32 v228, v229
    v_add_f32 v228, v228, v229
    v_rcp_f32 v228, v228
    s_nop 0
    v_mul_f32 v40, v40, v228
    v_mul_f32 v41, v41, v228
    v_mul_f32 v42, v42, v228
    v_mul_f32 v43, v43, v228
    v_mul_f32 v44, v44, v228
    v_mul_f32 v45, v45, v228
    v_mul_f32 v46, v46, v228
    v_mul_f32 v47, v47, v228
    v_cvt_pk_bf16_f32 v60, v40, v41
    v_cvt_pk_bf16_f32 v61, v42, v43
    v_cvt_pk_bf16_f32 v62, v44, v45
    v_cvt_pk_bf16_f32 v63, v46, v47
    s_add_u32 s48, s40, 92274688
    s_add_u32 s49, s48, 4096
    s_add_u32 s50, s48, 8192
    s_waitcnt lgkmcnt(0)
    v_mfma_f32_16x16x32_bf16 v[72:75], a[96:99], v[60:63], 0
    v_max3_f32 v226, v48, v49, v50
    v_max3_f32 v226, v226, v51, v52
    v_max3_f32 v226, v226, v53, v54
    v_mfma_f32_16x16x32_bf16 v[76:79], a[102:105], v[60:63], 0
    v_max3_f32 v226, v226, v55, v56
    v_max3_f32 v226, v226, v57, v58
    v_max_f32 v226, v226, v59
    v_mfma_f32_16x16x32_bf16 v[80:83], a[108:111], v[60:63], 0
    v_mov_b32 v227, v226
    s_nop 1
    v_permlane16_swap_b32 v226, v227
    v_max_f32 v226, v226, v227
    v_mfma_f32_16x16x32_bf16 v[84:87], a[114:117], v[60:63], 0
    v_mov_b32 v227, v226
    s_nop 1
    v_permlane32_swap_b32 v226, v227
    v_max_f32 v226, v226, v227
    v_mfma_f32_16x16x32_bf16 v[88:91], a[120:123], v[60:63], 0
    v_mul_f32 v226, s53, v226
    v_fma_f32 v48, v48, s52, v226
    v_fma_f32 v49, v49, s52, v226
    v_mfma_f32_16x16x32_bf16 v[92:95], a[126:129], v[60:63], 0
    v_fma_f32 v50, v50, s52, v226
    v_fma_f32 v51, v51, s52, v226
    v_fma_f32 v52, v52, s52, v226
    v_mfma_f32_16x16x32_bf16 v[96:99], a[132:135], v[60:63], 0
    v_fma_f32 v53, v53, s52, v226
    v_fma_f32 v54, v54, s52, v226
    v_fma_f32 v55, v55, s52, v226
    v_mfma_f32_16x16x32_bf16 v[100:103], a[138:141], v[60:63], 0
    v_fma_f32 v56, v56, s52, v226
    v_fma_f32 v57, v57, s52, v226
    v_fma_f32 v58, v58, s52, v226
    v_mfma_f32_16x16x32_bf16 v[104:107], a[144:147], v[60:63], 0
    v_fma_f32 v59, v59, s52, v226
    v_exp_f32 v48, v48
    v_exp_f32 v49, v49
    v_mfma_f32_16x16x32_bf16 v[108:111], a[150:153], v[60:63], 0
    v_exp_f32 v50, v50
    v_exp_f32 v51, v51
    v_exp_f32 v52, v52
    v_mfma_f32_16x16x32_bf16 v[112:115], a[156:159], v[60:63], 0
    v_exp_f32 v53, v53
    v_exp_f32 v54, v54
    v_exp_f32 v55, v55
    v_mfma_f32_16x16x32_bf16 v[116:119], a[162:165], v[60:63], 0
    v_exp_f32 v56, v56
    v_exp_f32 v57, v57
    v_exp_f32 v58, v58
    v_exp_f32 v59, v59
    v_add_f32 v228, v48, v49
    v_cvt_pk_bf16_f32 v136, v72, v73
    v_add_f32 v229, v50, v51
    v_add_f32 v228, v228, v52
    v_cvt_pk_bf16_f32 v137, v74, v75
    v_add_f32 v229, v229, v53
    v_add_f32 v228, v228, v54
    v_cvt_pk_bf16_f32 v138, v76, v77
    v_add_f32 v229, v229, v55
    v_add_f32 v228, v228, v56
    v_cvt_pk_bf16_f32 v139, v78, v79
    v_add_f32 v229, v229, v57
    v_add_f32 v228, v228, v58
    buffer_store_dwordx4 v[136:139], v2, s[4:7], s48 offen offset:0
    v_add_f32 v229, v229, v59
    v_add_f32 v228, v228, v229
    v_cvt_pk_bf16_f32 v140, v80, v81
    v_mov_b32 v229, v228
    s_nop 1
    v_permlane16_swap_b32 v228, v229
    v_cvt_pk_bf16_f32 v141, v82, v83
    v_add_f32 v228, v228, v229
    v_mov_b32 v229, v228
    v_cvt_pk_bf16_f32 v142, v84, v85
    s_nop 0
    v_permlane32_swap_b32 v228, v229
    v_add_f32 v228, v228, v229
    v_cvt_pk_bf16_f32 v143, v86, v87
    v_rcp_f32 v228, v228
    s_nop 0
    v_mul_f32 v48, v48, v228
    buffer_store_dwordx4 v[140:143], v2, s[4:7], s48 offen offset:1024
    v_mul_f32 v49, v49, v228
    v_mul_f32 v50, v50, v228
    v_cvt_pk_bf16_f32 v144, v88, v89
    v_mul_f32 v51, v51, v228
    v_mul_f32 v52, v52, v228
    v_cvt_pk_bf16_f32 v145, v90, v91
    v_mul_f32 v53, v53, v228
    v_mul_f32 v54, v54, v228
    v_cvt_pk_bf16_f32 v146, v92, v93
    v_mul_f32 v55, v55, v228
    v_mul_f32 v56, v56, v228
    v_cvt_pk_bf16_f32 v147, v94, v95
    v_mul_f32 v57, v57, v228
    v_mul_f32 v58, v58, v228
    buffer_store_dwordx4 v[144:147], v2, s[4:7], s48 offen offset:2048
    v_mul_f32 v59, v59, v228
    v_cvt_pk_bf16_f32 v64, v48, v49
    v_cvt_pk_bf16_f32 v148, v96, v97
    v_cvt_pk_bf16_f32 v65, v50, v51
    v_cvt_pk_bf16_f32 v66, v52, v53
    v_cvt_pk_bf16_f32 v149, v98, v99
    v_cvt_pk_bf16_f32 v67, v54, v55
    v_cvt_pk_bf16_f32 v68, v56, v57
    v_cvt_pk_bf16_f32 v150, v100, v101
    v_cvt_pk_bf16_f32 v69, v58, v59
    v_cvt_pk_bf16_f32 v151, v102, v103
    buffer_store_dwordx4 v[148:151], v2, s[4:7], s48 offen offset:3072
    v_cvt_pk_bf16_f32 v152, v104, v105
    v_cvt_pk_bf16_f32 v153, v106, v107
    v_cvt_pk_bf16_f32 v154, v108, v109
    v_cvt_pk_bf16_f32 v155, v110, v111
    buffer_store_dwordx4 v[152:155], v2, s[4:7], s49 offen offset:0
    v_cvt_pk_bf16_f32 v156, v112, v113
    v_cvt_pk_bf16_f32 v157, v114, v115
    v_cvt_pk_bf16_f32 v158, v116, v117
    v_cvt_pk_bf16_f32 v159, v118, v119
    buffer_store_dwordx4 v[156:159], v2, s[4:7], s49 offen offset:1024
    v_mfma_f32_16x16x16_bf16 v[120:123], a[96:97], v[64:65], 0
    v_mfma_f32_16x16x16_bf16 v[124:127], a[102:103], v[64:65], 0
    v_mfma_f32_16x16x32_bf16 v[120:123], a[98:101], v[66:69], v[120:123]
    v_mfma_f32_16x16x32_bf16 v[124:127], a[104:107], v[66:69], v[124:127]
    v_mfma_f32_16x16x16_bf16 v[128:131], a[108:109], v[64:65], 0
    v_mfma_f32_16x16x16_bf16 v[132:135], a[114:115], v[64:65], 0
    v_mfma_f32_16x16x32_bf16 v[128:131], a[110:113], v[66:69], v[128:131]
    v_mfma_f32_16x16x32_bf16 v[132:135], a[116:119], v[66:69], v[132:135]
    v_mfma_f32_16x16x16_bf16 v[72:75], a[120:121], v[64:65], 0
    v_mfma_f32_16x16x16_bf16 v[76:79], a[126:127], v[64:65], 0
    v_mfma_f32_16x16x32_bf16 v[72:75], a[122:125], v[66:69], v[72:75]
    v_mfma_f32_16x16x32_bf16 v[76:79], a[128:131], v[66:69], v[76:79]
    v_cvt_pk_bf16_f32 v160, v120, v121
    v_cvt_pk_bf16_f32 v161, v122, v123
    v_cvt_pk_bf16_f32 v162, v124, v125
    v_cvt_pk_bf16_f32 v163, v126, v127
    buffer_store_dwordx4 v[160:163], v2, s[4:7], s49 offen offset:2048
    v_mfma_f32_16x16x16_bf16 v[80:83], a[132:133], v[64:65], 0
    v_mfma_f32_16x16x16_bf16 v[84:87], a[138:139], v[64:65], 0
    v_mfma_f32_16x16x32_bf16 v[80:83], a[134:137], v[66:69], v[80:83]
    v_mfma_f32_16x16x32_bf16 v[84:87], a[140:143], v[66:69], v[84:87]
    v_cvt_pk_bf16_f32 v164, v128, v129
    v_cvt_pk_bf16_f32 v165, v130, v131
    v_cvt_pk_bf16_f32 v166, v132, v133
    v_cvt_pk_bf16_f32 v167, v134, v135
    buffer_store_dwordx4 v[164:167], v2, s[4:7], s49 offen offset:3072
    v_mfma_f32_16x16x16_bf16 v[88:91], a[144:145], v[64:65], 0
    v_mfma_f32_16x16x16_bf16 v[92:95], a[150:151], v[64:65], 0
    v_mfma_f32_16x16x32_bf16 v[88:91], a[146:149], v[66:69], v[88:91]
    v_mfma_f32_16x16x32_bf16 v[92:95], a[152:155], v[66:69], v[92:95]
    v_cvt_pk_bf16_f32 v168, v72, v73
    v_cvt_pk_bf16_f32 v169, v74, v75
    v_cvt_pk_bf16_f32 v170, v76, v77
    v_cvt_pk_bf16_f32 v171, v78, v79
    buffer_store_dwordx4 v[168:171], v2, s[4:7], s50 offen offset:0
    v_mfma_f32_16x16x16_bf16 v[96:99], a[156:157], v[64:65], 0
    v_mfma_f32_16x16x16_bf16 v[100:103], a[162:163], v[64:65], 0
    v_mfma_f32_16x16x32_bf16 v[96:99], a[158:161], v[66:69], v[96:99]
    v_mfma_f32_16x16x32_bf16 v[100:103], a[164:167], v[66:69], v[100:103]
    v_cvt_pk_bf16_f32 v172, v80, v81
    v_cvt_pk_bf16_f32 v173, v82, v83
    v_cvt_pk_bf16_f32 v174, v84, v85
    v_cvt_pk_bf16_f32 v175, v86, v87
    buffer_store_dwordx4 v[172:175], v2, s[4:7], s50 offen offset:1024
    v_cvt_pk_bf16_f32 v176, v88, v89
    v_cvt_pk_bf16_f32 v177, v90, v91
    v_cvt_pk_bf16_f32 v178, v92, v93
    v_cvt_pk_bf16_f32 v179, v94, v95
    buffer_store_dwordx4 v[176:179], v2, s[4:7], s50 offen offset:2048
    v_cvt_pk_bf16_f32 v180, v96, v97
    v_cvt_pk_bf16_f32 v181, v98, v99
    v_cvt_pk_bf16_f32 v182, v100, v101
    v_cvt_pk_bf16_f32 v183, v102, v103
    buffer_store_dwordx4 v[180:183], v2, s[4:7], s50 offen offset:3072
    s_lshl_b32 s50, s30, 3
    s_add_u32 s50, s50, s20
    s_lshl_b32 s50, s50, 6
    s_add_u32 s50, s50, 139264
    s_waitcnt vmcnt(0)
    s_mov_b64 exec, 1
    buffer_store_dword v252, v254, s[4:7], s50 offen
    s_mov_b64 exec, -1
    s_add_u32 s30, s30, 2
    s_cmp_lt_u32 s30, 64
    s_cbranch_scc1 Lat_162
    s_endpgm
L_atts:
    s_mov_b32 s30, s25
Lat_170:
    s_max_u32 s51, s30, 2
    s_lshl_b32 s51, s51, 11
    s_add_u32 s51, s51, s60
    s_and_b32 s42, s30, 7
    s_mul_i32 s40, s42, 393216
    s_lshl_b32 s41, s58, 1
    s_add_u32 s40, s40, s41
    s_mul_i32 s41, s42, 196608
    s_add_u32 s41, s41, s58
    s_mov_b32 s31, 262144
    s_mov_b32 exec_lo, 0xfff
    s_mov_b32 exec_hi, 0
Lf_171:
    buffer_load_dword v226, v253, s[4:7], s51 offen sc1
    s_waitcnt vmcnt(0)
    v_cmp_eq_u32 vcc, 0, v226
    s_cbranch_vccz Lfd_172
    s_sleep 2
    s_sub_u32 s31, s31, 1
    s_cbranch_scc0 Lf_171
    s_mov_b32 s31, 6
    s_branch L_fail
Lfd_172:
    s_mov_b64 exec, -1
    s_add_u32 s48, s40, 67108864
    s_add_u32 m0, s59, 0
    s_nop 0
    buffer_load_dwordx4 v2, s[4:7], s48 offen sc1 lds
    s_add_u32 s48, s48, 1024
    s_add_u32 m0, s59, 1024
    s_nop 0
    buffer_load_dwordx4 v2, s[4:7], s48 offen sc1 lds
    s_add_u32 s48, s48, 1024
    s_add_u32 m0, s59, 2048
    s_nop 0
    buffer_load_dwordx4 v2, s[4:7], s48 offen sc1 lds
    s_add_u32 s48, s48, 1024
    s_add_u32 m0, s59, 3072
    s_nop 0
    buffer_load_dwordx4 v2, s[4:7], s48 offen sc1 lds
    s_add_u32 s48, s48, 1024
    s_add_u32 m0, s59, 4096
    s_nop 0
    buffer_load_dwordx4 v2, s[4:7], s48 offen sc1 lds
    s_add_u32 s48, s48, 1024
    s_add_u32 m0, s59, 5120
    s_nop 0
    buffer_load_dwordx4 v2, s[4:7], s48 offen sc1 lds
    s_add_u32 s48, s48, 1024
    s_add_u32 m0, s59, 6144
    s_nop 0
    buffer_load_dwordx4 v2, s[4:7], s48 offen sc1 lds
    s_add_u32 s48, s48, 1024
    s_add_u32 m0, s59, 7168
    s_nop 0
    buffer_load_dwordx4 v2, s[4:7], s48 offen sc1 lds
    s_add_u32 s48, s48, 1024
    s_add_u32 m0, s59, 8192
    s_nop 0
    buffer_load_dwordx4 v2, s[4:7], s48 offen sc1 lds
    s_add_u32 s48, s48, 1024
    s_add_u32 m0, s59, 9216
    s_nop 0
    buffer_load_dwordx4 v2, s[4:7], s48 offen sc1 lds
    s_add_u32 s48, s48, 1024
    s_add_u32 m0, s59, 10240
    s_nop 0
    buffer_load_dwordx4 v2, s[4:7], s48 offen sc1 lds
    s_add_u32 s48, s48, 1024
    s_add_u32 m0, s59, 11264
    s_nop 0
    buffer_load_dwordx4 v2, s[4:7], s48 offen sc1 lds
    s_add_u32 s48, s48, 1024
    s_add_u32 s48, s40, 41943040
    buffer_load_dwordx4 a[0:3], v2, s[4:7], s48 offen offset:0 sc1
    buffer_load_dwordx4 a[4:7], v2, s[4:7], s48 offen offset:1024 sc1
    buffer_load_dwordx4 a[8:11], v2, s[4:7], s48 offen offset:2048 sc1
    buffer_load_dwordx4 a[12:15], v2, s[4:7], s48 offen offset:3072 sc1
    s_add_u32 s48, s48, 4096
    buffer_load_dwordx4 a[16:19], v2, s[4:7], s48 offen offset:0 sc1
    buffer_load_dwordx4 a[20:23], v2, s[4:7], s48 offen offset:1024 sc1
    buffer_load_dwordx4 a[24:27], v2, s[4:7], s48 offen offset:2048 sc1
    buffer_load_dwordx4 a[28:31], v2, s[4:7], s48 offen offset:3072 sc1
    s_add_u32 s48, s48, 4096
    buffer_load_dwordx4 a[32:35], v2, s[4:7], s48 offen offset:0 sc1
    buffer_load_dwordx4 a[36:39], v2, s[4:7], s48 offen offset:1024 sc1
    buffer_load_dwordx4 a[40:43], v2, s[4:7], s48 offen offset:2048 sc1
    buffer_load_dwordx4 a[44:47], v2, s[4:7], s48 offen offset:3072 sc1
    s_add_u32 s48, s40, 16777216
    buffer_load_dwordx4 a[48:51], v2, s[4:7], s48 offen offset:0 sc1
    buffer_load_dwordx4 a[52:55], v2, s[4:7], s48 offen offset:1024 sc1
    buffer_load_dwordx4 a[56:59], v2, s[4:7], s48 offen offset:2048 sc1
    buffer_load_dwordx4 a[60:63], v2, s[4:7], s48 offen offset:3072 sc1
    s_add_u32 s48, s48, 4096
    buffer_load_dwordx4 a[64:67], v2, s[4:7], s48 offen offset:0 sc1
    buffer_load_dwordx4 a[68:71], v2, s[4:7], s48 offen offset:1024 sc1
    buffer_load_dwordx4 a[72:75], v2, s[4:7], s48 offen offset:2048 sc1
    buffer_load_dwordx4 a[76:79], v2, s[4:7], s48 offen offset:3072 sc1
    s_add_u32 s48, s48, 4096
    buffer_load_dwordx4 a[80:83], v2, s[4:7], s48 offen offset:0 sc1
    buffer_load_dwordx4 a[84:87], v2, s[4:7], s48 offen offset:1024 sc1
    buffer_load_dwordx4 a[88:91], v2, s[4:7], s48 offen offset:2048 sc1
    buffer_load_dwordx4 a[92:95], v2, s[4:7], s48 offen offset:3072 sc1
    s_add_u32 s51, s30, 2
    s_lshl_b32 s51, s51, 11
    s_add_u32 s51, s51, s60
    s_waitcnt vmcnt(24)
    ds_read_b64_tr_b16 a[98:99], v4 offset:0
    ds_read_b64_tr_b16 a[100:101], v4 offset:6144
    ds_read_b64_tr_b16 a[104:105], v4 offset:8
    ds_read_b64_tr_b16 a[106:107], v4 offset:6152
    ds_read_b64_tr_b16 a[110:111], v4 offset:1024
    ds_read_b64_tr_b16 a[112:113], v4 offset:7168
    ds_read_b64_tr_b16 a[116:117], v4 offset:1032
    ds_read_b64_tr_b16 a[118:119], v4 offset:7176
    ds_read_b64_tr_b16 a[122:123], v4 offset:2048
    ds_read_b64_tr_b16 a[124:125], v4 offset:8192
    ds_read_b64_tr_b16 a[128:129], v4 offset:2056
    ds_read_b64_tr_b16 a[130:131], v4 offset:8200
    ds_read_b64_tr_b16 a[134:135], v4 offset:3072
    ds_read_b64_tr_b16 a[136:137], v4 offset:9216
    ds_read_b64_tr_b16 a[140:141], v4 offset:3080
    ds_read_b64_tr_b16 a[142:143], v4 offset:9224
    ds_read_b64_tr_b16 a[146:147], v4 offset:4096
    ds_read_b64_tr_b16 a[148:149], v4 offset:10240
    ds_read_b64_tr_b16 a[152:153], v4 offset:4104
    ds_read_b64_tr_b16 a[154:155], v4 offset:10248
    ds_read_b64_tr_b16 a[158:159], v4 offset:5120
    ds_read_b64_tr_b16 a[160:161], v4 offset:11264
    ds_read_b64_tr_b16 a[164:165], v4 offset:5128
    ds_read_b64_tr_b16 a[166:167], v4 offset:11272
    s_cmp_lt_u32 s30, 8
    s_cbranch_scc1 Lab_173
    s_sub_u32 s50, s30, 8
    s_mul_i32 s50, s50, 1280
    s_add_u32 s50, s50, 172032
    s_mov_b32 s31, 262144
    s_mov_b32 exec_lo, 0xfffff
    s_mov_b32 exec_hi, 0
Lf_174:
    buffer_load_dword v226, v12, s[4:7], s50 offen sc1
    s_waitcnt vmcnt(0)
    v_cmp_eq_u32 vcc, 0, v226
    s_cbranch_vccz Lfd_175
    s_sleep 16
    s_sub_u32 s31, s31, 1
    s_cbranch_scc0 Lf_174
    s_mov_b32 s31, 14
    s_branch L_fail
Lfd_175:
    s_mov_b64 exec, -1
Lab_173:
    s_waitcnt vmcnt(0)
    v_mfma_f32_16x16x32_bf16 v[44:47], a[0:3], a[48:51], v[236:239]
    v_mfma_f32_16x16x32_bf16 v[52:55], a[0:3], a[72:75], 0
    v_mfma_f32_16x16x32_bf16 v[56:59], a[24:27], a[72:75], v[236:239]
    v_mfma_f32_16x16x32_bf16 v[44:47], a[4:7], a[52:55], v[44:47]
    v_mfma_f32_16x16x32_bf16 v[52:55], a[4:7], a[76:79], v[52:55]
    v_mfma_f32_16x16x32_bf16 v[56:59], a[28:31], a[76:79], v[56:59]
    v_mfma_f32_16x16x32_bf16 v[44:47], a[8:11], a[56:59], v[44:47]
    v_mfma_f32_16x16x32_bf16 v[52:55], a[8:11], a[80:83], v[52:55]
    v_mfma_f32_16x16x32_bf16 v[56:59], a[32:35], a[80:83], v[56:59]
    v_mfma_f32_16x16x32_bf16 v[44:47], a[12:15], a[60:63], v[44:47]
    v_mfma_f32_16x16x32_bf16 v[52:55], a[12:15], a[84:87], v[52:55]
    v_mfma_f32_16x16x32_bf16 v[56:59], a[36:39], a[84:87], v[56:59]
    v_mfma_f32_16x16x32_bf16 v[44:47], a[16:19], a[64:67], v[44:47]
    v_mfma_f32_16x16x32_bf16 v[52:55], a[16:19], a[88:91], v[52:55]
    v_mfma_f32_16x16x32_bf16 v[56:59], a[40:43], a[88:91], v[56:59]
    v_mfma_f32_16x16x32_bf16 v[44:47], a[20:23], a[68:71], v[44:47]
    v_mfma_f32_16x16x32_bf16 v[52:55], a[20:23], a[92:95], v[52:55]
    v_mfma_f32_16x16x32_bf16 v[56:59], a[44:47], a[92:95], v[56:59]
    s_mov_b32 s31, 262144
    s_mov_b32 exec_lo, 0xfff
    s_mov_b32 exec_hi, 0
Lf_176:
    buffer_load_dword v226, v253, s[4:7], s51 offen sc1
    s_waitcnt vmcnt(0)
    v_cmp_eq_u32 vcc, 0, v226
    s_cbranch_vccz Lfd_177
    s_sleep 2
    s_sub_u32 s31, s31, 1
    s_cbranch_scc0 Lf_176
    s_mov_b32 s31, 6
    s_branch L_fail
Lfd_177:
    s_mov_b64 exec, -1
    s_add_u32 s48, s41, 117440512
    buffer_load_dwordx4 v[16:19], v2, s[4:7], s48 offen offset:0 sc1
    buffer_load_dwordx4 v[20:23], v2, s[4:7], s48 offen offset:1024 sc1
    buffer_load_dwordx4 v[24:27], v2, s[4:7], s48 offen offset:2048 sc1
    buffer_load_dwordx4 v[28:31], v2, s[4:7], s48 offen offset:3072 sc1
    s_add_u32 s48, s48, 4096
    buffer_load_dwordx4 v[32:35], v2, s[4:7], s48 offen offset:0 sc1
    buffer_load_dwordx4 v[36:39], v2, s[4:7], s48 offen offset:1024 sc1
    s_lshr_b32 s42, s41, 1
    s_add_u32 s48, s42, 130023424
    s_add_u32 m0, s59, 12288
    s_nop 0
    buffer_load_dwordx4 v2, s[4:7], s48 offen sc1 lds
    s_add_u32 s48, s48, 1024
    s_add_u32 m0, s59, 13312
    s_nop 0
    buffer_load_dwordx4 v2, s[4:7], s48 offen sc1 lds
    s_add_u32 s48, s48, 1024
    s_add_u32 m0, s59, 14336
    s_nop 0
    buffer_load_dwordx4 v2, s[4:7], s48 offen sc1 lds
    s_add_u32 s48, s48, 1024
    s_add_u32 s48, s30, 3
    s_and_b32 s48, s48, 3
    s_mul_i32 s48, s48, 327680
    s_add_u32 s48, s48, s61
    s_cmp_lt_u32 s30, 60
    s_cselect_b64 exec, -1, 0
    buffer_store_dwordx4 v[240:243], v7, s[4:7], s48 offen sc1
    s_add_u32 s48, s48, 65536
    buffer_store_dwordx4 v[240:243], v7, s[4:7], s48 offen sc1
    s_add_u32 s48, s48, 65536
    buffer_store_dwordx4 v[240:243], v7, s[4:7], s48 offen sc1
    s_add_u32 s48, s48, 65536
    buffer_store_dwordx4 v[240:243], v7, s[4:7], s48 offen sc1
    s_add_u32 s48, s48, 65536
    buffer_store_dwordx4 v[240:243], v7, s[4:7], s48 offen sc1
    s_mov_b64 exec, -1
    s_waitcnt vmcnt(13)
    v_mfma_f32_16x16x32_bf16 v[40:43], v[16:19], a[48:51], v[232:235]
    v_mfma_f32_16x16x32_bf16 v[48:51], v[16:19], a[72:75], v[232:235]
    s_waitcnt vmcnt(12)
    v_mfma_f32_16x16x32_bf16 v[40:43], v[20:23], a[52:55], v[40:43]
    v_mfma_f32_16x16x32_bf16 v[48:51], v[20:23], a[76:79], v[48:51]
    s_waitcnt vmcnt(11)
    v_mfma_f32_16x16x32_bf16 v[40:43], v[24:27], a[56:59], v[40:43]
    v_mfma_f32_16x16x32_bf16 v[48:51], v[24:27], a[80:83], v[48:51]
    s_waitcnt vmcnt(10)
    v_mfma_f32_16x16x32_bf16 v[40:43], v[28:31], a[60:63], v[40:43]
    v_mfma_f32_16x16x32_bf16 v[48:51], v[28:31], a[84:87], v[48:51]
    s_waitcnt vmcnt(9)
    v_mfma_f32_16x16x32_bf16 v[40:43], v[32:35], a[64:67], v[40:43]
    v_mfma_f32_16x16x32_bf16 v[48:51], v[32:35], a[88:91], v[48:51]
    s_waitcnt vmcnt(8)
    v_mfma_f32_16x16x32_bf16 v[40:43], v[36:39], a[68:71], v[40:43]
    v_mfma_f32_16x16x32_bf16 v[48:51], v[36:39], a[92:95], v[48:51]
    s_waitcnt vmcnt(0)
    s_add_u32 s48, s51, 2048
    s_cmp_lt_u32 s30, 61
    s_cselect_b64 exec, 1, 0
    buffer_store_dword v9, v8, s[4:7], s48 offen sc1
    s_mov_b64 exec, -1
    ds_read_b64_tr_b16 a[96:97], v5 offset:12288
    ds_read_b64_tr_b16 a[102:103], v5 offset:12296
    ds_read_b64_tr_b16 a[108:109], v5 offset:13312
    ds_read_b64_tr_b16 a[114:115], v5 offset:13320
    ds_read_b64_tr_b16 a[120:121], v5 offset:14336
    ds_read_b64_tr_b16 a[126:127], v5 offset:14344
    ds_read_b64_tr_b16 a[132:133], v5 offset:12416
    ds_read_b64_tr_b16 a[138:139], v5 offset:12424
    ds_read_b64_tr_b16 a[144:145], v5 offset:13440
    ds_read_b64_tr_b16 a[150:151], v5 offset:13448
    ds_read_b64_tr_b16 a[156:157], v5 offset:14464
    ds_read_b64_tr_b16 a[162:163], v5 offset:14472
    v_max3_f32 v226, v40, v41, v42
    v_max3_f32 v226, v226, v43, v44
    v_max3_f32 v226, v226, v45, v46
    v_max_f32 v226, v226, v47
    v_mov_b32 v227, v226
    s_nop 1
    v_permlane16_swap_b32 v226, v227
    v_max_f32 v226, v226, v227
    v_mov_b32 v227, v226
    s_nop 1
    v_permlane32_swap_b32 v226, v227
    v_max_f32 v226, v226, v227
    v_mul_f32 v226, s53, v226
    v_fma_f32 v40, v40, s52, v226
    v_fma_f32 v41, v41, s52, v226
    v_fma_f32 v42, v42, s52, v226
    v_fma_f32 v43, v43, s52, v226
    v_fma_f32 v44, v44, s52, v226
    v_fma_f32 v45, v45, s52, v226
    v_fma_f32 v46, v46, s52, v226
    v_fma_f32 v47, v47, s52, v226
    v_exp_f32 v40, v40
    v_exp_f32 v41, v41
    v_exp_f32 v42, v42
    v_exp_f32 v43, v43
    v_exp_f32 v44, v44
    v_exp_f32 v45, v45
    v_exp_f32 v46, v46
    v_exp_f32 v47, v47
    v_add_f32 v228, v40, v41
    v_add_f32 v229, v42, v43
    v_add_f32 v228, v228, v44
    v_add_f32 v229, v229, v45
    v_add_f32 v228, v228, v46
    v_add_f32 v229, v229, v47
    v_add_f32 v228, v228, v229
    v_mov_b32 v229, v228
    s_nop 1
    v_permlane16_swap_b32 v228, v229
    v_add_f32 v228, v228, v229
    v_mov_b32 v229, v228
    s_nop 1
    v_permlane32_swap_b32 v228, v229
    v_add_f32 v228, v228, v229
    v_rcp_f32 v228, v228
    s_nop 0
    v_mul_f32 v40, v40, v228
    v_mul_f32 v41, v41, v228
    v_mul_f32 v42, v42, v228
    v_mul_f32 v43, v43, v228
    v_mul_f32 v44, v44, v228
    v_mul_f32 v45, v45, v228
    v_mul_f32 v46, v46, v228
    v_mul_f32 v47, v47, v228
    v_cvt_pk_bf16_f32 v60, v40, v41
    v_cvt_pk_bf16_f32 v61, v42, v43
    v_cvt_pk_bf16_f32 v62, v44, v45
    v_cvt_pk_bf16_f32 v63, v46, v47
    s_add_u32 s48, s40, 92274688
    s_add_u32 s49, s48, 4096
    s_add_u32 s50, s48, 8192
    s_waitcnt lgkmcnt(0)
    v_mfma_f32_16x16x32_bf16 v[72:75], a[96:99], v[60:63], 0
    v_max3_f32 v226, v48, v49, v50
    v_max3_f32 v226, v226, v51, v52
    v_max3_f32 v226, v226, v53, v54
    v_mfma_f32_16x16x32_bf16 v[76:79], a[102:105], v[60:63], 0
    v_max3_f32 v226, v226, v55, v56
    v_max3_f32 v226, v226, v57, v58
    v_max_f32 v226, v226, v59
    v_mfma_f32_16x16x32_bf16 v[80:83], a[108:111], v[60:63], 0
    v_mov_b32 v227, v226
    s_nop 1
    v_permlane16_swap_b32 v226, v227
    v_max_f32 v226, v226, v227
    v_mfma_f32_16x16x32_bf16 v[84:87], a[114:117], v[60:63], 0
    v_mov_b32 v227, v226
    s_nop 1
    v_permlane32_swap_b32 v226, v227
    v_max_f32 v226, v226, v227
    v_mfma_f32_16x16x32_bf16 v[88:91], a[120:123], v[60:63], 0
    v_mul_f32 v226, s53, v226
    v_fma_f32 v48, v48, s52, v226
    v_fma_f32 v49, v49, s52, v226
    v_mfma_f32_16x16x32_bf16 v[92:95], a[126:129], v[60:63], 0
    v_fma_f32 v50, v50, s52, v226
    v_fma_f32 v51, v51, s52, v226
    v_fma_f32 v52, v52, s52, v226
    v_mfma_f32_16x16x32_bf16 v[96:99], a[132:135], v[60:63], 0
    v_fma_f32 v53, v53, s52, v226
    v_fma_f32 v54, v54, s52, v226
    v_fma_f32 v55, v55, s52, v226
    v_mfma_f32_16x16x32_bf16 v[100:103], a[138:141], v[60:63], 0
    v_fma_f32 v56, v56, s52, v226
    v_fma_f32 v57, v57, s52, v226
    v_fma_f32 v58, v58, s52, v226
    v_mfma_f32_16x16x32_bf16 v[104:107], a[144:147], v[60:63], 0
    v_fma_f32 v59, v59, s52, v226
    v_exp_f32 v48, v48
    v_exp_f32 v49, v49
    v_mfma_f32_16x16x32_bf16 v[108:111], a[150:153], v[60:63], 0
    v_exp_f32 v50, v50
    v_exp_f32 v51, v51
    v_exp_f32 v52, v52
    v_mfma_f32_16x16x32_bf16 v[112:115], a[156:159], v[60:63], 0
    v_exp_f32 v53, v53
    v_exp_f32 v54, v54
    v_exp_f32 v55, v55
    v_mfma_f32_16x16x32_bf16 v[116:119], a[162:165], v[60:63], 0
    v_exp_f32 v56, v56
    v_exp_f32 v57, v57
    v_exp_f32 v58, v58
    v_exp_f32 v59, v59
    v_add_f32 v228, v48, v49
    v_cvt_pk_bf16_f32 v136, v72, v73
    v_add_f32 v229, v50, v51
    v_add_f32 v228, v228, v52
    v_cvt_pk_bf16_f32 v137, v74, v75
    v_add_f32 v229, v229, v53
    v_add_f32 v228, v228, v54
    v_cvt_pk_bf16_f32 v138, v76, v77
    v_add_f32 v229, v229, v55
    v_add_f32 v228, v228, v56
    v_cvt_pk_bf16_f32 v139, v78, v79
    v_add_f32 v229, v229, v57
    v_add_f32 v228, v228, v58
    buffer_store_dwordx4 v[136:139], v2, s[4:7], s48 offen offset:0 sc1
    v_add_f32 v229, v229, v59
    v_add_f32 v228, v228, v229
    v_cvt_pk_bf16_f32 v140, v80, v81
    v_mov_b32 v229, v228
    s_nop 1
    v_permlane16_swap_b32 v228, v229
    v_cvt_pk_bf16_f32 v141, v82, v83
    v_add_f32 v228, v228, v229
    v_mov_b32 v229, v228
    v_cvt_pk_bf16_f32 v142, v84, v85
    s_nop 0
    v_permlane32_swap_b32 v228, v229
    v_add_f32 v228, v228, v229
    v_cvt_pk_bf16_f32 v143, v86, v87
    v_rcp_f32 v228, v228
    s_nop 0
    v_mul_f32 v48, v48, v228
    buffer_store_dwordx4 v[140:143], v2, s[4:7], s48 offen offset:1024 sc1
    v_mul_f32 v49, v49, v228
    v_mul_f32 v50, v50, v228
    v_cvt_pk_bf16_f32 v144, v88, v89
    v_mul_f32 v51, v51, v228
    v_mul_f32 v52, v52, v228
    v_cvt_pk_bf16_f32 v145, v90, v91
    v_mul_f32 v53, v53, v228
    v_mul_f32 v54, v54, v228
    v_cvt_pk_bf16_f32 v146, v92, v93
    v_mul_f32 v55, v55, v228
    v_mul_f32 v56, v56, v228
    v_cvt_pk_bf16_f32 v147, v94, v95
    v_mul_f32 v57, v57, v228
    v_mul_f32 v58, v58, v228
    buffer_store_dwordx4 v[144:147], v2, s[4:7], s48 offen offset:2048 sc1
    v_mul_f32 v59, v59, v228
    v_cvt_pk_bf16_f32 v64, v48, v49
    v_cvt_pk_bf16_f32 v148, v96, v97
    v_cvt_pk_bf16_f32 v65, v50, v51
    v_cvt_pk_bf16_f32 v66, v52, v53
    v_cvt_pk_bf16_f32 v149, v98, v99
    v_cvt_pk_bf16_f32 v67, v54, v55
    v_cvt_pk_bf16_f32 v68, v56, v57
    v_cvt_pk_bf16_f32 v150, v100, v101
    v_cvt_pk_bf16_f32 v69, v58, v59
    v_cvt_pk_bf16_f32 v151, v102, v103
    buffer_store_dwordx4 v[148:151], v2, s[4:7], s48 offen offset:3072 sc1
    v_cvt_pk_bf16_f32 v152, v104, v105
    v_cvt_pk_bf16_f32 v153, v106, v107
    v_cvt_pk_bf16_f32 v154, v108, v109
    v_cvt_pk_bf16_f32 v155, v110, v111
    buffer_store_dwordx4 v[152:155], v2, s[4:7], s49 offen offset:0 sc1
    v_cvt_pk_bf16_f32 v156, v112, v113
    v_cvt_pk_bf16_f32 v157, v114, v115
    v_cvt_pk_bf16_f32 v158, v116, v117
    v_cvt_pk_bf16_f32 v159, v118, v119
    buffer_store_dwordx4 v[156:159], v2, s[4:7], s49 offen offset:1024 sc1
    v_mfma_f32_16x16x16_bf16 v[120:123], a[96:97], v[64:65], 0
    v_mfma_f32_16x16x16_bf16 v[124:127], a[102:103], v[64:65], 0
    v_mfma_f32_16x16x32_bf16 v[120:123], a[98:101], v[66:69], v[120:123]
    v_mfma_f32_16x16x32_bf16 v[124:127], a[104:107], v[66:69], v[124:127]
    v_mfma_f32_16x16x16_bf16 v[128:131], a[108:109], v[64:65], 0
    v_mfma_f32_16x16x16_bf16 v[132:135], a[114:115], v[64:65], 0
    v_mfma_f32_16x16x32_bf16 v[128:131], a[110:113], v[66:69], v[128:131]
    v_mfma_f32_16x16x32_bf16 v[132:135], a[116:119], v[66:69], v[132:135]
    v_mfma_f32_16x16x16_bf16 v[72:75], a[120:121], v[64:65], 0
    v_mfma_f32_16x16x16_bf16 v[76:79], a[126:127], v[64:65], 0
    v_mfma_f32_16x16x32_bf16 v[72:75], a[122:125], v[66:69], v[72:75]
    v_mfma_f32_16x16x32_bf16 v[76:79], a[128:131], v[66:69], v[76:79]
    v_cvt_pk_bf16_f32 v160, v120, v121
    v_cvt_pk_bf16_f32 v161, v122, v123
    v_cvt_pk_bf16_f32 v162, v124, v125
    v_cvt_pk_bf16_f32 v163, v126, v127
    buffer_store_dwordx4 v[160:163], v2, s[4:7], s49 offen offset:2048 sc1
    v_mfma_f32_16x16x16_bf16 v[80:83], a[132:133], v[64:65], 0
    v_mfma_f32_16x16x16_bf16 v[84:87], a[138:139], v[64:65], 0
    v_mfma_f32_16x16x32_bf16 v[80:83], a[134:137], v[66:69], v[80:83]
    v_mfma_f32_16x16x32_bf16 v[84:87], a[140:143], v[66:69], v[84:87]
    v_cvt_pk_bf16_f32 v164, v128, v129
    v_cvt_pk_bf16_f32 v165, v130, v131
    v_cvt_pk_bf16_f32 v166, v132, v133
    v_cvt_pk_bf16_f32 v167, v134, v135
    buffer_store_dwordx4 v[164:167], v2, s[4:7], s49 offen offset:3072 sc1
    v_mfma_f32_16x16x16_bf16 v[88:91], a[144:145], v[64:65], 0
    v_mfma_f32_16x16x16_bf16 v[92:95], a[150:151], v[64:65], 0
    v_mfma_f32_16x16x32_bf16 v[88:91], a[146:149], v[66:69], v[88:91]
    v_mfma_f32_16x16x32_bf16 v[92:95], a[152:155], v[66:69], v[92:95]
    v_cvt_pk_bf16_f32 v168, v72, v73
    v_cvt_pk_bf16_f32 v169, v74, v75
    v_cvt_pk_bf16_f32 v170, v76, v77
    v_cvt_pk_bf16_f32 v171, v78, v79
    buffer_store_dwordx4 v[168:171], v2, s[4:7], s50 offen offset:0 sc1
    v_mfma_f32_16x16x16_bf16 v[96:99], a[156:157], v[64:65], 0
    v_mfma_f32_16x16x16_bf16 v[100:103], a[162:163], v[64:65], 0
    v_mfma_f32_16x16x32_bf16 v[96:99], a[158:161], v[66:69], v[96:99]
    v_mfma_f32_16x16x32_bf16 v[100:103], a[164:167], v[66:69], v[100:103]
    v_cvt_pk_bf16_f32 v172, v80, v81
    v_cvt_pk_bf16_f32 v173, v82, v83
    v_cvt_pk_bf16_f32 v174, v84, v85
    v_cvt_pk_bf16_f32 v175, v86, v87
    buffer_store_dwordx4 v[172:175], v2, s[4:7], s50 offen offset:1024 sc1
    v_cvt_pk_bf16_f32 v176, v88, v89
    v_cvt_pk_bf16_f32 v177, v90, v91
    v_cvt_pk_bf16_f32 v178, v92, v93
    v_cvt_pk_bf16_f32 v179, v94, v95
    buffer_store_dwordx4 v[176:179], v2, s[4:7], s50 offen offset:2048 sc1
    v_cvt_pk_bf16_f32 v180, v96, v97
    v_cvt_pk_bf16_f32 v181, v98, v99
    v_cvt_pk_bf16_f32 v182, v100, v101
    v_cvt_pk_bf16_f32 v183, v102, v103
    buffer_store_dwordx4 v[180:183], v2, s[4:7], s50 offen offset:3072 sc1
    s_lshl_b32 s50, s30, 3
    s_add_u32 s50, s50, s20
    s_lshl_b32 s50, s50, 6
    s_add_u32 s50, s50, 139264
    s_waitcnt vmcnt(0)
    s_mov_b64 exec, 1
    buffer_store_dword v252, v254, s[4:7], s50 offen sc1
    s_mov_b64 exec, -1
    s_add_u32 s30, s30, 2
    s_cmp_lt_u32 s30, 64
    s_cbranch_scc1 Lat_170
    s_endpgm
L_xw:
    s_sub_u32 s24, s21, 22
    s_mov_b32 s8, s66
    s_and_b32 s9, s67, 0xffff
    s_mov_b32 s10, 0x780000
    s_mov_b32 s11, 0x00020000
    s_mul_i32 s28, s20, 983040
    s_lshl_b32 s29, s24, 8
    s_add_u32 s28, s28, s29
    s_add_u32 s29, s28, 128
    v_lshlrev_b32 v253, 2, v1
    s_lshl_b32 s38, s20, 8
    s_add_u32 s38, s38, 4096
    v_lshrrev_b32 v4, 3, v1
    v_bfe_u32 v5, v1, 4, 2
    v_lshlrev_b32 v5, 1, v5
    v_and_b32 v6, 7, v1
    v_xor_b32 v6, v6, v5
    s_mov_b32 s54, 1280
    v_mul_lo_u32 v3, s54, v4
    v_lshl_add_u32 v3, v6, 4, v3
    v_lshrrev_b32 v4, 4, v1
    v_bfe_u32 v5, v1, 2, 2
    v_lshl_add_u32 v6, v4, 2, v5
    v_bfe_u32 v4, v6, 1, 2
    v_xor_b32 v4, s22, v4
    v_lshlrev_b32 v6, 7, v6
    v_lshl_add_u32 v6, v4, 5, v6
    v_and_b32 v4, 3, v1
    v_lshl_add_u32 v4, v4, 3, v6
    v_add_u32 v6, 65536, v4
    v_add_u32 v5, 32768, v4
    s_mul_i32 s55, s22, 10240
    s_lshl_b32 s56, s22, 10
    s_add_u32 s57, s28, s55
    s_add_u32 m0, s56, 0
    s_nop 0
    buffer_load_dwordx4 v3, s[8:11], s57 offen nt lds
    s_add_u32 s57, s57, 40960
    s_add_u32 m0, s56, 4096
    s_nop 0
    buffer_load_dwordx4 v3, s[8:11], s57 offen nt lds
    s_add_u32 s57, s57, 40960
    s_add_u32 m0, s56, 8192
    s_nop 0
    buffer_load_dwordx4 v3, s[8:11], s57 offen nt lds
    s_add_u32 s57, s57, 40960
    s_add_u32 m0, s56, 12288
    s_nop 0
    buffer_load_dwordx4 v3, s[8:11], s57 offen nt lds
    s_add_u32 s57, s57, 40960
    s_add_u32 m0, s56, 16384
    s_nop 0
    buffer_load_dwordx4 v3, s[8:11], s57 offen nt lds
    s_add_u32 s57, s57, 40960
    s_add_u32 m0, s56, 20480
    s_nop 0
    buffer_load_dwordx4 v3, s[8:11], s57 offen nt lds
    s_add_u32 s57, s57, 40960
    s_add_u32 m0, s56, 24576
    s_nop 0
    buffer_load_dwordx4 v3, s[8:11], s57 offen nt lds
    s_add_u32 s57, s57, 40960
    s_add_u32 m0, s56, 28672
    s_nop 0
    buffer_load_dwordx4 v3, s[8:11], s57 offen nt lds
    s_add_u32 s57, s28, s55
    s_add_u32 s57, s57, 327680
    s_add_u32 m0, s56, 32768
    s_nop 0
    buffer_load_dwordx4 v3, s[8:11], s57 offen nt lds
    s_add_u32 s57, s57, 40960
    s_add_u32 m0, s56, 36864
    s_nop 0
    buffer_load_dwordx4 v3, s[8:11], s57 offen nt lds
    s_add_u32 s57, s57, 40960
    s_add_u32 m0, s56, 40960
    s_nop 0
    buffer_load_dwordx4 v3, s[8:11], s57 offen nt lds
    s_add_u32 s57, s57, 40960
    s_add_u32 m0, s56, 45056
    s_nop 0
    buffer_load_dwordx4 v3, s[8:11], s57 offen nt lds
    s_add_u32 s57, s57, 40960
    s_add_u32 m0, s56, 49152
    s_nop 0
    buffer_load_dwordx4 v3, s[8:11], s57 offen nt lds
    s_add_u32 s57, s57, 40960
    s_add_u32 m0, s56, 53248
    s_nop 0
    buffer_load_dwordx4 v3, s[8:11], s57 offen nt lds
    s_add_u32 s57, s57, 40960
    s_add_u32 m0, s56, 57344
    s_nop 0
    buffer_load_dwordx4 v3, s[8:11], s57 offen nt lds
    s_add_u32 s57, s57, 40960
    s_add_u32 m0, s56, 61440
    s_nop 0
    buffer_load_dwordx4 v3, s[8:11], s57 offen nt lds
    s_add_u32 s57, s28, s55
    s_add_u32 s57, s57, 655360
    s_add_u32 m0, s56, 65536
    s_nop 0
    buffer_load_dwordx4 v3, s[8:11], s57 offen nt lds
    s_add_u32 s57, s57, 40960
    s_add_u32 m0, s56, 69632
    s_nop 0
    buffer_load_dwordx4 v3, s[8:11], s57 offen nt lds
    s_add_u32 s57, s57, 40960
    s_add_u32 m0, s56, 73728
    s_nop 0
    buffer_load_dwordx4 v3, s[8:11], s57 offen nt lds
    s_add_u32 s57, s57, 40960
    s_add_u32 m0, s56, 77824
    s_nop 0
    buffer_load_dwordx4 v3, s[8:11], s57 offen nt lds
    s_add_u32 s57, s57, 40960
    s_add_u32 m0, s56, 81920
    s_nop 0
    buffer_load_dwordx4 v3, s[8:11], s57 offen nt lds
    s_add_u32 s57, s57, 40960
    s_add_u32 m0, s56, 86016
    s_nop 0
    buffer_load_dwordx4 v3, s[8:11], s57 offen nt lds
    s_add_u32 s57, s57, 40960
    s_add_u32 m0, s56, 90112
    s_nop 0
    buffer_load_dwordx4 v3, s[8:11], s57 offen nt lds
    s_add_u32 s57, s57, 40960
    s_add_u32 m0, s56, 94208
    s_nop 0
    buffer_load_dwordx4 v3, s[8:11], s57 offen nt lds
    s_waitcnt vmcnt(16)
    s_barrier
    ds_read_b64_tr_b16 a[0:1], v4 offset:0
    ds_read_b64_tr_b16 a[2:3], v4 offset:2048
    ds_read_b64_tr_b16 a[4:5], v4 offset:4096
    ds_read_b64_tr_b16 a[6:7], v4 offset:6144
    ds_read_b64_tr_b16 a[8:9], v4 offset:8192
    ds_read_b64_tr_b16 a[10:11], v4 offset:10240
    ds_read_b64_tr_b16 a[12:13], v4 offset:12288
    ds_read_b64_tr_b16 a[14:15], v4 offset:14336
    ds_read_b64_tr_b16 a[16:17], v4 offset:16384
    ds_read_b64_tr_b16 a[18:19], v4 offset:18432
    ds_read_b64_tr_b16 a[20:21], v4 offset:20480
    ds_read_b64_tr_b16 a[22:23], v4 offset:22528
    ds_read_b64_tr_b16 a[24:25], v4 offset:24576
    ds_read_b64_tr_b16 a[26:27], v4 offset:26624
    ds_read_b64_tr_b16 a[28:29], v4 offset:28672
    ds_read_b64_tr_b16 a[30:31], v4 offset:30720
    s_waitcnt lgkmcnt(0)
    s_barrier
    s_add_u32 s57, s29, s55
    s_add_u32 m0, s56, 0
    s_nop 0
    buffer_load_dwordx4 v3, s[8:11], s57 offen nt lds
    s_add_u32 s57, s57, 40960
    s_add_u32 m0, s56, 4096
    s_nop 0
    buffer_load_dwordx4 v3, s[8:11], s57 offen nt lds
    s_add_u32 s57, s57, 40960
    s_add_u32 m0, s56, 8192
    s_nop 0
    buffer_load_dwordx4 v3, s[8:11], s57 offen nt lds
    s_add_u32 s57, s57, 40960
    s_add_u32 m0, s56, 12288
    s_nop 0
    buffer_load_dwordx4 v3, s[8:11], s57 offen nt lds
    s_add_u32 s57, s57, 40960
    s_add_u32 m0, s56, 16384
    s_nop 0
    buffer_load_dwordx4 v3, s[8:11], s57 offen nt lds
    s_add_u32 s57, s57, 40960
    s_add_u32 m0, s56, 20480
    s_nop 0
    buffer_load_dwordx4 v3, s[8:11], s57 offen nt lds
    s_add_u32 s57, s57, 40960
    s_add_u32 m0, s56, 24576
    s_nop 0
    buffer_load_dwordx4 v3, s[8:11], s57 offen nt lds
    s_add_u32 s57, s57, 40960
    s_add_u32 m0, s56, 28672
    s_nop 0
    buffer_load_dwordx4 v3, s[8:11], s57 offen nt lds
    s_waitcnt vmcnt(16)
    s_barrier
    ds_read_b64_tr_b16 a[32:33], v5 offset:0
    ds_read_b64_tr_b16 a[34:35], v5 offset:2048
    ds_read_b64_tr_b16 a[36:37], v5 offset:4096
    ds_read_b64_tr_b16 a[38:39], v5 offset:6144
    ds_read_b64_tr_b16 a[40:41], v5 offset:8192
    ds_read_b64_tr_b16 a[42:43], v5 offset:10240
    ds_read_b64_tr_b16 a[44:45], v5 offset:12288
    ds_read_b64_tr_b16 a[46:47], v5 offset:14336
    ds_read_b64_tr_b16 a[48:49], v5 offset:16384
    ds_read_b64_tr_b16 a[50:51], v5 offset:18432
    ds_read_b64_tr_b16 a[52:53], v5 offset:20480
    ds_read_b64_tr_b16 a[54:55], v5 offset:22528
    ds_read_b64_tr_b16 a[56:57], v5 offset:24576
    ds_read_b64_tr_b16 a[58:59], v5 offset:26624
    ds_read_b64_tr_b16 a[60:61], v5 offset:28672
    ds_read_b64_tr_b16 a[62:63], v5 offset:30720
    s_waitcnt lgkmcnt(0)
    s_barrier
    s_add_u32 s57, s29, s55
    s_add_u32 s57, s57, 327680
    s_add_u32 m0, s56, 32768
    s_nop 0
    buffer_load_dwordx4 v3, s[8:11], s57 offen nt lds
    s_add_u32 s57, s57, 40960
    s_add_u32 m0, s56, 36864
    s_nop 0
    buffer_load_dwordx4 v3, s[8:11], s57 offen nt lds
    s_add_u32 s57, s57, 40960
    s_add_u32 m0, s56, 40960
    s_nop 0
    buffer_load_dwordx4 v3, s[8:11], s57 offen nt lds
    s_add_u32 s57, s57, 40960
    s_add_u32 m0, s56, 45056
    s_nop 0
    buffer_load_dwordx4 v3, s[8:11], s57 offen nt lds
    s_add_u32 s57, s57, 40960
    s_add_u32 m0, s56, 49152
    s_nop 0
    buffer_load_dwordx4 v3, s[8:11], s57 offen nt lds
    s_add_u32 s57, s57, 40960
    s_add_u32 m0, s56, 53248
    s_nop 0
    buffer_load_dwordx4 v3, s[8:11], s57 offen nt lds
    s_add_u32 s57, s57, 40960
    s_add_u32 m0, s56, 57344
    s_nop 0
    buffer_load_dwordx4 v3, s[8:11], s57 offen nt lds
    s_add_u32 s57, s57, 40960
    s_add_u32 m0, s56, 61440
    s_nop 0
    buffer_load_dwordx4 v3, s[8:11], s57 offen nt lds
    s_waitcnt vmcnt(16)
    s_barrier
    ds_read_b64_tr_b16 a[64:65], v6 offset:0
    ds_read_b64_tr_b16 a[66:67], v6 offset:2048
    ds_read_b64_tr_b16 a[68:69], v6 offset:4096
    ds_read_b64_tr_b16 a[70:71], v6 offset:6144
    ds_read_b64_tr_b16 a[72:73], v6 offset:8192
    ds_read_b64_tr_b16 a[74:75], v6 offset:10240
    ds_read_b64_tr_b16 a[76:77], v6 offset:12288
    ds_read_b64_tr_b16 a[78:79], v6 offset:14336
    ds_read_b64_tr_b16 a[80:81], v6 offset:16384
    ds_read_b64_tr_b16 a[82:83], v6 offset:18432
    ds_read_b64_tr_b16 a[84:85], v6 offset:20480
    ds_read_b64_tr_b16 a[86:87], v6 offset:22528
    ds_read_b64_tr_b16 a[88:89], v6 offset:24576
    ds_read_b64_tr_b16 a[90:91], v6 offset:26624
    ds_read_b64_tr_b16 a[92:93], v6 offset:28672
    ds_read_b64_tr_b16 a[94:95], v6 offset:30720
    s_waitcnt lgkmcnt(0)
    s_barrier
    s_add_u32 s57, s29, s55
    s_add_u32 s57, s57, 655360
    s_add_u32 m0, s56, 65536
    s_nop 0
    buffer_load_dwordx4 v3, s[8:11], s57 offen nt lds
    s_add_u32 s57, s57, 40960
    s_add_u32 m0, s56, 69632
    s_nop 0
    buffer_load_dwordx4 v3, s[8:11], s57 offen nt lds
    s_add_u32 s57, s57, 40960
    s_add_u32 m0, s56, 73728
    s_nop 0
    buffer_load_dwordx4 v3, s[8:11], s57 offen nt lds
    s_add_u32 s57, s57, 40960
    s_add_u32 m0, s56, 77824
    s_nop 0
    buffer_load_dwordx4 v3, s[8:11], s57 offen nt lds
    s_add_u32 s57, s57, 40960
    s_add_u32 m0, s56, 81920
    s_nop 0
    buffer_load_dwordx4 v3, s[8:11], s57 offen nt lds
    s_add_u32 s57, s57, 40960
    s_add_u32 m0, s56, 86016
    s_nop 0
    buffer_load_dwordx4 v3, s[8:11], s57 offen nt lds
    s_add_u32 s57, s57, 40960
    s_add_u32 m0, s56, 90112
    s_nop 0
    buffer_load_dwordx4 v3, s[8:11], s57 offen nt lds
    s_add_u32 s57, s57, 40960
    s_add_u32 m0, s56, 94208
    s_nop 0
    buffer_load_dwordx4 v3, s[8:11], s57 offen nt lds
    s_waitcnt vmcnt(16)
    s_barrier
    ds_read_b64_tr_b16 a[96:97], v4 offset:0
    ds_read_b64_tr_b16 a[98:99], v4 offset:2048
    ds_read_b64_tr_b16 a[100:101], v4 offset:4096
    ds_read_b64_tr_b16 a[102:103], v4 offset:6144
    ds_read_b64_tr_b16 a[104:105], v4 offset:8192
    ds_read_b64_tr_b16 a[106:107], v4 offset:10240
    ds_read_b64_tr_b16 a[108:109], v4 offset:12288
    ds_read_b64_tr_b16 a[110:111], v4 offset:14336
    ds_read_b64_tr_b16 a[112:113], v4 offset:16384
    ds_read_b64_tr_b16 a[114:115], v4 offset:18432
    ds_read_b64_tr_b16 a[116:117], v4 offset:20480
    ds_read_b64_tr_b16 a[118:119], v4 offset:22528
    ds_read_b64_tr_b16 a[120:121], v4 offset:24576
    ds_read_b64_tr_b16 a[122:123], v4 offset:26624
    ds_read_b64_tr_b16 a[124:125], v4 offset:28672
    ds_read_b64_tr_b16 a[126:127], v4 offset:30720
    s_waitcnt lgkmcnt(0)
    s_barrier
    s_waitcnt vmcnt(8)
    s_barrier
    ds_read_b64_tr_b16 a[128:129], v5 offset:0
    ds_read_b64_tr_b16 a[130:131], v5 offset:2048
    ds_read_b64_tr_b16 a[132:133], v5 offset:4096
    ds_read_b64_tr_b16 a[134:135], v5 offset:6144
    ds_read_b64_tr_b16 a[136:137], v5 offset:8192
    ds_read_b64_tr_b16 a[138:139], v5 offset:10240
    ds_read_b64_tr_b16 a[140:141], v5 offset:12288
    ds_read_b64_tr_b16 a[142:143], v5 offset:14336
    ds_read_b64_tr_b16 a[144:145], v5 offset:16384
    ds_read_b64_tr_b16 a[146:147], v5 offset:18432
    ds_read_b64_tr_b16 a[148:149], v5 offset:20480
    ds_read_b64_tr_b16 a[150:151], v5 offset:22528
    ds_read_b64_tr_b16 a[152:153], v5 offset:24576
    ds_read_b64_tr_b16 a[154:155], v5 offset:26624
    ds_read_b64_tr_b16 a[156:157], v5 offset:28672
    ds_read_b64_tr_b16 a[158:159], v5 offset:30720
    s_waitcnt lgkmcnt(0)
    s_barrier
    s_waitcnt vmcnt(0)
    s_barrier
    ds_read_b64_tr_b16 a[160:161], v6 offset:0
    ds_read_b64_tr_b16 a[162:163], v6 offset:2048
    ds_read_b64_tr_b16 a[164:165], v6 offset:4096
    ds_read_b64_tr_b16 a[166:167], v6 offset:6144
    ds_read_b64_tr_b16 a[168:169], v6 offset:8192
    ds_read_b64_tr_b16 a[170:171], v6 offset:10240
    ds_read_b64_tr_b16 a[172:173], v6 offset:12288
    ds_read_b64_tr_b16 a[174:175], v6 offset:14336
    ds_read_b64_tr_b16 a[176:177], v6 offset:16384
    ds_read_b64_tr_b16 a[178:179], v6 offset:18432
    ds_read_b64_tr_b16 a[180:181], v6 offset:20480
    ds_read_b64_tr_b16 a[182:183], v6 offset:22528
    ds_read_b64_tr_b16 a[184:185], v6 offset:24576
    ds_read_b64_tr_b16 a[186:187], v6 offset:26624
    ds_read_b64_tr_b16 a[188:189], v6 offset:28672
    ds_read_b64_tr_b16 a[190:191], v6 offset:30720
    s_waitcnt lgkmcnt(0)
    s_barrier
    v_lshlrev_b32 v253, 2, v1
    s_lshl_b32 s38, s20, 2
    s_add_u32 s38, s38, s22
    s_lshl_b32 s39, s38, 2
    v_lshlrev_b32 v3, 7, v1
    v_add_u32 v3, s39, v3
    v_mov_b32 v252, 1
    s_mul_i32 s62, s22, 12288
    s_mul_i32 s63, s38, 12288
    s_add_u32 s63, s63, 92274688
    s_mul_i32 s64, s20, 40960
    s_lshl_b32 s65, s24, 2
    s_add_u32 s65, s65, s22
    s_lshl_b32 s65, s65, 10
    s_add_u32 s64, s64, s65
    s_add_u32 s64, s64, 142606336
    s_lshl_b32 s66, s24, 8
    s_add_u32 s66, s66, 172032
    s_lshl_b32 s40, s20, 2
    s_add_u32 s40, s40, s22
    v_min_u32 v17, 23, v1
    v_lshlrev_b32 v17, 7, v17
    v_min_u32 v18, 31, v1
    v_lshlrev_b32 v18, 7, v18
    v_min_u32 v19, 47, v1
    v_lshlrev_b32 v19, 7, v19
    v_min_u32 v20, 63, v1
    v_lshlrev_b32 v20, 7, v20
    s_cmp_lg_u32 s24, 0
    s_cbranch_scc1 Ltj_178
    s_mul_i32 s38, s40, 12288
    s_add_u32 s38, s38, 42729472
    buffer_load_dword v16, v20, s[4:7], s38 offen sc1
    s_mul_i32 s38, s40, 12288
    s_add_u32 s38, s38, 17571840
    buffer_load_dword v16, v18, s[4:7], s38 offen sc1
    s_mul_i32 s38, s40, 12288
    s_add_u32 s38, s38, 43122688
    buffer_load_dword v16, v20, s[4:7], s38 offen sc1
    s_mul_i32 s38, s40, 12288
    s_add_u32 s38, s38, 17965056
    buffer_load_dword v16, v18, s[4:7], s38 offen sc1
    s_mul_i32 s38, s40, 12288
    s_add_u32 s38, s38, 43515904
    buffer_load_dword v16, v20, s[4:7], s38 offen sc1
    s_mul_i32 s38, s40, 12288
    s_add_u32 s38, s38, 18358272
    buffer_load_dword v16, v18, s[4:7], s38 offen sc1
    s_mul_i32 s38, s40, 12288
    s_add_u32 s38, s38, 43909120
    buffer_load_dword v16, v20, s[4:7], s38 offen sc1
    s_mul_i32 s38, s40, 12288
    s_add_u32 s38, s38, 18751488
    buffer_load_dword v16, v18, s[4:7], s38 offen sc1
    s_mul_i32 s38, s40, 12288
    s_add_u32 s38, s38, 44302336
    buffer_load_dword v16, v20, s[4:7], s38 offen sc1
    s_mul_i32 s38, s40, 12288
    s_add_u32 s38, s38, 19144704
    buffer_load_dword v16, v18, s[4:7], s38 offen sc1
    s_mul_i32 s38, s40, 12288
    s_add_u32 s38, s38, 44695552
    buffer_load_dword v16, v20, s[4:7], s38 offen sc1
    s_mul_i32 s38, s40, 12288
    s_add_u32 s38, s38, 19537920
    buffer_load_dword v16, v18, s[4:7], s38 offen sc1
    s_mul_i32 s38, s40, 12288
    s_add_u32 s38, s38, 94633984
    buffer_load_dword v16, v20, s[4:7], s38 offen sc1
Ltj_178:
    s_cmp_lg_u32 s24, 1
    s_cbranch_scc1 Ltj_179
    s_mul_i32 s38, s40, 12288
    s_add_u32 s38, s38, 42737664
    buffer_load_dword v16, v18, s[4:7], s38 offen sc1
    s_mul_i32 s38, s40, 6144
    s_add_u32 s38, s38, 117833728
    buffer_load_dword v16, v19, s[4:7], s38 offen sc1
    s_mul_i32 s38, s40, 12288
    s_add_u32 s38, s38, 43130880
    buffer_load_dword v16, v18, s[4:7], s38 offen sc1
    s_mul_i32 s38, s40, 6144
    s_add_u32 s38, s38, 118030336
    buffer_load_dword v16, v19, s[4:7], s38 offen sc1
    s_mul_i32 s38, s40, 12288
    s_add_u32 s38, s38, 43524096
    buffer_load_dword v16, v18, s[4:7], s38 offen sc1
    s_mul_i32 s38, s40, 6144
    s_add_u32 s38, s38, 118226944
    buffer_load_dword v16, v19, s[4:7], s38 offen sc1
    s_mul_i32 s38, s40, 12288
    s_add_u32 s38, s38, 43917312
    buffer_load_dword v16, v18, s[4:7], s38 offen sc1
    s_mul_i32 s38, s40, 6144
    s_add_u32 s38, s38, 118423552
    buffer_load_dword v16, v19, s[4:7], s38 offen sc1
    s_mul_i32 s38, s40, 12288
    s_add_u32 s38, s38, 44310528
    buffer_load_dword v16, v18, s[4:7], s38 offen sc1
    s_mul_i32 s38, s40, 6144
    s_add_u32 s38, s38, 118620160
    buffer_load_dword v16, v19, s[4:7], s38 offen sc1
    s_mul_i32 s38, s40, 12288
    s_add_u32 s38, s38, 44703744
    buffer_load_dword v16, v18, s[4:7], s38 offen sc1
    s_mul_i32 s38, s40, 6144
    s_add_u32 s38, s38, 118816768
    buffer_load_dword v16, v19, s[4:7], s38 offen sc1
    s_mul_i32 s38, s40, 12288
    s_add_u32 s38, s38, 94642176
    buffer_load_dword v16, v18, s[4:7], s38 offen sc1
Ltj_179:
    s_cmp_lg_u32 s24, 2
    s_cbranch_scc1 Ltj_180
    s_mul_i32 s38, s40, 12288
    s_add_u32 s38, s38, 67895296
    buffer_load_dword v16, v20, s[4:7], s38 offen sc1
    s_mul_i32 s38, s40, 3072
    s_add_u32 s38, s38, 130220032
    buffer_load_dword v16, v17, s[4:7], s38 offen sc1
    s_mul_i32 s38, s40, 12288
    s_add_u32 s38, s38, 68288512
    buffer_load_dword v16, v20, s[4:7], s38 offen sc1
    s_mul_i32 s38, s40, 3072
    s_add_u32 s38, s38, 130318336
    buffer_load_dword v16, v17, s[4:7], s38 offen sc1
    s_mul_i32 s38, s40, 12288
    s_add_u32 s38, s38, 68681728
    buffer_load_dword v16, v20, s[4:7], s38 offen sc1
    s_mul_i32 s38, s40, 3072
    s_add_u32 s38, s38, 130416640
    buffer_load_dword v16, v17, s[4:7], s38 offen sc1
    s_mul_i32 s38, s40, 12288
    s_add_u32 s38, s38, 69074944
    buffer_load_dword v16, v20, s[4:7], s38 offen sc1
    s_mul_i32 s38, s40, 3072
    s_add_u32 s38, s38, 130514944
    buffer_load_dword v16, v17, s[4:7], s38 offen sc1
    s_mul_i32 s38, s40, 12288
    s_add_u32 s38, s38, 69468160
    buffer_load_dword v16, v20, s[4:7], s38 offen sc1
    s_mul_i32 s38, s40, 3072
    s_add_u32 s38, s38, 130613248
    buffer_load_dword v16, v17, s[4:7], s38 offen sc1
    s_mul_i32 s38, s40, 12288
    s_add_u32 s38, s38, 69861376
    buffer_load_dword v16, v20, s[4:7], s38 offen sc1
    s_mul_i32 s38, s40, 3072
    s_add_u32 s38, s38, 130711552
    buffer_load_dword v16, v17, s[4:7], s38 offen sc1
    s_mul_i32 s38, s40, 12288
    s_add_u32 s38, s38, 95027200
    buffer_load_dword v16, v20, s[4:7], s38 offen sc1
Ltj_180:
    s_cmp_lg_u32 s24, 3
    s_cbranch_scc1 Ltj_181
    s_mul_i32 s38, s40, 12288
    s_add_u32 s38, s38, 67903488
    buffer_load_dword v16, v18, s[4:7], s38 offen sc1
    s_mul_i32 s38, s40, 12288
    s_add_u32 s38, s38, 92274688
    buffer_load_dword v16, v20, s[4:7], s38 offen sc1
    s_mul_i32 s38, s40, 12288
    s_add_u32 s38, s38, 68296704
    buffer_load_dword v16, v18, s[4:7], s38 offen sc1
    s_mul_i32 s38, s40, 12288
    s_add_u32 s38, s38, 92667904
    buffer_load_dword v16, v20, s[4:7], s38 offen sc1
    s_mul_i32 s38, s40, 12288
    s_add_u32 s38, s38, 68689920
    buffer_load_dword v16, v18, s[4:7], s38 offen sc1
    s_mul_i32 s38, s40, 12288
    s_add_u32 s38, s38, 93061120
    buffer_load_dword v16, v20, s[4:7], s38 offen sc1
    s_mul_i32 s38, s40, 12288
    s_add_u32 s38, s38, 69083136
    buffer_load_dword v16, v18, s[4:7], s38 offen sc1
    s_mul_i32 s38, s40, 12288
    s_add_u32 s38, s38, 93454336
    buffer_load_dword v16, v20, s[4:7], s38 offen sc1
    s_mul_i32 s38, s40, 12288
    s_add_u32 s38, s38, 69476352
    buffer_load_dword v16, v18, s[4:7], s38 offen sc1
    s_mul_i32 s38, s40, 12288
    s_add_u32 s38, s38, 93847552
    buffer_load_dword v16, v20, s[4:7], s38 offen sc1
    s_mul_i32 s38, s40, 12288
    s_add_u32 s38, s38, 69869568
    buffer_load_dword v16, v18, s[4:7], s38 offen sc1
    s_mul_i32 s38, s40, 12288
    s_add_u32 s38, s38, 94240768
    buffer_load_dword v16, v20, s[4:7], s38 offen sc1
    s_mul_i32 s38, s40, 12288
    s_add_u32 s38, s38, 95035392
    buffer_load_dword v16, v18, s[4:7], s38 offen sc1
Ltj_181:
    s_cmp_lg_u32 s24, 4
    s_cbranch_scc1 Ltj_182
    s_mul_i32 s38, s40, 12288
    s_add_u32 s38, s38, 17563648
    buffer_load_dword v16, v20, s[4:7], s38 offen sc1
    s_mul_i32 s38, s40, 12288
    s_add_u32 s38, s38, 92282880
    buffer_load_dword v16, v18, s[4:7], s38 offen sc1
    s_mul_i32 s38, s40, 12288
    s_add_u32 s38, s38, 17956864
    buffer_load_dword v16, v20, s[4:7], s38 offen sc1
    s_mul_i32 s38, s40, 12288
    s_add_u32 s38, s38, 92676096
    buffer_load_dword v16, v18, s[4:7], s38 offen sc1
    s_mul_i32 s38, s40, 12288
    s_add_u32 s38, s38, 18350080
    buffer_load_dword v16, v20, s[4:7], s38 offen sc1
    s_mul_i32 s38, s40, 12288
    s_add_u32 s38, s38, 93069312
    buffer_load_dword v16, v18, s[4:7], s38 offen sc1
    s_mul_i32 s38, s40, 12288
    s_add_u32 s38, s38, 18743296
    buffer_load_dword v16, v20, s[4:7], s38 offen sc1
    s_mul_i32 s38, s40, 12288
    s_add_u32 s38, s38, 93462528
    buffer_load_dword v16, v18, s[4:7], s38 offen sc1
    s_mul_i32 s38, s40, 12288
    s_add_u32 s38, s38, 19136512
    buffer_load_dword v16, v20, s[4:7], s38 offen sc1
    s_mul_i32 s38, s40, 12288
    s_add_u32 s38, s38, 93855744
    buffer_load_dword v16, v18, s[4:7], s38 offen sc1
    s_mul_i32 s38, s40, 12288
    s_add_u32 s38, s38, 19529728
    buffer_load_dword v16, v20, s[4:7], s38 offen sc1
    s_mul_i32 s38, s40, 12288
    s_add_u32 s38, s38, 94248960
    buffer_load_dword v16, v18, s[4:7], s38 offen sc1
Ltj_182:
    s_mov_b32 s31, 262144
    v_lshlrev_b32 v162, 2, v1
    s_mov_b32 exec_hi, 0
Lwr_183:
    global_load_dword v160, v162, s[74:75] offset:128 sc1
    s_mov_b32 s23, 0
    s_mov_b32 s38, 0
    s_waitcnt vmcnt(0)
    v_cmp_eq_u32 vcc, 0x20, v160
    s_nop 0
    s_or_b32 s38, s38, vcc_lo
    v_cmp_eq_u32 vcc, 0x2000, v160
    s_nop 0
    s_or_b32 s38, s38, vcc_lo
    v_cmp_eq_u32 vcc, 0x200000, v160
    s_nop 0
    s_or_b32 s38, s38, vcc_lo
    v_cmp_eq_u32 vcc, 0x20000000, v160
    s_nop 0
    s_or_b32 s38, s38, vcc_lo
    v_sad_u8 v161, v160, 0, 0
    s_bcnt1_i32_b32 s38, s38
    s_cmp_eq_u32 s38, 8
    s_cbranch_scc1 Lwd_184
    v_add_u32_dpp v161, v161, v161 row_shr:1 row_mask:0xf bank_mask:0xf bound_ctrl:0
    s_nop 1
    v_add_u32_dpp v161, v161, v161 row_shr:2 row_mask:0xf bank_mask:0xf bound_ctrl:0
    s_nop 1
    v_add_u32_dpp v161, v161, v161 row_shr:4 row_mask:0xf bank_mask:0xf bound_ctrl:0
    s_nop 1
    v_add_u32_dpp v161, v161, v161 row_shr:8 row_mask:0xf bank_mask:0xf bound_ctrl:0
    s_nop 0
    v_readlane_b32 s38, v161, 15
    v_readlane_b32 s39, v161, 31
    s_mov_b32 s23, 1
    s_add_u32 s38, s38, s39
    s_cmp_eq_u32 s38, 256
    s_cbranch_scc1 Lwd_184
    s_sleep 4
    s_sub_u32 s31, s31, 1
    s_cbranch_scc0 Lwr_183
    s_mov_b32 s31, 10
    s_branch L_fail
Lwd_184:
    s_mov_b64 exec, -1
    s_lshl_b32 s67, s20, 6
    s_lshl_b32 s38, s22, 2
    s_add_u32 s67, s67, s38
    s_add_u32 s67, s67, 139264
    s_lshl_b32 s38, s20, 5
    s_add_u32 s38, s38, s24
    s_lshl_b32 s38, s38, 2
    v_mov_b32 v6, s38
    v_mov_b32 v4, 0
    v_mov_b32 v5, v2
    s_mov_b32 s30, 0
    s_mov_b32 s31, 262144
    s_mov_b32 exec_lo, 0x1
    s_mov_b32 exec_hi, 0
Lf_190:
    buffer_load_dword v160, v4, s[4:7], s67 offen sc1
    s_waitcnt vmcnt(0)
    v_cmp_eq_u32 vcc, 0, v160
    s_cbranch_vccz Lfd_191
    s_sleep 2
    s_sub_u32 s31, s31, 1
    s_cbranch_scc0 Lf_190
    s_mov_b32 s31, 5
    s_branch L_fail
Lfd_191:
    s_mov_b64 exec, -1
    s_and_b32 s55, s30, 7
    s_mul_i32 s55, s55, 393216
    s_add_u32 s55, s55, s63
    s_and_b32 s56, s30, 1
    s_mul_i32 s56, s56, 49152
    s_add_u32 s56, s56, s62
    s_add_u32 m0, s56, 0
    s_nop 0
    buffer_load_dwordx4 v2, s[4:7], s55 offen sc1 lds
    s_add_u32 s55, s55, 1024
    s_add_u32 m0, s56, 1024
    s_nop 0
    buffer_load_dwordx4 v2, s[4:7], s55 offen sc1 lds
    s_add_u32 s55, s55, 1024
    s_add_u32 m0, s56, 2048
    s_nop 0
    buffer_load_dwordx4 v2, s[4:7], s55 offen sc1 lds
    s_add_u32 s55, s55, 1024
    s_add_u32 m0, s56, 3072
    s_nop 0
    buffer_load_dwordx4 v2, s[4:7], s55 offen sc1 lds
    s_add_u32 s55, s55, 1024
    s_add_u32 m0, s56, 4096
    s_nop 0
    buffer_load_dwordx4 v2, s[4:7], s55 offen sc1 lds
    s_add_u32 s55, s55, 1024
    s_add_u32 m0, s56, 5120
    s_nop 0
    buffer_load_dwordx4 v2, s[4:7], s55 offen sc1 lds
    s_add_u32 s55, s55, 1024
    s_add_u32 m0, s56, 6144
    s_nop 0
    buffer_load_dwordx4 v2, s[4:7], s55 offen sc1 lds
    s_add_u32 s55, s55, 1024
    s_add_u32 m0, s56, 7168
    s_nop 0
    buffer_load_dwordx4 v2, s[4:7], s55 offen sc1 lds
    s_add_u32 s55, s55, 1024
    s_add_u32 m0, s56, 8192
    s_nop 0
    buffer_load_dwordx4 v2, s[4:7], s55 offen sc1 lds
    s_add_u32 s55, s55, 1024
    s_add_u32 m0, s56, 9216
    s_nop 0
    buffer_load_dwordx4 v2, s[4:7], s55 offen sc1 lds
    s_add_u32 s55, s55, 1024
    s_add_u32 m0, s56, 10240
    s_nop 0
    buffer_load_dwordx4 v2, s[4:7], s55 offen sc1 lds
    s_add_u32 s55, s55, 1024
    s_add_u32 m0, s56, 11264
    s_nop 0
    buffer_load_dwordx4 v2, s[4:7], s55 offen sc1 lds
Lxt_185:
    s_add_u32 s58, s30, 1
    s_min_u32 s57, s58, 61
    s_lshl_b32 s57, s57, 9
    s_add_u32 s57, s57, s67
    s_waitcnt vmcnt(0)
    buffer_load_dword v160, v4, s[4:7], s57 offen sc1
    s_cmp_eq_u32 s30, 0
    s_cbranch_scc1 Lxn_186
    s_cmp_lg_u32 s59, 0
    s_cbranch_scc1 Lxn_186
    s_mov_b64 exec, 3
    buffer_store_dword v252, v3, s[4:7], s54 offen sc1
    s_mov_b64 exec, s[60:61]
    buffer_store_dword v252, v6, s[4:7], s53 offen sc1
    s_mov_b64 exec, -1
    s_branch Lxm_192
Lxn_186:
    buffer_load_dword v161, v4, s[4:7], s57 offen sc1
    buffer_load_dword v161, v4, s[4:7], s57 offen sc1
Lxm_192:
    s_barrier
    s_mul_i32 s50, s30, 327680
    s_add_u32 s50, s50, s64
    s_add_u32 s51, s50, 20480
    s_mul_i32 s54, s30, 1280
    s_add_u32 s54, s54, s66
    s_and_b32 s53, s30, 3
    s_lshl_b32 s53, s53, 10
    s_add_u32 s53, s53, 258048
    s_cmp_ge_u32 s30, 61
    s_cselect_b32 s60, 1, 0
    s_cmp_eq_u32 s22, 0
    s_cselect_b32 s60, s60, 0
    s_mov_b32 s61, 0
    ds_read_b128 v[16:19], v5 offset:0
    ds_read_b128 v[20:23], v5 offset:6144
    ds_read_b128 v[24:27], v5 offset:1024
    ds_read_b128 v[28:31], v5 offset:7168
    ds_read_b128 v[32:35], v5 offset:2048
    ds_read_b128 v[36:39], v5 offset:8192
    ds_read_b128 v[40:43], v5 offset:3072
    ds_read_b128 v[44:47], v5 offset:9216
    ds_read_b128 v[48:51], v5 offset:4096
    ds_read_b128 v[52:55], v5 offset:10240
    ds_read_b128 v[56:59], v5 offset:5120
    ds_read_b128 v[60:63], v5 offset:11264
    s_waitcnt lgkmcnt(10)
    v_mfma_f32_16x16x32_bf16 v[112:115], a[0:3], v[16:19], 0
    v_mfma_f32_16x16x32_bf16 v[116:119], a[96:99], v[16:19], 0
    v_mfma_f32_16x16x32_bf16 v[120:123], a[0:3], v[20:23], 0
    v_mfma_f32_16x16x32_bf16 v[124:127], a[96:99], v[20:23], 0
    ds_read_b128 v[64:67], v5 offset:12288
    ds_read_b128 v[68:71], v5 offset:18432
    s_waitcnt lgkmcnt(10)
    v_mfma_f32_16x16x32_bf16 v[112:115], a[4:7], v[24:27], v[112:115]
    v_mfma_f32_16x16x32_bf16 v[116:119], a[100:103], v[24:27], v[116:119]
    v_mfma_f32_16x16x32_bf16 v[120:123], a[4:7], v[28:31], v[120:123]
    v_mfma_f32_16x16x32_bf16 v[124:127], a[100:103], v[28:31], v[124:127]
    ds_read_b128 v[72:75], v5 offset:13312
    ds_read_b128 v[76:79], v5 offset:19456
    s_waitcnt lgkmcnt(10)
    v_mfma_f32_16x16x32_bf16 v[112:115], a[8:11], v[32:35], v[112:115]
    v_mfma_f32_16x16x32_bf16 v[116:119], a[104:107], v[32:35], v[116:119]
    v_mfma_f32_16x16x32_bf16 v[120:123], a[8:11], v[36:39], v[120:123]
    v_mfma_f32_16x16x32_bf16 v[124:127], a[104:107], v[36:39], v[124:127]
    ds_read_b128 v[80:83], v5 offset:14336
    ds_read_b128 v[84:87], v5 offset:20480
    s_waitcnt lgkmcnt(10)
    v_mfma_f32_16x16x32_bf16 v[112:115], a[12:15], v[40:43], v[112:115]
    v_mfma_f32_16x16x32_bf16 v[116:119], a[108:111], v[40:43], v[116:119]
    v_mfma_f32_16x16x32_bf16 v[120:123], a[12:15], v[44:47], v[120:123]
    v_mfma_f32_16x16x32_bf16 v[124:127], a[108:111], v[44:47], v[124:127]
    ds_read_b128 v[88:91], v5 offset:15360
    ds_read_b128 v[92:95], v5 offset:21504
    s_waitcnt lgkmcnt(10)
    v_mfma_f32_16x16x32_bf16 v[112:115], a[16:19], v[48:51], v[112:115]
    v_mfma_f32_16x16x32_bf16 v[116:119], a[112:115], v[48:51], v[116:119]
    v_mfma_f32_16x16x32_bf16 v[120:123], a[16:19], v[52:55], v[120:123]
    v_mfma_f32_16x16x32_bf16 v[124:127], a[112:115], v[52:55], v[124:127]
    ds_read_b128 v[96:99], v5 offset:16384
    ds_read_b128 v[100:103], v5 offset:22528
    s_waitcnt vmcnt(2)
    v_readfirstlane_b32 s59, v160
    s_cmp_eq_u32 s30, 61
    s_cselect_b32 s59, 0, s59
    s_cmp_eq_u32 s59, 0
    s_cbranch_scc1 Lxl_187
    s_and_b32 s55, s58, 7
    s_mul_i32 s55, s55, 393216
    s_add_u32 s55, s55, s63
    s_and_b32 s56, s58, 1
    s_mul_i32 s56, s56, 49152
    s_add_u32 s56, s56, s62
    s_add_u32 m0, s56, 0
    s_nop 0
    buffer_load_dwordx4 v2, s[4:7], s55 offen sc1 lds
    s_add_u32 s55, s55, 1024
    s_add_u32 m0, s56, 1024
    s_nop 0
    buffer_load_dwordx4 v2, s[4:7], s55 offen sc1 lds
    s_add_u32 s55, s55, 1024
    s_add_u32 m0, s56, 2048
    s_nop 0
    buffer_load_dwordx4 v2, s[4:7], s55 offen sc1 lds
    s_add_u32 s55, s55, 1024
    s_add_u32 m0, s56, 3072
    s_nop 0
    buffer_load_dwordx4 v2, s[4:7], s55 offen sc1 lds
    s_add_u32 s55, s55, 1024
    s_add_u32 m0, s56, 4096
    s_nop 0
    buffer_load_dwordx4 v2, s[4:7], s55 offen sc1 lds
    s_add_u32 s55, s55, 1024
    s_add_u32 m0, s56, 5120
    s_nop 0
    buffer_load_dwordx4 v2, s[4:7], s55 offen sc1 lds
    s_add_u32 s55, s55, 1024
    s_add_u32 m0, s56, 6144
    s_nop 0
    buffer_load_dwordx4 v2, s[4:7], s55 offen sc1 lds
    s_add_u32 s55, s55, 1024
    s_add_u32 m0, s56, 7168
    s_nop 0
    buffer_load_dwordx4 v2, s[4:7], s55 offen sc1 lds
    s_add_u32 s55, s55, 1024
    s_add_u32 m0, s56, 8192
    s_nop 0
    buffer_load_dwordx4 v2, s[4:7], s55 offen sc1 lds
    s_add_u32 s55, s55, 1024
    s_add_u32 m0, s56, 9216
    s_nop 0
    buffer_load_dwordx4 v2, s[4:7], s55 offen sc1 lds
    s_add_u32 s55, s55, 1024
    s_add_u32 m0, s56, 10240
    s_nop 0
    buffer_load_dwordx4 v2, s[4:7], s55 offen sc1 lds
    s_add_u32 s55, s55, 1024
    s_add_u32 m0, s56, 11264
    s_nop 0
    buffer_load_dwordx4 v2, s[4:7], s55 offen sc1 lds
Lxl_187:
    s_waitcnt lgkmcnt(10)
    v_mfma_f32_16x16x32_bf16 v[112:115], a[20:23], v[56:59], v[112:115]
    v_mfma_f32_16x16x32_bf16 v[116:119], a[116:119], v[56:59], v[116:119]
    v_mfma_f32_16x16x32_bf16 v[120:123], a[20:23], v[60:63], v[120:123]
    v_mfma_f32_16x16x32_bf16 v[124:127], a[116:119], v[60:63], v[124:127]
    ds_read_b128 v[104:107], v5 offset:17408
    ds_read_b128 v[108:111], v5 offset:23552
    s_waitcnt lgkmcnt(10)
    v_mfma_f32_16x16x32_bf16 v[112:115], a[24:27], v[64:67], v[112:115]
    v_mfma_f32_16x16x32_bf16 v[116:119], a[120:123], v[64:67], v[116:119]
    v_mfma_f32_16x16x32_bf16 v[120:123], a[24:27], v[68:71], v[120:123]
    v_mfma_f32_16x16x32_bf16 v[124:127], a[120:123], v[68:71], v[124:127]
    ds_read_b128 v[16:19], v5 offset:24576
    ds_read_b128 v[20:23], v5 offset:30720
    s_waitcnt lgkmcnt(10)
    v_mfma_f32_16x16x32_bf16 v[112:115], a[28:31], v[72:75], v[112:115]
    v_mfma_f32_16x16x32_bf16 v[116:119], a[124:127], v[72:75], v[116:119]
    v_mfma_f32_16x16x32_bf16 v[120:123], a[28:31], v[76:79], v[120:123]
    v_mfma_f32_16x16x32_bf16 v[124:127], a[124:127], v[76:79], v[124:127]
    ds_read_b128 v[24:27], v5 offset:25600
    ds_read_b128 v[28:31], v5 offset:31744
    s_waitcnt lgkmcnt(10)
    v_mfma_f32_16x16x32_bf16 v[112:115], a[32:35], v[80:83], v[112:115]
    v_mfma_f32_16x16x32_bf16 v[116:119], a[128:131], v[80:83], v[116:119]
    v_mfma_f32_16x16x32_bf16 v[120:123], a[32:35], v[84:87], v[120:123]
    v_mfma_f32_16x16x32_bf16 v[124:127], a[128:131], v[84:87], v[124:127]
    ds_read_b128 v[32:35], v5 offset:26624
    ds_read_b128 v[36:39], v5 offset:32768
    s_waitcnt lgkmcnt(10)
    v_mfma_f32_16x16x32_bf16 v[112:115], a[36:39], v[88:91], v[112:115]
    v_mfma_f32_16x16x32_bf16 v[116:119], a[132:135], v[88:91], v[116:119]
    v_mfma_f32_16x16x32_bf16 v[120:123], a[36:39], v[92:95], v[120:123]
    v_mfma_f32_16x16x32_bf16 v[124:127], a[132:135], v[92:95], v[124:127]
    ds_read_b128 v[40:43], v5 offset:27648
    ds_read_b128 v[44:47], v5 offset:33792
    s_waitcnt lgkmcnt(10)
    v_mfma_f32_16x16x32_bf16 v[112:115], a[40:43], v[96:99], v[112:115]
    v_mfma_f32_16x16x32_bf16 v[116:119], a[136:139], v[96:99], v[116:119]
    v_mfma_f32_16x16x32_bf16 v[120:123], a[40:43], v[100:103], v[120:123]
    v_mfma_f32_16x16x32_bf16 v[124:127], a[136:139], v[100:103], v[124:127]
    ds_read_b128 v[48:51], v5 offset:28672
    ds_read_b128 v[52:55], v5 offset:34816
    s_waitcnt lgkmcnt(10)
    v_mfma_f32_16x16x32_bf16 v[112:115], a[44:47], v[104:107], v[112:115]
    v_mfma_f32_16x16x32_bf16 v[116:119], a[140:143], v[104:107], v[116:119]
    v_mfma_f32_16x16x32_bf16 v[120:123], a[44:47], v[108:111], v[120:123]
    v_mfma_f32_16x16x32_bf16 v[124:127], a[140:143], v[108:111], v[124:127]
    ds_read_b128 v[56:59], v5 offset:29696
    ds_read_b128 v[60:63], v5 offset:35840
    s_waitcnt lgkmcnt(10)
    v_mfma_f32_16x16x32_bf16 v[112:115], a[48:51], v[16:19], v[112:115]
    v_mfma_f32_16x16x32_bf16 v[116:119], a[144:147], v[16:19], v[116:119]
    v_mfma_f32_16x16x32_bf16 v[120:123], a[48:51], v[20:23], v[120:123]
    v_mfma_f32_16x16x32_bf16 v[124:127], a[144:147], v[20:23], v[124:127]
    ds_read_b128 v[64:67], v5 offset:36864
    ds_read_b128 v[68:71], v5 offset:43008
    s_waitcnt lgkmcnt(10)
    v_mfma_f32_16x16x32_bf16 v[112:115], a[52:55], v[24:27], v[112:115]
    v_mfma_f32_16x16x32_bf16 v[116:119], a[148:151], v[24:27], v[116:119]
    v_mfma_f32_16x16x32_bf16 v[120:123], a[52:55], v[28:31], v[120:123]
    v_mfma_f32_16x16x32_bf16 v[124:127], a[148:151], v[28:31], v[124:127]
    ds_read_b128 v[72:75], v5 offset:37888
    ds_read_b128 v[76:79], v5 offset:44032
    s_waitcnt lgkmcnt(10)
    v_mfma_f32_16x16x32_bf16 v[112:115], a[56:59], v[32:35], v[112:115]
    v_mfma_f32_16x16x32_bf16 v[116:119], a[152:155], v[32:35], v[116:119]
    v_mfma_f32_16x16x32_bf16 v[120:123], a[56:59], v[36:39], v[120:123]
    v_mfma_f32_16x16x32_bf16 v[124:127], a[152:155], v[36:39], v[124:127]
    ds_read_b128 v[80:83], v5 offset:38912
    ds_read_b128 v[84:87], v5 offset:45056
    s_waitcnt lgkmcnt(10)
    v_mfma_f32_16x16x32_bf16 v[112:115], a[60:63], v[40:43], v[112:115]
    v_mfma_f32_16x16x32_bf16 v[116:119], a[156:159], v[40:43], v[116:119]
    v_mfma_f32_16x16x32_bf16 v[120:123], a[60:63], v[44:47], v[120:123]
    v_mfma_f32_16x16x32_bf16 v[124:127], a[156:159], v[44:47], v[124:127]
    ds_read_b128 v[88:91], v5 offset:39936
    ds_read_b128 v[92:95], v5 offset:46080
    s_waitcnt lgkmcnt(10)
    v_mfma_f32_16x16x32_bf16 v[112:115], a[64:67], v[48:51], v[112:115]
    v_mfma_f32_16x16x32_bf16 v[116:119], a[160:163], v[48:51], v[116:119]
    v_mfma_f32_16x16x32_bf16 v[120:123], a[64:67], v[52:55], v[120:123]
    v_mfma_f32_16x16x32_bf16 v[124:127], a[160:163], v[52:55], v[124:127]
    ds_read_b128 v[96:99], v5 offset:40960
    ds_read_b128 v[100:103], v5 offset:47104
    buffer_load_dword v160, v4, s[4:7], s57 offen sc1
    s_waitcnt lgkmcnt(10)
    v_mfma_f32_16x16x32_bf16 v[112:115], a[68:71], v[56:59], v[112:115]
    v_mfma_f32_16x16x32_bf16 v[116:119], a[164:167], v[56:59], v[116:119]
    v_mfma_f32_16x16x32_bf16 v[120:123], a[68:71], v[60:63], v[120:123]
    v_mfma_f32_16x16x32_bf16 v[124:127], a[164:167], v[60:63], v[124:127]
    ds_read_b128 v[104:107], v5 offset:41984
    ds_read_b128 v[108:111], v5 offset:48128
    s_waitcnt lgkmcnt(10)
    v_mfma_f32_16x16x32_bf16 v[112:115], a[72:75], v[64:67], v[112:115]
    v_mfma_f32_16x16x32_bf16 v[116:119], a[168:171], v[64:67], v[116:119]
    v_mfma_f32_16x16x32_bf16 v[120:123], a[72:75], v[68:71], v[120:123]
    v_mfma_f32_16x16x32_bf16 v[124:127], a[168:171], v[68:71], v[124:127]
    s_waitcnt lgkmcnt(8)
    v_mfma_f32_16x16x32_bf16 v[112:115], a[76:79], v[72:75], v[112:115]
    v_mfma_f32_16x16x32_bf16 v[116:119], a[172:175], v[72:75], v[116:119]
    v_mfma_f32_16x16x32_bf16 v[120:123], a[76:79], v[76:79], v[120:123]
    v_mfma_f32_16x16x32_bf16 v[124:127], a[172:175], v[76:79], v[124:127]
    s_waitcnt lgkmcnt(6)
    v_mfma_f32_16x16x32_bf16 v[112:115], a[80:83], v[80:83], v[112:115]
    v_mfma_f32_16x16x32_bf16 v[116:119], a[176:179], v[80:83], v[116:119]
    v_mfma_f32_16x16x32_bf16 v[120:123], a[80:83], v[84:87], v[120:123]
    v_mfma_f32_16x16x32_bf16 v[124:127], a[176:179], v[84:87], v[124:127]
    s_waitcnt lgkmcnt(4)
    v_mfma_f32_16x16x32_bf16 v[112:115], a[84:87], v[88:91], v[112:115]
    v_mfma_f32_16x16x32_bf16 v[116:119], a[180:183], v[88:91], v[116:119]
    v_mfma_f32_16x16x32_bf16 v[120:123], a[84:87], v[92:95], v[120:123]
    v_mfma_f32_16x16x32_bf16 v[124:127], a[180:183], v[92:95], v[124:127]
    s_waitcnt lgkmcnt(2)
    v_mfma_f32_16x16x32_bf16 v[112:115], a[88:91], v[96:99], v[112:115]
    v_mfma_f32_16x16x32_bf16 v[116:119], a[184:187], v[96:99], v[116:119]
    v_mfma_f32_16x16x32_bf16 v[120:123], a[88:91], v[100:103], v[120:123]
    v_mfma_f32_16x16x32_bf16 v[124:127], a[184:187], v[100:103], v[124:127]
    s_waitcnt lgkmcnt(0)
    v_mfma_f32_16x16x32_bf16 v[112:115], a[92:95], v[104:107], v[112:115]
    v_mfma_f32_16x16x32_bf16 v[116:119], a[188:191], v[104:107], v[116:119]
    v_mfma_f32_16x16x32_bf16 v[120:123], a[92:95], v[108:111], v[120:123]
    v_mfma_f32_16x16x32_bf16 v[124:127], a[188:191], v[108:111], v[124:127]
    s_cmp_lg_u32 s59, 0
    s_cbranch_scc1 Lxs_193
    s_cmp_eq_u32 s30, 61
    s_cbranch_scc1 Lxs_193
    s_waitcnt vmcnt(0)
    v_readfirstlane_b32 s59, v160
    s_nop 0
    s_cmp_eq_u32 s59, 0
    s_cbranch_scc1 Lxs_193
    s_and_b32 s55, s58, 7
    s_mul_i32 s55, s55, 393216
    s_add_u32 s55, s55, s63
    s_and_b32 s56, s58, 1
    s_mul_i32 s56, s56, 49152
    s_add_u32 s56, s56, s62
    s_add_u32 m0, s56, 0
    s_nop 0
    buffer_load_dwordx4 v2, s[4:7], s55 offen sc1 lds
    s_add_u32 s55, s55, 1024
    s_add_u32 m0, s56, 1024
    s_nop 0
    buffer_load_dwordx4 v2, s[4:7], s55 offen sc1 lds
    s_add_u32 s55, s55, 1024
    s_add_u32 m0, s56, 2048
    s_nop 0
    buffer_load_dwordx4 v2, s[4:7], s55 offen sc1 lds
    s_add_u32 s55, s55, 1024
    s_add_u32 m0, s56, 3072
    s_nop 0
    buffer_load_dwordx4 v2, s[4:7], s55 offen sc1 lds
    s_add_u32 s55, s55, 1024
    s_add_u32 m0, s56, 4096
    s_nop 0
    buffer_load_dwordx4 v2, s[4:7], s55 offen sc1 lds
    s_add_u32 s55, s55, 1024
    s_add_u32 m0, s56, 5120
    s_nop 0
    buffer_load_dwordx4 v2, s[4:7], s55 offen sc1 lds
    s_add_u32 s55, s55, 1024
    s_add_u32 m0, s56, 6144
    s_nop 0
    buffer_load_dwordx4 v2, s[4:7], s55 offen sc1 lds
    s_add_u32 s55, s55, 1024
    s_add_u32 m0, s56, 7168
    s_nop 0
    buffer_load_dwordx4 v2, s[4:7], s55 offen sc1 lds
    s_add_u32 s55, s55, 1024
    s_add_u32 m0, s56, 8192
    s_nop 0
    buffer_load_dwordx4 v2, s[4:7], s55 offen sc1 lds
    s_add_u32 s55, s55, 1024
    s_add_u32 m0, s56, 9216
    s_nop 0
    buffer_load_dwordx4 v2, s[4:7], s55 offen sc1 lds
    s_add_u32 s55, s55, 1024
    s_add_u32 m0, s56, 10240
    s_nop 0
    buffer_load_dwordx4 v2, s[4:7], s55 offen sc1 lds
    s_add_u32 s55, s55, 1024
    s_add_u32 m0, s56, 11264
    s_nop 0
    buffer_load_dwordx4 v2, s[4:7], s55 offen sc1 lds
Lxs_193:
    v_cvt_pk_bf16_f32 v128, v112, v113
    v_cvt_pk_bf16_f32 v129, v114, v115
    v_cvt_pk_bf16_f32 v130, v116, v117
    v_cvt_pk_bf16_f32 v131, v118, v119
    buffer_store_dwordx4 v[128:131], v2, s[4:7], s50 offen sc1
    v_cvt_pk_bf16_f32 v132, v120, v121
    v_cvt_pk_bf16_f32 v133, v122, v123
    v_cvt_pk_bf16_f32 v134, v124, v125
    v_cvt_pk_bf16_f32 v135, v126, v127
    buffer_store_dwordx4 v[132:135], v2, s[4:7], s51 offen sc1
    v_xor_b32 v5, 49152, v5
    s_cmp_eq_u32 s30, 61
    s_cbranch_scc1 Lxe_189
    s_cmp_lg_u32 s59, 0
    s_mov_b32 s59, 0
    s_cbranch_scc1 Lxx_188
    buffer_load_dword v160, v4, s[4:7], s57 offen sc1
    s_waitcnt vmcnt(0)
    v_readfirstlane_b32 s38, v160
    s_nop 0
    s_cmp_lg_u32 s38, 0
    s_cbranch_scc1 Lxq_194
    s_mov_b64 exec, 3
    buffer_store_dword v252, v3, s[4:7], s54 offen sc1
    s_mov_b64 exec, s[60:61]
    buffer_store_dword v252, v6, s[4:7], s53 offen sc1
    s_mov_b64 exec, -1
    s_mov_b32 s59, 1
    s_mov_b32 s31, 262144
    s_mov_b32 exec_lo, 0x1
    s_mov_b32 exec_hi, 0
Lf_195:
    buffer_load_dword v160, v4, s[4:7], s57 offen sc1
    s_waitcnt vmcnt(0)
    v_cmp_eq_u32 vcc, 0, v160
    s_cbranch_vccz Lfd_196
    s_sleep 2
    s_sub_u32 s31, s31, 1
    s_cbranch_scc0 Lf_195
    s_mov_b32 s31, 5
    s_branch L_fail
Lfd_196:
    s_mov_b64 exec, -1
Lxq_194:
    s_and_b32 s55, s58, 7
    s_mul_i32 s55, s55, 393216
    s_add_u32 s55, s55, s63
    s_and_b32 s56, s58, 1
    s_mul_i32 s56, s56, 49152
    s_add_u32 s56, s56, s62
    s_add_u32 m0, s56, 0
    s_nop 0
    buffer_load_dwordx4 v2, s[4:7], s55 offen sc1 lds
    s_add_u32 s55, s55, 1024
    s_add_u32 m0, s56, 1024
    s_nop 0
    buffer_load_dwordx4 v2, s[4:7], s55 offen sc1 lds
    s_add_u32 s55, s55, 1024
    s_add_u32 m0, s56, 2048
    s_nop 0
    buffer_load_dwordx4 v2, s[4:7], s55 offen sc1 lds
    s_add_u32 s55, s55, 1024
    s_add_u32 m0, s56, 3072
    s_nop 0
    buffer_load_dwordx4 v2, s[4:7], s55 offen sc1 lds
    s_add_u32 s55, s55, 1024
    s_add_u32 m0, s56, 4096
    s_nop 0
    buffer_load_dwordx4 v2, s[4:7], s55 offen sc1 lds
    s_add_u32 s55, s55, 1024
    s_add_u32 m0, s56, 5120
    s_nop 0
    buffer_load_dwordx4 v2, s[4:7], s55 offen sc1 lds
    s_add_u32 s55, s55, 1024
    s_add_u32 m0, s56, 6144
    s_nop 0
    buffer_load_dwordx4 v2, s[4:7], s55 offen sc1 lds
    s_add_u32 s55, s55, 1024
    s_add_u32 m0, s56, 7168
    s_nop 0
    buffer_load_dwordx4 v2, s[4:7], s55 offen sc1 lds
    s_add_u32 s55, s55, 1024
    s_add_u32 m0, s56, 8192
    s_nop 0
    buffer_load_dwordx4 v2, s[4:7], s55 offen sc1 lds
    s_add_u32 s55, s55, 1024
    s_add_u32 m0, s56, 9216
    s_nop 0
    buffer_load_dwordx4 v2, s[4:7], s55 offen sc1 lds
    s_add_u32 s55, s55, 1024
    s_add_u32 m0, s56, 10240
    s_nop 0
    buffer_load_dwordx4 v2, s[4:7], s55 offen sc1 lds
    s_add_u32 s55, s55, 1024
    s_add_u32 m0, s56, 11264
    s_nop 0
    buffer_load_dwordx4 v2, s[4:7], s55 offen sc1 lds
Lxx_188:
    s_mov_b32 s30, s58
    s_branch Lxt_185
Lxe_189:
    s_waitcnt vmcnt(0)
    s_mov_b64 exec, 3
    buffer_store_dword v252, v3, s[4:7], s54 offen sc1
    s_mov_b64 exec, s[60:61]
    buffer_store_dword v252, v6, s[4:7], s53 offen sc1
    s_mov_b64 exec, -1
    s_endpgm
L_ffn:
    s_sub_u32 s26, s21, 29
    s_mul_i32 s25, s20, 3
    s_add_u32 s26, s26, s25
    s_mov_b32 s24, s26
    s_mov_b32 s8, s56
    s_and_b32 s9, s57, 0xffff
    s_mov_b32 s10, 0x1e0000
    s_mov_b32 s11, 0x00020000
    s_mov_b32 s12, s58
    s_and_b32 s13, s59, 0xffff
    s_mov_b32 s14, 0x1e0000
    s_mov_b32 s15, 0x00020000
    s_mov_b32 s31, 262144
    v_lshlrev_b32 v18, 2, v1
    s_mov_b32 exec_hi, 0
Lwr_197:
    global_load_dword v16, v18, s[74:75] offset:128 sc1
    s_mov_b32 s23, 0
    s_mov_b32 s38, 0
    s_waitcnt vmcnt(0)
    v_cmp_eq_u32 vcc, 0x20, v16
    s_nop 0
    s_or_b32 s38, s38, vcc_lo
    v_cmp_eq_u32 vcc, 0x2000, v16
    s_nop 0
    s_or_b32 s38, s38, vcc_lo
    v_cmp_eq_u32 vcc, 0x200000, v16
    s_nop 0
    s_or_b32 s38, s38, vcc_lo
    v_cmp_eq_u32 vcc, 0x20000000, v16
    s_nop 0
    s_or_b32 s38, s38, vcc_lo
    v_sad_u8 v17, v16, 0, 0
    s_bcnt1_i32_b32 s38, s38
    s_cmp_eq_u32 s38, 8
    s_cbranch_scc1 Lwd_198
    v_add_u32_dpp v17, v17, v17 row_shr:1 row_mask:0xf bank_mask:0xf bound_ctrl:0
    s_nop 1
    v_add_u32_dpp v17, v17, v17 row_shr:2 row_mask:0xf bank_mask:0xf bound_ctrl:0
    s_nop 1
    v_add_u32_dpp v17, v17, v17 row_shr:4 row_mask:0xf bank_mask:0xf bound_ctrl:0
    s_nop 1
    v_add_u32_dpp v17, v17, v17 row_shr:8 row_mask:0xf bank_mask:0xf bound_ctrl:0
    s_nop 0
    v_readlane_b32 s38, v17, 15
    v_readlane_b32 s39, v17, 31
    s_mov_b32 s23, 1
    s_add_u32 s38, s38, s39
    s_cmp_eq_u32 s38, 256
    s_cbranch_scc1 Lwd_198
    s_sleep 32
    s_sub_u32 s31, s31, 1
    s_cbranch_scc0 Lwr_197
    s_mov_b32 s31, 10
    s_branch L_fail
Lwd_198:
    s_mov_b64 exec, -1
    s_lshl_b32 s38, s20, 8
    s_add_u32 s38, s38, 10240
    v_lshlrev_b32 v17, 6, v1
    s_mov_b32 s31, 262144
    s_mov_b32 exec_lo, 0xf
    s_mov_b32 exec_hi, 0
Lf_199:
    buffer_load_dword v16, v17, s[4:7], s38 offen sc1
    s_waitcnt vmcnt(0)
    v_cmp_eq_u32 vcc, 0, v16
    s_cbranch_vccz Lfd_200
    s_sleep 16
    s_sub_u32 s31, s31, 1
    s_cbranch_scc0 Lf_199
    s_mov_b32 s31, 15
    s_branch L_fail
Lfd_200:
    s_mov_b64 exec, -1
    v_lshrrev_b32 v3, 3, v1
    v_and_b32 v4, 7, v1
    v_lshrrev_b32 v8, 4, v1
    v_bfe_u32 v9, v1, 2, 2
    v_and_b32 v10, 3, v1
    s_lshl_b32 s44, s22, 12
    v_mul_u32_u24 v5, 3072, v3
    v_lshl_add_u32 v5, v4, 4, v5
    v_lshl_add_u32 v11, v8, 3, v9
    v_lshlrev_b32 v11, 7, v11
    v_lshl_add_u32 v11, v10, 3, v11
    s_lshl_b32 s46, s22, 5
    v_add_u32 v11, s46, v11
    v_add_u32 v12, 0x8000, v11
    v_add_u32 v13, 0x10000, v11
    s_mul_i32 s40, s26, 5
    s_add_u32 s40, s40, 0
    s_mul_i32 s41, s40, 205
    s_lshr_b32 s41, s41, 10
    s_mul_i32 s42, s41, 5
    s_sub_u32 s42, s40, s42
    s_lshl_b32 s43, s42, 2
    s_add_u32 s43, s43, s22
    s_mul_i32 s45, s43, 98304
    s_lshl_b32 s46, s41, 7
    s_add_u32 s45, s45, s46
    s_add_u32 m0, s44, 0
    s_add_u32 s46, s45, 0
    buffer_load_dwordx4 v5, s[8:11], s46 offen nt lds
    s_add_u32 m0, s44, 1024
    s_add_u32 s46, s45, 24576
    buffer_load_dwordx4 v5, s[8:11], s46 offen nt lds
    s_add_u32 m0, s44, 2048
    s_add_u32 s46, s45, 49152
    buffer_load_dwordx4 v5, s[8:11], s46 offen nt lds
    s_add_u32 m0, s44, 3072
    s_add_u32 s46, s45, 73728
    buffer_load_dwordx4 v5, s[8:11], s46 offen nt lds
    s_lshl_b32 s46, s41, 2
    s_add_u32 s46, s46, s22
    s_mul_i32 s46, s46, 20
    s_lshl_b32 s47, s42, 2
    s_add_u32 s46, s46, s47
    s_lshl_b32 s46, s46, 10
    s_add_u32 s50, s46, 6815744
    s_mul_i32 s40, s26, 5
    s_add_u32 s40, s40, 1
    s_mul_i32 s41, s40, 205
    s_lshr_b32 s41, s41, 10
    s_mul_i32 s42, s41, 5
    s_sub_u32 s42, s40, s42
    s_lshl_b32 s43, s42, 2
    s_add_u32 s43, s43, s22
    s_mul_i32 s45, s43, 98304
    s_lshl_b32 s46, s41, 7
    s_add_u32 s45, s45, s46
    s_add_u32 m0, s44, 16384
    s_add_u32 s46, s45, 0
    buffer_load_dwordx4 v5, s[8:11], s46 offen nt lds
    s_add_u32 m0, s44, 17408
    s_add_u32 s46, s45, 24576
    buffer_load_dwordx4 v5, s[8:11], s46 offen nt lds
    s_add_u32 m0, s44, 18432
    s_add_u32 s46, s45, 49152
    buffer_load_dwordx4 v5, s[8:11], s46 offen nt lds
    s_add_u32 m0, s44, 19456
    s_add_u32 s46, s45, 73728
    buffer_load_dwordx4 v5, s[8:11], s46 offen nt lds
    s_lshl_b32 s46, s41, 2
    s_add_u32 s46, s46, s22
    s_mul_i32 s46, s46, 20
    s_lshl_b32 s47, s42, 2
    s_add_u32 s46, s46, s47
    s_lshl_b32 s46, s46, 10
    s_add_u32 s51, s46, 6815744
    s_mul_i32 s40, s26, 5
    s_add_u32 s40, s40, 2
    s_mul_i32 s41, s40, 205
    s_lshr_b32 s41, s41, 10
    s_mul_i32 s42, s41, 5
    s_sub_u32 s42, s40, s42
    s_lshl_b32 s43, s42, 2
    s_add_u32 s43, s43, s22
    s_mul_i32 s45, s43, 98304
    s_lshl_b32 s46, s41, 7
    s_add_u32 s45, s45, s46
    s_add_u32 m0, s44, 32768
    s_add_u32 s46, s45, 0
    buffer_load_dwordx4 v5, s[8:11], s46 offen nt lds
    s_add_u32 m0, s44, 33792
    s_add_u32 s46, s45, 24576
    buffer_load_dwordx4 v5, s[8:11], s46 offen nt lds
    s_add_u32 m0, s44, 34816
    s_add_u32 s46, s45, 49152
    buffer_load_dwordx4 v5, s[8:11], s46 offen nt lds
    s_add_u32 m0, s44, 35840
    s_add_u32 s46, s45, 73728
    buffer_load_dwordx4 v5, s[8:11], s46 offen nt lds
    s_lshl_b32 s46, s41, 2
    s_add_u32 s46, s46, s22
    s_mul_i32 s46, s46, 20
    s_lshl_b32 s47, s42, 2
    s_add_u32 s46, s46, s47
    s_lshl_b32 s46, s46, 10
    s_add_u32 s52, s46, 6815744
    s_mul_i32 s40, s26, 5
    s_add_u32 s40, s40, 3
    s_mul_i32 s41, s40, 205
    s_lshr_b32 s41, s41, 10
    s_mul_i32 s42, s41, 5
    s_sub_u32 s42, s40, s42
    s_lshl_b32 s43, s42, 2
    s_add_u32 s43, s43, s22
    s_mul_i32 s45, s43, 98304
    s_lshl_b32 s46, s41, 7
    s_add_u32 s45, s45, s46
    s_add_u32 m0, s44, 49152
    s_add_u32 s46, s45, 0
    buffer_load_dwordx4 v5, s[8:11], s46 offen nt lds
    s_add_u32 m0, s44, 50176
    s_add_u32 s46, s45, 24576
    buffer_load_dwordx4 v5, s[8:11], s46 offen nt lds
    s_add_u32 m0, s44, 51200
    s_add_u32 s46, s45, 49152
    buffer_load_dwordx4 v5, s[8:11], s46 offen nt lds
    s_add_u32 m0, s44, 52224
    s_add_u32 s46, s45, 73728
    buffer_load_dwordx4 v5, s[8:11], s46 offen nt lds
    s_lshl_b32 s46, s41, 2
    s_add_u32 s46, s46, s22
    s_mul_i32 s46, s46, 20
    s_lshl_b32 s47, s42, 2
    s_add_u32 s46, s46, s47
    s_lshl_b32 s46, s46, 10
    s_add_u32 s53, s46, 6815744
    s_mul_i32 s40, s26, 5
    s_add_u32 s40, s40, 4
    s_mul_i32 s41, s40, 205
    s_lshr_b32 s41, s41, 10
    s_mul_i32 s42, s41, 5
    s_sub_u32 s42, s40, s42
    s_lshl_b32 s43, s42, 2
    s_add_u32 s43, s43, s22
    s_mul_i32 s45, s43, 98304
    s_lshl_b32 s46, s41, 7
    s_add_u32 s45, s45, s46
    s_add_u32 m0, s44, 65536
    s_add_u32 s46, s45, 0
    buffer_load_dwordx4 v5, s[8:11], s46 offen nt lds
    s_add_u32 m0, s44, 66560
    s_add_u32 s46, s45, 24576
    buffer_load_dwordx4 v5, s[8:11], s46 offen nt lds
    s_add_u32 m0, s44, 67584
    s_add_u32 s46, s45, 49152
    buffer_load_dwordx4 v5, s[8:11], s46 offen nt lds
    s_add_u32 m0, s44, 68608
    s_add_u32 s46, s45, 73728
    buffer_load_dwordx4 v5, s[8:11], s46 offen nt lds
    s_lshl_b32 s46, s41, 2
    s_add_u32 s46, s46, s22
    s_mul_i32 s46, s46, 20
    s_lshl_b32 s47, s42, 2
    s_add_u32 s46, s46, s47
    s_lshl_b32 s46, s46, 10
    s_add_u32 s54, s46, 6815744
    s_waitcnt vmcnt(0)
    s_barrier
    ds_read_b64_tr_b16 v[16:17], v11 offset:0
    ds_read_b64_tr_b16 v[18:19], v11 offset:512
    ds_read_b64_tr_b16 v[20:21], v11 offset:4096
    ds_read_b64_tr_b16 v[22:23], v11 offset:4608
    ds_read_b64_tr_b16 v[24:25], v11 offset:8192
    ds_read_b64_tr_b16 v[26:27], v11 offset:8704
    ds_read_b64_tr_b16 v[28:29], v11 offset:12288
    ds_read_b64_tr_b16 v[30:31], v11 offset:12800
    ds_read_b64_tr_b16 v[32:33], v11 offset:16384
    ds_read_b64_tr_b16 v[34:35], v11 offset:16896
    ds_read_b64_tr_b16 v[36:37], v11 offset:20480
    ds_read_b64_tr_b16 v[38:39], v11 offset:20992
    ds_read_b64_tr_b16 v[40:41], v11 offset:24576
    ds_read_b64_tr_b16 v[42:43], v11 offset:25088
    ds_read_b64_tr_b16 v[44:45], v11 offset:28672
    ds_read_b64_tr_b16 v[46:47], v11 offset:29184
    ds_read_b64_tr_b16 v[48:49], v12 offset:0
    ds_read_b64_tr_b16 v[50:51], v12 offset:512
    ds_read_b64_tr_b16 v[52:53], v12 offset:4096
    ds_read_b64_tr_b16 v[54:55], v12 offset:4608
    ds_read_b64_tr_b16 v[56:57], v12 offset:8192
    ds_read_b64_tr_b16 v[58:59], v12 offset:8704
    ds_read_b64_tr_b16 v[60:61], v12 offset:12288
    ds_read_b64_tr_b16 v[62:63], v12 offset:12800
    ds_read_b64_tr_b16 v[64:65], v12 offset:16384
    ds_read_b64_tr_b16 v[66:67], v12 offset:16896
    ds_read_b64_tr_b16 v[68:69], v12 offset:20480
    ds_read_b64_tr_b16 v[70:71], v12 offset:20992
    ds_read_b64_tr_b16 v[72:73], v12 offset:24576
    ds_read_b64_tr_b16 v[74:75], v12 offset:25088
    ds_read_b64_tr_b16 v[76:77], v12 offset:28672
    ds_read_b64_tr_b16 v[78:79], v12 offset:29184
    ds_read_b64_tr_b16 v[80:81], v13 offset:0
    ds_read_b64_tr_b16 v[82:83], v13 offset:512
    ds_read_b64_tr_b16 v[84:85], v13 offset:4096
    ds_read_b64_tr_b16 v[86:87], v13 offset:4608
    ds_read_b64_tr_b16 v[88:89], v13 offset:8192
    ds_read_b64_tr_b16 v[90:91], v13 offset:8704
    ds_read_b64_tr_b16 v[92:93], v13 offset:12288
    ds_read_b64_tr_b16 v[94:95], v13 offset:12800
    s_waitcnt lgkmcnt(0)
    s_barrier
    buffer_store_dwordx4 v[16:19], v2, s[4:7], s50 offen offset:0 sc1
    buffer_store_dwordx4 v[20:23], v2, s[4:7], s50 offen offset:1024 sc1
    buffer_store_dwordx4 v[24:27], v2, s[4:7], s50 offen offset:2048 sc1
    buffer_store_dwordx4 v[28:31], v2, s[4:7], s50 offen offset:3072 sc1
    buffer_store_dwordx4 v[32:35], v2, s[4:7], s51 offen offset:0 sc1
    buffer_store_dwordx4 v[36:39], v2, s[4:7], s51 offen offset:1024 sc1
    buffer_store_dwordx4 v[40:43], v2, s[4:7], s51 offen offset:2048 sc1
    buffer_store_dwordx4 v[44:47], v2, s[4:7], s51 offen offset:3072 sc1
    buffer_store_dwordx4 v[48:51], v2, s[4:7], s52 offen offset:0 sc1
    buffer_store_dwordx4 v[52:55], v2, s[4:7], s52 offen offset:1024 sc1
    buffer_store_dwordx4 v[56:59], v2, s[4:7], s52 offen offset:2048 sc1
    buffer_store_dwordx4 v[60:63], v2, s[4:7], s52 offen offset:3072 sc1
    buffer_store_dwordx4 v[64:67], v2, s[4:7], s53 offen offset:0 sc1
    buffer_store_dwordx4 v[68:71], v2, s[4:7], s53 offen offset:1024 sc1
    buffer_store_dwordx4 v[72:75], v2, s[4:7], s53 offen offset:2048 sc1
    buffer_store_dwordx4 v[76:79], v2, s[4:7], s53 offen offset:3072 sc1
    buffer_store_dwordx4 v[80:83], v2, s[4:7], s54 offen offset:0 sc1
    buffer_store_dwordx4 v[84:87], v2, s[4:7], s54 offen offset:1024 sc1
    buffer_store_dwordx4 v[88:91], v2, s[4:7], s54 offen offset:2048 sc1
    buffer_store_dwordx4 v[92:95], v2, s[4:7], s54 offen offset:3072 sc1
    v_mul_u32_u24 v5, 1280, v3
    v_lshl_add_u32 v5, v4, 4, v5
    v_lshl_add_u32 v11, v8, 2, v9
    v_lshlrev_b32 v11, 7, v11
    v_lshl_add_u32 v11, v10, 3, v11
    s_lshl_b32 s46, s22, 5
    v_add_u32 v11, s46, v11
    v_add_u32 v12, 0x8000, v11
    v_add_u32 v13, 0x10000, v11
    s_mul_i32 s40, s26, 5
    s_add_u32 s40, s40, 0
    s_mul_i32 s41, s40, 171
    s_lshr_b32 s41, s41, 11
    s_mul_i32 s42, s41, 12
    s_sub_u32 s42, s40, s42
    s_lshl_b32 s43, s42, 2
    s_add_u32 s43, s43, s22
    s_mul_i32 s45, s43, 40960
    s_lshl_b32 s46, s41, 7
    s_add_u32 s45, s45, s46
    s_add_u32 m0, s44, 0
    s_add_u32 s46, s45, 0
    buffer_load_dwordx4 v5, s[12:15], s46 offen nt lds
    s_add_u32 m0, s44, 1024
    s_add_u32 s46, s45, 10240
    buffer_load_dwordx4 v5, s[12:15], s46 offen nt lds
    s_add_u32 m0, s44, 2048
    s_add_u32 s46, s45, 20480
    buffer_load_dwordx4 v5, s[12:15], s46 offen nt lds
    s_add_u32 m0, s44, 3072
    s_add_u32 s46, s45, 30720
    buffer_load_dwordx4 v5, s[12:15], s46 offen nt lds
    s_lshl_b32 s46, s41, 2
    s_add_u32 s46, s46, s22
    s_mul_i32 s46, s46, 48
    s_lshl_b32 s47, s42, 2
    s_add_u32 s46, s46, s47
    s_lshl_b32 s46, s46, 10
    s_add_u32 s50, s46, 8781824
    s_mul_i32 s40, s26, 5
    s_add_u32 s40, s40, 1
    s_mul_i32 s41, s40, 171
    s_lshr_b32 s41, s41, 11
    s_mul_i32 s42, s41, 12
    s_sub_u32 s42, s40, s42
    s_lshl_b32 s43, s42, 2
    s_add_u32 s43, s43, s22
    s_mul_i32 s45, s43, 40960
    s_lshl_b32 s46, s41, 7
    s_add_u32 s45, s45, s46
    s_add_u32 m0, s44, 16384
    s_add_u32 s46, s45, 0
    buffer_load_dwordx4 v5, s[12:15], s46 offen nt lds
    s_add_u32 m0, s44, 17408
    s_add_u32 s46, s45, 10240
    buffer_load_dwordx4 v5, s[12:15], s46 offen nt lds
    s_add_u32 m0, s44, 18432
    s_add_u32 s46, s45, 20480
    buffer_load_dwordx4 v5, s[12:15], s46 offen nt lds
    s_add_u32 m0, s44, 19456
    s_add_u32 s46, s45, 30720
    buffer_load_dwordx4 v5, s[12:15], s46 offen nt lds
    s_lshl_b32 s46, s41, 2
    s_add_u32 s46, s46, s22
    s_mul_i32 s46, s46, 48
    s_lshl_b32 s47, s42, 2
    s_add_u32 s46, s46, s47
    s_lshl_b32 s46, s46, 10
    s_add_u32 s51, s46, 8781824
    s_mul_i32 s40, s26, 5
    s_add_u32 s40, s40, 2
    s_mul_i32 s41, s40, 171
    s_lshr_b32 s41, s41, 11
    s_mul_i32 s42, s41, 12
    s_sub_u32 s42, s40, s42
    s_lshl_b32 s43, s42, 2
    s_add_u32 s43, s43, s22
    s_mul_i32 s45, s43, 40960
    s_lshl_b32 s46, s41, 7
    s_add_u32 s45, s45, s46
    s_add_u32 m0, s44, 32768
    s_add_u32 s46, s45, 0
    buffer_load_dwordx4 v5, s[12:15], s46 offen nt lds
    s_add_u32 m0, s44, 33792
    s_add_u32 s46, s45, 10240
    buffer_load_dwordx4 v5, s[12:15], s46 offen nt lds
    s_add_u32 m0, s44, 34816
    s_add_u32 s46, s45, 20480
    buffer_load_dwordx4 v5, s[12:15], s46 offen nt lds
    s_add_u32 m0, s44, 35840
    s_add_u32 s46, s45, 30720
    buffer_load_dwordx4 v5, s[12:15], s46 offen nt lds
    s_lshl_b32 s46, s41, 2
    s_add_u32 s46, s46, s22
    s_mul_i32 s46, s46, 48
    s_lshl_b32 s47, s42, 2
    s_add_u32 s46, s46, s47
    s_lshl_b32 s46, s46, 10
    s_add_u32 s52, s46, 8781824
    s_mul_i32 s40, s26, 5
    s_add_u32 s40, s40, 3
    s_mul_i32 s41, s40, 171
    s_lshr_b32 s41, s41, 11
    s_mul_i32 s42, s41, 12
    s_sub_u32 s42, s40, s42
    s_lshl_b32 s43, s42, 2
    s_add_u32 s43, s43, s22
    s_mul_i32 s45, s43, 40960
    s_lshl_b32 s46, s41, 7
    s_add_u32 s45, s45, s46
    s_add_u32 m0, s44, 49152
    s_add_u32 s46, s45, 0
    buffer_load_dwordx4 v5, s[12:15], s46 offen nt lds
    s_add_u32 m0, s44, 50176
    s_add_u32 s46, s45, 10240
    buffer_load_dwordx4 v5, s[12:15], s46 offen nt lds
    s_add_u32 m0, s44, 51200
    s_add_u32 s46, s45, 20480
    buffer_load_dwordx4 v5, s[12:15], s46 offen nt lds
    s_add_u32 m0, s44, 52224
    s_add_u32 s46, s45, 30720
    buffer_load_dwordx4 v5, s[12:15], s46 offen nt lds
    s_lshl_b32 s46, s41, 2
    s_add_u32 s46, s46, s22
    s_mul_i32 s46, s46, 48
    s_lshl_b32 s47, s42, 2
    s_add_u32 s46, s46, s47
    s_lshl_b32 s46, s46, 10
    s_add_u32 s53, s46, 8781824
    s_mul_i32 s40, s26, 5
    s_add_u32 s40, s40, 4
    s_mul_i32 s41, s40, 171
    s_lshr_b32 s41, s41, 11
    s_mul_i32 s42, s41, 12
    s_sub_u32 s42, s40, s42
    s_lshl_b32 s43, s42, 2
    s_add_u32 s43, s43, s22
    s_mul_i32 s45, s43, 40960
    s_lshl_b32 s46, s41, 7
    s_add_u32 s45, s45, s46
    s_add_u32 m0, s44, 65536
    s_add_u32 s46, s45, 0
    buffer_load_dwordx4 v5, s[12:15], s46 offen nt lds
    s_add_u32 m0, s44, 66560
    s_add_u32 s46, s45, 10240
    buffer_load_dwordx4 v5, s[12:15], s46 offen nt lds
    s_add_u32 m0, s44, 67584
    s_add_u32 s46, s45, 20480
    buffer_load_dwordx4 v5, s[12:15], s46 offen nt lds
    s_add_u32 m0, s44, 68608
    s_add_u32 s46, s45, 30720
    buffer_load_dwordx4 v5, s[12:15], s46 offen nt lds
    s_lshl_b32 s46, s41, 2
    s_add_u32 s46, s46, s22
    s_mul_i32 s46, s46, 48
    s_lshl_b32 s47, s42, 2
    s_add_u32 s46, s46, s47
    s_lshl_b32 s46, s46, 10
    s_add_u32 s54, s46, 8781824
    s_waitcnt vmcnt(0)
    s_barrier
    ds_read_b64_tr_b16 v[16:17], v11 offset:0
    ds_read_b64_tr_b16 v[18:19], v11 offset:2048
    ds_read_b64_tr_b16 v[20:21], v11 offset:4096
    ds_read_b64_tr_b16 v[22:23], v11 offset:6144
    ds_read_b64_tr_b16 v[24:25], v11 offset:8192
    ds_read_b64_tr_b16 v[26:27], v11 offset:10240
    ds_read_b64_tr_b16 v[28:29], v11 offset:12288
    ds_read_b64_tr_b16 v[30:31], v11 offset:14336
    ds_read_b64_tr_b16 v[32:33], v11 offset:16384
    ds_read_b64_tr_b16 v[34:35], v11 offset:18432
    ds_read_b64_tr_b16 v[36:37], v11 offset:20480
    ds_read_b64_tr_b16 v[38:39], v11 offset:22528
    ds_read_b64_tr_b16 v[40:41], v11 offset:24576
    ds_read_b64_tr_b16 v[42:43], v11 offset:26624
    ds_read_b64_tr_b16 v[44:45], v11 offset:28672
    ds_read_b64_tr_b16 v[46:47], v11 offset:30720
    ds_read_b64_tr_b16 v[48:49], v12 offset:0
    ds_read_b64_tr_b16 v[50:51], v12 offset:2048
    ds_read_b64_tr_b16 v[52:53], v12 offset:4096
    ds_read_b64_tr_b16 v[54:55], v12 offset:6144
    ds_read_b64_tr_b16 v[56:57], v12 offset:8192
    ds_read_b64_tr_b16 v[58:59], v12 offset:10240
    ds_read_b64_tr_b16 v[60:61], v12 offset:12288
    ds_read_b64_tr_b16 v[62:63], v12 offset:14336
    ds_read_b64_tr_b16 v[64:65], v12 offset:16384
    ds_read_b64_tr_b16 v[66:67], v12 offset:18432
    ds_read_b64_tr_b16 v[68:69], v12 offset:20480
    ds_read_b64_tr_b16 v[70:71], v12 offset:22528
    ds_read_b64_tr_b16 v[72:73], v12 offset:24576
    ds_read_b64_tr_b16 v[74:75], v12 offset:26624
    ds_read_b64_tr_b16 v[76:77], v12 offset:28672
    ds_read_b64_tr_b16 v[78:79], v12 offset:30720
    ds_read_b64_tr_b16 v[80:81], v13 offset:0
    ds_read_b64_tr_b16 v[82:83], v13 offset:2048
    ds_read_b64_tr_b16 v[84:85], v13 offset:4096
    ds_read_b64_tr_b16 v[86:87], v13 offset:6144
    ds_read_b64_tr_b16 v[88:89], v13 offset:8192
    ds_read_b64_tr_b16 v[90:91], v13 offset:10240
    ds_read_b64_tr_b16 v[92:93], v13 offset:12288
    ds_read_b64_tr_b16 v[94:95], v13 offset:14336
    s_waitcnt lgkmcnt(0)
    s_barrier
    buffer_store_dwordx4 v[16:19], v2, s[4:7], s50 offen offset:0 sc1
    buffer_store_dwordx4 v[20:23], v2, s[4:7], s50 offen offset:1024 sc1
    buffer_store_dwordx4 v[24:27], v2, s[4:7], s50 offen offset:2048 sc1
    buffer_store_dwordx4 v[28:31], v2, s[4:7], s50 offen offset:3072 sc1
    buffer_store_dwordx4 v[32:35], v2, s[4:7], s51 offen offset:0 sc1
    buffer_store_dwordx4 v[36:39], v2, s[4:7], s51 offen offset:1024 sc1
    buffer_store_dwordx4 v[40:43], v2, s[4:7], s51 offen offset:2048 sc1
    buffer_store_dwordx4 v[44:47], v2, s[4:7], s51 offen offset:3072 sc1
    buffer_store_dwordx4 v[48:51], v2, s[4:7], s52 offen offset:0 sc1
    buffer_store_dwordx4 v[52:55], v2, s[4:7], s52 offen offset:1024 sc1
    buffer_store_dwordx4 v[56:59], v2, s[4:7], s52 offen offset:2048 sc1
    buffer_store_dwordx4 v[60:63], v2, s[4:7], s52 offen offset:3072 sc1
    buffer_store_dwordx4 v[64:67], v2, s[4:7], s53 offen offset:0 sc1
    buffer_store_dwordx4 v[68:71], v2, s[4:7], s53 offen offset:1024 sc1
    buffer_store_dwordx4 v[72:75], v2, s[4:7], s53 offen offset:2048 sc1
    buffer_store_dwordx4 v[76:79], v2, s[4:7], s53 offen offset:3072 sc1
    buffer_store_dwordx4 v[80:83], v2, s[4:7], s54 offen offset:0 sc1
    buffer_store_dwordx4 v[84:87], v2, s[4:7], s54 offen offset:1024 sc1
    buffer_store_dwordx4 v[88:91], v2, s[4:7], s54 offen offset:2048 sc1
    buffer_store_dwordx4 v[92:95], v2, s[4:7], s54 offen offset:3072 sc1
    s_waitcnt vmcnt(0)
    s_barrier
    s_cmp_lg_u32 s22, 0
    s_cbranch_scc1 Lcu_201
    v_mov_b32 v3, 0
    v_mov_b32 v4, 1
    s_mov_b64 exec, 1
    global_atomic_add v3, v4, s[74:75] offset:64 sc1
    s_mov_b64 exec, -1
Lcu_201:
    s_mov_b32 s31, 262144
    v_mov_b32 v4, 0
Lwc_202:
    global_load_dword v3, v4, s[74:75] offset:64 sc1
    s_waitcnt vmcnt(0)
    v_cmp_gt_u32 vcc, 24, v3
    s_cbranch_vccz Lwe_203
    s_sleep 16
    s_sub_u32 s31, s31, 1
    s_cbranch_scc0 Lwc_202
    s_mov_b32 s31, 10
    s_branch L_fail
Lwe_203:
    s_mov_b32 s31, 262144
    v_lshlrev_b32 v18, 2, v1
    s_mov_b32 exec_hi, 0
Lwr_204:
    global_load_dword v16, v18, s[74:75] offset:128 sc1
    s_mov_b32 s23, 0
    s_mov_b32 s38, 0
    s_waitcnt vmcnt(0)
    v_cmp_eq_u32 vcc, 0x20, v16
    s_nop 0
    s_or_b32 s38, s38, vcc_lo
    v_cmp_eq_u32 vcc, 0x2000, v16
    s_nop 0
    s_or_b32 s38, s38, vcc_lo
    v_cmp_eq_u32 vcc, 0x200000, v16
    s_nop 0
    s_or_b32 s38, s38, vcc_lo
    v_cmp_eq_u32 vcc, 0x20000000, v16
    s_nop 0
    s_or_b32 s38, s38, vcc_lo
    v_sad_u8 v17, v16, 0, 0
    s_bcnt1_i32_b32 s38, s38
    s_cmp_eq_u32 s38, 8
    s_cbranch_scc1 Lwd_205
    v_add_u32_dpp v17, v17, v17 row_shr:1 row_mask:0xf bank_mask:0xf bound_ctrl:0
    s_nop 1
    v_add_u32_dpp v17, v17, v17 row_shr:2 row_mask:0xf bank_mask:0xf bound_ctrl:0
    s_nop 1
    v_add_u32_dpp v17, v17, v17 row_shr:4 row_mask:0xf bank_mask:0xf bound_ctrl:0
    s_nop 1
    v_add_u32_dpp v17, v17, v17 row_shr:8 row_mask:0xf bank_mask:0xf bound_ctrl:0
    s_nop 0
    v_readlane_b32 s38, v17, 15
    v_readlane_b32 s39, v17, 31
    s_mov_b32 s23, 1
    s_add_u32 s38, s38, s39
    s_cmp_eq_u32 s38, 256
    s_cbranch_scc1 Lwd_205
    s_sleep 32
    s_sub_u32 s31, s31, 1
    s_cbranch_scc0 Lwr_204
    s_mov_b32 s31, 10
    s_branch L_fail
Lwd_205:
    s_mov_b64 exec, -1
L_ffn_task:
    s_lshl_b32 s38, s24, 2
    s_add_u32 s38, s38, s22
    s_mul_i32 s39, s38, 20480
    s_add_u32 s39, s39, 4194304
    s_mul_i32 s40, s22, 20480
    s_add_u32 m0, s40, 0
    s_nop 0
    buffer_load_dwordx4 v2, s[4:7], s39 offen lds
    s_add_u32 s39, s39, 1024
    s_add_u32 m0, s40, 1024
    s_nop 0
    buffer_load_dwordx4 v2, s[4:7], s39 offen lds
    s_add_u32 s39, s39, 1024
    s_add_u32 m0, s40, 2048
    s_nop 0
    buffer_load_dwordx4 v2, s[4:7], s39 offen lds
    s_add_u32 s39, s39, 1024
    s_add_u32 m0, s40, 3072
    s_nop 0
    buffer_load_dwordx4 v2, s[4:7], s39 offen lds
    s_add_u32 s39, s39, 1024
    s_add_u32 m0, s40, 4096
    s_nop 0
    buffer_load_dwordx4 v2, s[4:7], s39 offen lds
    s_add_u32 s39, s39, 1024
    s_add_u32 m0, s40, 5120
    s_nop 0
    buffer_load_dwordx4 v2, s[4:7], s39 offen lds
    s_add_u32 s39, s39, 1024
    s_add_u32 m0, s40, 6144
    s_nop 0
    buffer_load_dwordx4 v2, s[4:7], s39 offen lds
    s_add_u32 s39, s39, 1024
    s_add_u32 m0, s40, 7168
    s_nop 0
    buffer_load_dwordx4 v2, s[4:7], s39 offen lds
    s_add_u32 s39, s39, 1024
    s_add_u32 m0, s40, 8192
    s_nop 0
    buffer_load_dwordx4 v2, s[4:7], s39 offen lds
    s_add_u32 s39, s39, 1024
    s_add_u32 m0, s40, 9216
    s_nop 0
    buffer_load_dwordx4 v2, s[4:7], s39 offen lds
    s_add_u32 s39, s39, 1024
    s_add_u32 m0, s40, 10240
    s_nop 0
    buffer_load_dwordx4 v2, s[4:7], s39 offen lds
    s_add_u32 s39, s39, 1024
    s_add_u32 m0, s40, 11264
    s_nop 0
    buffer_load_dwordx4 v2, s[4:7], s39 offen lds
    s_add_u32 s39, s39, 1024
    s_add_u32 m0, s40, 12288
    s_nop 0
    buffer_load_dwordx4 v2, s[4:7], s39 offen lds
    s_add_u32 s39, s39, 1024
    s_add_u32 m0, s40, 13312
    s_nop 0
    buffer_load_dwordx4 v2, s[4:7], s39 offen lds
    s_add_u32 s39, s39, 1024
    s_add_u32 m0, s40, 14336
    s_nop 0
    buffer_load_dwordx4 v2, s[4:7], s39 offen lds
    s_add_u32 s39, s39, 1024
    s_add_u32 m0, s40, 15360
    s_nop 0
    buffer_load_dwordx4 v2, s[4:7], s39 offen lds
    s_add_u32 s39, s39, 1024
    s_add_u32 m0, s40, 16384
    s_nop 0
    buffer_load_dwordx4 v2, s[4:7], s39 offen lds
    s_add_u32 s39, s39, 1024
    s_add_u32 m0, s40, 17408
    s_nop 0
    buffer_load_dwordx4 v2, s[4:7], s39 offen lds
    s_add_u32 s39, s39, 1024
    s_add_u32 m0, s40, 18432
    s_nop 0
    buffer_load_dwordx4 v2, s[4:7], s39 offen lds
    s_add_u32 s39, s39, 1024
    s_add_u32 m0, s40, 19456
    s_nop 0
    buffer_load_dwordx4 v2, s[4:7], s39 offen lds
    s_add_u32 s39, s39, 1024
    v_accvgpr_write_b32 a0, 0
    v_accvgpr_write_b32 a1, 0
    v_accvgpr_write_b32 a2, 0
    v_accvgpr_write_b32 a3, 0
    v_accvgpr_write_b32 a4, 0
    v_accvgpr_write_b32 a5, 0
    v_accvgpr_write_b32 a6, 0
    v_accvgpr_write_b32 a7, 0
    v_accvgpr_write_b32 a8, 0
    v_accvgpr_write_b32 a9, 0
    v_accvgpr_write_b32 a10, 0
    v_accvgpr_write_b32 a11, 0
    v_accvgpr_write_b32 a12, 0
    v_accvgpr_write_b32 a13, 0
    v_accvgpr_write_b32 a14, 0
    v_accvgpr_write_b32 a15, 0
    v_accvgpr_write_b32 a16, 0
    v_accvgpr_write_b32 a17, 0
    v_accvgpr_write_b32 a18, 0
    v_accvgpr_write_b32 a19, 0
    v_accvgpr_write_b32 a20, 0
    v_accvgpr_write_b32 a21, 0
    v_accvgpr_write_b32 a22, 0
    v_accvgpr_write_b32 a23, 0
    v_accvgpr_write_b32 a24, 0
    v_accvgpr_write_b32 a25, 0
    v_accvgpr_write_b32 a26, 0
    v_accvgpr_write_b32 a27, 0
    v_accvgpr_write_b32 a28, 0
    v_accvgpr_write_b32 a29, 0
    v_accvgpr_write_b32 a30, 0
    v_accvgpr_write_b32 a31, 0
    v_accvgpr_write_b32 a32, 0
    v_accvgpr_write_b32 a33, 0
    v_accvgpr_write_b32 a34, 0
    v_accvgpr_write_b32 a35, 0
    v_accvgpr_write_b32 a36, 0
    v_accvgpr_write_b32 a37, 0
    v_accvgpr_write_b32 a38, 0
    v_accvgpr_write_b32 a39, 0
    v_accvgpr_write_b32 a40, 0
    v_accvgpr_write_b32 a41, 0
    v_accvgpr_write_b32 a42, 0
    v_accvgpr_write_b32 a43, 0
    v_accvgpr_write_b32 a44, 0
    v_accvgpr_write_b32 a45, 0
    v_accvgpr_write_b32 a46, 0
    v_accvgpr_write_b32 a47, 0
    v_accvgpr_write_b32 a48, 0
    v_accvgpr_write_b32 a49, 0
    v_accvgpr_write_b32 a50, 0
    v_accvgpr_write_b32 a51, 0
    v_accvgpr_write_b32 a52, 0
    v_accvgpr_write_b32 a53, 0
    v_accvgpr_write_b32 a54, 0
    v_accvgpr_write_b32 a55, 0
    v_accvgpr_write_b32 a56, 0
    v_accvgpr_write_b32 a57, 0
    v_accvgpr_write_b32 a58, 0
    v_accvgpr_write_b32 a59, 0
    v_accvgpr_write_b32 a60, 0
    v_accvgpr_write_b32 a61, 0
    v_accvgpr_write_b32 a62, 0
    v_accvgpr_write_b32 a63, 0
    v_accvgpr_write_b32 a64, 0
    v_accvgpr_write_b32 a65, 0
    v_accvgpr_write_b32 a66, 0
    v_accvgpr_write_b32 a67, 0
    v_accvgpr_write_b32 a68, 0
    v_accvgpr_write_b32 a69, 0
    v_accvgpr_write_b32 a70, 0
    v_accvgpr_write_b32 a71, 0
    v_accvgpr_write_b32 a72, 0
    v_accvgpr_write_b32 a73, 0
    v_accvgpr_write_b32 a74, 0
    v_accvgpr_write_b32 a75, 0
    v_accvgpr_write_b32 a76, 0
    v_accvgpr_write_b32 a77, 0
    v_accvgpr_write_b32 a78, 0
    v_accvgpr_write_b32 a79, 0
    v_accvgpr_write_b32 a80, 0
    v_accvgpr_write_b32 a81, 0
    v_accvgpr_write_b32 a82, 0
    v_accvgpr_write_b32 a83, 0
    v_accvgpr_write_b32 a84, 0
    v_accvgpr_write_b32 a85, 0
    v_accvgpr_write_b32 a86, 0
    v_accvgpr_write_b32 a87, 0
    v_accvgpr_write_b32 a88, 0
    v_accvgpr_write_b32 a89, 0
    v_accvgpr_write_b32 a90, 0
    v_accvgpr_write_b32 a91, 0
    v_accvgpr_write_b32 a92, 0
    v_accvgpr_write_b32 a93, 0
    v_accvgpr_write_b32 a94, 0
    v_accvgpr_write_b32 a95, 0
    v_accvgpr_write_b32 a96, 0
    v_accvgpr_write_b32 a97, 0
    v_accvgpr_write_b32 a98, 0
    v_accvgpr_write_b32 a99, 0
    v_accvgpr_write_b32 a100, 0
    v_accvgpr_write_b32 a101, 0
    v_accvgpr_write_b32 a102, 0
    v_accvgpr_write_b32 a103, 0
    v_accvgpr_write_b32 a104, 0
    v_accvgpr_write_b32 a105, 0
    v_accvgpr_write_b32 a106, 0
    v_accvgpr_write_b32 a107, 0
    v_accvgpr_write_b32 a108, 0
    v_accvgpr_write_b32 a109, 0
    v_accvgpr_write_b32 a110, 0
    v_accvgpr_write_b32 a111, 0
    v_accvgpr_write_b32 a112, 0
    v_accvgpr_write_b32 a113, 0
    v_accvgpr_write_b32 a114, 0
    v_accvgpr_write_b32 a115, 0
    v_accvgpr_write_b32 a116, 0
    v_accvgpr_write_b32 a117, 0
    v_accvgpr_write_b32 a118, 0
    v_accvgpr_write_b32 a119, 0
    v_accvgpr_write_b32 a120, 0
    v_accvgpr_write_b32 a121, 0
    v_accvgpr_write_b32 a122, 0
    v_accvgpr_write_b32 a123, 0
    v_accvgpr_write_b32 a124, 0
    v_accvgpr_write_b32 a125, 0
    v_accvgpr_write_b32 a126, 0
    v_accvgpr_write_b32 a127, 0
    v_accvgpr_write_b32 a128, 0
    v_accvgpr_write_b32 a129, 0
    v_accvgpr_write_b32 a130, 0
    v_accvgpr_write_b32 a131, 0
    v_accvgpr_write_b32 a132, 0
    v_accvgpr_write_b32 a133, 0
    v_accvgpr_write_b32 a134, 0
    v_accvgpr_write_b32 a135, 0
    v_accvgpr_write_b32 a136, 0
    v_accvgpr_write_b32 a137, 0
    v_accvgpr_write_b32 a138, 0
    v_accvgpr_write_b32 a139, 0
    v_accvgpr_write_b32 a140, 0
    v_accvgpr_write_b32 a141, 0
    v_accvgpr_write_b32 a142, 0
    v_accvgpr_write_b32 a143, 0
    v_accvgpr_write_b32 a144, 0
    v_accvgpr_write_b32 a145, 0
    v_accvgpr_write_b32 a146, 0
    v_accvgpr_write_b32 a147, 0
    v_accvgpr_write_b32 a148, 0
    v_accvgpr_write_b32 a149, 0
    v_accvgpr_write_b32 a150, 0
    v_accvgpr_write_b32 a151, 0
    v_accvgpr_write_b32 a152, 0
    v_accvgpr_write_b32 a153, 0
    v_accvgpr_write_b32 a154, 0
    v_accvgpr_write_b32 a155, 0
    v_accvgpr_write_b32 a156, 0
    v_accvgpr_write_b32 a157, 0
    v_accvgpr_write_b32 a158, 0
    v_accvgpr_write_b32 a159, 0
    s_mul_i32 s41, s22, 40960
    s_add_u32 s41, s41, 6815744
    s_mul_i32 s42, s22, 491520
    s_add_u32 s42, s42, 8781824
    v_add_u32 v3, 20480, v2
    s_mov_b32 s54, 0
    v_add_u32 v4, s54, v2
    s_mov_b32 s54, 49152
    v_add_u32 v5, s54, v2
    s_mov_b32 s54, 98304
    v_add_u32 v6, s54, v2
    s_mov_b32 s54, 147456
    v_add_u32 v7, s54, v2
    s_mov_b32 s54, 196608
    v_add_u32 v8, s54, v2
    s_mov_b32 s54, 245760
    v_add_u32 v9, s54, v2
    s_mov_b32 s54, 294912
    v_add_u32 v10, s54, v2
    s_mov_b32 s54, 344064
    v_add_u32 v11, s54, v2
    s_mov_b32 s54, 393216
    v_add_u32 v12, s54, v2
    s_mov_b32 s54, 442368
    v_add_u32 v13, s54, v2
    v_add_u32 v14, 98304, v2
    s_lshl_b32 s38, s22, 12
    v_add_u32 v15, s38, v14
    s_add_u32 s45, s41, 0
    buffer_load_dwordx4 v[96:99], v2, s[4:7], s45 offen offset:0
    s_add_u32 s45, s41, 0
    buffer_load_dwordx4 v[100:103], v3, s[4:7], s45 offen offset:0
    s_add_u32 s45, s41, 0
    buffer_load_dwordx4 v[104:107], v2, s[4:7], s45 offen offset:1024
    s_add_u32 s45, s41, 0
    buffer_load_dwordx4 v[108:111], v3, s[4:7], s45 offen offset:1024
    s_add_u32 s45, s41, 0
    buffer_load_dwordx4 v[112:115], v2, s[4:7], s45 offen offset:2048
    s_add_u32 s45, s41, 0
    buffer_load_dwordx4 v[116:119], v3, s[4:7], s45 offen offset:2048
    s_add_u32 s45, s41, 0
    buffer_load_dwordx4 v[120:123], v2, s[4:7], s45 offen offset:3072
    s_add_u32 s45, s41, 0
    buffer_load_dwordx4 v[124:127], v3, s[4:7], s45 offen offset:3072
    s_add_u32 s45, s41, 4096
    buffer_load_dwordx4 v[128:131], v2, s[4:7], s45 offen offset:0
    s_add_u32 s45, s41, 4096
    buffer_load_dwordx4 v[132:135], v3, s[4:7], s45 offen offset:0
    s_add_u32 s45, s41, 4096
    buffer_load_dwordx4 v[136:139], v2, s[4:7], s45 offen offset:1024
    s_add_u32 s45, s41, 4096
    buffer_load_dwordx4 v[140:143], v3, s[4:7], s45 offen offset:1024
    s_add_u32 s45, s41, 4096
    buffer_load_dwordx4 v[144:147], v2, s[4:7], s45 offen offset:2048
    s_add_u32 s45, s41, 4096
    buffer_load_dwordx4 v[148:151], v3, s[4:7], s45 offen offset:2048
    s_add_u32 s45, s41, 4096
    buffer_load_dwordx4 v[152:155], v2, s[4:7], s45 offen offset:3072
    s_add_u32 s45, s41, 4096
    buffer_load_dwordx4 v[156:159], v3, s[4:7], s45 offen offset:3072
    s_add_u32 s45, s41, 8192
    buffer_load_dwordx4 v[160:163], v2, s[4:7], s45 offen offset:0
    s_add_u32 s45, s41, 8192
    buffer_load_dwordx4 v[164:167], v3, s[4:7], s45 offen offset:0
    s_add_u32 s45, s41, 8192
    buffer_load_dwordx4 v[168:171], v2, s[4:7], s45 offen offset:1024
    s_add_u32 s45, s41, 8192
    buffer_load_dwordx4 v[172:175], v3, s[4:7], s45 offen offset:1024
    s_add_u32 s45, s41, 8192
    buffer_load_dwordx4 v[176:179], v2, s[4:7], s45 offen offset:2048
    s_add_u32 s45, s41, 8192
    buffer_load_dwordx4 v[180:183], v3, s[4:7], s45 offen offset:2048
    s_add_u32 s45, s41, 8192
    buffer_load_dwordx4 v[184:187], v2, s[4:7], s45 offen offset:3072
    s_add_u32 s45, s41, 8192
    buffer_load_dwordx4 v[188:191], v3, s[4:7], s45 offen offset:3072
    s_waitcnt vmcnt(24)
    s_barrier
    s_mov_b32 s30, 0
Lft_206:
    s_cmp_lt_u32 s30, 11
    s_cselect_b32 s46, 163840, 0
    s_cselect_b32 s47, 4096, 0
    s_add_u32 s43, s41, s46
    s_add_u32 s44, s42, s47
    ds_read_b128 v[48:51], v2 offset:0
    ds_read_b128 v[52:55], v2 offset:20480
    ds_read_b128 v[56:59], v2 offset:40960
    ds_read_b128 v[60:63], v3 offset:40960
    ds_read_b128 v[64:67], v2 offset:1024
    ds_read_b128 v[68:71], v2 offset:21504
    ds_read_b128 v[72:75], v2 offset:41984
    ds_read_b128 v[76:79], v3 offset:41984
    s_waitcnt vmcnt(22) lgkmcnt(4)
    v_mfma_f32_16x16x32_bf16 v[16:19], v[96:99], v[48:51], 0
    v_mfma_f32_16x16x32_bf16 v[20:23], v[96:99], v[52:55], 0
    v_mfma_f32_16x16x32_bf16 v[24:27], v[96:99], v[56:59], 0
    v_mfma_f32_16x16x32_bf16 v[28:31], v[96:99], v[60:63], 0
    v_mfma_f32_16x16x32_bf16 v[32:35], v[100:103], v[48:51], 0
    v_mfma_f32_16x16x32_bf16 v[36:39], v[100:103], v[52:55], 0
    v_mfma_f32_16x16x32_bf16 v[40:43], v[100:103], v[56:59], 0
    v_mfma_f32_16x16x32_bf16 v[44:47], v[100:103], v[60:63], 0
    s_add_u32 s45, s41, 12288
    buffer_load_dwordx4 v[192:195], v2, s[4:7], s45 offen offset:0
    s_add_u32 s45, s41, 12288
    buffer_load_dwordx4 v[196:199], v3, s[4:7], s45 offen offset:0
    ds_read_b128 v[48:51], v2 offset:2048
    ds_read_b128 v[52:55], v2 offset:22528
    ds_read_b128 v[56:59], v2 offset:43008
    ds_read_b128 v[60:63], v3 offset:43008
    s_waitcnt vmcnt(22) lgkmcnt(4)
    v_mfma_f32_16x16x32_bf16 v[16:19], v[104:107], v[64:67], v[16:19]
    v_mfma_f32_16x16x32_bf16 v[20:23], v[104:107], v[68:71], v[20:23]
    v_mfma_f32_16x16x32_bf16 v[24:27], v[104:107], v[72:75], v[24:27]
    v_mfma_f32_16x16x32_bf16 v[28:31], v[104:107], v[76:79], v[28:31]
    v_mfma_f32_16x16x32_bf16 v[32:35], v[108:111], v[64:67], v[32:35]
    v_mfma_f32_16x16x32_bf16 v[36:39], v[108:111], v[68:71], v[36:39]
    v_mfma_f32_16x16x32_bf16 v[40:43], v[108:111], v[72:75], v[40:43]
    v_mfma_f32_16x16x32_bf16 v[44:47], v[108:111], v[76:79], v[44:47]
    s_add_u32 s45, s41, 12288
    buffer_load_dwordx4 v[200:203], v2, s[4:7], s45 offen offset:1024
    s_add_u32 s45, s41, 12288
    buffer_load_dwordx4 v[204:207], v3, s[4:7], s45 offen offset:1024
    ds_read_b128 v[64:67], v2 offset:3072
    ds_read_b128 v[68:71], v2 offset:23552
    ds_read_b128 v[72:75], v2 offset:44032
    ds_read_b128 v[76:79], v3 offset:44032
    s_waitcnt vmcnt(22) lgkmcnt(4)
    v_mfma_f32_16x16x32_bf16 v[16:19], v[112:115], v[48:51], v[16:19]
    v_mfma_f32_16x16x32_bf16 v[20:23], v[112:115], v[52:55], v[20:23]
    v_mfma_f32_16x16x32_bf16 v[24:27], v[112:115], v[56:59], v[24:27]
    v_mfma_f32_16x16x32_bf16 v[28:31], v[112:115], v[60:63], v[28:31]
    v_mfma_f32_16x16x32_bf16 v[32:35], v[116:119], v[48:51], v[32:35]
    v_mfma_f32_16x16x32_bf16 v[36:39], v[116:119], v[52:55], v[36:39]
    v_mfma_f32_16x16x32_bf16 v[40:43], v[116:119], v[56:59], v[40:43]
    v_mfma_f32_16x16x32_bf16 v[44:47], v[116:119], v[60:63], v[44:47]
    s_add_u32 s45, s41, 12288
    buffer_load_dwordx4 v[208:211], v2, s[4:7], s45 offen offset:2048
    s_add_u32 s45, s41, 12288
    buffer_load_dwordx4 v[212:215], v3, s[4:7], s45 offen offset:2048
    ds_read_b128 v[48:51], v2 offset:4096
    ds_read_b128 v[52:55], v2 offset:24576
    ds_read_b128 v[56:59], v2 offset:45056
    ds_read_b128 v[60:63], v3 offset:45056
    s_waitcnt vmcnt(22) lgkmcnt(4)
    v_mfma_f32_16x16x32_bf16 v[16:19], v[120:123], v[64:67], v[16:19]
    v_mfma_f32_16x16x32_bf16 v[20:23], v[120:123], v[68:71], v[20:23]
    v_mfma_f32_16x16x32_bf16 v[24:27], v[120:123], v[72:75], v[24:27]
    v_mfma_f32_16x16x32_bf16 v[28:31], v[120:123], v[76:79], v[28:31]
    v_mfma_f32_16x16x32_bf16 v[32:35], v[124:127], v[64:67], v[32:35]
    v_mfma_f32_16x16x32_bf16 v[36:39], v[124:127], v[68:71], v[36:39]
    v_mfma_f32_16x16x32_bf16 v[40:43], v[124:127], v[72:75], v[40:43]
    v_mfma_f32_16x16x32_bf16 v[44:47], v[124:127], v[76:79], v[44:47]
    s_add_u32 s45, s41, 12288
    buffer_load_dwordx4 v[216:219], v2, s[4:7], s45 offen offset:3072
    s_add_u32 s45, s41, 12288
    buffer_load_dwordx4 v[220:223], v3, s[4:7], s45 offen offset:3072
    ds_read_b128 v[64:67], v2 offset:5120
    ds_read_b128 v[68:71], v2 offset:25600
    ds_read_b128 v[72:75], v2 offset:46080
    ds_read_b128 v[76:79], v3 offset:46080
    s_waitcnt vmcnt(22) lgkmcnt(4)
    v_mfma_f32_16x16x32_bf16 v[16:19], v[128:131], v[48:51], v[16:19]
    v_mfma_f32_16x16x32_bf16 v[20:23], v[128:131], v[52:55], v[20:23]
    v_mfma_f32_16x16x32_bf16 v[24:27], v[128:131], v[56:59], v[24:27]
    v_mfma_f32_16x16x32_bf16 v[28:31], v[128:131], v[60:63], v[28:31]
    v_mfma_f32_16x16x32_bf16 v[32:35], v[132:135], v[48:51], v[32:35]
    v_mfma_f32_16x16x32_bf16 v[36:39], v[132:135], v[52:55], v[36:39]
    v_mfma_f32_16x16x32_bf16 v[40:43], v[132:135], v[56:59], v[40:43]
    v_mfma_f32_16x16x32_bf16 v[44:47], v[132:135], v[60:63], v[44:47]
    s_add_u32 s45, s41, 16384
    buffer_load_dwordx4 v[224:227], v2, s[4:7], s45 offen offset:0
    s_add_u32 s45, s41, 16384
    buffer_load_dwordx4 v[228:231], v3, s[4:7], s45 offen offset:0
    ds_read_b128 v[48:51], v2 offset:6144
    ds_read_b128 v[52:55], v2 offset:26624
    ds_read_b128 v[56:59], v2 offset:47104
    ds_read_b128 v[60:63], v3 offset:47104
    s_waitcnt vmcnt(22) lgkmcnt(4)
    v_mfma_f32_16x16x32_bf16 v[16:19], v[136:139], v[64:67], v[16:19]
    v_mfma_f32_16x16x32_bf16 v[20:23], v[136:139], v[68:71], v[20:23]
    v_mfma_f32_16x16x32_bf16 v[24:27], v[136:139], v[72:75], v[24:27]
    v_mfma_f32_16x16x32_bf16 v[28:31], v[136:139], v[76:79], v[28:31]
    v_mfma_f32_16x16x32_bf16 v[32:35], v[140:143], v[64:67], v[32:35]
    v_mfma_f32_16x16x32_bf16 v[36:39], v[140:143], v[68:71], v[36:39]
    v_mfma_f32_16x16x32_bf16 v[40:43], v[140:143], v[72:75], v[40:43]
    v_mfma_f32_16x16x32_bf16 v[44:47], v[140:143], v[76:79], v[44:47]
    s_add_u32 s45, s41, 16384
    buffer_load_dwordx4 v[232:235], v2, s[4:7], s45 offen offset:1024
    s_add_u32 s45, s41, 16384
    buffer_load_dwordx4 v[236:239], v3, s[4:7], s45 offen offset:1024
    ds_read_b128 v[64:67], v2 offset:7168
    ds_read_b128 v[68:71], v2 offset:27648
    ds_read_b128 v[72:75], v2 offset:48128
    ds_read_b128 v[76:79], v3 offset:48128
    s_waitcnt vmcnt(22) lgkmcnt(4)
    v_mfma_f32_16x16x32_bf16 v[16:19], v[144:147], v[48:51], v[16:19]
    v_mfma_f32_16x16x32_bf16 v[20:23], v[144:147], v[52:55], v[20:23]
    v_mfma_f32_16x16x32_bf16 v[24:27], v[144:147], v[56:59], v[24:27]
    v_mfma_f32_16x16x32_bf16 v[28:31], v[144:147], v[60:63], v[28:31]
    v_mfma_f32_16x16x32_bf16 v[32:35], v[148:151], v[48:51], v[32:35]
    v_mfma_f32_16x16x32_bf16 v[36:39], v[148:151], v[52:55], v[36:39]
    v_mfma_f32_16x16x32_bf16 v[40:43], v[148:151], v[56:59], v[40:43]
    v_mfma_f32_16x16x32_bf16 v[44:47], v[148:151], v[60:63], v[44:47]
    s_add_u32 s45, s41, 16384
    buffer_load_dwordx4 v[240:243], v2, s[4:7], s45 offen offset:2048
    s_add_u32 s45, s41, 16384
    buffer_load_dwordx4 v[244:247], v3, s[4:7], s45 offen offset:2048
    ds_read_b128 v[48:51], v2 offset:8192
    ds_read_b128 v[52:55], v2 offset:28672
    ds_read_b128 v[56:59], v2 offset:49152
    ds_read_b128 v[60:63], v3 offset:49152
    s_waitcnt vmcnt(22) lgkmcnt(4)
    v_mfma_f32_16x16x32_bf16 v[16:19], v[152:155], v[64:67], v[16:19]
    v_mfma_f32_16x16x32_bf16 v[20:23], v[152:155], v[68:71], v[20:23]
    v_mfma_f32_16x16x32_bf16 v[24:27], v[152:155], v[72:75], v[24:27]
    v_mfma_f32_16x16x32_bf16 v[28:31], v[152:155], v[76:79], v[28:31]
    v_mfma_f32_16x16x32_bf16 v[32:35], v[156:159], v[64:67], v[32:35]
    v_mfma_f32_16x16x32_bf16 v[36:39], v[156:159], v[68:71], v[36:39]
    v_mfma_f32_16x16x32_bf16 v[40:43], v[156:159], v[72:75], v[40:43]
    v_mfma_f32_16x16x32_bf16 v[44:47], v[156:159], v[76:79], v[44:47]
    s_add_u32 s45, s41, 16384
    buffer_load_dwordx4 v[248:251], v2, s[4:7], s45 offen offset:3072
    s_add_u32 s45, s41, 16384
    buffer_load_dwordx4 v[252:255], v3, s[4:7], s45 offen offset:3072
    ds_read_b128 v[64:67], v2 offset:9216
    ds_read_b128 v[68:71], v2 offset:29696
    ds_read_b128 v[72:75], v2 offset:50176
    ds_read_b128 v[76:79], v3 offset:50176
    s_waitcnt vmcnt(22) lgkmcnt(4)
    v_mfma_f32_16x16x32_bf16 v[16:19], v[160:163], v[48:51], v[16:19]
    v_mfma_f32_16x16x32_bf16 v[20:23], v[160:163], v[52:55], v[20:23]
    v_mfma_f32_16x16x32_bf16 v[24:27], v[160:163], v[56:59], v[24:27]
    v_mfma_f32_16x16x32_bf16 v[28:31], v[160:163], v[60:63], v[28:31]
    v_mfma_f32_16x16x32_bf16 v[32:35], v[164:167], v[48:51], v[32:35]
    v_mfma_f32_16x16x32_bf16 v[36:39], v[164:167], v[52:55], v[36:39]
    v_mfma_f32_16x16x32_bf16 v[40:43], v[164:167], v[56:59], v[40:43]
    v_mfma_f32_16x16x32_bf16 v[44:47], v[164:167], v[60:63], v[44:47]
    buffer_load_dwordx4 v[96:99], v4, s[4:7], s42 offen offset:0
    buffer_load_dwordx4 v[100:103], v5, s[4:7], s42 offen offset:0
    ds_read_b128 v[48:51], v2 offset:10240
    ds_read_b128 v[52:55], v2 offset:30720
    ds_read_b128 v[56:59], v2 offset:51200
    ds_read_b128 v[60:63], v3 offset:51200
    s_waitcnt vmcnt(22) lgkmcnt(4)
    v_mfma_f32_16x16x32_bf16 v[16:19], v[168:171], v[64:67], v[16:19]
    v_mfma_f32_16x16x32_bf16 v[20:23], v[168:171], v[68:71], v[20:23]
    v_mfma_f32_16x16x32_bf16 v[24:27], v[168:171], v[72:75], v[24:27]
    v_mfma_f32_16x16x32_bf16 v[28:31], v[168:171], v[76:79], v[28:31]
    v_mfma_f32_16x16x32_bf16 v[32:35], v[172:175], v[64:67], v[32:35]
    v_mfma_f32_16x16x32_bf16 v[36:39], v[172:175], v[68:71], v[36:39]
    v_mfma_f32_16x16x32_bf16 v[40:43], v[172:175], v[72:75], v[40:43]
    v_mfma_f32_16x16x32_bf16 v[44:47], v[172:175], v[76:79], v[44:47]
    buffer_load_dwordx4 v[104:107], v6, s[4:7], s42 offen offset:0
    buffer_load_dwordx4 v[108:111], v7, s[4:7], s42 offen offset:0
    ds_read_b128 v[64:67], v2 offset:11264
    ds_read_b128 v[68:71], v2 offset:31744
    ds_read_b128 v[72:75], v2 offset:52224
    ds_read_b128 v[76:79], v3 offset:52224
    s_waitcnt vmcnt(22) lgkmcnt(4)
    v_mfma_f32_16x16x32_bf16 v[16:19], v[176:179], v[48:51], v[16:19]
    v_mfma_f32_16x16x32_bf16 v[20:23], v[176:179], v[52:55], v[20:23]
    v_mfma_f32_16x16x32_bf16 v[24:27], v[176:179], v[56:59], v[24:27]
    v_mfma_f32_16x16x32_bf16 v[28:31], v[176:179], v[60:63], v[28:31]
    v_mfma_f32_16x16x32_bf16 v[32:35], v[180:183], v[48:51], v[32:35]
    v_mfma_f32_16x16x32_bf16 v[36:39], v[180:183], v[52:55], v[36:39]
    v_mfma_f32_16x16x32_bf16 v[40:43], v[180:183], v[56:59], v[40:43]
    v_mfma_f32_16x16x32_bf16 v[44:47], v[180:183], v[60:63], v[44:47]
    buffer_load_dwordx4 v[112:115], v8, s[4:7], s42 offen offset:0
    buffer_load_dwordx4 v[116:119], v9, s[4:7], s42 offen offset:0
    ds_read_b128 v[48:51], v2 offset:12288
    ds_read_b128 v[52:55], v2 offset:32768
    ds_read_b128 v[56:59], v2 offset:53248
    ds_read_b128 v[60:63], v3 offset:53248
    s_waitcnt vmcnt(22) lgkmcnt(4)
    v_mfma_f32_16x16x32_bf16 v[16:19], v[184:187], v[64:67], v[16:19]
    v_mfma_f32_16x16x32_bf16 v[20:23], v[184:187], v[68:71], v[20:23]
    v_mfma_f32_16x16x32_bf16 v[24:27], v[184:187], v[72:75], v[24:27]
    v_mfma_f32_16x16x32_bf16 v[28:31], v[184:187], v[76:79], v[28:31]
    v_mfma_f32_16x16x32_bf16 v[32:35], v[188:191], v[64:67], v[32:35]
    v_mfma_f32_16x16x32_bf16 v[36:39], v[188:191], v[68:71], v[36:39]
    v_mfma_f32_16x16x32_bf16 v[40:43], v[188:191], v[72:75], v[40:43]
    v_mfma_f32_16x16x32_bf16 v[44:47], v[188:191], v[76:79], v[44:47]
    buffer_load_dwordx4 v[120:123], v10, s[4:7], s42 offen offset:0
    buffer_load_dwordx4 v[124:127], v11, s[4:7], s42 offen offset:0
    ds_read_b128 v[64:67], v2 offset:13312
    ds_read_b128 v[68:71], v2 offset:33792
    ds_read_b128 v[72:75], v2 offset:54272
    ds_read_b128 v[76:79], v3 offset:54272
    s_waitcnt vmcnt(22) lgkmcnt(4)
    v_mfma_f32_16x16x32_bf16 v[16:19], v[192:195], v[48:51], v[16:19]
    v_mfma_f32_16x16x32_bf16 v[20:23], v[192:195], v[52:55], v[20:23]
    v_mfma_f32_16x16x32_bf16 v[24:27], v[192:195], v[56:59], v[24:27]
    v_mfma_f32_16x16x32_bf16 v[28:31], v[192:195], v[60:63], v[28:31]
    v_mfma_f32_16x16x32_bf16 v[32:35], v[196:199], v[48:51], v[32:35]
    v_mfma_f32_16x16x32_bf16 v[36:39], v[196:199], v[52:55], v[36:39]
    v_mfma_f32_16x16x32_bf16 v[40:43], v[196:199], v[56:59], v[40:43]
    v_mfma_f32_16x16x32_bf16 v[44:47], v[196:199], v[60:63], v[44:47]
    buffer_load_dwordx4 v[128:131], v12, s[4:7], s42 offen offset:0
    buffer_load_dwordx4 v[132:135], v13, s[4:7], s42 offen offset:0
    ds_read_b128 v[48:51], v2 offset:14336
    ds_read_b128 v[52:55], v2 offset:34816
    ds_read_b128 v[56:59], v2 offset:55296
    ds_read_b128 v[60:63], v3 offset:55296
    s_waitcnt vmcnt(22) lgkmcnt(4)
    v_mfma_f32_16x16x32_bf16 v[16:19], v[200:203], v[64:67], v[16:19]
    v_mfma_f32_16x16x32_bf16 v[20:23], v[200:203], v[68:71], v[20:23]
    v_mfma_f32_16x16x32_bf16 v[24:27], v[200:203], v[72:75], v[24:27]
    v_mfma_f32_16x16x32_bf16 v[28:31], v[200:203], v[76:79], v[28:31]
    v_mfma_f32_16x16x32_bf16 v[32:35], v[204:207], v[64:67], v[32:35]
    v_mfma_f32_16x16x32_bf16 v[36:39], v[204:207], v[68:71], v[36:39]
    v_mfma_f32_16x16x32_bf16 v[40:43], v[204:207], v[72:75], v[40:43]
    v_mfma_f32_16x16x32_bf16 v[44:47], v[204:207], v[76:79], v[44:47]
    buffer_load_dwordx4 v[136:139], v4, s[4:7], s42 offen offset:1024
    buffer_load_dwordx4 v[140:143], v5, s[4:7], s42 offen offset:1024
    ds_read_b128 v[64:67], v2 offset:15360
    ds_read_b128 v[68:71], v2 offset:35840
    ds_read_b128 v[72:75], v2 offset:56320
    ds_read_b128 v[76:79], v3 offset:56320
    s_waitcnt vmcnt(22) lgkmcnt(4)
    v_mfma_f32_16x16x32_bf16 v[16:19], v[208:211], v[48:51], v[16:19]
    v_mfma_f32_16x16x32_bf16 v[20:23], v[208:211], v[52:55], v[20:23]
    v_mfma_f32_16x16x32_bf16 v[24:27], v[208:211], v[56:59], v[24:27]
    v_mfma_f32_16x16x32_bf16 v[28:31], v[208:211], v[60:63], v[28:31]
    v_mfma_f32_16x16x32_bf16 v[32:35], v[212:215], v[48:51], v[32:35]
    v_mfma_f32_16x16x32_bf16 v[36:39], v[212:215], v[52:55], v[36:39]
    v_mfma_f32_16x16x32_bf16 v[40:43], v[212:215], v[56:59], v[40:43]
    v_mfma_f32_16x16x32_bf16 v[44:47], v[212:215], v[60:63], v[44:47]
    buffer_load_dwordx4 v[144:147], v6, s[4:7], s42 offen offset:1024
    buffer_load_dwordx4 v[148:151], v7, s[4:7], s42 offen offset:1024
    ds_read_b128 v[48:51], v2 offset:16384
    ds_read_b128 v[52:55], v2 offset:36864
    ds_read_b128 v[56:59], v2 offset:57344
    ds_read_b128 v[60:63], v3 offset:57344
    s_waitcnt vmcnt(22) lgkmcnt(4)
    v_mfma_f32_16x16x32_bf16 v[16:19], v[216:219], v[64:67], v[16:19]
    v_mfma_f32_16x16x32_bf16 v[20:23], v[216:219], v[68:71], v[20:23]
    v_mfma_f32_16x16x32_bf16 v[24:27], v[216:219], v[72:75], v[24:27]
    v_mfma_f32_16x16x32_bf16 v[28:31], v[216:219], v[76:79], v[28:31]
    v_mfma_f32_16x16x32_bf16 v[32:35], v[220:223], v[64:67], v[32:35]
    v_mfma_f32_16x16x32_bf16 v[36:39], v[220:223], v[68:71], v[36:39]
    v_mfma_f32_16x16x32_bf16 v[40:43], v[220:223], v[72:75], v[40:43]
    v_mfma_f32_16x16x32_bf16 v[44:47], v[220:223], v[76:79], v[44:47]
    buffer_load_dwordx4 v[152:155], v8, s[4:7], s42 offen offset:1024
    buffer_load_dwordx4 v[156:159], v9, s[4:7], s42 offen offset:1024
    ds_read_b128 v[64:67], v2 offset:17408
    ds_read_b128 v[68:71], v2 offset:37888
    ds_read_b128 v[72:75], v2 offset:58368
    ds_read_b128 v[76:79], v3 offset:58368
    s_waitcnt vmcnt(22) lgkmcnt(4)
    v_mfma_f32_16x16x32_bf16 v[16:19], v[224:227], v[48:51], v[16:19]
    v_mfma_f32_16x16x32_bf16 v[20:23], v[224:227], v[52:55], v[20:23]
    v_mfma_f32_16x16x32_bf16 v[24:27], v[224:227], v[56:59], v[24:27]
    v_mfma_f32_16x16x32_bf16 v[28:31], v[224:227], v[60:63], v[28:31]
    v_mfma_f32_16x16x32_bf16 v[32:35], v[228:231], v[48:51], v[32:35]
    v_mfma_f32_16x16x32_bf16 v[36:39], v[228:231], v[52:55], v[36:39]
    v_mfma_f32_16x16x32_bf16 v[40:43], v[228:231], v[56:59], v[40:43]
    v_mfma_f32_16x16x32_bf16 v[44:47], v[228:231], v[60:63], v[44:47]
    buffer_load_dwordx4 v[160:163], v10, s[4:7], s42 offen offset:1024
    buffer_load_dwordx4 v[164:167], v11, s[4:7], s42 offen offset:1024
    ds_read_b128 v[48:51], v2 offset:18432
    ds_read_b128 v[52:55], v2 offset:38912
    ds_read_b128 v[56:59], v2 offset:59392
    ds_read_b128 v[60:63], v3 offset:59392
    s_waitcnt vmcnt(22) lgkmcnt(4)
    v_mfma_f32_16x16x32_bf16 v[16:19], v[232:235], v[64:67], v[16:19]
    v_mfma_f32_16x16x32_bf16 v[20:23], v[232:235], v[68:71], v[20:23]
    v_mfma_f32_16x16x32_bf16 v[24:27], v[232:235], v[72:75], v[24:27]
    v_mfma_f32_16x16x32_bf16 v[28:31], v[232:235], v[76:79], v[28:31]
    v_mfma_f32_16x16x32_bf16 v[32:35], v[236:239], v[64:67], v[32:35]
    v_mfma_f32_16x16x32_bf16 v[36:39], v[236:239], v[68:71], v[36:39]
    v_mfma_f32_16x16x32_bf16 v[40:43], v[236:239], v[72:75], v[40:43]
    v_mfma_f32_16x16x32_bf16 v[44:47], v[236:239], v[76:79], v[44:47]
    buffer_load_dwordx4 v[168:171], v12, s[4:7], s42 offen offset:1024
    buffer_load_dwordx4 v[172:175], v13, s[4:7], s42 offen offset:1024
    ds_read_b128 v[64:67], v2 offset:19456
    ds_read_b128 v[68:71], v2 offset:39936
    ds_read_b128 v[72:75], v2 offset:60416
    ds_read_b128 v[76:79], v3 offset:60416
    s_waitcnt vmcnt(22) lgkmcnt(4)
    v_mfma_f32_16x16x32_bf16 v[16:19], v[240:243], v[48:51], v[16:19]
    v_mfma_f32_16x16x32_bf16 v[20:23], v[240:243], v[52:55], v[20:23]
    v_mfma_f32_16x16x32_bf16 v[24:27], v[240:243], v[56:59], v[24:27]
    v_mfma_f32_16x16x32_bf16 v[28:31], v[240:243], v[60:63], v[28:31]
    v_mfma_f32_16x16x32_bf16 v[32:35], v[244:247], v[48:51], v[32:35]
    v_mfma_f32_16x16x32_bf16 v[36:39], v[244:247], v[52:55], v[36:39]
    v_mfma_f32_16x16x32_bf16 v[40:43], v[244:247], v[56:59], v[40:43]
    v_mfma_f32_16x16x32_bf16 v[44:47], v[244:247], v[60:63], v[44:47]
    buffer_load_dwordx4 v[176:179], v4, s[4:7], s42 offen offset:2048
    buffer_load_dwordx4 v[180:183], v5, s[4:7], s42 offen offset:2048
    s_waitcnt vmcnt(22) lgkmcnt(0)
    v_mfma_f32_16x16x32_bf16 v[16:19], v[248:251], v[64:67], v[16:19]
    v_mfma_f32_16x16x32_bf16 v[20:23], v[248:251], v[68:71], v[20:23]
    v_mfma_f32_16x16x32_bf16 v[24:27], v[248:251], v[72:75], v[24:27]
    v_mfma_f32_16x16x32_bf16 v[28:31], v[248:251], v[76:79], v[28:31]
    v_mfma_f32_16x16x32_bf16 v[32:35], v[252:255], v[64:67], v[32:35]
    v_mfma_f32_16x16x32_bf16 v[36:39], v[252:255], v[68:71], v[36:39]
    v_mfma_f32_16x16x32_bf16 v[40:43], v[252:255], v[72:75], v[40:43]
    v_mfma_f32_16x16x32_bf16 v[44:47], v[252:255], v[76:79], v[44:47]
    buffer_load_dwordx4 v[184:187], v6, s[4:7], s42 offen offset:2048
    buffer_load_dwordx4 v[188:191], v7, s[4:7], s42 offen offset:2048
    v_max_f32 v16, 0, v16
    v_max_f32 v17, 0, v17
    v_max_f32 v18, 0, v18
    v_max_f32 v19, 0, v19
    v_cvt_pk_bf16_f32 v80, v16, v17
    v_cvt_pk_bf16_f32 v81, v18, v19
    v_max_f32 v32, 0, v32
    v_max_f32 v33, 0, v33
    v_max_f32 v34, 0, v34
    v_max_f32 v35, 0, v35
    v_cvt_pk_bf16_f32 v82, v32, v33
    v_cvt_pk_bf16_f32 v83, v34, v35
    ds_write_b128 v15, v[80:83] offset:0
    v_max_f32 v20, 0, v20
    v_max_f32 v21, 0, v21
    v_max_f32 v22, 0, v22
    v_max_f32 v23, 0, v23
    v_cvt_pk_bf16_f32 v84, v20, v21
    v_cvt_pk_bf16_f32 v85, v22, v23
    v_max_f32 v36, 0, v36
    v_max_f32 v37, 0, v37
    v_max_f32 v38, 0, v38
    v_max_f32 v39, 0, v39
    v_cvt_pk_bf16_f32 v86, v36, v37
    v_cvt_pk_bf16_f32 v87, v38, v39
    ds_write_b128 v15, v[84:87] offset:1024
    v_max_f32 v24, 0, v24
    v_max_f32 v25, 0, v25
    v_max_f32 v26, 0, v26
    v_max_f32 v27, 0, v27
    v_cvt_pk_bf16_f32 v88, v24, v25
    v_cvt_pk_bf16_f32 v89, v26, v27
    v_max_f32 v40, 0, v40
    v_max_f32 v41, 0, v41
    v_max_f32 v42, 0, v42
    v_max_f32 v43, 0, v43
    v_cvt_pk_bf16_f32 v90, v40, v41
    v_cvt_pk_bf16_f32 v91, v42, v43
    ds_write_b128 v15, v[88:91] offset:2048
    v_max_f32 v28, 0, v28
    v_max_f32 v29, 0, v29
    v_max_f32 v30, 0, v30
    v_max_f32 v31, 0, v31
    v_cvt_pk_bf16_f32 v92, v28, v29
    v_cvt_pk_bf16_f32 v93, v30, v31
    v_max_f32 v44, 0, v44
    v_max_f32 v45, 0, v45
    v_max_f32 v46, 0, v46
    v_max_f32 v47, 0, v47
    v_cvt_pk_bf16_f32 v94, v44, v45
    v_cvt_pk_bf16_f32 v95, v46, v47
    ds_write_b128 v15, v[92:95] offset:3072
    s_waitcnt lgkmcnt(0)
    s_barrier
    ds_read_b128 v[48:51], v14 offset:0
    ds_read_b128 v[52:55], v14 offset:1024
    ds_read_b128 v[56:59], v14 offset:2048
    ds_read_b128 v[60:63], v14 offset:3072
    ds_read_b128 v[64:67], v14 offset:4096
    ds_read_b128 v[68:71], v14 offset:5120
    ds_read_b128 v[72:75], v14 offset:6144
    ds_read_b128 v[76:79], v14 offset:7168
    s_waitcnt vmcnt(23) lgkmcnt(4)
    v_mfma_f32_16x16x32_bf16 a[0:3], v[96:99], v[48:51], a[0:3]
    v_mfma_f32_16x16x32_bf16 a[4:7], v[96:99], v[52:55], a[4:7]
    v_mfma_f32_16x16x32_bf16 a[8:11], v[96:99], v[56:59], a[8:11]
    v_mfma_f32_16x16x32_bf16 a[12:15], v[96:99], v[60:63], a[12:15]
    buffer_load_dwordx4 v[192:195], v8, s[4:7], s42 offen offset:2048
    s_waitcnt vmcnt(23)
    v_mfma_f32_16x16x32_bf16 a[16:19], v[100:103], v[48:51], a[16:19]
    v_mfma_f32_16x16x32_bf16 a[20:23], v[100:103], v[52:55], a[20:23]
    v_mfma_f32_16x16x32_bf16 a[24:27], v[100:103], v[56:59], a[24:27]
    v_mfma_f32_16x16x32_bf16 a[28:31], v[100:103], v[60:63], a[28:31]
    buffer_load_dwordx4 v[196:199], v9, s[4:7], s42 offen offset:2048
    s_waitcnt vmcnt(23)
    v_mfma_f32_16x16x32_bf16 a[32:35], v[104:107], v[48:51], a[32:35]
    v_mfma_f32_16x16x32_bf16 a[36:39], v[104:107], v[52:55], a[36:39]
    v_mfma_f32_16x16x32_bf16 a[40:43], v[104:107], v[56:59], a[40:43]
    v_mfma_f32_16x16x32_bf16 a[44:47], v[104:107], v[60:63], a[44:47]
    buffer_load_dwordx4 v[200:203], v10, s[4:7], s42 offen offset:2048
    s_waitcnt vmcnt(23)
    v_mfma_f32_16x16x32_bf16 a[48:51], v[108:111], v[48:51], a[48:51]
    v_mfma_f32_16x16x32_bf16 a[52:55], v[108:111], v[52:55], a[52:55]
    v_mfma_f32_16x16x32_bf16 a[56:59], v[108:111], v[56:59], a[56:59]
    v_mfma_f32_16x16x32_bf16 a[60:63], v[108:111], v[60:63], a[60:63]
    buffer_load_dwordx4 v[204:207], v11, s[4:7], s42 offen offset:2048
    s_waitcnt vmcnt(23)
    v_mfma_f32_16x16x32_bf16 a[64:67], v[112:115], v[48:51], a[64:67]
    v_mfma_f32_16x16x32_bf16 a[68:71], v[112:115], v[52:55], a[68:71]
    v_mfma_f32_16x16x32_bf16 a[72:75], v[112:115], v[56:59], a[72:75]
    v_mfma_f32_16x16x32_bf16 a[76:79], v[112:115], v[60:63], a[76:79]
    buffer_load_dwordx4 v[208:211], v12, s[4:7], s42 offen offset:2048
    s_waitcnt vmcnt(23)
    v_mfma_f32_16x16x32_bf16 a[80:83], v[116:119], v[48:51], a[80:83]
    v_mfma_f32_16x16x32_bf16 a[84:87], v[116:119], v[52:55], a[84:87]
    v_mfma_f32_16x16x32_bf16 a[88:91], v[116:119], v[56:59], a[88:91]
    v_mfma_f32_16x16x32_bf16 a[92:95], v[116:119], v[60:63], a[92:95]
    buffer_load_dwordx4 v[212:215], v13, s[4:7], s42 offen offset:2048
    s_waitcnt vmcnt(23)
    v_mfma_f32_16x16x32_bf16 a[96:99], v[120:123], v[48:51], a[96:99]
    v_mfma_f32_16x16x32_bf16 a[100:103], v[120:123], v[52:55], a[100:103]
    v_mfma_f32_16x16x32_bf16 a[104:107], v[120:123], v[56:59], a[104:107]
    v_mfma_f32_16x16x32_bf16 a[108:111], v[120:123], v[60:63], a[108:111]
    buffer_load_dwordx4 v[216:219], v4, s[4:7], s42 offen offset:3072
    s_waitcnt vmcnt(23)
    v_mfma_f32_16x16x32_bf16 a[112:115], v[124:127], v[48:51], a[112:115]
    v_mfma_f32_16x16x32_bf16 a[116:119], v[124:127], v[52:55], a[116:119]
    v_mfma_f32_16x16x32_bf16 a[120:123], v[124:127], v[56:59], a[120:123]
    v_mfma_f32_16x16x32_bf16 a[124:127], v[124:127], v[60:63], a[124:127]
    buffer_load_dwordx4 v[220:223], v5, s[4:7], s42 offen offset:3072
    s_waitcnt vmcnt(23)
    v_mfma_f32_16x16x32_bf16 a[128:131], v[128:131], v[48:51], a[128:131]
    v_mfma_f32_16x16x32_bf16 a[132:135], v[128:131], v[52:55], a[132:135]
    v_mfma_f32_16x16x32_bf16 a[136:139], v[128:131], v[56:59], a[136:139]
    v_mfma_f32_16x16x32_bf16 a[140:143], v[128:131], v[60:63], a[140:143]
    buffer_load_dwordx4 v[224:227], v6, s[4:7], s42 offen offset:3072
    s_waitcnt vmcnt(23)
    v_mfma_f32_16x16x32_bf16 a[144:147], v[132:135], v[48:51], a[144:147]
    v_mfma_f32_16x16x32_bf16 a[148:151], v[132:135], v[52:55], a[148:151]
    v_mfma_f32_16x16x32_bf16 a[152:155], v[132:135], v[56:59], a[152:155]
    v_mfma_f32_16x16x32_bf16 a[156:159], v[132:135], v[60:63], a[156:159]
    buffer_load_dwordx4 v[228:231], v7, s[4:7], s42 offen offset:3072
    ds_read_b128 v[48:51], v14 offset:8192
    ds_read_b128 v[52:55], v14 offset:9216
    ds_read_b128 v[56:59], v14 offset:10240
    ds_read_b128 v[60:63], v14 offset:11264
    s_waitcnt vmcnt(23) lgkmcnt(4)
    v_mfma_f32_16x16x32_bf16 a[0:3], v[136:139], v[64:67], a[0:3]
    v_mfma_f32_16x16x32_bf16 a[4:7], v[136:139], v[68:71], a[4:7]
    v_mfma_f32_16x16x32_bf16 a[8:11], v[136:139], v[72:75], a[8:11]
    v_mfma_f32_16x16x32_bf16 a[12:15], v[136:139], v[76:79], a[12:15]
    buffer_load_dwordx4 v[232:235], v8, s[4:7], s42 offen offset:3072
    s_waitcnt vmcnt(23)
    v_mfma_f32_16x16x32_bf16 a[16:19], v[140:143], v[64:67], a[16:19]
    v_mfma_f32_16x16x32_bf16 a[20:23], v[140:143], v[68:71], a[20:23]
    v_mfma_f32_16x16x32_bf16 a[24:27], v[140:143], v[72:75], a[24:27]
    v_mfma_f32_16x16x32_bf16 a[28:31], v[140:143], v[76:79], a[28:31]
    buffer_load_dwordx4 v[236:239], v9, s[4:7], s42 offen offset:3072
    s_waitcnt vmcnt(23)
    v_mfma_f32_16x16x32_bf16 a[32:35], v[144:147], v[64:67], a[32:35]
    v_mfma_f32_16x16x32_bf16 a[36:39], v[144:147], v[68:71], a[36:39]
    v_mfma_f32_16x16x32_bf16 a[40:43], v[144:147], v[72:75], a[40:43]
    v_mfma_f32_16x16x32_bf16 a[44:47], v[144:147], v[76:79], a[44:47]
    buffer_load_dwordx4 v[240:243], v10, s[4:7], s42 offen offset:3072
    s_waitcnt vmcnt(23)
    v_mfma_f32_16x16x32_bf16 a[48:51], v[148:151], v[64:67], a[48:51]
    v_mfma_f32_16x16x32_bf16 a[52:55], v[148:151], v[68:71], a[52:55]
    v_mfma_f32_16x16x32_bf16 a[56:59], v[148:151], v[72:75], a[56:59]
    v_mfma_f32_16x16x32_bf16 a[60:63], v[148:151], v[76:79], a[60:63]
    buffer_load_dwordx4 v[244:247], v11, s[4:7], s42 offen offset:3072
    s_waitcnt vmcnt(23)
    v_mfma_f32_16x16x32_bf16 a[64:67], v[152:155], v[64:67], a[64:67]
    v_mfma_f32_16x16x32_bf16 a[68:71], v[152:155], v[68:71], a[68:71]
    v_mfma_f32_16x16x32_bf16 a[72:75], v[152:155], v[72:75], a[72:75]
    v_mfma_f32_16x16x32_bf16 a[76:79], v[152:155], v[76:79], a[76:79]
    buffer_load_dwordx4 v[248:251], v12, s[4:7], s42 offen offset:3072
    s_waitcnt vmcnt(23)
    v_mfma_f32_16x16x32_bf16 a[80:83], v[156:159], v[64:67], a[80:83]
    v_mfma_f32_16x16x32_bf16 a[84:87], v[156:159], v[68:71], a[84:87]
    v_mfma_f32_16x16x32_bf16 a[88:91], v[156:159], v[72:75], a[88:91]
    v_mfma_f32_16x16x32_bf16 a[92:95], v[156:159], v[76:79], a[92:95]
    buffer_load_dwordx4 v[252:255], v13, s[4:7], s42 offen offset:3072
    s_waitcnt vmcnt(23)
    v_mfma_f32_16x16x32_bf16 a[96:99], v[160:163], v[64:67], a[96:99]
    v_mfma_f32_16x16x32_bf16 a[100:103], v[160:163], v[68:71], a[100:103]
    v_mfma_f32_16x16x32_bf16 a[104:107], v[160:163], v[72:75], a[104:107]
    v_mfma_f32_16x16x32_bf16 a[108:111], v[160:163], v[76:79], a[108:111]
    s_add_u32 s45, s43, 0
    buffer_load_dwordx4 v[96:99], v2, s[4:7], s45 offen offset:0
    s_waitcnt vmcnt(23)
    v_mfma_f32_16x16x32_bf16 a[112:115], v[164:167], v[64:67], a[112:115]
    v_mfma_f32_16x16x32_bf16 a[116:119], v[164:167], v[68:71], a[116:119]
    v_mfma_f32_16x16x32_bf16 a[120:123], v[164:167], v[72:75], a[120:123]
    v_mfma_f32_16x16x32_bf16 a[124:127], v[164:167], v[76:79], a[124:127]
    s_add_u32 s45, s43, 0
    buffer_load_dwordx4 v[100:103], v3, s[4:7], s45 offen offset:0
    s_waitcnt vmcnt(23)
    v_mfma_f32_16x16x32_bf16 a[128:131], v[168:171], v[64:67], a[128:131]
    v_mfma_f32_16x16x32_bf16 a[132:135], v[168:171], v[68:71], a[132:135]
    v_mfma_f32_16x16x32_bf16 a[136:139], v[168:171], v[72:75], a[136:139]
    v_mfma_f32_16x16x32_bf16 a[140:143], v[168:171], v[76:79], a[140:143]
    s_add_u32 s45, s43, 0
    buffer_load_dwordx4 v[104:107], v2, s[4:7], s45 offen offset:1024
    s_waitcnt vmcnt(23)
    v_mfma_f32_16x16x32_bf16 a[144:147], v[172:175], v[64:67], a[144:147]
    v_mfma_f32_16x16x32_bf16 a[148:151], v[172:175], v[68:71], a[148:151]
    v_mfma_f32_16x16x32_bf16 a[152:155], v[172:175], v[72:75], a[152:155]
    v_mfma_f32_16x16x32_bf16 a[156:159], v[172:175], v[76:79], a[156:159]
    s_add_u32 s45, s43, 0
    buffer_load_dwordx4 v[108:111], v3, s[4:7], s45 offen offset:1024
    ds_read_b128 v[64:67], v14 offset:12288
    ds_read_b128 v[68:71], v14 offset:13312
    ds_read_b128 v[72:75], v14 offset:14336
    ds_read_b128 v[76:79], v14 offset:15360
    s_waitcnt vmcnt(23) lgkmcnt(4)
    v_mfma_f32_16x16x32_bf16 a[0:3], v[176:179], v[48:51], a[0:3]
    v_mfma_f32_16x16x32_bf16 a[4:7], v[176:179], v[52:55], a[4:7]
    v_mfma_f32_16x16x32_bf16 a[8:11], v[176:179], v[56:59], a[8:11]
    v_mfma_f32_16x16x32_bf16 a[12:15], v[176:179], v[60:63], a[12:15]
    s_add_u32 s45, s43, 0
    buffer_load_dwordx4 v[112:115], v2, s[4:7], s45 offen offset:2048
    s_waitcnt vmcnt(23)
    v_mfma_f32_16x16x32_bf16 a[16:19], v[180:183], v[48:51], a[16:19]
    v_mfma_f32_16x16x32_bf16 a[20:23], v[180:183], v[52:55], a[20:23]
    v_mfma_f32_16x16x32_bf16 a[24:27], v[180:183], v[56:59], a[24:27]
    v_mfma_f32_16x16x32_bf16 a[28:31], v[180:183], v[60:63], a[28:31]
    s_add_u32 s45, s43, 0
    buffer_load_dwordx4 v[116:119], v3, s[4:7], s45 offen offset:2048
    s_waitcnt vmcnt(23)
    v_mfma_f32_16x16x32_bf16 a[32:35], v[184:187], v[48:51], a[32:35]
    v_mfma_f32_16x16x32_bf16 a[36:39], v[184:187], v[52:55], a[36:39]
    v_mfma_f32_16x16x32_bf16 a[40:43], v[184:187], v[56:59], a[40:43]
    v_mfma_f32_16x16x32_bf16 a[44:47], v[184:187], v[60:63], a[44:47]
    s_add_u32 s45, s43, 0
    buffer_load_dwordx4 v[120:123], v2, s[4:7], s45 offen offset:3072
    s_waitcnt vmcnt(23)
    v_mfma_f32_16x16x32_bf16 a[48:51], v[188:191], v[48:51], a[48:51]
    v_mfma_f32_16x16x32_bf16 a[52:55], v[188:191], v[52:55], a[52:55]
    v_mfma_f32_16x16x32_bf16 a[56:59], v[188:191], v[56:59], a[56:59]
    v_mfma_f32_16x16x32_bf16 a[60:63], v[188:191], v[60:63], a[60:63]
    s_add_u32 s45, s43, 0
    buffer_load_dwordx4 v[124:127], v3, s[4:7], s45 offen offset:3072
    s_waitcnt vmcnt(23)
    v_mfma_f32_16x16x32_bf16 a[64:67], v[192:195], v[48:51], a[64:67]
    v_mfma_f32_16x16x32_bf16 a[68:71], v[192:195], v[52:55], a[68:71]
    v_mfma_f32_16x16x32_bf16 a[72:75], v[192:195], v[56:59], a[72:75]
    v_mfma_f32_16x16x32_bf16 a[76:79], v[192:195], v[60:63], a[76:79]
    s_add_u32 s45, s43, 4096
    buffer_load_dwordx4 v[128:131], v2, s[4:7], s45 offen offset:0
    s_waitcnt vmcnt(23)
    v_mfma_f32_16x16x32_bf16 a[80:83], v[196:199], v[48:51], a[80:83]
    v_mfma_f32_16x16x32_bf16 a[84:87], v[196:199], v[52:55], a[84:87]
    v_mfma_f32_16x16x32_bf16 a[88:91], v[196:199], v[56:59], a[88:91]
    v_mfma_f32_16x16x32_bf16 a[92:95], v[196:199], v[60:63], a[92:95]
    s_add_u32 s45, s43, 4096
    buffer_load_dwordx4 v[132:135], v3, s[4:7], s45 offen offset:0
    s_waitcnt vmcnt(23)
    v_mfma_f32_16x16x32_bf16 a[96:99], v[200:203], v[48:51], a[96:99]
    v_mfma_f32_16x16x32_bf16 a[100:103], v[200:203], v[52:55], a[100:103]
    v_mfma_f32_16x16x32_bf16 a[104:107], v[200:203], v[56:59], a[104:107]
    v_mfma_f32_16x16x32_bf16 a[108:111], v[200:203], v[60:63], a[108:111]
    s_add_u32 s45, s43, 4096
    buffer_load_dwordx4 v[136:139], v2, s[4:7], s45 offen offset:1024
    s_waitcnt vmcnt(23)
    v_mfma_f32_16x16x32_bf16 a[112:115], v[204:207], v[48:51], a[112:115]
    v_mfma_f32_16x16x32_bf16 a[116:119], v[204:207], v[52:55], a[116:119]
    v_mfma_f32_16x16x32_bf16 a[120:123], v[204:207], v[56:59], a[120:123]
    v_mfma_f32_16x16x32_bf16 a[124:127], v[204:207], v[60:63], a[124:127]
    s_add_u32 s45, s43, 4096
    buffer_load_dwordx4 v[140:143], v3, s[4:7], s45 offen offset:1024
    s_waitcnt vmcnt(23)
    v_mfma_f32_16x16x32_bf16 a[128:131], v[208:211], v[48:51], a[128:131]
    v_mfma_f32_16x16x32_bf16 a[132:135], v[208:211], v[52:55], a[132:135]
    v_mfma_f32_16x16x32_bf16 a[136:139], v[208:211], v[56:59], a[136:139]
    v_mfma_f32_16x16x32_bf16 a[140:143], v[208:211], v[60:63], a[140:143]
    s_add_u32 s45, s43, 4096
    buffer_load_dwordx4 v[144:147], v2, s[4:7], s45 offen offset:2048
    s_waitcnt vmcnt(23)
    v_mfma_f32_16x16x32_bf16 a[144:147], v[212:215], v[48:51], a[144:147]
    v_mfma_f32_16x16x32_bf16 a[148:151], v[212:215], v[52:55], a[148:151]
    v_mfma_f32_16x16x32_bf16 a[152:155], v[212:215], v[56:59], a[152:155]
    v_mfma_f32_16x16x32_bf16 a[156:159], v[212:215], v[60:63], a[156:159]
    s_add_u32 s45, s43, 4096
    buffer_load_dwordx4 v[148:151], v3, s[4:7], s45 offen offset:2048
    s_waitcnt vmcnt(23) lgkmcnt(0)
    v_mfma_f32_16x16x32_bf16 a[0:3], v[216:219], v[64:67], a[0:3]
    v_mfma_f32_16x16x32_bf16 a[4:7], v[216:219], v[68:71], a[4:7]
    v_mfma_f32_16x16x32_bf16 a[8:11], v[216:219], v[72:75], a[8:11]
    v_mfma_f32_16x16x32_bf16 a[12:15], v[216:219], v[76:79], a[12:15]
    s_add_u32 s45, s43, 4096
    buffer_load_dwordx4 v[152:155], v2, s[4:7], s45 offen offset:3072
    s_waitcnt vmcnt(23)
    v_mfma_f32_16x16x32_bf16 a[16:19], v[220:223], v[64:67], a[16:19]
    v_mfma_f32_16x16x32_bf16 a[20:23], v[220:223], v[68:71], a[20:23]
    v_mfma_f32_16x16x32_bf16 a[24:27], v[220:223], v[72:75], a[24:27]
    v_mfma_f32_16x16x32_bf16 a[28:31], v[220:223], v[76:79], a[28:31]
    s_add_u32 s45, s43, 4096
    buffer_load_dwordx4 v[156:159], v3, s[4:7], s45 offen offset:3072
    s_waitcnt vmcnt(23)
    v_mfma_f32_16x16x32_bf16 a[32:35], v[224:227], v[64:67], a[32:35]
    v_mfma_f32_16x16x32_bf16 a[36:39], v[224:227], v[68:71], a[36:39]
    v_mfma_f32_16x16x32_bf16 a[40:43], v[224:227], v[72:75], a[40:43]
    v_mfma_f32_16x16x32_bf16 a[44:47], v[224:227], v[76:79], a[44:47]
    s_add_u32 s45, s43, 8192
    buffer_load_dwordx4 v[160:163], v2, s[4:7], s45 offen offset:0
    s_waitcnt vmcnt(23)
    v_mfma_f32_16x16x32_bf16 a[48:51], v[228:231], v[64:67], a[48:51]
    v_mfma_f32_16x16x32_bf16 a[52:55], v[228:231], v[68:71], a[52:55]
    v_mfma_f32_16x16x32_bf16 a[56:59], v[228:231], v[72:75], a[56:59]
    v_mfma_f32_16x16x32_bf16 a[60:63], v[228:231], v[76:79], a[60:63]
    s_add_u32 s45, s43, 8192
    buffer_load_dwordx4 v[164:167], v3, s[4:7], s45 offen offset:0
    s_waitcnt vmcnt(23)
    v_mfma_f32_16x16x32_bf16 a[64:67], v[232:235], v[64:67], a[64:67]
    v_mfma_f32_16x16x32_bf16 a[68:71], v[232:235], v[68:71], a[68:71]
    v_mfma_f32_16x16x32_bf16 a[72:75], v[232:235], v[72:75], a[72:75]
    v_mfma_f32_16x16x32_bf16 a[76:79], v[232:235], v[76:79], a[76:79]
    s_add_u32 s45, s43, 8192
    buffer_load_dwordx4 v[168:171], v2, s[4:7], s45 offen offset:1024
    s_waitcnt vmcnt(23)
    v_mfma_f32_16x16x32_bf16 a[80:83], v[236:239], v[64:67], a[80:83]
    v_mfma_f32_16x16x32_bf16 a[84:87], v[236:239], v[68:71], a[84:87]
    v_mfma_f32_16x16x32_bf16 a[88:91], v[236:239], v[72:75], a[88:91]
    v_mfma_f32_16x16x32_bf16 a[92:95], v[236:239], v[76:79], a[92:95]
    s_add_u32 s45, s43, 8192
    buffer_load_dwordx4 v[172:175], v3, s[4:7], s45 offen offset:1024
    s_waitcnt vmcnt(23)
    v_mfma_f32_16x16x32_bf16 a[96:99], v[240:243], v[64:67], a[96:99]
    v_mfma_f32_16x16x32_bf16 a[100:103], v[240:243], v[68:71], a[100:103]
    v_mfma_f32_16x16x32_bf16 a[104:107], v[240:243], v[72:75], a[104:107]
    v_mfma_f32_16x16x32_bf16 a[108:111], v[240:243], v[76:79], a[108:111]
    s_add_u32 s45, s43, 8192
    buffer_load_dwordx4 v[176:179], v2, s[4:7], s45 offen offset:2048
    s_waitcnt vmcnt(23)
    v_mfma_f32_16x16x32_bf16 a[112:115], v[244:247], v[64:67], a[112:115]
    v_mfma_f32_16x16x32_bf16 a[116:119], v[244:247], v[68:71], a[116:119]
    v_mfma_f32_16x16x32_bf16 a[120:123], v[244:247], v[72:75], a[120:123]
    v_mfma_f32_16x16x32_bf16 a[124:127], v[244:247], v[76:79], a[124:127]
    s_add_u32 s45, s43, 8192
    buffer_load_dwordx4 v[180:183], v3, s[4:7], s45 offen offset:2048
    s_waitcnt vmcnt(23)
    v_mfma_f32_16x16x32_bf16 a[128:131], v[248:251], v[64:67], a[128:131]
    v_mfma_f32_16x16x32_bf16 a[132:135], v[248:251], v[68:71], a[132:135]
    v_mfma_f32_16x16x32_bf16 a[136:139], v[248:251], v[72:75], a[136:139]
    v_mfma_f32_16x16x32_bf16 a[140:143], v[248:251], v[76:79], a[140:143]
    s_add_u32 s45, s43, 8192
    buffer_load_dwordx4 v[184:187], v2, s[4:7], s45 offen offset:3072
    s_waitcnt vmcnt(23)
    v_mfma_f32_16x16x32_bf16 a[144:147], v[252:255], v[64:67], a[144:147]
    v_mfma_f32_16x16x32_bf16 a[148:151], v[252:255], v[68:71], a[148:151]
    v_mfma_f32_16x16x32_bf16 a[152:155], v[252:255], v[72:75], a[152:155]
    v_mfma_f32_16x16x32_bf16 a[156:159], v[252:255], v[76:79], a[156:159]
    s_add_u32 s45, s43, 8192
    buffer_load_dwordx4 v[188:191], v3, s[4:7], s45 offen offset:3072
    v_xor_b32 v14, 16384, v14
    v_xor_b32 v15, 16384, v15
    s_mov_b32 s41, s43
    s_mov_b32 s42, s44
    s_add_u32 s30, s30, 1
    s_cmp_lt_u32 s30, 12
    s_cbranch_scc1 Lft_206
    s_waitcnt vmcnt(0)
    v_lshlrev_b32 v3, 3, v1
    s_mul_i32 s38, s24, 81920
    s_mul_i32 s39, s22, 5120
    s_add_u32 s38, s38, s39
    s_add_u32 s38, s38, 10747904
    s_mov_b32 s52, 0xbfb8aa3b
    s_add_u32 s39, s38, 0
    s_add_u32 s40, s39, 4096
    v_accvgpr_read_b32 v16, a0
    v_accvgpr_read_b32 v17, a1
    v_accvgpr_read_b32 v18, a2
    v_accvgpr_read_b32 v19, a3
    v_cvt_pk_bf16_f32 v20, v16, v17
    v_cvt_pk_bf16_f32 v21, v18, v19
    v_lshlrev_b32 v16, 16, v20
    v_and_b32 v17, 0xffff0000, v20
    v_lshlrev_b32 v18, 16, v21
    v_and_b32 v19, 0xffff0000, v21
    v_mul_f32 v20, s52, v16
    v_mul_f32 v21, s52, v17
    v_mul_f32 v22, s52, v18
    v_mul_f32 v23, s52, v19
    v_exp_f32 v20, v20
    v_exp_f32 v21, v21
    v_exp_f32 v22, v22
    v_exp_f32 v23, v23
    v_add_f32 v20, 1.0, v20
    v_add_f32 v21, 1.0, v21
    v_add_f32 v22, 1.0, v22
    v_add_f32 v23, 1.0, v23
    v_rcp_f32 v20, v20
    v_rcp_f32 v21, v21
    v_rcp_f32 v22, v22
    v_rcp_f32 v23, v23
    v_mul_f32 v16, v16, v20
    v_mul_f32 v17, v17, v21
    v_mul_f32 v18, v18, v22
    v_mul_f32 v19, v19, v23
    v_cvt_pk_bf16_f32 v24, v16, v17
    v_cvt_pk_bf16_f32 v25, v18, v19
    buffer_store_dwordx2 v[24:25], v3, s[4:7], s39 offen offset:0 sc1
    v_accvgpr_read_b32 v32, a16
    v_accvgpr_read_b32 v33, a17
    v_accvgpr_read_b32 v34, a18
    v_accvgpr_read_b32 v35, a19
    v_cvt_pk_bf16_f32 v36, v32, v33
    v_cvt_pk_bf16_f32 v37, v34, v35
    v_lshlrev_b32 v32, 16, v36
    v_and_b32 v33, 0xffff0000, v36
    v_lshlrev_b32 v34, 16, v37
    v_and_b32 v35, 0xffff0000, v37
    v_mul_f32 v36, s52, v32
    v_mul_f32 v37, s52, v33
    v_mul_f32 v38, s52, v34
    v_mul_f32 v39, s52, v35
    v_exp_f32 v36, v36
    v_exp_f32 v37, v37
    v_exp_f32 v38, v38
    v_exp_f32 v39, v39
    v_add_f32 v36, 1.0, v36
    v_add_f32 v37, 1.0, v37
    v_add_f32 v38, 1.0, v38
    v_add_f32 v39, 1.0, v39
    v_rcp_f32 v36, v36
    v_rcp_f32 v37, v37
    v_rcp_f32 v38, v38
    v_rcp_f32 v39, v39
    v_mul_f32 v32, v32, v36
    v_mul_f32 v33, v33, v37
    v_mul_f32 v34, v34, v38
    v_mul_f32 v35, v35, v39
    v_cvt_pk_bf16_f32 v40, v32, v33
    v_cvt_pk_bf16_f32 v41, v34, v35
    buffer_store_dwordx2 v[40:41], v3, s[4:7], s39 offen offset:512 sc1
    v_accvgpr_read_b32 v48, a32
    v_accvgpr_read_b32 v49, a33
    v_accvgpr_read_b32 v50, a34
    v_accvgpr_read_b32 v51, a35
    v_cvt_pk_bf16_f32 v52, v48, v49
    v_cvt_pk_bf16_f32 v53, v50, v51
    v_lshlrev_b32 v48, 16, v52
    v_and_b32 v49, 0xffff0000, v52
    v_lshlrev_b32 v50, 16, v53
    v_and_b32 v51, 0xffff0000, v53
    v_mul_f32 v52, s52, v48
    v_mul_f32 v53, s52, v49
    v_mul_f32 v54, s52, v50
    v_mul_f32 v55, s52, v51
    v_exp_f32 v52, v52
    v_exp_f32 v53, v53
    v_exp_f32 v54, v54
    v_exp_f32 v55, v55
    v_add_f32 v52, 1.0, v52
    v_add_f32 v53, 1.0, v53
    v_add_f32 v54, 1.0, v54
    v_add_f32 v55, 1.0, v55
    v_rcp_f32 v52, v52
    v_rcp_f32 v53, v53
    v_rcp_f32 v54, v54
    v_rcp_f32 v55, v55
    v_mul_f32 v48, v48, v52
    v_mul_f32 v49, v49, v53
    v_mul_f32 v50, v50, v54
    v_mul_f32 v51, v51, v55
    v_cvt_pk_bf16_f32 v56, v48, v49
    v_cvt_pk_bf16_f32 v57, v50, v51
    buffer_store_dwordx2 v[56:57], v3, s[4:7], s39 offen offset:1024 sc1
    v_accvgpr_read_b32 v64, a48
    v_accvgpr_read_b32 v65, a49
    v_accvgpr_read_b32 v66, a50
    v_accvgpr_read_b32 v67, a51
    v_cvt_pk_bf16_f32 v68, v64, v65
    v_cvt_pk_bf16_f32 v69, v66, v67
    v_lshlrev_b32 v64, 16, v68
    v_and_b32 v65, 0xffff0000, v68
    v_lshlrev_b32 v66, 16, v69
    v_and_b32 v67, 0xffff0000, v69
    v_mul_f32 v68, s52, v64
    v_mul_f32 v69, s52, v65
    v_mul_f32 v70, s52, v66
    v_mul_f32 v71, s52, v67
    v_exp_f32 v68, v68
    v_exp_f32 v69, v69
    v_exp_f32 v70, v70
    v_exp_f32 v71, v71
    v_add_f32 v68, 1.0, v68
    v_add_f32 v69, 1.0, v69
    v_add_f32 v70, 1.0, v70
    v_add_f32 v71, 1.0, v71
    v_rcp_f32 v68, v68
    v_rcp_f32 v69, v69
    v_rcp_f32 v70, v70
    v_rcp_f32 v71, v71
    v_mul_f32 v64, v64, v68
    v_mul_f32 v65, v65, v69
    v_mul_f32 v66, v66, v70
    v_mul_f32 v67, v67, v71
    v_cvt_pk_bf16_f32 v72, v64, v65
    v_cvt_pk_bf16_f32 v73, v66, v67
    buffer_store_dwordx2 v[72:73], v3, s[4:7], s39 offen offset:1536 sc1
    v_accvgpr_read_b32 v16, a64
    v_accvgpr_read_b32 v17, a65
    v_accvgpr_read_b32 v18, a66
    v_accvgpr_read_b32 v19, a67
    v_cvt_pk_bf16_f32 v20, v16, v17
    v_cvt_pk_bf16_f32 v21, v18, v19
    v_lshlrev_b32 v16, 16, v20
    v_and_b32 v17, 0xffff0000, v20
    v_lshlrev_b32 v18, 16, v21
    v_and_b32 v19, 0xffff0000, v21
    v_mul_f32 v20, s52, v16
    v_mul_f32 v21, s52, v17
    v_mul_f32 v22, s52, v18
    v_mul_f32 v23, s52, v19
    v_exp_f32 v20, v20
    v_exp_f32 v21, v21
    v_exp_f32 v22, v22
    v_exp_f32 v23, v23
    v_add_f32 v20, 1.0, v20
    v_add_f32 v21, 1.0, v21
    v_add_f32 v22, 1.0, v22
    v_add_f32 v23, 1.0, v23
    v_rcp_f32 v20, v20
    v_rcp_f32 v21, v21
    v_rcp_f32 v22, v22
    v_rcp_f32 v23, v23
    v_mul_f32 v16, v16, v20
    v_mul_f32 v17, v17, v21
    v_mul_f32 v18, v18, v22
    v_mul_f32 v19, v19, v23
    v_cvt_pk_bf16_f32 v24, v16, v17
    v_cvt_pk_bf16_f32 v25, v18, v19
    buffer_store_dwordx2 v[24:25], v3, s[4:7], s39 offen offset:2048 sc1
    v_accvgpr_read_b32 v32, a80
    v_accvgpr_read_b32 v33, a81
    v_accvgpr_read_b32 v34, a82
    v_accvgpr_read_b32 v35, a83
    v_cvt_pk_bf16_f32 v36, v32, v33
    v_cvt_pk_bf16_f32 v37, v34, v35
    v_lshlrev_b32 v32, 16, v36
    v_and_b32 v33, 0xffff0000, v36
    v_lshlrev_b32 v34, 16, v37
    v_and_b32 v35, 0xffff0000, v37
    v_mul_f32 v36, s52, v32
    v_mul_f32 v37, s52, v33
    v_mul_f32 v38, s52, v34
    v_mul_f32 v39, s52, v35
    v_exp_f32 v36, v36
    v_exp_f32 v37, v37
    v_exp_f32 v38, v38
    v_exp_f32 v39, v39
    v_add_f32 v36, 1.0, v36
    v_add_f32 v37, 1.0, v37
    v_add_f32 v38, 1.0, v38
    v_add_f32 v39, 1.0, v39
    v_rcp_f32 v36, v36
    v_rcp_f32 v37, v37
    v_rcp_f32 v38, v38
    v_rcp_f32 v39, v39
    v_mul_f32 v32, v32, v36
    v_mul_f32 v33, v33, v37
    v_mul_f32 v34, v34, v38
    v_mul_f32 v35, v35, v39
    v_cvt_pk_bf16_f32 v40, v32, v33
    v_cvt_pk_bf16_f32 v41, v34, v35
    buffer_store_dwordx2 v[40:41], v3, s[4:7], s39 offen offset:2560 sc1
    v_accvgpr_read_b32 v48, a96
    v_accvgpr_read_b32 v49, a97
    v_accvgpr_read_b32 v50, a98
    v_accvgpr_read_b32 v51, a99
    v_cvt_pk_bf16_f32 v52, v48, v49
    v_cvt_pk_bf16_f32 v53, v50, v51
    v_lshlrev_b32 v48, 16, v52
    v_and_b32 v49, 0xffff0000, v52
    v_lshlrev_b32 v50, 16, v53
    v_and_b32 v51, 0xffff0000, v53
    v_mul_f32 v52, s52, v48
    v_mul_f32 v53, s52, v49
    v_mul_f32 v54, s52, v50
    v_mul_f32 v55, s52, v51
    v_exp_f32 v52, v52
    v_exp_f32 v53, v53
    v_exp_f32 v54, v54
    v_exp_f32 v55, v55
    v_add_f32 v52, 1.0, v52
    v_add_f32 v53, 1.0, v53
    v_add_f32 v54, 1.0, v54
    v_add_f32 v55, 1.0, v55
    v_rcp_f32 v52, v52
    v_rcp_f32 v53, v53
    v_rcp_f32 v54, v54
    v_rcp_f32 v55, v55
    v_mul_f32 v48, v48, v52
    v_mul_f32 v49, v49, v53
    v_mul_f32 v50, v50, v54
    v_mul_f32 v51, v51, v55
    v_cvt_pk_bf16_f32 v56, v48, v49
    v_cvt_pk_bf16_f32 v57, v50, v51
    buffer_store_dwordx2 v[56:57], v3, s[4:7], s39 offen offset:3072 sc1
    v_accvgpr_read_b32 v64, a112
    v_accvgpr_read_b32 v65, a113
    v_accvgpr_read_b32 v66, a114
    v_accvgpr_read_b32 v67, a115
    v_cvt_pk_bf16_f32 v68, v64, v65
    v_cvt_pk_bf16_f32 v69, v66, v67
    v_lshlrev_b32 v64, 16, v68
    v_and_b32 v65, 0xffff0000, v68
    v_lshlrev_b32 v66, 16, v69
    v_and_b32 v67, 0xffff0000, v69
    v_mul_f32 v68, s52, v64
    v_mul_f32 v69, s52, v65
    v_mul_f32 v70, s52, v66
    v_mul_f32 v71, s52, v67
    v_exp_f32 v68, v68
    v_exp_f32 v69, v69
    v_exp_f32 v70, v70
    v_exp_f32 v71, v71
    v_add_f32 v68, 1.0, v68
    v_add_f32 v69, 1.0, v69
    v_add_f32 v70, 1.0, v70
    v_add_f32 v71, 1.0, v71
    v_rcp_f32 v68, v68
    v_rcp_f32 v69, v69
    v_rcp_f32 v70, v70
    v_rcp_f32 v71, v71
    v_mul_f32 v64, v64, v68
    v_mul_f32 v65, v65, v69
    v_mul_f32 v66, v66, v70
    v_mul_f32 v67, v67, v71
    v_cvt_pk_bf16_f32 v72, v64, v65
    v_cvt_pk_bf16_f32 v73, v66, v67
    buffer_store_dwordx2 v[72:73], v3, s[4:7], s39 offen offset:3584 sc1
    v_accvgpr_read_b32 v16, a128
    v_accvgpr_read_b32 v17, a129
    v_accvgpr_read_b32 v18, a130
    v_accvgpr_read_b32 v19, a131
    v_cvt_pk_bf16_f32 v20, v16, v17
    v_cvt_pk_bf16_f32 v21, v18, v19
    v_lshlrev_b32 v16, 16, v20
    v_and_b32 v17, 0xffff0000, v20
    v_lshlrev_b32 v18, 16, v21
    v_and_b32 v19, 0xffff0000, v21
    v_mul_f32 v20, s52, v16
    v_mul_f32 v21, s52, v17
    v_mul_f32 v22, s52, v18
    v_mul_f32 v23, s52, v19
    v_exp_f32 v20, v20
    v_exp_f32 v21, v21
    v_exp_f32 v22, v22
    v_exp_f32 v23, v23
    v_add_f32 v20, 1.0, v20
    v_add_f32 v21, 1.0, v21
    v_add_f32 v22, 1.0, v22
    v_add_f32 v23, 1.0, v23
    v_rcp_f32 v20, v20
    v_rcp_f32 v21, v21
    v_rcp_f32 v22, v22
    v_rcp_f32 v23, v23
    v_mul_f32 v16, v16, v20
    v_mul_f32 v17, v17, v21
    v_mul_f32 v18, v18, v22
    v_mul_f32 v19, v19, v23
    v_cvt_pk_bf16_f32 v24, v16, v17
    v_cvt_pk_bf16_f32 v25, v18, v19
    buffer_store_dwordx2 v[24:25], v3, s[4:7], s40 offen offset:0 sc1
    v_accvgpr_read_b32 v32, a144
    v_accvgpr_read_b32 v33, a145
    v_accvgpr_read_b32 v34, a146
    v_accvgpr_read_b32 v35, a147
    v_cvt_pk_bf16_f32 v36, v32, v33
    v_cvt_pk_bf16_f32 v37, v34, v35
    v_lshlrev_b32 v32, 16, v36
    v_and_b32 v33, 0xffff0000, v36
    v_lshlrev_b32 v34, 16, v37
    v_and_b32 v35, 0xffff0000, v37
    v_mul_f32 v36, s52, v32
    v_mul_f32 v37, s52, v33
    v_mul_f32 v38, s52, v34
    v_mul_f32 v39, s52, v35
    v_exp_f32 v36, v36
    v_exp_f32 v37, v37
    v_exp_f32 v38, v38
    v_exp_f32 v39, v39
    v_add_f32 v36, 1.0, v36
    v_add_f32 v37, 1.0, v37
    v_add_f32 v38, 1.0, v38
    v_add_f32 v39, 1.0, v39
    v_rcp_f32 v36, v36
    v_rcp_f32 v37, v37
    v_rcp_f32 v38, v38
    v_rcp_f32 v39, v39
    v_mul_f32 v32, v32, v36
    v_mul_f32 v33, v33, v37
    v_mul_f32 v34, v34, v38
    v_mul_f32 v35, v35, v39
    v_cvt_pk_bf16_f32 v40, v32, v33
    v_cvt_pk_bf16_f32 v41, v34, v35
    buffer_store_dwordx2 v[40:41], v3, s[4:7], s40 offen offset:512 sc1
    s_add_u32 s39, s38, 20480
    s_add_u32 s40, s39, 4096
    v_accvgpr_read_b32 v48, a4
    v_accvgpr_read_b32 v49, a5
    v_accvgpr_read_b32 v50, a6
    v_accvgpr_read_b32 v51, a7
    v_cvt_pk_bf16_f32 v52, v48, v49
    v_cvt_pk_bf16_f32 v53, v50, v51
    v_lshlrev_b32 v48, 16, v52
    v_and_b32 v49, 0xffff0000, v52
    v_lshlrev_b32 v50, 16, v53
    v_and_b32 v51, 0xffff0000, v53
    v_mul_f32 v52, s52, v48
    v_mul_f32 v53, s52, v49
    v_mul_f32 v54, s52, v50
    v_mul_f32 v55, s52, v51
    v_exp_f32 v52, v52
    v_exp_f32 v53, v53
    v_exp_f32 v54, v54
    v_exp_f32 v55, v55
    v_add_f32 v52, 1.0, v52
    v_add_f32 v53, 1.0, v53
    v_add_f32 v54, 1.0, v54
    v_add_f32 v55, 1.0, v55
    v_rcp_f32 v52, v52
    v_rcp_f32 v53, v53
    v_rcp_f32 v54, v54
    v_rcp_f32 v55, v55
    v_mul_f32 v48, v48, v52
    v_mul_f32 v49, v49, v53
    v_mul_f32 v50, v50, v54
    v_mul_f32 v51, v51, v55
    v_cvt_pk_bf16_f32 v56, v48, v49
    v_cvt_pk_bf16_f32 v57, v50, v51
    buffer_store_dwordx2 v[56:57], v3, s[4:7], s39 offen offset:0 sc1
    v_accvgpr_read_b32 v64, a20
    v_accvgpr_read_b32 v65, a21
    v_accvgpr_read_b32 v66, a22
    v_accvgpr_read_b32 v67, a23
    v_cvt_pk_bf16_f32 v68, v64, v65
    v_cvt_pk_bf16_f32 v69, v66, v67
    v_lshlrev_b32 v64, 16, v68
    v_and_b32 v65, 0xffff0000, v68
    v_lshlrev_b32 v66, 16, v69
    v_and_b32 v67, 0xffff0000, v69
    v_mul_f32 v68, s52, v64
    v_mul_f32 v69, s52, v65
    v_mul_f32 v70, s52, v66
    v_mul_f32 v71, s52, v67
    v_exp_f32 v68, v68
    v_exp_f32 v69, v69
    v_exp_f32 v70, v70
    v_exp_f32 v71, v71
    v_add_f32 v68, 1.0, v68
    v_add_f32 v69, 1.0, v69
    v_add_f32 v70, 1.0, v70
    v_add_f32 v71, 1.0, v71
    v_rcp_f32 v68, v68
    v_rcp_f32 v69, v69
    v_rcp_f32 v70, v70
    v_rcp_f32 v71, v71
    v_mul_f32 v64, v64, v68
    v_mul_f32 v65, v65, v69
    v_mul_f32 v66, v66, v70
    v_mul_f32 v67, v67, v71
    v_cvt_pk_bf16_f32 v72, v64, v65
    v_cvt_pk_bf16_f32 v73, v66, v67
    buffer_store_dwordx2 v[72:73], v3, s[4:7], s39 offen offset:512 sc1
    v_accvgpr_read_b32 v16, a36
    v_accvgpr_read_b32 v17, a37
    v_accvgpr_read_b32 v18, a38
    v_accvgpr_read_b32 v19, a39
    v_cvt_pk_bf16_f32 v20, v16, v17
    v_cvt_pk_bf16_f32 v21, v18, v19
    v_lshlrev_b32 v16, 16, v20
    v_and_b32 v17, 0xffff0000, v20
    v_lshlrev_b32 v18, 16, v21
    v_and_b32 v19, 0xffff0000, v21
    v_mul_f32 v20, s52, v16
    v_mul_f32 v21, s52, v17
    v_mul_f32 v22, s52, v18
    v_mul_f32 v23, s52, v19
    v_exp_f32 v20, v20
    v_exp_f32 v21, v21
    v_exp_f32 v22, v22
    v_exp_f32 v23, v23
    v_add_f32 v20, 1.0, v20
    v_add_f32 v21, 1.0, v21
    v_add_f32 v22, 1.0, v22
    v_add_f32 v23, 1.0, v23
    v_rcp_f32 v20, v20
    v_rcp_f32 v21, v21
    v_rcp_f32 v22, v22
    v_rcp_f32 v23, v23
    v_mul_f32 v16, v16, v20
    v_mul_f32 v17, v17, v21
    v_mul_f32 v18, v18, v22
    v_mul_f32 v19, v19, v23
    v_cvt_pk_bf16_f32 v24, v16, v17
    v_cvt_pk_bf16_f32 v25, v18, v19
    buffer_store_dwordx2 v[24:25], v3, s[4:7], s39 offen offset:1024 sc1
    v_accvgpr_read_b32 v32, a52
    v_accvgpr_read_b32 v33, a53
    v_accvgpr_read_b32 v34, a54
    v_accvgpr_read_b32 v35, a55
    v_cvt_pk_bf16_f32 v36, v32, v33
    v_cvt_pk_bf16_f32 v37, v34, v35
    v_lshlrev_b32 v32, 16, v36
    v_and_b32 v33, 0xffff0000, v36
    v_lshlrev_b32 v34, 16, v37
    v_and_b32 v35, 0xffff0000, v37
    v_mul_f32 v36, s52, v32
    v_mul_f32 v37, s52, v33
    v_mul_f32 v38, s52, v34
    v_mul_f32 v39, s52, v35
    v_exp_f32 v36, v36
    v_exp_f32 v37, v37
    v_exp_f32 v38, v38
    v_exp_f32 v39, v39
    v_add_f32 v36, 1.0, v36
    v_add_f32 v37, 1.0, v37
    v_add_f32 v38, 1.0, v38
    v_add_f32 v39, 1.0, v39
    v_rcp_f32 v36, v36
    v_rcp_f32 v37, v37
    v_rcp_f32 v38, v38
    v_rcp_f32 v39, v39
    v_mul_f32 v32, v32, v36
    v_mul_f32 v33, v33, v37
    v_mul_f32 v34, v34, v38
    v_mul_f32 v35, v35, v39
    v_cvt_pk_bf16_f32 v40, v32, v33
    v_cvt_pk_bf16_f32 v41, v34, v35
    buffer_store_dwordx2 v[40:41], v3, s[4:7], s39 offen offset:1536 sc1
    v_accvgpr_read_b32 v48, a68
    v_accvgpr_read_b32 v49, a69
    v_accvgpr_read_b32 v50, a70
    v_accvgpr_read_b32 v51, a71
    v_cvt_pk_bf16_f32 v52, v48, v49
    v_cvt_pk_bf16_f32 v53, v50, v51
    v_lshlrev_b32 v48, 16, v52
    v_and_b32 v49, 0xffff0000, v52
    v_lshlrev_b32 v50, 16, v53
    v_and_b32 v51, 0xffff0000, v53
    v_mul_f32 v52, s52, v48
    v_mul_f32 v53, s52, v49
    v_mul_f32 v54, s52, v50
    v_mul_f32 v55, s52, v51
    v_exp_f32 v52, v52
    v_exp_f32 v53, v53
    v_exp_f32 v54, v54
    v_exp_f32 v55, v55
    v_add_f32 v52, 1.0, v52
    v_add_f32 v53, 1.0, v53
    v_add_f32 v54, 1.0, v54
    v_add_f32 v55, 1.0, v55
    v_rcp_f32 v52, v52
    v_rcp_f32 v53, v53
    v_rcp_f32 v54, v54
    v_rcp_f32 v55, v55
    v_mul_f32 v48, v48, v52
    v_mul_f32 v49, v49, v53
    v_mul_f32 v50, v50, v54
    v_mul_f32 v51, v51, v55
    v_cvt_pk_bf16_f32 v56, v48, v49
    v_cvt_pk_bf16_f32 v57, v50, v51
    buffer_store_dwordx2 v[56:57], v3, s[4:7], s39 offen offset:2048 sc1
    v_accvgpr_read_b32 v64, a84
    v_accvgpr_read_b32 v65, a85
    v_accvgpr_read_b32 v66, a86
    v_accvgpr_read_b32 v67, a87
    v_cvt_pk_bf16_f32 v68, v64, v65
    v_cvt_pk_bf16_f32 v69, v66, v67
    v_lshlrev_b32 v64, 16, v68
    v_and_b32 v65, 0xffff0000, v68
    v_lshlrev_b32 v66, 16, v69
    v_and_b32 v67, 0xffff0000, v69
    v_mul_f32 v68, s52, v64
    v_mul_f32 v69, s52, v65
    v_mul_f32 v70, s52, v66
    v_mul_f32 v71, s52, v67
    v_exp_f32 v68, v68
    v_exp_f32 v69, v69
    v_exp_f32 v70, v70
    v_exp_f32 v71, v71
    v_add_f32 v68, 1.0, v68
    v_add_f32 v69, 1.0, v69
    v_add_f32 v70, 1.0, v70
    v_add_f32 v71, 1.0, v71
    v_rcp_f32 v68, v68
    v_rcp_f32 v69, v69
    v_rcp_f32 v70, v70
    v_rcp_f32 v71, v71
    v_mul_f32 v64, v64, v68
    v_mul_f32 v65, v65, v69
    v_mul_f32 v66, v66, v70
    v_mul_f32 v67, v67, v71
    v_cvt_pk_bf16_f32 v72, v64, v65
    v_cvt_pk_bf16_f32 v73, v66, v67
    buffer_store_dwordx2 v[72:73], v3, s[4:7], s39 offen offset:2560 sc1
    v_accvgpr_read_b32 v16, a100
    v_accvgpr_read_b32 v17, a101
    v_accvgpr_read_b32 v18, a102
    v_accvgpr_read_b32 v19, a103
    v_cvt_pk_bf16_f32 v20, v16, v17
    v_cvt_pk_bf16_f32 v21, v18, v19
    v_lshlrev_b32 v16, 16, v20
    v_and_b32 v17, 0xffff0000, v20
    v_lshlrev_b32 v18, 16, v21
    v_and_b32 v19, 0xffff0000, v21
    v_mul_f32 v20, s52, v16
    v_mul_f32 v21, s52, v17
    v_mul_f32 v22, s52, v18
    v_mul_f32 v23, s52, v19
    v_exp_f32 v20, v20
    v_exp_f32 v21, v21
    v_exp_f32 v22, v22
    v_exp_f32 v23, v23
    v_add_f32 v20, 1.0, v20
    v_add_f32 v21, 1.0, v21
    v_add_f32 v22, 1.0, v22
    v_add_f32 v23, 1.0, v23
    v_rcp_f32 v20, v20
    v_rcp_f32 v21, v21
    v_rcp_f32 v22, v22
    v_rcp_f32 v23, v23
    v_mul_f32 v16, v16, v20
    v_mul_f32 v17, v17, v21
    v_mul_f32 v18, v18, v22
    v_mul_f32 v19, v19, v23
    v_cvt_pk_bf16_f32 v24, v16, v17
    v_cvt_pk_bf16_f32 v25, v18, v19
    buffer_store_dwordx2 v[24:25], v3, s[4:7], s39 offen offset:3072 sc1
    v_accvgpr_read_b32 v32, a116
    v_accvgpr_read_b32 v33, a117
    v_accvgpr_read_b32 v34, a118
    v_accvgpr_read_b32 v35, a119
    v_cvt_pk_bf16_f32 v36, v32, v33
    v_cvt_pk_bf16_f32 v37, v34, v35
    v_lshlrev_b32 v32, 16, v36
    v_and_b32 v33, 0xffff0000, v36
    v_lshlrev_b32 v34, 16, v37
    v_and_b32 v35, 0xffff0000, v37
    v_mul_f32 v36, s52, v32
    v_mul_f32 v37, s52, v33
    v_mul_f32 v38, s52, v34
    v_mul_f32 v39, s52, v35
    v_exp_f32 v36, v36
    v_exp_f32 v37, v37
    v_exp_f32 v38, v38
    v_exp_f32 v39, v39
    v_add_f32 v36, 1.0, v36
    v_add_f32 v37, 1.0, v37
    v_add_f32 v38, 1.0, v38
    v_add_f32 v39, 1.0, v39
    v_rcp_f32 v36, v36
    v_rcp_f32 v37, v37
    v_rcp_f32 v38, v38
    v_rcp_f32 v39, v39
    v_mul_f32 v32, v32, v36
    v_mul_f32 v33, v33, v37
    v_mul_f32 v34, v34, v38
    v_mul_f32 v35, v35, v39
    v_cvt_pk_bf16_f32 v40, v32, v33
    v_cvt_pk_bf16_f32 v41, v34, v35
    buffer_store_dwordx2 v[40:41], v3, s[4:7], s39 offen offset:3584 sc1
    v_accvgpr_read_b32 v48, a132
    v_accvgpr_read_b32 v49, a133
    v_accvgpr_read_b32 v50, a134
    v_accvgpr_read_b32 v51, a135
    v_cvt_pk_bf16_f32 v52, v48, v49
    v_cvt_pk_bf16_f32 v53, v50, v51
    v_lshlrev_b32 v48, 16, v52
    v_and_b32 v49, 0xffff0000, v52
    v_lshlrev_b32 v50, 16, v53
    v_and_b32 v51, 0xffff0000, v53
    v_mul_f32 v52, s52, v48
    v_mul_f32 v53, s52, v49
    v_mul_f32 v54, s52, v50
    v_mul_f32 v55, s52, v51
    v_exp_f32 v52, v52
    v_exp_f32 v53, v53
    v_exp_f32 v54, v54
    v_exp_f32 v55, v55
    v_add_f32 v52, 1.0, v52
    v_add_f32 v53, 1.0, v53
    v_add_f32 v54, 1.0, v54
    v_add_f32 v55, 1.0, v55
    v_rcp_f32 v52, v52
    v_rcp_f32 v53, v53
    v_rcp_f32 v54, v54
    v_rcp_f32 v55, v55
    v_mul_f32 v48, v48, v52
    v_mul_f32 v49, v49, v53
    v_mul_f32 v50, v50, v54
    v_mul_f32 v51, v51, v55
    v_cvt_pk_bf16_f32 v56, v48, v49
    v_cvt_pk_bf16_f32 v57, v50, v51
    buffer_store_dwordx2 v[56:57], v3, s[4:7], s40 offen offset:0 sc1
    v_accvgpr_read_b32 v64, a148
    v_accvgpr_read_b32 v65, a149
    v_accvgpr_read_b32 v66, a150
    v_accvgpr_read_b32 v67, a151
    v_cvt_pk_bf16_f32 v68, v64, v65
    v_cvt_pk_bf16_f32 v69, v66, v67
    v_lshlrev_b32 v64, 16, v68
    v_and_b32 v65, 0xffff0000, v68
    v_lshlrev_b32 v66, 16, v69
    v_and_b32 v67, 0xffff0000, v69
    v_mul_f32 v68, s52, v64
    v_mul_f32 v69, s52, v65
    v_mul_f32 v70, s52, v66
    v_mul_f32 v71, s52, v67
    v_exp_f32 v68, v68
    v_exp_f32 v69, v69
    v_exp_f32 v70, v70
    v_exp_f32 v71, v71
    v_add_f32 v68, 1.0, v68
    v_add_f32 v69, 1.0, v69
    v_add_f32 v70, 1.0, v70
    v_add_f32 v71, 1.0, v71
    v_rcp_f32 v68, v68
    v_rcp_f32 v69, v69
    v_rcp_f32 v70, v70
    v_rcp_f32 v71, v71
    v_mul_f32 v64, v64, v68
    v_mul_f32 v65, v65, v69
    v_mul_f32 v66, v66, v70
    v_mul_f32 v67, v67, v71
    v_cvt_pk_bf16_f32 v72, v64, v65
    v_cvt_pk_bf16_f32 v73, v66, v67
    buffer_store_dwordx2 v[72:73], v3, s[4:7], s40 offen offset:512 sc1
    s_add_u32 s39, s38, 40960
    s_add_u32 s40, s39, 4096
    v_accvgpr_read_b32 v16, a8
    v_accvgpr_read_b32 v17, a9
    v_accvgpr_read_b32 v18, a10
    v_accvgpr_read_b32 v19, a11
    v_cvt_pk_bf16_f32 v20, v16, v17
    v_cvt_pk_bf16_f32 v21, v18, v19
    v_lshlrev_b32 v16, 16, v20
    v_and_b32 v17, 0xffff0000, v20
    v_lshlrev_b32 v18, 16, v21
    v_and_b32 v19, 0xffff0000, v21
    v_mul_f32 v20, s52, v16
    v_mul_f32 v21, s52, v17
    v_mul_f32 v22, s52, v18
    v_mul_f32 v23, s52, v19
    v_exp_f32 v20, v20
    v_exp_f32 v21, v21
    v_exp_f32 v22, v22
    v_exp_f32 v23, v23
    v_add_f32 v20, 1.0, v20
    v_add_f32 v21, 1.0, v21
    v_add_f32 v22, 1.0, v22
    v_add_f32 v23, 1.0, v23
    v_rcp_f32 v20, v20
    v_rcp_f32 v21, v21
    v_rcp_f32 v22, v22
    v_rcp_f32 v23, v23
    v_mul_f32 v16, v16, v20
    v_mul_f32 v17, v17, v21
    v_mul_f32 v18, v18, v22
    v_mul_f32 v19, v19, v23
    v_cvt_pk_bf16_f32 v24, v16, v17
    v_cvt_pk_bf16_f32 v25, v18, v19
    buffer_store_dwordx2 v[24:25], v3, s[4:7], s39 offen offset:0 sc1
    v_accvgpr_read_b32 v32, a24
    v_accvgpr_read_b32 v33, a25
    v_accvgpr_read_b32 v34, a26
    v_accvgpr_read_b32 v35, a27
    v_cvt_pk_bf16_f32 v36, v32, v33
    v_cvt_pk_bf16_f32 v37, v34, v35
    v_lshlrev_b32 v32, 16, v36
    v_and_b32 v33, 0xffff0000, v36
    v_lshlrev_b32 v34, 16, v37
    v_and_b32 v35, 0xffff0000, v37
    v_mul_f32 v36, s52, v32
    v_mul_f32 v37, s52, v33
    v_mul_f32 v38, s52, v34
    v_mul_f32 v39, s52, v35
    v_exp_f32 v36, v36
    v_exp_f32 v37, v37
    v_exp_f32 v38, v38
    v_exp_f32 v39, v39
    v_add_f32 v36, 1.0, v36
    v_add_f32 v37, 1.0, v37
    v_add_f32 v38, 1.0, v38
    v_add_f32 v39, 1.0, v39
    v_rcp_f32 v36, v36
    v_rcp_f32 v37, v37
    v_rcp_f32 v38, v38
    v_rcp_f32 v39, v39
    v_mul_f32 v32, v32, v36
    v_mul_f32 v33, v33, v37
    v_mul_f32 v34, v34, v38
    v_mul_f32 v35, v35, v39
    v_cvt_pk_bf16_f32 v40, v32, v33
    v_cvt_pk_bf16_f32 v41, v34, v35
    buffer_store_dwordx2 v[40:41], v3, s[4:7], s39 offen offset:512 sc1
    v_accvgpr_read_b32 v48, a40
    v_accvgpr_read_b32 v49, a41
    v_accvgpr_read_b32 v50, a42
    v_accvgpr_read_b32 v51, a43
    v_cvt_pk_bf16_f32 v52, v48, v49
    v_cvt_pk_bf16_f32 v53, v50, v51
    v_lshlrev_b32 v48, 16, v52
    v_and_b32 v49, 0xffff0000, v52
    v_lshlrev_b32 v50, 16, v53
    v_and_b32 v51, 0xffff0000, v53
    v_mul_f32 v52, s52, v48
    v_mul_f32 v53, s52, v49
    v_mul_f32 v54, s52, v50
    v_mul_f32 v55, s52, v51
    v_exp_f32 v52, v52
    v_exp_f32 v53, v53
    v_exp_f32 v54, v54
    v_exp_f32 v55, v55
    v_add_f32 v52, 1.0, v52
    v_add_f32 v53, 1.0, v53
    v_add_f32 v54, 1.0, v54
    v_add_f32 v55, 1.0, v55
    v_rcp_f32 v52, v52
    v_rcp_f32 v53, v53
    v_rcp_f32 v54, v54
    v_rcp_f32 v55, v55
    v_mul_f32 v48, v48, v52
    v_mul_f32 v49, v49, v53
    v_mul_f32 v50, v50, v54
    v_mul_f32 v51, v51, v55
    v_cvt_pk_bf16_f32 v56, v48, v49
    v_cvt_pk_bf16_f32 v57, v50, v51
    buffer_store_dwordx2 v[56:57], v3, s[4:7], s39 offen offset:1024 sc1
    v_accvgpr_read_b32 v64, a56
    v_accvgpr_read_b32 v65, a57
    v_accvgpr_read_b32 v66, a58
    v_accvgpr_read_b32 v67, a59
    v_cvt_pk_bf16_f32 v68, v64, v65
    v_cvt_pk_bf16_f32 v69, v66, v67
    v_lshlrev_b32 v64, 16, v68
    v_and_b32 v65, 0xffff0000, v68
    v_lshlrev_b32 v66, 16, v69
    v_and_b32 v67, 0xffff0000, v69
    v_mul_f32 v68, s52, v64
    v_mul_f32 v69, s52, v65
    v_mul_f32 v70, s52, v66
    v_mul_f32 v71, s52, v67
    v_exp_f32 v68, v68
    v_exp_f32 v69, v69
    v_exp_f32 v70, v70
    v_exp_f32 v71, v71
    v_add_f32 v68, 1.0, v68
    v_add_f32 v69, 1.0, v69
    v_add_f32 v70, 1.0, v70
    v_add_f32 v71, 1.0, v71
    v_rcp_f32 v68, v68
    v_rcp_f32 v69, v69
    v_rcp_f32 v70, v70
    v_rcp_f32 v71, v71
    v_mul_f32 v64, v64, v68
    v_mul_f32 v65, v65, v69
    v_mul_f32 v66, v66, v70
    v_mul_f32 v67, v67, v71
    v_cvt_pk_bf16_f32 v72, v64, v65
    v_cvt_pk_bf16_f32 v73, v66, v67
    buffer_store_dwordx2 v[72:73], v3, s[4:7], s39 offen offset:1536 sc1
    v_accvgpr_read_b32 v16, a72
    v_accvgpr_read_b32 v17, a73
    v_accvgpr_read_b32 v18, a74
    v_accvgpr_read_b32 v19, a75
    v_cvt_pk_bf16_f32 v20, v16, v17
    v_cvt_pk_bf16_f32 v21, v18, v19
    v_lshlrev_b32 v16, 16, v20
    v_and_b32 v17, 0xffff0000, v20
    v_lshlrev_b32 v18, 16, v21
    v_and_b32 v19, 0xffff0000, v21
    v_mul_f32 v20, s52, v16
    v_mul_f32 v21, s52, v17
    v_mul_f32 v22, s52, v18
    v_mul_f32 v23, s52, v19
    v_exp_f32 v20, v20
    v_exp_f32 v21, v21
    v_exp_f32 v22, v22
    v_exp_f32 v23, v23
    v_add_f32 v20, 1.0, v20
    v_add_f32 v21, 1.0, v21
    v_add_f32 v22, 1.0, v22
    v_add_f32 v23, 1.0, v23
    v_rcp_f32 v20, v20
    v_rcp_f32 v21, v21
    v_rcp_f32 v22, v22
    v_rcp_f32 v23, v23
    v_mul_f32 v16, v16, v20
    v_mul_f32 v17, v17, v21
    v_mul_f32 v18, v18, v22
    v_mul_f32 v19, v19, v23
    v_cvt_pk_bf16_f32 v24, v16, v17
    v_cvt_pk_bf16_f32 v25, v18, v19
    buffer_store_dwordx2 v[24:25], v3, s[4:7], s39 offen offset:2048 sc1
    v_accvgpr_read_b32 v32, a88
    v_accvgpr_read_b32 v33, a89
    v_accvgpr_read_b32 v34, a90
    v_accvgpr_read_b32 v35, a91
    v_cvt_pk_bf16_f32 v36, v32, v33
    v_cvt_pk_bf16_f32 v37, v34, v35
    v_lshlrev_b32 v32, 16, v36
    v_and_b32 v33, 0xffff0000, v36
    v_lshlrev_b32 v34, 16, v37
    v_and_b32 v35, 0xffff0000, v37
    v_mul_f32 v36, s52, v32
    v_mul_f32 v37, s52, v33
    v_mul_f32 v38, s52, v34
    v_mul_f32 v39, s52, v35
    v_exp_f32 v36, v36
    v_exp_f32 v37, v37
    v_exp_f32 v38, v38
    v_exp_f32 v39, v39
    v_add_f32 v36, 1.0, v36
    v_add_f32 v37, 1.0, v37
    v_add_f32 v38, 1.0, v38
    v_add_f32 v39, 1.0, v39
    v_rcp_f32 v36, v36
    v_rcp_f32 v37, v37
    v_rcp_f32 v38, v38
    v_rcp_f32 v39, v39
    v_mul_f32 v32, v32, v36
    v_mul_f32 v33, v33, v37
    v_mul_f32 v34, v34, v38
    v_mul_f32 v35, v35, v39
    v_cvt_pk_bf16_f32 v40, v32, v33
    v_cvt_pk_bf16_f32 v41, v34, v35
    buffer_store_dwordx2 v[40:41], v3, s[4:7], s39 offen offset:2560 sc1
    v_accvgpr_read_b32 v48, a104
    v_accvgpr_read_b32 v49, a105
    v_accvgpr_read_b32 v50, a106
    v_accvgpr_read_b32 v51, a107
    v_cvt_pk_bf16_f32 v52, v48, v49
    v_cvt_pk_bf16_f32 v53, v50, v51
    v_lshlrev_b32 v48, 16, v52
    v_and_b32 v49, 0xffff0000, v52
    v_lshlrev_b32 v50, 16, v53
    v_and_b32 v51, 0xffff0000, v53
    v_mul_f32 v52, s52, v48
    v_mul_f32 v53, s52, v49
    v_mul_f32 v54, s52, v50
    v_mul_f32 v55, s52, v51
    v_exp_f32 v52, v52
    v_exp_f32 v53, v53
    v_exp_f32 v54, v54
    v_exp_f32 v55, v55
    v_add_f32 v52, 1.0, v52
    v_add_f32 v53, 1.0, v53
    v_add_f32 v54, 1.0, v54
    v_add_f32 v55, 1.0, v55
    v_rcp_f32 v52, v52
    v_rcp_f32 v53, v53
    v_rcp_f32 v54, v54
    v_rcp_f32 v55, v55
    v_mul_f32 v48, v48, v52
    v_mul_f32 v49, v49, v53
    v_mul_f32 v50, v50, v54
    v_mul_f32 v51, v51, v55
    v_cvt_pk_bf16_f32 v56, v48, v49
    v_cvt_pk_bf16_f32 v57, v50, v51
    buffer_store_dwordx2 v[56:57], v3, s[4:7], s39 offen offset:3072 sc1
    v_accvgpr_read_b32 v64, a120
    v_accvgpr_read_b32 v65, a121
    v_accvgpr_read_b32 v66, a122
    v_accvgpr_read_b32 v67, a123
    v_cvt_pk_bf16_f32 v68, v64, v65
    v_cvt_pk_bf16_f32 v69, v66, v67
    v_lshlrev_b32 v64, 16, v68
    v_and_b32 v65, 0xffff0000, v68
    v_lshlrev_b32 v66, 16, v69
    v_and_b32 v67, 0xffff0000, v69
    v_mul_f32 v68, s52, v64
    v_mul_f32 v69, s52, v65
    v_mul_f32 v70, s52, v66
    v_mul_f32 v71, s52, v67
    v_exp_f32 v68, v68
    v_exp_f32 v69, v69
    v_exp_f32 v70, v70
    v_exp_f32 v71, v71
    v_add_f32 v68, 1.0, v68
    v_add_f32 v69, 1.0, v69
    v_add_f32 v70, 1.0, v70
    v_add_f32 v71, 1.0, v71
    v_rcp_f32 v68, v68
    v_rcp_f32 v69, v69
    v_rcp_f32 v70, v70
    v_rcp_f32 v71, v71
    v_mul_f32 v64, v64, v68
    v_mul_f32 v65, v65, v69
    v_mul_f32 v66, v66, v70
    v_mul_f32 v67, v67, v71
    v_cvt_pk_bf16_f32 v72, v64, v65
    v_cvt_pk_bf16_f32 v73, v66, v67
    buffer_store_dwordx2 v[72:73], v3, s[4:7], s39 offen offset:3584 sc1
    v_accvgpr_read_b32 v16, a136
    v_accvgpr_read_b32 v17, a137
    v_accvgpr_read_b32 v18, a138
    v_accvgpr_read_b32 v19, a139
    v_cvt_pk_bf16_f32 v20, v16, v17
    v_cvt_pk_bf16_f32 v21, v18, v19
    v_lshlrev_b32 v16, 16, v20
    v_and_b32 v17, 0xffff0000, v20
    v_lshlrev_b32 v18, 16, v21
    v_and_b32 v19, 0xffff0000, v21
    v_mul_f32 v20, s52, v16
    v_mul_f32 v21, s52, v17
    v_mul_f32 v22, s52, v18
    v_mul_f32 v23, s52, v19
    v_exp_f32 v20, v20
    v_exp_f32 v21, v21
    v_exp_f32 v22, v22
    v_exp_f32 v23, v23
    v_add_f32 v20, 1.0, v20
    v_add_f32 v21, 1.0, v21
    v_add_f32 v22, 1.0, v22
    v_add_f32 v23, 1.0, v23
    v_rcp_f32 v20, v20
    v_rcp_f32 v21, v21
    v_rcp_f32 v22, v22
    v_rcp_f32 v23, v23
    v_mul_f32 v16, v16, v20
    v_mul_f32 v17, v17, v21
    v_mul_f32 v18, v18, v22
    v_mul_f32 v19, v19, v23
    v_cvt_pk_bf16_f32 v24, v16, v17
    v_cvt_pk_bf16_f32 v25, v18, v19
    buffer_store_dwordx2 v[24:25], v3, s[4:7], s40 offen offset:0 sc1
    v_accvgpr_read_b32 v32, a152
    v_accvgpr_read_b32 v33, a153
    v_accvgpr_read_b32 v34, a154
    v_accvgpr_read_b32 v35, a155
    v_cvt_pk_bf16_f32 v36, v32, v33
    v_cvt_pk_bf16_f32 v37, v34, v35
    v_lshlrev_b32 v32, 16, v36
    v_and_b32 v33, 0xffff0000, v36
    v_lshlrev_b32 v34, 16, v37
    v_and_b32 v35, 0xffff0000, v37
    v_mul_f32 v36, s52, v32
    v_mul_f32 v37, s52, v33
    v_mul_f32 v38, s52, v34
    v_mul_f32 v39, s52, v35
    v_exp_f32 v36, v36
    v_exp_f32 v37, v37
    v_exp_f32 v38, v38
    v_exp_f32 v39, v39
    v_add_f32 v36, 1.0, v36
    v_add_f32 v37, 1.0, v37
    v_add_f32 v38, 1.0, v38
    v_add_f32 v39, 1.0, v39
    v_rcp_f32 v36, v36
    v_rcp_f32 v37, v37
    v_rcp_f32 v38, v38
    v_rcp_f32 v39, v39
    v_mul_f32 v32, v32, v36
    v_mul_f32 v33, v33, v37
    v_mul_f32 v34, v34, v38
    v_mul_f32 v35, v35, v39
    v_cvt_pk_bf16_f32 v40, v32, v33
    v_cvt_pk_bf16_f32 v41, v34, v35
    buffer_store_dwordx2 v[40:41], v3, s[4:7], s40 offen offset:512 sc1
    s_add_u32 s39, s38, 61440
    s_add_u32 s40, s39, 4096
    v_accvgpr_read_b32 v48, a12
    v_accvgpr_read_b32 v49, a13
    v_accvgpr_read_b32 v50, a14
    v_accvgpr_read_b32 v51, a15
    v_cvt_pk_bf16_f32 v52, v48, v49
    v_cvt_pk_bf16_f32 v53, v50, v51
    v_lshlrev_b32 v48, 16, v52
    v_and_b32 v49, 0xffff0000, v52
    v_lshlrev_b32 v50, 16, v53
    v_and_b32 v51, 0xffff0000, v53
    v_mul_f32 v52, s52, v48
    v_mul_f32 v53, s52, v49
    v_mul_f32 v54, s52, v50
    v_mul_f32 v55, s52, v51
    v_exp_f32 v52, v52
    v_exp_f32 v53, v53
    v_exp_f32 v54, v54
    v_exp_f32 v55, v55
    v_add_f32 v52, 1.0, v52
    v_add_f32 v53, 1.0, v53
    v_add_f32 v54, 1.0, v54
    v_add_f32 v55, 1.0, v55
    v_rcp_f32 v52, v52
    v_rcp_f32 v53, v53
    v_rcp_f32 v54, v54
    v_rcp_f32 v55, v55
    v_mul_f32 v48, v48, v52
    v_mul_f32 v49, v49, v53
    v_mul_f32 v50, v50, v54
    v_mul_f32 v51, v51, v55
    v_cvt_pk_bf16_f32 v56, v48, v49
    v_cvt_pk_bf16_f32 v57, v50, v51
    buffer_store_dwordx2 v[56:57], v3, s[4:7], s39 offen offset:0 sc1
    v_accvgpr_read_b32 v64, a28
    v_accvgpr_read_b32 v65, a29
    v_accvgpr_read_b32 v66, a30
    v_accvgpr_read_b32 v67, a31
    v_cvt_pk_bf16_f32 v68, v64, v65
    v_cvt_pk_bf16_f32 v69, v66, v67
    v_lshlrev_b32 v64, 16, v68
    v_and_b32 v65, 0xffff0000, v68
    v_lshlrev_b32 v66, 16, v69
    v_and_b32 v67, 0xffff0000, v69
    v_mul_f32 v68, s52, v64
    v_mul_f32 v69, s52, v65
    v_mul_f32 v70, s52, v66
    v_mul_f32 v71, s52, v67
    v_exp_f32 v68, v68
    v_exp_f32 v69, v69
    v_exp_f32 v70, v70
    v_exp_f32 v71, v71
    v_add_f32 v68, 1.0, v68
    v_add_f32 v69, 1.0, v69
    v_add_f32 v70, 1.0, v70
    v_add_f32 v71, 1.0, v71
    v_rcp_f32 v68, v68
    v_rcp_f32 v69, v69
    v_rcp_f32 v70, v70
    v_rcp_f32 v71, v71
    v_mul_f32 v64, v64, v68
    v_mul_f32 v65, v65, v69
    v_mul_f32 v66, v66, v70
    v_mul_f32 v67, v67, v71
    v_cvt_pk_bf16_f32 v72, v64, v65
    v_cvt_pk_bf16_f32 v73, v66, v67
    buffer_store_dwordx2 v[72:73], v3, s[4:7], s39 offen offset:512 sc1
    v_accvgpr_read_b32 v16, a44
    v_accvgpr_read_b32 v17, a45
    v_accvgpr_read_b32 v18, a46
    v_accvgpr_read_b32 v19, a47
    v_cvt_pk_bf16_f32 v20, v16, v17
    v_cvt_pk_bf16_f32 v21, v18, v19
    v_lshlrev_b32 v16, 16, v20
    v_and_b32 v17, 0xffff0000, v20
    v_lshlrev_b32 v18, 16, v21
    v_and_b32 v19, 0xffff0000, v21
    v_mul_f32 v20, s52, v16
    v_mul_f32 v21, s52, v17
    v_mul_f32 v22, s52, v18
    v_mul_f32 v23, s52, v19
    v_exp_f32 v20, v20
    v_exp_f32 v21, v21
    v_exp_f32 v22, v22
    v_exp_f32 v23, v23
    v_add_f32 v20, 1.0, v20
    v_add_f32 v21, 1.0, v21
    v_add_f32 v22, 1.0, v22
    v_add_f32 v23, 1.0, v23
    v_rcp_f32 v20, v20
    v_rcp_f32 v21, v21
    v_rcp_f32 v22, v22
    v_rcp_f32 v23, v23
    v_mul_f32 v16, v16, v20
    v_mul_f32 v17, v17, v21
    v_mul_f32 v18, v18, v22
    v_mul_f32 v19, v19, v23
    v_cvt_pk_bf16_f32 v24, v16, v17
    v_cvt_pk_bf16_f32 v25, v18, v19
    buffer_store_dwordx2 v[24:25], v3, s[4:7], s39 offen offset:1024 sc1
    v_accvgpr_read_b32 v32, a60
    v_accvgpr_read_b32 v33, a61
    v_accvgpr_read_b32 v34, a62
    v_accvgpr_read_b32 v35, a63
    v_cvt_pk_bf16_f32 v36, v32, v33
    v_cvt_pk_bf16_f32 v37, v34, v35
    v_lshlrev_b32 v32, 16, v36
    v_and_b32 v33, 0xffff0000, v36
    v_lshlrev_b32 v34, 16, v37
    v_and_b32 v35, 0xffff0000, v37
    v_mul_f32 v36, s52, v32
    v_mul_f32 v37, s52, v33
    v_mul_f32 v38, s52, v34
    v_mul_f32 v39, s52, v35
    v_exp_f32 v36, v36
    v_exp_f32 v37, v37
    v_exp_f32 v38, v38
    v_exp_f32 v39, v39
    v_add_f32 v36, 1.0, v36
    v_add_f32 v37, 1.0, v37
    v_add_f32 v38, 1.0, v38
    v_add_f32 v39, 1.0, v39
    v_rcp_f32 v36, v36
    v_rcp_f32 v37, v37
    v_rcp_f32 v38, v38
    v_rcp_f32 v39, v39
    v_mul_f32 v32, v32, v36
    v_mul_f32 v33, v33, v37
    v_mul_f32 v34, v34, v38
    v_mul_f32 v35, v35, v39
    v_cvt_pk_bf16_f32 v40, v32, v33
    v_cvt_pk_bf16_f32 v41, v34, v35
    buffer_store_dwordx2 v[40:41], v3, s[4:7], s39 offen offset:1536 sc1
    v_accvgpr_read_b32 v48, a76
    v_accvgpr_read_b32 v49, a77
    v_accvgpr_read_b32 v50, a78
    v_accvgpr_read_b32 v51, a79
    v_cvt_pk_bf16_f32 v52, v48, v49
    v_cvt_pk_bf16_f32 v53, v50, v51
    v_lshlrev_b32 v48, 16, v52
    v_and_b32 v49, 0xffff0000, v52
    v_lshlrev_b32 v50, 16, v53
    v_and_b32 v51, 0xffff0000, v53
    v_mul_f32 v52, s52, v48
    v_mul_f32 v53, s52, v49
    v_mul_f32 v54, s52, v50
    v_mul_f32 v55, s52, v51
    v_exp_f32 v52, v52
    v_exp_f32 v53, v53
    v_exp_f32 v54, v54
    v_exp_f32 v55, v55
    v_add_f32 v52, 1.0, v52
    v_add_f32 v53, 1.0, v53
    v_add_f32 v54, 1.0, v54
    v_add_f32 v55, 1.0, v55
    v_rcp_f32 v52, v52
    v_rcp_f32 v53, v53
    v_rcp_f32 v54, v54
    v_rcp_f32 v55, v55
    v_mul_f32 v48, v48, v52
    v_mul_f32 v49, v49, v53
    v_mul_f32 v50, v50, v54
    v_mul_f32 v51, v51, v55
    v_cvt_pk_bf16_f32 v56, v48, v49
    v_cvt_pk_bf16_f32 v57, v50, v51
    buffer_store_dwordx2 v[56:57], v3, s[4:7], s39 offen offset:2048 sc1
    v_accvgpr_read_b32 v64, a92
    v_accvgpr_read_b32 v65, a93
    v_accvgpr_read_b32 v66, a94
    v_accvgpr_read_b32 v67, a95
    v_cvt_pk_bf16_f32 v68, v64, v65
    v_cvt_pk_bf16_f32 v69, v66, v67
    v_lshlrev_b32 v64, 16, v68
    v_and_b32 v65, 0xffff0000, v68
    v_lshlrev_b32 v66, 16, v69
    v_and_b32 v67, 0xffff0000, v69
    v_mul_f32 v68, s52, v64
    v_mul_f32 v69, s52, v65
    v_mul_f32 v70, s52, v66
    v_mul_f32 v71, s52, v67
    v_exp_f32 v68, v68
    v_exp_f32 v69, v69
    v_exp_f32 v70, v70
    v_exp_f32 v71, v71
    v_add_f32 v68, 1.0, v68
    v_add_f32 v69, 1.0, v69
    v_add_f32 v70, 1.0, v70
    v_add_f32 v71, 1.0, v71
    v_rcp_f32 v68, v68
    v_rcp_f32 v69, v69
    v_rcp_f32 v70, v70
    v_rcp_f32 v71, v71
    v_mul_f32 v64, v64, v68
    v_mul_f32 v65, v65, v69
    v_mul_f32 v66, v66, v70
    v_mul_f32 v67, v67, v71
    v_cvt_pk_bf16_f32 v72, v64, v65
    v_cvt_pk_bf16_f32 v73, v66, v67
    buffer_store_dwordx2 v[72:73], v3, s[4:7], s39 offen offset:2560 sc1
    v_accvgpr_read_b32 v16, a108
    v_accvgpr_read_b32 v17, a109
    v_accvgpr_read_b32 v18, a110
    v_accvgpr_read_b32 v19, a111
    v_cvt_pk_bf16_f32 v20, v16, v17
    v_cvt_pk_bf16_f32 v21, v18, v19
    v_lshlrev_b32 v16, 16, v20
    v_and_b32 v17, 0xffff0000, v20
    v_lshlrev_b32 v18, 16, v21
    v_and_b32 v19, 0xffff0000, v21
    v_mul_f32 v20, s52, v16
    v_mul_f32 v21, s52, v17
    v_mul_f32 v22, s52, v18
    v_mul_f32 v23, s52, v19
    v_exp_f32 v20, v20
    v_exp_f32 v21, v21
    v_exp_f32 v22, v22
    v_exp_f32 v23, v23
    v_add_f32 v20, 1.0, v20
    v_add_f32 v21, 1.0, v21
    v_add_f32 v22, 1.0, v22
    v_add_f32 v23, 1.0, v23
    v_rcp_f32 v20, v20
    v_rcp_f32 v21, v21
    v_rcp_f32 v22, v22
    v_rcp_f32 v23, v23
    v_mul_f32 v16, v16, v20
    v_mul_f32 v17, v17, v21
    v_mul_f32 v18, v18, v22
    v_mul_f32 v19, v19, v23
    v_cvt_pk_bf16_f32 v24, v16, v17
    v_cvt_pk_bf16_f32 v25, v18, v19
    buffer_store_dwordx2 v[24:25], v3, s[4:7], s39 offen offset:3072 sc1
    v_accvgpr_read_b32 v32, a124
    v_accvgpr_read_b32 v33, a125
    v_accvgpr_read_b32 v34, a126
    v_accvgpr_read_b32 v35, a127
    v_cvt_pk_bf16_f32 v36, v32, v33
    v_cvt_pk_bf16_f32 v37, v34, v35
    v_lshlrev_b32 v32, 16, v36
    v_and_b32 v33, 0xffff0000, v36
    v_lshlrev_b32 v34, 16, v37
    v_and_b32 v35, 0xffff0000, v37
    v_mul_f32 v36, s52, v32
    v_mul_f32 v37, s52, v33
    v_mul_f32 v38, s52, v34
    v_mul_f32 v39, s52, v35
    v_exp_f32 v36, v36
    v_exp_f32 v37, v37
    v_exp_f32 v38, v38
    v_exp_f32 v39, v39
    v_add_f32 v36, 1.0, v36
    v_add_f32 v37, 1.0, v37
    v_add_f32 v38, 1.0, v38
    v_add_f32 v39, 1.0, v39
    v_rcp_f32 v36, v36
    v_rcp_f32 v37, v37
    v_rcp_f32 v38, v38
    v_rcp_f32 v39, v39
    v_mul_f32 v32, v32, v36
    v_mul_f32 v33, v33, v37
    v_mul_f32 v34, v34, v38
    v_mul_f32 v35, v35, v39
    v_cvt_pk_bf16_f32 v40, v32, v33
    v_cvt_pk_bf16_f32 v41, v34, v35
    buffer_store_dwordx2 v[40:41], v3, s[4:7], s39 offen offset:3584 sc1
    v_accvgpr_read_b32 v48, a140
    v_accvgpr_read_b32 v49, a141
    v_accvgpr_read_b32 v50, a142
    v_accvgpr_read_b32 v51, a143
    v_cvt_pk_bf16_f32 v52, v48, v49
    v_cvt_pk_bf16_f32 v53, v50, v51
    v_lshlrev_b32 v48, 16, v52
    v_and_b32 v49, 0xffff0000, v52
    v_lshlrev_b32 v50, 16, v53
    v_and_b32 v51, 0xffff0000, v53
    v_mul_f32 v52, s52, v48
    v_mul_f32 v53, s52, v49
    v_mul_f32 v54, s52, v50
    v_mul_f32 v55, s52, v51
    v_exp_f32 v52, v52
    v_exp_f32 v53, v53
    v_exp_f32 v54, v54
    v_exp_f32 v55, v55
    v_add_f32 v52, 1.0, v52
    v_add_f32 v53, 1.0, v53
    v_add_f32 v54, 1.0, v54
    v_add_f32 v55, 1.0, v55
    v_rcp_f32 v52, v52
    v_rcp_f32 v53, v53
    v_rcp_f32 v54, v54
    v_rcp_f32 v55, v55
    v_mul_f32 v48, v48, v52
    v_mul_f32 v49, v49, v53
    v_mul_f32 v50, v50, v54
    v_mul_f32 v51, v51, v55
    v_cvt_pk_bf16_f32 v56, v48, v49
    v_cvt_pk_bf16_f32 v57, v50, v51
    buffer_store_dwordx2 v[56:57], v3, s[4:7], s40 offen offset:0 sc1
    v_accvgpr_read_b32 v64, a156
    v_accvgpr_read_b32 v65, a157
    v_accvgpr_read_b32 v66, a158
    v_accvgpr_read_b32 v67, a159
    v_cvt_pk_bf16_f32 v68, v64, v65
    v_cvt_pk_bf16_f32 v69, v66, v67
    v_lshlrev_b32 v64, 16, v68
    v_and_b32 v65, 0xffff0000, v68
    v_lshlrev_b32 v66, 16, v69
    v_and_b32 v67, 0xffff0000, v69
    v_mul_f32 v68, s52, v64
    v_mul_f32 v69, s52, v65
    v_mul_f32 v70, s52, v66
    v_mul_f32 v71, s52, v67
    v_exp_f32 v68, v68
    v_exp_f32 v69, v69
    v_exp_f32 v70, v70
    v_exp_f32 v71, v71
    v_add_f32 v68, 1.0, v68
    v_add_f32 v69, 1.0, v69
    v_add_f32 v70, 1.0, v70
    v_add_f32 v71, 1.0, v71
    v_rcp_f32 v68, v68
    v_rcp_f32 v69, v69
    v_rcp_f32 v70, v70
    v_rcp_f32 v71, v71
    v_mul_f32 v64, v64, v68
    v_mul_f32 v65, v65, v69
    v_mul_f32 v66, v66, v70
    v_mul_f32 v67, v67, v71
    v_cvt_pk_bf16_f32 v72, v64, v65
    v_cvt_pk_bf16_f32 v73, v66, v67
    buffer_store_dwordx2 v[72:73], v3, s[4:7], s40 offen offset:512 sc1
    s_waitcnt vmcnt(0)
    s_barrier
    s_cmp_lg_u32 s22, 0
    s_cbranch_scc1 L_ffn_nf
    v_mov_b32 v4, 1
    s_lshl_b32 s38, s24, 2
    v_mov_b32 v5, s38
    s_mov_b32 s39, 253952
    s_mov_b64 exec, 1
    buffer_store_dword v4, v5, s[4:7], s39 offen sc1
    s_mov_b64 exec, -1
    s_waitcnt vmcnt(0)
L_ffn_nf:
    s_cmp_ge_u32 s26, 8
    s_cbranch_scc1 L_cmb
    s_add_u32 s24, s24, 24
    s_cmp_lt_u32 s24, 32
    s_cbranch_scc1 L_ffn_task
    s_endpgm
L_cmb:
    s_sub_u32 s24, s26, 8
    s_lshl_b32 s24, s24, 2
    s_add_u32 s30, s24, s22
    s_mov_b32 s33, 1220
L_cmb2:
    s_mov_b32 s8, s68
    s_and_b32 s9, s69, 0xffff
    s_mov_b32 s10, 0x280000
    s_mov_b32 s11, 0x00020000
    s_mov_b32 s12, s70
    s_and_b32 s13, s71, 0xffff
    s_mov_b32 s14, 0x280000
    s_mov_b32 s15, 0x00020000
    v_lshlrev_b32 v3, 2, v1
    v_lshlrev_b32 v4, 3, v1
    v_mov_b32 v6, 0
    v_and_b32 v14, 15, v1
    v_lshrrev_b32 v15, 4, v1
    v_mul_u32_u24 v5, 1280, v14
    v_lshl_add_u32 v5, v15, 3, v5
    s_mov_b32 s49, 0
    s_mov_b32 s52, 0x3f80
    s_mov_b32 s53, 0x3f800000
    v_lshrrev_b32 v7, 4, v1
    v_mul_u32_u24 v7, 40960, v7
    v_lshl_add_u32 v7, v14, 7, v7
    v_add_u32 v8, 163840, v7
    s_cmp_eq_u32 s33, 0
    s_cbranch_scc1 Lct_207
    s_add_u32 s38, s30, 1216
    s_mul_i32 s39, s38, 3277
    s_lshr_b32 s39, s39, 16
    s_mul_i32 s40, s39, 20
    s_sub_u32 s40, s38, s40
    s_mul_i32 s43, s39, 327680
    s_lshl_b32 s40, s40, 11
    s_add_u32 s43, s43, s40
    s_add_u32 s43, s43, 142606336
    buffer_load_dword v160, v7, s[4:7], s43 offen sc1
    buffer_load_dword v160, v8, s[4:7], s43 offen sc1
Lct_207:
    s_mul_i32 s38, s30, 3277
    s_lshr_b32 s38, s38, 16
    s_mul_i32 s39, s38, 20
    s_sub_u32 s39, s30, s39
    s_cmp_ge_u32 s39, 10
    s_cselect_b32 s40, 1, 0
    s_mul_i32 s41, s40, 10
    s_sub_u32 s41, s39, s41
    s_cmp_lg_u32 s49, 0
    s_cbranch_scc1 Lcg_208
    s_mov_b32 s42, 253952
    s_mov_b32 exec_hi, 0
    buffer_load_dword v160, v3, s[4:7], s42 offen sc1
    s_waitcnt vmcnt(0)
    v_cmp_eq_u32 vcc, 0, v160
    s_mov_b64 exec, -1
    s_cmp_eq_u32 vcc_lo, 0
    s_cselect_b32 s49, 1, 0
    s_cbranch_scc1 Lcg_208
    s_lshr_b32 s42, s38, 1
    s_lshl_b32 s42, s42, 2
    s_add_u32 s42, s42, 253952
    s_mov_b32 s31, 262144
    s_mov_b32 exec_lo, 0x1
    s_mov_b32 exec_hi, 0
Lf_209:
    buffer_load_dword v160, v6, s[4:7], s42 offen sc1
    s_waitcnt vmcnt(0)
    v_cmp_eq_u32 vcc, 0, v160
    s_cbranch_vccz Lfd_210
    s_sleep 32
    s_sub_u32 s31, s31, 1
    s_cbranch_scc0 Lf_209
    s_mov_b32 s31, 7
    s_branch L_fail
Lfd_210:
    s_mov_b64 exec, -1
Lcg_208:
    s_mul_i32 s43, s38, 327680
    s_mul_i32 s44, s40, 20480
    s_add_u32 s43, s43, s44
    s_lshl_b32 s44, s41, 11
    s_add_u32 s43, s43, s44
    s_add_u32 s43, s43, 142606336
    s_lshl_b32 s45, s38, 1
    s_add_u32 s45, s45, s40
    s_mul_i32 s46, s45, 20480
    s_lshr_b32 s47, s41, 1
    s_lshl_b32 s47, s47, 2
    s_and_b32 s48, s41, 1
    s_add_u32 s44, s47, s48
    s_lshl_b32 s47, s44, 10
    s_add_u32 s47, s47, s46
    s_add_u32 s47, s47, 10747904
    s_lshl_b32 s48, s44, 6
    s_add_u32 s48, s48, s46
    buffer_load_dwordx2 v[144:145], v4, s[4:7], s47 offen offset:0 sc1
    buffer_load_dwordx2 v[152:153], v5, s[8:11], s48 offen offset:0
    buffer_load_dwordx2 v[146:147], v4, s[4:7], s47 offen offset:2048 sc1
    buffer_load_dwordx2 v[154:155], v5, s[8:11], s48 offen offset:128
    buffer_load_dwordx2 v[148:149], v4, s[4:7], s47 offen offset:512 sc1
    buffer_load_dwordx2 v[156:157], v5, s[8:11], s48 offen offset:32
    buffer_load_dwordx2 v[150:151], v4, s[4:7], s47 offen offset:2560 sc1
    buffer_load_dwordx2 v[158:159], v5, s[8:11], s48 offen offset:160
    s_mul_i32 s50, s38, 10
    s_and_b32 s44, s41, 14
    s_add_u32 s50, s50, s44
    s_lshl_b32 s50, s50, 7
    s_add_u32 s50, s50, 172032
    s_cmp_ge_u32 s38, 61
    s_cbranch_scc1 Lc1_211
    s_add_u32 s42, s38, 2
    s_lshl_b32 s42, s42, 3
    s_add_u32 s42, s42, s20
    s_lshl_b32 s42, s42, 6
    s_add_u32 s42, s42, 139264
    s_mov_b32 s31, 262144
    s_mov_b32 exec_lo, 0x1
    s_mov_b32 exec_hi, 0
Lf_213:
    buffer_load_dword v160, v6, s[4:7], s42 offen sc1
    s_waitcnt vmcnt(0)
    v_cmp_eq_u32 vcc, 0, v160
    s_cbranch_vccz Lfd_214
    s_sleep 8
    s_sub_u32 s31, s31, 1
    s_cbranch_scc0 Lf_213
    s_mov_b32 s31, 9
    s_branch L_fail
Lfd_214:
    s_mov_b64 exec, -1
    s_mov_b32 s31, 262144
    s_mov_b64 exec, -1
Lf_215:
    buffer_load_dword v160, v3, s[4:7], s50 offen sc1
    s_waitcnt vmcnt(0)
    v_cmp_eq_u32 vcc, 0, v160
    s_cbranch_vccz Lfd_216
    s_sleep 8
    s_sub_u32 s31, s31, 1
    s_cbranch_scc0 Lf_215
    s_mov_b32 s31, 8
    s_branch L_fail
Lfd_216:
    s_mov_b64 exec, -1
    s_branch Lc2_212
Lc1_211:
    s_and_b32 s42, s38, 3
    s_lshl_b32 s42, s42, 3
    s_add_u32 s42, s42, s20
    s_lshl_b32 s42, s42, 7
    s_lshl_b32 s44, s44, 1
    s_add_u32 s42, s42, s44
    s_add_u32 s42, s42, 258048
    s_mul_i32 s51, s20, 5
    s_lshr_b32 s44, s41, 1
    s_add_u32 s51, s51, s44
    s_lshl_b32 s51, s51, 7
    s_add_u32 s51, s51, 1769472
    s_and_b32 s44, s38, 1
    s_lshl_b32 s44, s44, 2
    s_add_u32 s51, s51, s44
    s_cmp_ge_u32 s38, 62
    s_cselect_b32 s42, s51, s42
    s_mov_b32 s31, 262144
    s_mov_b32 exec_lo, 0x1
    s_mov_b32 exec_hi, 0
Lf_217:
    buffer_load_dword v160, v6, s[4:7], s42 offen sc1
    s_waitcnt vmcnt(0)
    v_cmp_eq_u32 vcc, 0, v160
    s_cbranch_vccz Lfd_218
    s_sleep 2
    s_sub_u32 s31, s31, 1
    s_cbranch_scc0 Lf_217
    s_mov_b32 s31, 9
    s_branch L_fail
Lfd_218:
    s_mov_b64 exec, -1
    s_cmp_ge_u32 s38, 62
    s_cbranch_scc1 Lc2_212
    s_mov_b32 s31, 262144
    s_mov_b64 exec, -1
Lf_219:
    buffer_load_dword v160, v3, s[4:7], s50 offen sc1
    s_waitcnt vmcnt(0)
    v_cmp_eq_u32 vcc, 0, v160
    s_cbranch_vccz Lfd_220
    s_sleep 4
    s_sub_u32 s31, s31, 1
    s_cbranch_scc0 Lf_219
    s_mov_b32 s31, 8
    s_branch L_fail
Lfd_220:
    s_mov_b64 exec, -1
Lc2_212:
    v_mov_b32 v16, 0
    v_mov_b32 v17, 0
    v_mov_b32 v18, 0
    v_mov_b32 v19, 0
    v_mov_b32 v20, 0
    v_mov_b32 v21, 0
    v_mov_b32 v22, 0
    v_mov_b32 v23, 0
    v_mov_b32 v24, 0
    v_mov_b32 v25, 0
    v_mov_b32 v26, 0
    v_mov_b32 v27, 0
    v_mov_b32 v28, 0
    v_mov_b32 v29, 0
    v_mov_b32 v30, 0
    v_mov_b32 v31, 0
    s_cmp_ge_u32 s38, 61
    s_cbranch_scc1 Lcf_221
    buffer_load_dwordx4 v[48:51], v2, s[4:7], s43 offen offset:0 sc1
    buffer_load_dwordx4 v[52:55], v2, s[4:7], s43 offen offset:1024 sc1
    s_add_u32 s43, s43, 40960
    buffer_load_dwordx4 v[56:59], v2, s[4:7], s43 offen offset:0 sc1
    buffer_load_dwordx4 v[60:63], v2, s[4:7], s43 offen offset:1024 sc1
    s_add_u32 s43, s43, 40960
    s_waitcnt vmcnt(2)
    buffer_load_dwordx4 v[64:67], v2, s[4:7], s43 offen offset:0 sc1
    buffer_load_dwordx4 v[68:71], v2, s[4:7], s43 offen offset:1024 sc1
    s_add_u32 s43, s43, 40960
    v_dot2c_f32_bf16 v16, s52, v48
    v_dot2c_f32_bf16 v17, s53, v48
    v_dot2c_f32_bf16 v18, s52, v49
    v_dot2c_f32_bf16 v19, s53, v49
    v_dot2c_f32_bf16 v20, s52, v50
    v_dot2c_f32_bf16 v21, s53, v50
    v_dot2c_f32_bf16 v22, s52, v51
    v_dot2c_f32_bf16 v23, s53, v51
    v_dot2c_f32_bf16 v24, s52, v52
    v_dot2c_f32_bf16 v25, s53, v52
    v_dot2c_f32_bf16 v26, s52, v53
    v_dot2c_f32_bf16 v27, s53, v53
    v_dot2c_f32_bf16 v28, s52, v54
    v_dot2c_f32_bf16 v29, s53, v54
    v_dot2c_f32_bf16 v30, s52, v55
    v_dot2c_f32_bf16 v31, s53, v55
    s_waitcnt vmcnt(2)
    buffer_load_dwordx4 v[72:75], v2, s[4:7], s43 offen offset:0 sc1
    buffer_load_dwordx4 v[76:79], v2, s[4:7], s43 offen offset:1024 sc1
    s_add_u32 s43, s43, 40960
    v_dot2c_f32_bf16 v16, s52, v56
    v_dot2c_f32_bf16 v17, s53, v56
    v_dot2c_f32_bf16 v18, s52, v57
    v_dot2c_f32_bf16 v19, s53, v57
    v_dot2c_f32_bf16 v20, s52, v58
    v_dot2c_f32_bf16 v21, s53, v58
    v_dot2c_f32_bf16 v22, s52, v59
    v_dot2c_f32_bf16 v23, s53, v59
    v_dot2c_f32_bf16 v24, s52, v60
    v_dot2c_f32_bf16 v25, s53, v60
    v_dot2c_f32_bf16 v26, s52, v61
    v_dot2c_f32_bf16 v27, s53, v61
    v_dot2c_f32_bf16 v28, s52, v62
    v_dot2c_f32_bf16 v29, s53, v62
    v_dot2c_f32_bf16 v30, s52, v63
    v_dot2c_f32_bf16 v31, s53, v63
    s_waitcnt vmcnt(2)
    buffer_load_dwordx4 v[80:83], v2, s[4:7], s43 offen offset:0 sc1
    buffer_load_dwordx4 v[84:87], v2, s[4:7], s43 offen offset:1024 sc1
    s_add_u32 s43, s43, 40960
    v_dot2c_f32_bf16 v16, s52, v64
    v_dot2c_f32_bf16 v17, s53, v64
    v_dot2c_f32_bf16 v18, s52, v65
    v_dot2c_f32_bf16 v19, s53, v65
    v_dot2c_f32_bf16 v20, s52, v66
    v_dot2c_f32_bf16 v21, s53, v66
    v_dot2c_f32_bf16 v22, s52, v67
    v_dot2c_f32_bf16 v23, s53, v67
    v_dot2c_f32_bf16 v24, s52, v68
    v_dot2c_f32_bf16 v25, s53, v68
    v_dot2c_f32_bf16 v26, s52, v69
    v_dot2c_f32_bf16 v27, s53, v69
    v_dot2c_f32_bf16 v28, s52, v70
    v_dot2c_f32_bf16 v29, s53, v70
    v_dot2c_f32_bf16 v30, s52, v71
    v_dot2c_f32_bf16 v31, s53, v71
    s_waitcnt vmcnt(2)
    buffer_load_dwordx4 v[88:91], v2, s[4:7], s43 offen offset:0 sc1
    buffer_load_dwordx4 v[92:95], v2, s[4:7], s43 offen offset:1024 sc1
    s_add_u32 s43, s43, 40960
    v_dot2c_f32_bf16 v16, s52, v72
    v_dot2c_f32_bf16 v17, s53, v72
    v_dot2c_f32_bf16 v18, s52, v73
    v_dot2c_f32_bf16 v19, s53, v73
    v_dot2c_f32_bf16 v20, s52, v74
    v_dot2c_f32_bf16 v21, s53, v74
    v_dot2c_f32_bf16 v22, s52, v75
    v_dot2c_f32_bf16 v23, s53, v75
    v_dot2c_f32_bf16 v24, s52, v76
    v_dot2c_f32_bf16 v25, s53, v76
    v_dot2c_f32_bf16 v26, s52, v77
    v_dot2c_f32_bf16 v27, s53, v77
    v_dot2c_f32_bf16 v28, s52, v78
    v_dot2c_f32_bf16 v29, s53, v78
    v_dot2c_f32_bf16 v30, s52, v79
    v_dot2c_f32_bf16 v31, s53, v79
    s_waitcnt vmcnt(2)
    buffer_load_dwordx4 v[96:99], v2, s[4:7], s43 offen offset:0 sc1
    buffer_load_dwordx4 v[100:103], v2, s[4:7], s43 offen offset:1024 sc1
    s_add_u32 s43, s43, 40960
    v_dot2c_f32_bf16 v16, s52, v80
    v_dot2c_f32_bf16 v17, s53, v80
    v_dot2c_f32_bf16 v18, s52, v81
    v_dot2c_f32_bf16 v19, s53, v81
    v_dot2c_f32_bf16 v20, s52, v82
    v_dot2c_f32_bf16 v21, s53, v82
    v_dot2c_f32_bf16 v22, s52, v83
    v_dot2c_f32_bf16 v23, s53, v83
    v_dot2c_f32_bf16 v24, s52, v84
    v_dot2c_f32_bf16 v25, s53, v84
    v_dot2c_f32_bf16 v26, s52, v85
    v_dot2c_f32_bf16 v27, s53, v85
    v_dot2c_f32_bf16 v28, s52, v86
    v_dot2c_f32_bf16 v29, s53, v86
    v_dot2c_f32_bf16 v30, s52, v87
    v_dot2c_f32_bf16 v31, s53, v87
    s_waitcnt vmcnt(2)
    buffer_load_dwordx4 v[104:107], v2, s[4:7], s43 offen offset:0 sc1
    buffer_load_dwordx4 v[108:111], v2, s[4:7], s43 offen offset:1024 sc1
    v_dot2c_f32_bf16 v16, s52, v88
    v_dot2c_f32_bf16 v17, s53, v88
    v_dot2c_f32_bf16 v18, s52, v89
    v_dot2c_f32_bf16 v19, s53, v89
    v_dot2c_f32_bf16 v20, s52, v90
    v_dot2c_f32_bf16 v21, s53, v90
    v_dot2c_f32_bf16 v22, s52, v91
    v_dot2c_f32_bf16 v23, s53, v91
    v_dot2c_f32_bf16 v24, s52, v92
    v_dot2c_f32_bf16 v25, s53, v92
    v_dot2c_f32_bf16 v26, s52, v93
    v_dot2c_f32_bf16 v27, s53, v93
    v_dot2c_f32_bf16 v28, s52, v94
    v_dot2c_f32_bf16 v29, s53, v94
    v_dot2c_f32_bf16 v30, s52, v95
    v_dot2c_f32_bf16 v31, s53, v95
    s_waitcnt vmcnt(2)
    v_dot2c_f32_bf16 v16, s52, v96
    v_dot2c_f32_bf16 v17, s53, v96
    v_dot2c_f32_bf16 v18, s52, v97
    v_dot2c_f32_bf16 v19, s53, v97
    v_dot2c_f32_bf16 v20, s52, v98
    v_dot2c_f32_bf16 v21, s53, v98
    v_dot2c_f32_bf16 v22, s52, v99
    v_dot2c_f32_bf16 v23, s53, v99
    v_dot2c_f32_bf16 v24, s52, v100
    v_dot2c_f32_bf16 v25, s53, v100
    v_dot2c_f32_bf16 v26, s52, v101
    v_dot2c_f32_bf16 v27, s53, v101
    v_dot2c_f32_bf16 v28, s52, v102
    v_dot2c_f32_bf16 v29, s53, v102
    v_dot2c_f32_bf16 v30, s52, v103
    v_dot2c_f32_bf16 v31, s53, v103
    s_waitcnt vmcnt(0)
    v_dot2c_f32_bf16 v16, s52, v104
    v_dot2c_f32_bf16 v17, s53, v104
    v_dot2c_f32_bf16 v18, s52, v105
    v_dot2c_f32_bf16 v19, s53, v105
    v_dot2c_f32_bf16 v20, s52, v106
    v_dot2c_f32_bf16 v21, s53, v106
    v_dot2c_f32_bf16 v22, s52, v107
    v_dot2c_f32_bf16 v23, s53, v107
    v_dot2c_f32_bf16 v24, s52, v108
    v_dot2c_f32_bf16 v25, s53, v108
    v_dot2c_f32_bf16 v26, s52, v109
    v_dot2c_f32_bf16 v27, s53, v109
    v_dot2c_f32_bf16 v28, s52, v110
    v_dot2c_f32_bf16 v29, s53, v110
    v_dot2c_f32_bf16 v30, s52, v111
    v_dot2c_f32_bf16 v31, s53, v111
    s_nop 2
    s_branch Lcj_222
Lcf_221:
    s_cmp_lt_u32 s38, 62
    s_cbranch_scc1 Lcg_223
    s_mov_b32 s31, 262144
    s_mov_b32 s51, s43
Lcp_224:
    s_mov_b32 s43, s51
    buffer_load_dwordx4 v[48:51], v2, s[4:7], s43 offen offset:0 sc1
    buffer_load_dwordx4 v[52:55], v2, s[4:7], s43 offen offset:1024 sc1
    s_add_u32 s43, s43, 40960
    buffer_load_dwordx4 v[56:59], v2, s[4:7], s43 offen offset:0 sc1
    buffer_load_dwordx4 v[60:63], v2, s[4:7], s43 offen offset:1024 sc1
    s_add_u32 s43, s43, 40960
    buffer_load_dwordx4 v[64:67], v2, s[4:7], s43 offen offset:0 sc1
    buffer_load_dwordx4 v[68:71], v2, s[4:7], s43 offen offset:1024 sc1
    s_add_u32 s43, s43, 40960
    buffer_load_dwordx4 v[72:75], v2, s[4:7], s43 offen offset:0 sc1
    buffer_load_dwordx4 v[76:79], v2, s[4:7], s43 offen offset:1024 sc1
    s_add_u32 s43, s43, 40960
    buffer_load_dwordx4 v[80:83], v2, s[4:7], s43 offen offset:0 sc1
    buffer_load_dwordx4 v[84:87], v2, s[4:7], s43 offen offset:1024 sc1
    s_add_u32 s43, s43, 40960
    buffer_load_dwordx4 v[88:91], v2, s[4:7], s43 offen offset:0 sc1
    buffer_load_dwordx4 v[92:95], v2, s[4:7], s43 offen offset:1024 sc1
    s_add_u32 s43, s43, 40960
    buffer_load_dwordx4 v[96:99], v2, s[4:7], s43 offen offset:0 sc1
    buffer_load_dwordx4 v[100:103], v2, s[4:7], s43 offen offset:1024 sc1
    s_add_u32 s43, s43, 40960
    buffer_load_dwordx4 v[104:107], v2, s[4:7], s43 offen offset:0 sc1
    buffer_load_dwordx4 v[108:111], v2, s[4:7], s43 offen offset:1024 sc1
    s_waitcnt vmcnt(0)
    v_max3_u32 v160, v48, v49, v50
    v_max3_u32 v161, v80, v81, v82
    v_max3_u32 v160, v160, v51, v52
    v_max3_u32 v161, v161, v83, v84
    v_max3_u32 v160, v160, v53, v54
    v_max3_u32 v161, v161, v85, v86
    v_max3_u32 v160, v160, v55, v56
    v_max3_u32 v161, v161, v87, v88
    v_max3_u32 v160, v160, v57, v58
    v_max3_u32 v161, v161, v89, v90
    v_max3_u32 v160, v160, v59, v60
    v_max3_u32 v161, v161, v91, v92
    v_max3_u32 v160, v160, v61, v62
    v_max3_u32 v161, v161, v93, v94
    v_max3_u32 v160, v160, v63, v64
    v_max3_u32 v161, v161, v95, v96
    v_max3_u32 v160, v160, v65, v66
    v_max3_u32 v161, v161, v97, v98
    v_max3_u32 v160, v160, v67, v68
    v_max3_u32 v161, v161, v99, v100
    v_max3_u32 v160, v160, v69, v70
    v_max3_u32 v161, v161, v101, v102
    v_max3_u32 v160, v160, v71, v72
    v_max3_u32 v161, v161, v103, v104
    v_max3_u32 v160, v160, v73, v74
    v_max3_u32 v161, v161, v105, v106
    v_max3_u32 v160, v160, v75, v76
    v_max3_u32 v161, v161, v107, v108
    v_max3_u32 v160, v160, v77, v78
    v_max3_u32 v161, v161, v109, v110
    v_max_u32 v160, v160, v79
    v_max_u32 v161, v161, v111
    v_max_u32 v160, v160, v161
    v_cmp_eq_u32 vcc, -1, v160
    s_cbranch_vccz Lck_225
    s_sub_u32 s31, s31, 1
    s_cbranch_scc0 Lcp_224
    s_mov_b32 s31, 8
    s_branch L_fail
Lck_225:
    v_dot2c_f32_bf16 v16, s52, v48
    v_dot2c_f32_bf16 v17, s53, v48
    v_dot2c_f32_bf16 v18, s52, v49
    v_dot2c_f32_bf16 v19, s53, v49
    v_dot2c_f32_bf16 v20, s52, v50
    v_dot2c_f32_bf16 v21, s53, v50
    v_dot2c_f32_bf16 v22, s52, v51
    v_dot2c_f32_bf16 v23, s53, v51
    v_dot2c_f32_bf16 v24, s52, v52
    v_dot2c_f32_bf16 v25, s53, v52
    v_dot2c_f32_bf16 v26, s52, v53
    v_dot2c_f32_bf16 v27, s53, v53
    v_dot2c_f32_bf16 v28, s52, v54
    v_dot2c_f32_bf16 v29, s53, v54
    v_dot2c_f32_bf16 v30, s52, v55
    v_dot2c_f32_bf16 v31, s53, v55
    v_dot2c_f32_bf16 v16, s52, v56
    v_dot2c_f32_bf16 v17, s53, v56
    v_dot2c_f32_bf16 v18, s52, v57
    v_dot2c_f32_bf16 v19, s53, v57
    v_dot2c_f32_bf16 v20, s52, v58
    v_dot2c_f32_bf16 v21, s53, v58
    v_dot2c_f32_bf16 v22, s52, v59
    v_dot2c_f32_bf16 v23, s53, v59
    v_dot2c_f32_bf16 v24, s52, v60
    v_dot2c_f32_bf16 v25, s53, v60
    v_dot2c_f32_bf16 v26, s52, v61
    v_dot2c_f32_bf16 v27, s53, v61
    v_dot2c_f32_bf16 v28, s52, v62
    v_dot2c_f32_bf16 v29, s53, v62
    v_dot2c_f32_bf16 v30, s52, v63
    v_dot2c_f32_bf16 v31, s53, v63
    v_dot2c_f32_bf16 v16, s52, v64
    v_dot2c_f32_bf16 v17, s53, v64
    v_dot2c_f32_bf16 v18, s52, v65
    v_dot2c_f32_bf16 v19, s53, v65
    v_dot2c_f32_bf16 v20, s52, v66
    v_dot2c_f32_bf16 v21, s53, v66
    v_dot2c_f32_bf16 v22, s52, v67
    v_dot2c_f32_bf16 v23, s53, v67
    v_dot2c_f32_bf16 v24, s52, v68
    v_dot2c_f32_bf16 v25, s53, v68
    v_dot2c_f32_bf16 v26, s52, v69
    v_dot2c_f32_bf16 v27, s53, v69
    v_dot2c_f32_bf16 v28, s52, v70
    v_dot2c_f32_bf16 v29, s53, v70
    v_dot2c_f32_bf16 v30, s52, v71
    v_dot2c_f32_bf16 v31, s53, v71
    v_dot2c_f32_bf16 v16, s52, v72
    v_dot2c_f32_bf16 v17, s53, v72
    v_dot2c_f32_bf16 v18, s52, v73
    v_dot2c_f32_bf16 v19, s53, v73
    v_dot2c_f32_bf16 v20, s52, v74
    v_dot2c_f32_bf16 v21, s53, v74
    v_dot2c_f32_bf16 v22, s52, v75
    v_dot2c_f32_bf16 v23, s53, v75
    v_dot2c_f32_bf16 v24, s52, v76
    v_dot2c_f32_bf16 v25, s53, v76
    v_dot2c_f32_bf16 v26, s52, v77
    v_dot2c_f32_bf16 v27, s53, v77
    v_dot2c_f32_bf16 v28, s52, v78
    v_dot2c_f32_bf16 v29, s53, v78
    v_dot2c_f32_bf16 v30, s52, v79
    v_dot2c_f32_bf16 v31, s53, v79
    v_dot2c_f32_bf16 v16, s52, v80
    v_dot2c_f32_bf16 v17, s53, v80
    v_dot2c_f32_bf16 v18, s52, v81
    v_dot2c_f32_bf16 v19, s53, v81
    v_dot2c_f32_bf16 v20, s52, v82
    v_dot2c_f32_bf16 v21, s53, v82
    v_dot2c_f32_bf16 v22, s52, v83
    v_dot2c_f32_bf16 v23, s53, v83
    v_dot2c_f32_bf16 v24, s52, v84
    v_dot2c_f32_bf16 v25, s53, v84
    v_dot2c_f32_bf16 v26, s52, v85
    v_dot2c_f32_bf16 v27, s53, v85
    v_dot2c_f32_bf16 v28, s52, v86
    v_dot2c_f32_bf16 v29, s53, v86
    v_dot2c_f32_bf16 v30, s52, v87
    v_dot2c_f32_bf16 v31, s53, v87
    v_dot2c_f32_bf16 v16, s52, v88
    v_dot2c_f32_bf16 v17, s53, v88
    v_dot2c_f32_bf16 v18, s52, v89
    v_dot2c_f32_bf16 v19, s53, v89
    v_dot2c_f32_bf16 v20, s52, v90
    v_dot2c_f32_bf16 v21, s53, v90
    v_dot2c_f32_bf16 v22, s52, v91
    v_dot2c_f32_bf16 v23, s53, v91
    v_dot2c_f32_bf16 v24, s52, v92
    v_dot2c_f32_bf16 v25, s53, v92
    v_dot2c_f32_bf16 v26, s52, v93
    v_dot2c_f32_bf16 v27, s53, v93
    v_dot2c_f32_bf16 v28, s52, v94
    v_dot2c_f32_bf16 v29, s53, v94
    v_dot2c_f32_bf16 v30, s52, v95
    v_dot2c_f32_bf16 v31, s53, v95
    v_dot2c_f32_bf16 v16, s52, v96
    v_dot2c_f32_bf16 v17, s53, v96
    v_dot2c_f32_bf16 v18, s52, v97
    v_dot2c_f32_bf16 v19, s53, v97
    v_dot2c_f32_bf16 v20, s52, v98
    v_dot2c_f32_bf16 v21, s53, v98
    v_dot2c_f32_bf16 v22, s52, v99
    v_dot2c_f32_bf16 v23, s53, v99
    v_dot2c_f32_bf16 v24, s52, v100
    v_dot2c_f32_bf16 v25, s53, v100
    v_dot2c_f32_bf16 v26, s52, v101
    v_dot2c_f32_bf16 v27, s53, v101
    v_dot2c_f32_bf16 v28, s52, v102
    v_dot2c_f32_bf16 v29, s53, v102
    v_dot2c_f32_bf16 v30, s52, v103
    v_dot2c_f32_bf16 v31, s53, v103
    v_dot2c_f32_bf16 v16, s52, v104
    v_dot2c_f32_bf16 v17, s53, v104
    v_dot2c_f32_bf16 v18, s52, v105
    v_dot2c_f32_bf16 v19, s53, v105
    v_dot2c_f32_bf16 v20, s52, v106
    v_dot2c_f32_bf16 v21, s53, v106
    v_dot2c_f32_bf16 v22, s52, v107
    v_dot2c_f32_bf16 v23, s53, v107
    v_dot2c_f32_bf16 v24, s52, v108
    v_dot2c_f32_bf16 v25, s53, v108
    v_dot2c_f32_bf16 v26, s52, v109
    v_dot2c_f32_bf16 v27, s53, v109
    v_dot2c_f32_bf16 v28, s52, v110
    v_dot2c_f32_bf16 v29, s53, v110
    v_dot2c_f32_bf16 v30, s52, v111
    v_dot2c_f32_bf16 v31, s53, v111
    s_nop 2
    s_branch Lcj_222
Lcg_223:
    buffer_load_dwordx4 v[48:51], v2, s[4:7], s43 offen offset:0 sc1
    buffer_load_dwordx4 v[52:55], v2, s[4:7], s43 offen offset:1024 sc1
    s_add_u32 s43, s43, 40960
    buffer_load_dwordx4 v[56:59], v2, s[4:7], s43 offen offset:0 sc1
    buffer_load_dwordx4 v[60:63], v2, s[4:7], s43 offen offset:1024 sc1
    s_add_u32 s43, s43, 40960
    buffer_load_dwordx4 v[64:67], v2, s[4:7], s43 offen offset:0 sc1
    buffer_load_dwordx4 v[68:71], v2, s[4:7], s43 offen offset:1024 sc1
    s_add_u32 s43, s43, 40960
    buffer_load_dwordx4 v[72:75], v2, s[4:7], s43 offen offset:0 sc1
    buffer_load_dwordx4 v[76:79], v2, s[4:7], s43 offen offset:1024 sc1
    s_add_u32 s43, s43, 40960
    buffer_load_dwordx4 v[80:83], v2, s[4:7], s43 offen offset:0 sc1
    buffer_load_dwordx4 v[84:87], v2, s[4:7], s43 offen offset:1024 sc1
    s_add_u32 s43, s43, 40960
    buffer_load_dwordx4 v[88:91], v2, s[4:7], s43 offen offset:0 sc1
    buffer_load_dwordx4 v[92:95], v2, s[4:7], s43 offen offset:1024 sc1
    s_add_u32 s43, s43, 40960
    buffer_load_dwordx4 v[96:99], v2, s[4:7], s43 offen offset:0 sc1
    buffer_load_dwordx4 v[100:103], v2, s[4:7], s43 offen offset:1024 sc1
    s_add_u32 s43, s43, 40960
    buffer_load_dwordx4 v[104:107], v2, s[4:7], s43 offen offset:0 sc1
    buffer_load_dwordx4 v[108:111], v2, s[4:7], s43 offen offset:1024 sc1
    s_waitcnt vmcnt(14)
    v_dot2c_f32_bf16 v16, s52, v48
    v_dot2c_f32_bf16 v17, s53, v48
    v_dot2c_f32_bf16 v18, s52, v49
    v_dot2c_f32_bf16 v19, s53, v49
    v_dot2c_f32_bf16 v20, s52, v50
    v_dot2c_f32_bf16 v21, s53, v50
    v_dot2c_f32_bf16 v22, s52, v51
    v_dot2c_f32_bf16 v23, s53, v51
    v_dot2c_f32_bf16 v24, s52, v52
    v_dot2c_f32_bf16 v25, s53, v52
    v_dot2c_f32_bf16 v26, s52, v53
    v_dot2c_f32_bf16 v27, s53, v53
    v_dot2c_f32_bf16 v28, s52, v54
    v_dot2c_f32_bf16 v29, s53, v54
    v_dot2c_f32_bf16 v30, s52, v55
    v_dot2c_f32_bf16 v31, s53, v55
    s_waitcnt vmcnt(12)
    v_dot2c_f32_bf16 v16, s52, v56
    v_dot2c_f32_bf16 v17, s53, v56
    v_dot2c_f32_bf16 v18, s52, v57
    v_dot2c_f32_bf16 v19, s53, v57
    v_dot2c_f32_bf16 v20, s52, v58
    v_dot2c_f32_bf16 v21, s53, v58
    v_dot2c_f32_bf16 v22, s52, v59
    v_dot2c_f32_bf16 v23, s53, v59
    v_dot2c_f32_bf16 v24, s52, v60
    v_dot2c_f32_bf16 v25, s53, v60
    v_dot2c_f32_bf16 v26, s52, v61
    v_dot2c_f32_bf16 v27, s53, v61
    v_dot2c_f32_bf16 v28, s52, v62
    v_dot2c_f32_bf16 v29, s53, v62
    v_dot2c_f32_bf16 v30, s52, v63
    v_dot2c_f32_bf16 v31, s53, v63
    s_waitcnt vmcnt(10)
    v_dot2c_f32_bf16 v16, s52, v64
    v_dot2c_f32_bf16 v17, s53, v64
    v_dot2c_f32_bf16 v18, s52, v65
    v_dot2c_f32_bf16 v19, s53, v65
    v_dot2c_f32_bf16 v20, s52, v66
    v_dot2c_f32_bf16 v21, s53, v66
    v_dot2c_f32_bf16 v22, s52, v67
    v_dot2c_f32_bf16 v23, s53, v67
    v_dot2c_f32_bf16 v24, s52, v68
    v_dot2c_f32_bf16 v25, s53, v68
    v_dot2c_f32_bf16 v26, s52, v69
    v_dot2c_f32_bf16 v27, s53, v69
    v_dot2c_f32_bf16 v28, s52, v70
    v_dot2c_f32_bf16 v29, s53, v70
    v_dot2c_f32_bf16 v30, s52, v71
    v_dot2c_f32_bf16 v31, s53, v71
    s_waitcnt vmcnt(8)
    v_dot2c_f32_bf16 v16, s52, v72
    v_dot2c_f32_bf16 v17, s53, v72
    v_dot2c_f32_bf16 v18, s52, v73
    v_dot2c_f32_bf16 v19, s53, v73
    v_dot2c_f32_bf16 v20, s52, v74
    v_dot2c_f32_bf16 v21, s53, v74
    v_dot2c_f32_bf16 v22, s52, v75
    v_dot2c_f32_bf16 v23, s53, v75
    v_dot2c_f32_bf16 v24, s52, v76
    v_dot2c_f32_bf16 v25, s53, v76
    v_dot2c_f32_bf16 v26, s52, v77
    v_dot2c_f32_bf16 v27, s53, v77
    v_dot2c_f32_bf16 v28, s52, v78
    v_dot2c_f32_bf16 v29, s53, v78
    v_dot2c_f32_bf16 v30, s52, v79
    v_dot2c_f32_bf16 v31, s53, v79
    s_waitcnt vmcnt(6)
    v_dot2c_f32_bf16 v16, s52, v80
    v_dot2c_f32_bf16 v17, s53, v80
    v_dot2c_f32_bf16 v18, s52, v81
    v_dot2c_f32_bf16 v19, s53, v81
    v_dot2c_f32_bf16 v20, s52, v82
    v_dot2c_f32_bf16 v21, s53, v82
    v_dot2c_f32_bf16 v22, s52, v83
    v_dot2c_f32_bf16 v23, s53, v83
    v_dot2c_f32_bf16 v24, s52, v84
    v_dot2c_f32_bf16 v25, s53, v84
    v_dot2c_f32_bf16 v26, s52, v85
    v_dot2c_f32_bf16 v27, s53, v85
    v_dot2c_f32_bf16 v28, s52, v86
    v_dot2c_f32_bf16 v29, s53, v86
    v_dot2c_f32_bf16 v30, s52, v87
    v_dot2c_f32_bf16 v31, s53, v87
    s_waitcnt vmcnt(4)
    v_dot2c_f32_bf16 v16, s52, v88
    v_dot2c_f32_bf16 v17, s53, v88
    v_dot2c_f32_bf16 v18, s52, v89
    v_dot2c_f32_bf16 v19, s53, v89
    v_dot2c_f32_bf16 v20, s52, v90
    v_dot2c_f32_bf16 v21, s53, v90
    v_dot2c_f32_bf16 v22, s52, v91
    v_dot2c_f32_bf16 v23, s53, v91
    v_dot2c_f32_bf16 v24, s52, v92
    v_dot2c_f32_bf16 v25, s53, v92
    v_dot2c_f32_bf16 v26, s52, v93
    v_dot2c_f32_bf16 v27, s53, v93
    v_dot2c_f32_bf16 v28, s52, v94
    v_dot2c_f32_bf16 v29, s53, v94
    v_dot2c_f32_bf16 v30, s52, v95
    v_dot2c_f32_bf16 v31, s53, v95
    s_waitcnt vmcnt(2)
    v_dot2c_f32_bf16 v16, s52, v96
    v_dot2c_f32_bf16 v17, s53, v96
    v_dot2c_f32_bf16 v18, s52, v97
    v_dot2c_f32_bf16 v19, s53, v97
    v_dot2c_f32_bf16 v20, s52, v98
    v_dot2c_f32_bf16 v21, s53, v98
    v_dot2c_f32_bf16 v22, s52, v99
    v_dot2c_f32_bf16 v23, s53, v99
    v_dot2c_f32_bf16 v24, s52, v100
    v_dot2c_f32_bf16 v25, s53, v100
    v_dot2c_f32_bf16 v26, s52, v101
    v_dot2c_f32_bf16 v27, s53, v101
    v_dot2c_f32_bf16 v28, s52, v102
    v_dot2c_f32_bf16 v29, s53, v102
    v_dot2c_f32_bf16 v30, s52, v103
    v_dot2c_f32_bf16 v31, s53, v103
    s_waitcnt vmcnt(0)
    v_dot2c_f32_bf16 v16, s52, v104
    v_dot2c_f32_bf16 v17, s53, v104
    v_dot2c_f32_bf16 v18, s52, v105
    v_dot2c_f32_bf16 v19, s53, v105
    v_dot2c_f32_bf16 v20, s52, v106
    v_dot2c_f32_bf16 v21, s53, v106
    v_dot2c_f32_bf16 v22, s52, v107
    v_dot2c_f32_bf16 v23, s53, v107
    v_dot2c_f32_bf16 v24, s52, v108
    v_dot2c_f32_bf16 v25, s53, v108
    v_dot2c_f32_bf16 v26, s52, v109
    v_dot2c_f32_bf16 v27, s53, v109
    v_dot2c_f32_bf16 v28, s52, v110
    v_dot2c_f32_bf16 v29, s53, v110
    v_dot2c_f32_bf16 v30, s52, v111
    v_dot2c_f32_bf16 v31, s53, v111
    s_nop 2
Lcj_222:
    v_cvt_pk_bf16_f32 v160, v16, v17
    v_cvt_pk_bf16_f32 v161, v18, v19
    v_lshlrev_b32 v16, 16, v160
    v_and_b32 v17, 0xffff0000, v160
    v_lshlrev_b32 v162, 16, v144
    v_and_b32 v163, 0xffff0000, v144
    v_lshlrev_b32 v18, 16, v161
    v_and_b32 v19, 0xffff0000, v161
    v_lshlrev_b32 v164, 16, v145
    v_and_b32 v165, 0xffff0000, v145
    v_mul_f32 v16, v16, v162
    v_mul_f32 v17, v17, v163
    v_mul_f32 v18, v18, v164
    v_mul_f32 v19, v19, v165
    v_cvt_pk_bf16_f32 v160, v16, v17
    v_cvt_pk_bf16_f32 v161, v18, v19
    v_lshlrev_b32 v16, 16, v160
    v_and_b32 v17, 0xffff0000, v160
    v_lshlrev_b32 v162, 16, v152
    v_and_b32 v163, 0xffff0000, v152
    v_lshlrev_b32 v18, 16, v161
    v_and_b32 v19, 0xffff0000, v161
    v_lshlrev_b32 v164, 16, v153
    v_and_b32 v165, 0xffff0000, v153
    v_add_f32 v16, v16, v162
    v_add_f32 v17, v17, v163
    v_add_f32 v18, v18, v164
    v_add_f32 v19, v19, v165
    v_cvt_pk_bf16_f32 v166, v16, v17
    v_cvt_pk_bf16_f32 v167, v18, v19
    buffer_store_dwordx2 v[166:167], v5, s[12:15], s48 offen offset:0
    v_cvt_pk_bf16_f32 v168, v20, v21
    v_cvt_pk_bf16_f32 v169, v22, v23
    v_lshlrev_b32 v20, 16, v168
    v_and_b32 v21, 0xffff0000, v168
    v_lshlrev_b32 v170, 16, v146
    v_and_b32 v171, 0xffff0000, v146
    v_lshlrev_b32 v22, 16, v169
    v_and_b32 v23, 0xffff0000, v169
    v_lshlrev_b32 v172, 16, v147
    v_and_b32 v173, 0xffff0000, v147
    v_mul_f32 v20, v20, v170
    v_mul_f32 v21, v21, v171
    v_mul_f32 v22, v22, v172
    v_mul_f32 v23, v23, v173
    v_cvt_pk_bf16_f32 v168, v20, v21
    v_cvt_pk_bf16_f32 v169, v22, v23
    v_lshlrev_b32 v20, 16, v168
    v_and_b32 v21, 0xffff0000, v168
    v_lshlrev_b32 v170, 16, v154
    v_and_b32 v171, 0xffff0000, v154
    v_lshlrev_b32 v22, 16, v169
    v_and_b32 v23, 0xffff0000, v169
    v_lshlrev_b32 v172, 16, v155
    v_and_b32 v173, 0xffff0000, v155
    v_add_f32 v20, v20, v170
    v_add_f32 v21, v21, v171
    v_add_f32 v22, v22, v172
    v_add_f32 v23, v23, v173
    v_cvt_pk_bf16_f32 v174, v20, v21
    v_cvt_pk_bf16_f32 v175, v22, v23
    buffer_store_dwordx2 v[174:175], v5, s[12:15], s48 offen offset:128
    v_cvt_pk_bf16_f32 v160, v24, v25
    v_cvt_pk_bf16_f32 v161, v26, v27
    v_lshlrev_b32 v24, 16, v160
    v_and_b32 v25, 0xffff0000, v160
    v_lshlrev_b32 v162, 16, v148
    v_and_b32 v163, 0xffff0000, v148
    v_lshlrev_b32 v26, 16, v161
    v_and_b32 v27, 0xffff0000, v161
    v_lshlrev_b32 v164, 16, v149
    v_and_b32 v165, 0xffff0000, v149
    v_mul_f32 v24, v24, v162
    v_mul_f32 v25, v25, v163
    v_mul_f32 v26, v26, v164
    v_mul_f32 v27, v27, v165
    v_cvt_pk_bf16_f32 v160, v24, v25
    v_cvt_pk_bf16_f32 v161, v26, v27
    v_lshlrev_b32 v24, 16, v160
    v_and_b32 v25, 0xffff0000, v160
    v_lshlrev_b32 v162, 16, v156
    v_and_b32 v163, 0xffff0000, v156
    v_lshlrev_b32 v26, 16, v161
    v_and_b32 v27, 0xffff0000, v161
    v_lshlrev_b32 v164, 16, v157
    v_and_b32 v165, 0xffff0000, v157
    v_add_f32 v24, v24, v162
    v_add_f32 v25, v25, v163
    v_add_f32 v26, v26, v164
    v_add_f32 v27, v27, v165
    v_cvt_pk_bf16_f32 v166, v24, v25
    v_cvt_pk_bf16_f32 v167, v26, v27
    buffer_store_dwordx2 v[166:167], v5, s[12:15], s48 offen offset:32
    v_cvt_pk_bf16_f32 v168, v28, v29
    v_cvt_pk_bf16_f32 v169, v30, v31
    v_lshlrev_b32 v28, 16, v168
    v_and_b32 v29, 0xffff0000, v168
    v_lshlrev_b32 v170, 16, v150
    v_and_b32 v171, 0xffff0000, v150
    v_lshlrev_b32 v30, 16, v169
    v_and_b32 v31, 0xffff0000, v169
    v_lshlrev_b32 v172, 16, v151
    v_and_b32 v173, 0xffff0000, v151
    v_mul_f32 v28, v28, v170
    v_mul_f32 v29, v29, v171
    v_mul_f32 v30, v30, v172
    v_mul_f32 v31, v31, v173
    v_cvt_pk_bf16_f32 v168, v28, v29
    v_cvt_pk_bf16_f32 v169, v30, v31
    v_lshlrev_b32 v28, 16, v168
    v_and_b32 v29, 0xffff0000, v168
    v_lshlrev_b32 v170, 16, v158
    v_and_b32 v171, 0xffff0000, v158
    v_lshlrev_b32 v30, 16, v169
    v_and_b32 v31, 0xffff0000, v169
    v_lshlrev_b32 v172, 16, v159
    v_and_b32 v173, 0xffff0000, v159
    v_add_f32 v28, v28, v170
    v_add_f32 v29, v29, v171
    v_add_f32 v30, v30, v172
    v_add_f32 v31, v31, v173
    v_cvt_pk_bf16_f32 v174, v28, v29
    v_cvt_pk_bf16_f32 v175, v30, v31
    buffer_store_dwordx2 v[174:175], v5, s[12:15], s48 offen offset:160
    s_add_u32 s30, s30, 64
    s_cmp_lt_u32 s30, s33
    s_cbranch_scc1 Lct_207
    s_cmp_lg_u32 s30, 1343
    s_cbranch_scc1 L_end
    s_mov_b32 exec_hi, 0xffff
    global_store_dword v3, v6, s[74:75] offset:64 sc1
    s_endpgm
L_fail:
    s_mov_b64 exec, 1
    s_lshl_b32 s31, s31, 2
    v_mov_b32 v3, s31
    v_mov_b32 v4, 1
    global_atomic_add v3, v4, s[74:75]
L_end:
L_last:
    s_endpgm
.section .rodata,"a"
.p2align 6
.amdhsa_kernel recurrent_scan__memory_aug_recurrent_mem_tr__dense_activation_relu__prompt_kernel
  .amdhsa_next_free_vgpr 512
  .amdhsa_next_free_sgpr 100
  .amdhsa_accum_offset 256
  .amdhsa_group_segment_fixed_size 0
  .amdhsa_kernarg_size 104
  .amdhsa_user_sgpr_count 2
  .amdhsa_user_sgpr_kernarg_segment_ptr 1
  .amdhsa_system_sgpr_workgroup_id_x 1
.end_amdhsa_kernel
```
